```python
import torch

def _softmax(x, axis=-1):
    return torch.softmax(x, dim=axis)
def _gelu(x):
    return torch.nn.functional.gelu(x, approximate="tanh")
def _silu(x):
    return torch.nn.functional.silu(x)
def _sigmoid(x):
    return torch.sigmoid(x)
def _layernorm(x, axis=-1, eps=1e-5):
    m = x.mean(dim=axis, keepdim=True)
    v = x.var(dim=axis, keepdim=True, unbiased=False)
    return (x - m) / torch.sqrt(v + eps)
def _scatter_add(tgt, idx, src, axis=0):
    return tgt.clone().index_add_(axis, idx, src)
def _segment_sum(src, seg, n):
    out = torch.zeros((n,) + src.shape[1:], dtype=src.dtype)
    return out.index_add_(0, seg, src)
def _pad(x, pw):
    flat = tuple(v for pair in reversed(pw) for v in pair)
    return torch.nn.functional.pad(x, flat)

kernel_name = 'recurrent_scan__compressed_kv_cla__dense_activation_gelu__prompt'

def setup_inputs():

    _w = (lambda a: (lambda t: t.to(torch.bfloat16) if t.is_floating_point() else t)(torch.as_tensor(a)))
    def _A_setup():
        B, H, Sq, Sk, D, M = 1, 32, 2048, 2048, 128, 512
        Dc = 4 * D
        return {
            "x": _w((lambda *s: torch.randn(*s, dtype=torch.bfloat16) * 0.05)(B, Sq, M)),
            "c_kv": _w((lambda *s: torch.randn(*s, dtype=torch.bfloat16) * 0.8)(B, Sk, Dc)),
            "w_q": _w((lambda *s: torch.randn(*s, dtype=torch.bfloat16) * 1.6)(M, H, D) * (M ** -0.5)),
            "w_uk": _w((lambda *s: torch.randn(*s, dtype=torch.bfloat16) * 1.6)(Dc, H, D) * (Dc ** -0.5)),
            "w_uv": _w((lambda *s: torch.randn(*s, dtype=torch.bfloat16) * 0.8)(Dc, H, D) * (Dc ** -0.5)),
            "w_o": _w((lambda *s: torch.randn(*s, dtype=torch.bfloat16) * 0.8)(H, D, M) * ((H * D) ** -0.5)),
        }
    _A_in = _A_setup()

    def _B_setup():
        B, S, D, F = 1, 2048, 512, 1376
        return {
            "x": _w((lambda *s: torch.randn(*s, dtype=torch.bfloat16) * 0.05)(B, S, D)),
            "w1": _w((lambda *s: torch.randn(*s, dtype=torch.bfloat16) * 0.8)(D, F) * (D ** -0.5)),
            "b1": _w((lambda *s: torch.randn(*s, dtype=torch.bfloat16) * 0.8)(F) * 0.01),
            "w2": _w((lambda *s: torch.randn(*s, dtype=torch.bfloat16) * 0.2)(F, D) * (F ** -0.5)),
            "b2": _w((lambda *s: torch.randn(*s, dtype=torch.bfloat16) * 0.2)(D) * 0.01),
        }
    _B_in = _B_setup()

    return {
        "A_x": _A_in["x"],
        "A_c_kv": _A_in["c_kv"],
        "A_w_q": _A_in["w_q"],
        "A_w_uk": _A_in["w_uk"],
        "A_w_uv": _A_in["w_uv"],
        "A_w_o": _A_in["w_o"],
        "B_x": _B_in["x"],
        "B_w1": _B_in["w1"],
        "B_b1": _B_in["b1"],
        "B_w2": _B_in["w2"],
        "B_b2": _B_in["b2"],
    }

def reference(A_x, A_c_kv, A_w_q, A_w_uk, A_w_uv, A_w_o, B_x, B_w1, B_b1, B_w2, B_b2):
    def _A_ref(x, c_kv, w_q, w_uk, w_uv, w_o):
        B, Sq, M = x.shape[0], x.shape[1], x.shape[2]
        Sk = c_kv.shape[1]
        H, D = w_q.shape[1], w_q.shape[2]
        q = torch.einsum("bqm,mhd->bhqd", x, w_q)
        k = torch.einsum("bkc,chd->bhkd", c_kv, w_uk)
        v = torch.einsum("bkc,chd->bhkd", c_kv, w_uv)
        scores = torch.einsum("bhqd,bhkd->bhqk", q, k) * (D ** -0.5)
        off = Sk - Sq
        qi = torch.arange(Sq)[:, None]
        kj = torch.arange(Sk)[None, :]
        cmask = kj <= (qi + off)
        scores = torch.where(cmask[None, None], scores, -1e9)
        p = _softmax(scores, axis=-1)
        ctx = torch.einsum("bhqk,bhkd->bhqd", p, v)
        return torch.einsum("bhqd,hdm->bqm", ctx, w_o)

    def _B_ref(x, w1, b1, w2, b2):
        h = torch.einsum("bsd,df->bsf", x, w1) + b1
        h = _gelu(h)
        return torch.einsum("bsf,fd->bsd", h, w2) + b2

    x = A_x
    xn = _layernorm(x, axis=-1)
    s = _A_ref(xn, A_c_kv, A_w_q, A_w_uk, A_w_uv, A_w_o)
    g = _silu(_B_ref(xn, B_w1, B_b1, B_w2, B_b2))
    return x + s * g
```

```asm
; @launch grid=(256,1,1) block=(256,1,1) lds=163840
.amdgcn_target "amdgcn-amd-amdhsa--gfx950"
.text
.globl recurrent_scan__compressed_kv_cla__dense_activation_gelu__prompt_kernel
.p2align 8
.type recurrent_scan__compressed_kv_cla__dense_activation_gelu__prompt_kernel,@function
recurrent_scan__compressed_kv_cla__dense_activation_gelu__prompt_kernel:
  s_cmp_ge_u32 s2, 256
  s_cbranch_scc1 L_end
  s_load_dwordx4 s[4:7], s[0:1], 0
  s_load_dwordx4 s[8:11], s[0:1], 24
  s_load_dwordx4 s[12:15], s[0:1], 96
  s_getpc_b64 s[62:63]
L_pcbase:
  v_lshlrev_b32 v244, 4, v0
  global_load_dwordx4 v[252:255], v244, s[62:63]
  v_add_u32 v245, 4096, v244
  global_load_dwordx4 v[252:255], v245, s[62:63]
  s_memrealtime s[52:53]
  s_mov_b32 s60, -1
  v_and_b32 v1, 63, v0
  v_lshrrev_b32 v248, 6, v0
  s_and_b32 s37, s2, 7
  v_readfirstlane_b32 s36, v248
  s_nop 0
  s_cmp_eq_u32 s36, 0
  s_cbranch_scc1 L_st0
  s_cmp_eq_u32 s36, 1
  s_cbranch_scc1 L_st1
  s_cmp_eq_u32 s36, 2
  s_cbranch_scc1 L_st2
  s_cmp_eq_u32 s36, 3
  s_cbranch_scc1 L_st3
L_swret:
  s_lshr_b32 s47, s2, 3
  s_lshl_b32 s37, s37, 2
  s_and_b32 s48, s47, 3
  s_add_u32 s37, s37, s48
  s_lshr_b32 s38, s47, 2
  v_lshlrev_b32 v2, 4, v1
  v_and_b32 v248, 15, v1
  v_lshrrev_b32 v249, 4, v1
  v_and_b32 v250, 7, v1
  v_xor_b32 v250, v250, v249
  v_lshrrev_b32 v251, 3, v1
  v_lshlrev_b32 v251, 10, v251
  v_lshl_add_u32 v208, v250, 4, v251
  v_xor_b32 v250, 4, v250
  v_lshl_add_u32 v209, v250, 4, v251
  v_add_u32 v210, 14336, v208
  v_add_u32 v211, 21504, v209
  v_add_u32 v209, 7168, v209
  v_lshrrev_b32 v250, 1, v248
  v_xor_b32 v250, v250, v249
  v_and_b32 v251, 1, v248
  v_lshlrev_b32 v251, 4, v251
  v_lshl_add_u32 v251, v249, 13, v251
  v_lshl_add_u32 v4, v250, 5, v251
  v_add_u32 v5, 31744, v4
  v_xor_b32 v250, 4, v250
  v_lshl_add_u32 v6, v250, 5, v251
  v_add_u32 v6, 63488, v6
  v_add_u32 v7, 31744, v6
  s_branch L_sk0
L_st0:
  s_branch L_swret
L_sk0:
  s_lshl_b32 s40, s38, 8
  s_lshl_b32 s47, s36, 6
  s_add_u32 s40, s40, s47
  s_lshl_b32 s40, s40, 10
  s_lshl_b32 s42, s36, 13
  s_lshl_b32 s44, s36, 17
  s_lshl_b32 s47, s37, 8
  s_add_u32 s44, s44, s47
  s_lshl_b32 s41, s36, 12
  s_waitcnt lgkmcnt(0)
  s_mov_b32 s24, s8
  s_mov_b32 s25, s9
  s_mov_b32 s26, 4194304
  s_mov_b32 s27, 0x20000
  s_mov_b32 s20, s6
  s_mov_b32 s21, s7
  s_mov_b32 s22, 2097152
  s_mov_b32 s23, 0x20000
  s_lshl_b32 s54, s2, 2
  s_add_u32 s54, s54, s36
  s_lshl_b32 s55, s54, 12
  s_lshl_b32 s54, s54, 11
  s_mov_b32 s53, s54
  s_add_u32 s49, s44, 0
  s_add_u32 m0, s41, 114688
  s_nop 0
  buffer_load_dwordx4 v4, s[24:27], s49 offen offset:0 lds
  buffer_load_dwordx4 v5, s[24:27], s49 offen offset:1024 lds
  buffer_load_dwordx4 v6, s[24:27], s49 offen offset:2048 lds
  buffer_load_dwordx4 v7, s[24:27], s49 offen offset:3072 lds
  s_add_u32 s43, s40, 0
  s_add_u32 m0, s42, 0
  s_nop 0
  s_nop 0
  buffer_load_dwordx4 v208, s[20:23], s43 offen offset:0 lds
  buffer_load_dwordx4 v209, s[20:23], s43 offen offset:1024 lds
  buffer_load_dwordx4 v210, s[20:23], s43 offen offset:2048 lds
  buffer_load_dwordx4 v211, s[20:23], s43 offen offset:3072 lds
  s_add_u32 s43, s43, 32768
  s_add_u32 m0, s42, 4096
  s_nop 0
  buffer_load_dwordx4 v208, s[20:23], s43 offen offset:0 lds
  buffer_load_dwordx4 v209, s[20:23], s43 offen offset:1024 lds
  buffer_load_dwordx4 v210, s[20:23], s43 offen offset:2048 lds
  buffer_load_dwordx4 v211, s[20:23], s43 offen offset:3072 lds
  s_branch L_sk1
L_st1:
  s_branch L_swret
L_sk1:
  s_mov_b32 s32, s4
  s_mov_b32 s33, s5
  s_mov_b32 s34, 2097152
  s_mov_b32 s35, 0x20000
  s_mov_b32 s16, s14
  s_mov_b32 s17, s15
  s_mov_b32 s18, 100663296
  s_mov_b32 s19, 0x20000
  s_mov_b32 s28, s10
  s_mov_b32 s29, s11
  s_mov_b32 s30, 4194304
  s_mov_b32 s31, 0x20000
  s_lshl_b32 s47, s2, 3
  s_lshl_b32 s48, s36, 1
  s_add_u32 s47, s47, s48
  v_lshrrev_b32 v241, 5, v1
  v_add_u32 v241, s47, v241
  v_and_b32 v242, 31, v1
  v_lshlrev_b32 v243, 10, v241
  v_lshl_add_u32 v243, v242, 4, v243
  buffer_load_dwordx4 v[216:219], v243, s[32:35], 0 offen
  buffer_load_dwordx4 v[220:223], v243, s[32:35], 0 offen offset:512
  s_load_dwordx2 s[68:69], s[0:1], 16
  s_load_dwordx2 s[70:71], s[0:1], 40
  s_load_dwordx2 s[64:65], s[0:1], 56
  s_load_dwordx2 s[66:67], s[0:1], 72
  s_add_u32 s49, s44, 524288
  s_add_u32 m0, s41, 131072
  s_nop 0
  s_nop 0
  buffer_load_dwordx4 v4, s[24:27], s49 offen offset:0 lds
  buffer_load_dwordx4 v5, s[24:27], s49 offen offset:1024 lds
  buffer_load_dwordx4 v6, s[24:27], s49 offen offset:2048 lds
  buffer_load_dwordx4 v7, s[24:27], s49 offen offset:3072 lds
  s_add_u32 s43, s40, 128
  s_add_u32 m0, s42, 32768
  s_nop 0
  s_nop 0
  buffer_load_dwordx4 v208, s[20:23], s43 offen offset:0 lds
  buffer_load_dwordx4 v209, s[20:23], s43 offen offset:1024 lds
  buffer_load_dwordx4 v210, s[20:23], s43 offen offset:2048 lds
  buffer_load_dwordx4 v211, s[20:23], s43 offen offset:3072 lds
  s_add_u32 s43, s43, 32768
  s_add_u32 m0, s42, 36864
  s_nop 0
  buffer_load_dwordx4 v208, s[20:23], s43 offen offset:0 lds
  buffer_load_dwordx4 v209, s[20:23], s43 offen offset:1024 lds
  buffer_load_dwordx4 v210, s[20:23], s43 offen offset:2048 lds
  buffer_load_dwordx4 v211, s[20:23], s43 offen offset:3072 lds
  s_branch L_sk2
L_st2:
  s_branch L_swret
L_sk2:
  s_lshr_b32 s50, s2, 3
  s_lshl_b32 s50, s50, 2
  s_add_u32 s50, s50, s36
  s_lshl_b32 s50, s50, 10
  s_and_b32 s50, s50, 131071
  s_add_u32 s50, s50, 0
  s_min_u32 s50, s50, L_codeend-L_pcbase-1024
  v_add_u32 v244, s50, v2
  global_load_dwordx4 v[252:255], v244, s[62:63]
  s_or_b32 s47, s2, s36
  s_cmp_lg_u32 s47, 0
  s_cbranch_scc1 L_nocas
  s_and_b32 s52, s52, 0xffffff00
  s_or_b32 s52, s52, 0x100
  v_mov_b32 v184, s52
  v_mov_b32 v185, 0
  s_mov_b64 exec, 1
  global_store_dword v185, v184, s[12:13] sc1
  s_mov_b64 exec, -1
L_nocas:
  v_lshrrev_b32 v250, 1, v248
  v_xor_b32 v250, v250, v249
  v_lshlrev_b32 v251, 7, v248
  v_add_u32 v251, s42, v251
  v_lshl_add_u32 v212, v250, 4, v251
  v_xor_b32 v250, 4, v250
  v_lshl_add_u32 v213, v250, 4, v251
  v_bfe_u32 v248, v1, 2, 2
  v_lshlrev_b32 v250, 3, v249
  v_add_u32 v250, v250, v248
  v_lshlrev_b32 v250, 8, v250
  v_and_b32 v251, 3, v1
  v_lshl_add_u32 v250, v251, 3, v250
  v_add_u32 v250, 114688, v250
  v_and_b32 v251, 1, v249
  v_lshl_add_u32 v248, v251, 2, v248
  v_xor_b32 v251, 0, v248
  v_lshl_add_u32 v8, v251, 5, v250
  v_xor_b32 v251, 1, v248
  v_lshl_add_u32 v9, v251, 5, v250
  v_xor_b32 v251, 2, v248
  v_lshl_add_u32 v10, v251, 5, v250
  v_xor_b32 v251, 3, v248
  v_lshl_add_u32 v11, v251, 5, v250
  v_xor_b32 v251, 4, v248
  v_lshl_add_u32 v12, v251, 5, v250
  v_xor_b32 v251, 5, v248
  v_lshl_add_u32 v13, v251, 5, v250
  v_xor_b32 v251, 6, v248
  v_lshl_add_u32 v14, v251, 5, v250
  v_xor_b32 v251, 7, v248
  v_lshl_add_u32 v15, v251, 5, v250
  s_branch L_sk3
L_st3:
  s_branch L_swret
L_sk3:
  v_lshrrev_b32 v250, 4, v241
  v_lshlrev_b32 v250, 14, v250
  v_lshrrev_b32 v251, 2, v242
  v_lshl_add_u32 v250, v251, 10, v250
  v_and_b32 v251, 3, v242
  v_lshl_add_u32 v250, v251, 8, v250
  v_and_b32 v251, 15, v241
  v_lshl_add_u32 v240, v251, 4, v250
  s_lshl_b32 s46, s37, 5
  s_lshl_b32 s47, s38, 2
  s_add_u32 s46, s46, s47
  s_add_u32 s46, s46, s36
  s_lshl_b32 s46, s46, 15
  s_add_u32 s46, s46, 2097152
  v_and_b32 v3, 31, v1
  v_lshlrev_b32 v3, 7, v3
  v_add_u32 v3, s55, v3
  s_mul_i32 s54, s54, 11
  s_lshr_b32 s54, s54, 4
  v_min_u32 v250, 10, v1
  v_lshlrev_b32 v250, 7, v250
  v_add_u32 v250, s54, v250
  v_min_u32 v250, 1409020, v250
  v_add_u32 v241, 8192, v240
  s_getreg_b32 s45, hwreg(HW_REG_XCC_ID)
  s_lshr_b32 s47, s45, 12
  s_and_b32 s47, s47, 0xf0
  s_and_b32 s45, s45, 15
  s_or_b32 s45, s45, s47
  s_waitcnt lgkmcnt(0)
  s_waitcnt vmcnt(13)
  s_barrier
  s_nop 0
  ds_read_b128 a[0:3], v212 offset:0
  ds_read_b128 a[64:67], v212 offset:2048
  ds_read_b128 a[128:131], v212 offset:4096
  ds_read_b128 a[192:195], v212 offset:6144
  ds_read_b128 a[4:7], v213 offset:0
  ds_read_b128 a[68:71], v213 offset:2048
  ds_read_b128 a[132:135], v213 offset:4096
  ds_read_b128 a[196:199], v213 offset:6144
  ds_read_b64_tr_b16 v[144:145], v8 offset:0
  ds_read_b64_tr_b16 v[146:147], v8 offset:1024
  ds_read_b64_tr_b16 v[148:149], v8 offset:8192
  ds_read_b64_tr_b16 v[150:151], v8 offset:9216
  ds_read_b64_tr_b16 v[152:153], v9 offset:0
  ds_read_b64_tr_b16 v[154:155], v9 offset:1024
  ds_read_b64_tr_b16 v[156:157], v9 offset:8192
  ds_read_b64_tr_b16 v[158:159], v9 offset:9216
  ds_read_b64_tr_b16 v[160:161], v10 offset:0
  ds_read_b64_tr_b16 v[162:163], v10 offset:1024
  ds_read_b64_tr_b16 v[164:165], v10 offset:8192
  ds_read_b64_tr_b16 v[166:167], v10 offset:9216
  ds_read_b64_tr_b16 v[168:169], v11 offset:0
  ds_read_b64_tr_b16 v[170:171], v11 offset:1024
  ds_read_b64_tr_b16 v[172:173], v11 offset:8192
  ds_read_b64_tr_b16 v[174:175], v11 offset:9216
  ds_read_b64_tr_b16 v[176:177], v12 offset:0
  ds_read_b64_tr_b16 v[178:179], v12 offset:1024
  ds_read_b64_tr_b16 v[180:181], v12 offset:8192
  ds_read_b64_tr_b16 v[182:183], v12 offset:9216
  ds_read_b64_tr_b16 v[184:185], v13 offset:0
  ds_read_b64_tr_b16 v[186:187], v13 offset:1024
  ds_read_b64_tr_b16 v[188:189], v13 offset:8192
  ds_read_b64_tr_b16 v[190:191], v13 offset:9216
  ds_read_b64_tr_b16 v[192:193], v14 offset:0
  ds_read_b64_tr_b16 v[194:195], v14 offset:1024
  ds_read_b64_tr_b16 v[196:197], v14 offset:8192
  ds_read_b64_tr_b16 v[198:199], v14 offset:9216
  buffer_load_dwordx4 v[252:255], v2, s[20:23], s53 offen offset:0
  buffer_load_dwordx4 v[252:255], v2, s[20:23], s53 offen offset:1024
  buffer_load_dwordx4 v[252:255], v2, s[24:27], s55 offen offset:0
  buffer_load_dwordx4 v[252:255], v2, s[24:27], s55 offen offset:1024
  buffer_load_dwordx4 v[252:255], v2, s[24:27], s55 offen offset:2048
  buffer_load_dwordx4 v[252:255], v2, s[24:27], s55 offen offset:3072
  s_waitcnt lgkmcnt(15)
  v_mfma_f32_16x16x32_bf16 v[16:19], v[144:147], a[0:3], 0
  s_add_u32 s49, s44, 1048576
  s_add_u32 m0, s41, 147456
  ds_read_b64_tr_b16 v[200:201], v15 offset:0
  v_lshlrev_b32 v224, 16, v216
  v_mfma_f32_16x16x32_bf16 v[16:19], v[148:151], a[4:7], v[16:19]
  buffer_load_dwordx4 v4, s[24:27], s49 offen offset:0 lds
  v_mfma_f32_16x16x32_bf16 v[20:23], v[144:147], a[64:67], 0
  ds_read_b64_tr_b16 v[202:203], v15 offset:1024
  v_and_b32 v225, 0xffff0000, v216
  v_mfma_f32_16x16x32_bf16 v[20:23], v[148:151], a[68:71], v[20:23]
  v_lshlrev_b32 v226, 16, v217
  v_and_b32 v227, 0xffff0000, v217
  v_mfma_f32_16x16x32_bf16 v[24:27], v[144:147], a[128:131], 0
  ds_read_b64_tr_b16 v[204:205], v15 offset:8192
  v_lshlrev_b32 v228, 16, v218
  v_mfma_f32_16x16x32_bf16 v[24:27], v[148:151], a[132:135], v[24:27]
  buffer_load_dwordx4 v5, s[24:27], s49 offen offset:1024 lds
  v_mfma_f32_16x16x32_bf16 v[28:31], v[144:147], a[192:195], 0
  ds_read_b64_tr_b16 v[206:207], v15 offset:9216
  v_and_b32 v229, 0xffff0000, v218
  v_mfma_f32_16x16x32_bf16 v[28:31], v[148:151], a[196:199], v[28:31]
  s_waitcnt lgkmcnt(15)
  v_lshlrev_b32 v230, 16, v219
  v_and_b32 v231, 0xffff0000, v219
  v_mfma_f32_16x16x32_bf16 v[32:35], v[152:155], a[0:3], 0
  s_cmp_lg_u32 s36, 0
  s_cbranch_scc1 L_nst0_0
  s_call_b64 s[52:53], L_w_main_d
L_nst0_0:
  s_cmp_lg_u32 s36, 1
  s_cbranch_scc1 L_nst0_1
  s_call_b64 s[52:53], L_w_main_s
L_nst0_1:
  s_cmp_lg_u32 s36, 2
  s_cbranch_scc1 L_nst0_2
  s_call_b64 s[52:53], L_w_b_full_full_1fd
L_nst0_2:
  s_cmp_lg_u32 s36, 3
  s_cbranch_scc1 L_nst0_3
  s_call_b64 s[52:53], L_w_b_full_full_1
L_nst0_3:
  v_lshlrev_b32 v232, 16, v220
  v_and_b32 v233, 0xffff0000, v220
  v_mfma_f32_16x16x32_bf16 v[32:35], v[156:159], a[4:7], v[32:35]
  s_waitcnt vmcnt(17) lgkmcnt(0)
  s_barrier
  v_lshlrev_b32 v234, 16, v221
  v_and_b32 v235, 0xffff0000, v221
  v_mfma_f32_16x16x32_bf16 v[36:39], v[152:155], a[64:67], 0
  ds_read_b64_tr_b16 v[144:145], v8 offset:16384
  v_lshlrev_b32 v236, 16, v222
  v_mfma_f32_16x16x32_bf16 v[36:39], v[156:159], a[68:71], v[36:39]
  buffer_load_dwordx4 v6, s[24:27], s49 offen offset:2048 lds
  v_mfma_f32_16x16x32_bf16 v[40:43], v[152:155], a[128:131], 0
  ds_read_b64_tr_b16 v[146:147], v8 offset:17408
  v_and_b32 v237, 0xffff0000, v222
  v_mfma_f32_16x16x32_bf16 v[40:43], v[156:159], a[132:135], v[40:43]
  v_lshlrev_b32 v238, 16, v223
  v_and_b32 v239, 0xffff0000, v223
  v_mfma_f32_16x16x32_bf16 v[44:47], v[152:155], a[192:195], 0
  ds_read_b64_tr_b16 v[148:149], v8 offset:24576
  v_add_f32 v243, v224, v225
  v_mfma_f32_16x16x32_bf16 v[44:47], v[156:159], a[196:199], v[44:47]
  buffer_load_dwordx4 v7, s[24:27], s49 offen offset:3072 lds
  v_mfma_f32_16x16x32_bf16 v[48:51], v[160:163], a[0:3], 0
  ds_read_b64_tr_b16 v[150:151], v8 offset:25600
  v_add_f32 v244, v226, v227
  v_mfma_f32_16x16x32_bf16 v[48:51], v[164:167], a[4:7], v[48:51]
  v_add_f32 v243, v243, v228
  v_add_f32 v244, v244, v229
  v_mfma_f32_16x16x32_bf16 v[52:55], v[160:163], a[64:67], 0
  ds_read_b64_tr_b16 v[152:153], v9 offset:16384
  v_add_f32 v243, v243, v230
  v_mfma_f32_16x16x32_bf16 v[52:55], v[164:167], a[68:71], v[52:55]
  v_add_f32 v244, v244, v231
  v_add_f32 v243, v243, v232
  v_mfma_f32_16x16x32_bf16 v[56:59], v[160:163], a[128:131], 0
  s_add_u32 s43, s40, 256
  s_add_u32 m0, s42, 0
  ds_read_b64_tr_b16 v[154:155], v9 offset:17408
  v_add_f32 v244, v244, v233
  v_mfma_f32_16x16x32_bf16 v[56:59], v[164:167], a[132:135], v[56:59]
  buffer_load_dwordx4 v208, s[20:23], s43 offen offset:0 lds
  v_mfma_f32_16x16x32_bf16 v[60:63], v[160:163], a[192:195], 0
  ds_read_b64_tr_b16 v[156:157], v9 offset:24576
  v_add_f32 v243, v243, v234
  v_mfma_f32_16x16x32_bf16 v[60:63], v[164:167], a[196:199], v[60:63]
  ds_read_b64_tr_b16 v[158:159], v9 offset:25600
  v_add_f32 v244, v244, v235
  v_mfma_f32_16x16x32_bf16 v[64:67], v[168:171], a[0:3], 0
  ds_read_b64_tr_b16 v[160:161], v10 offset:16384
  v_add_f32 v243, v243, v236
  v_mfma_f32_16x16x32_bf16 v[64:67], v[172:175], a[4:7], v[64:67]
  buffer_load_dwordx4 v209, s[20:23], s43 offen offset:1024 lds
  v_mfma_f32_16x16x32_bf16 v[68:71], v[168:171], a[64:67], 0
  ds_read_b64_tr_b16 v[162:163], v10 offset:17408
  v_add_f32 v244, v244, v237
  v_mfma_f32_16x16x32_bf16 v[68:71], v[172:175], a[68:71], v[68:71]
  v_add_f32 v243, v243, v238
  v_add_f32 v244, v244, v239
  v_mfma_f32_16x16x32_bf16 v[72:75], v[168:171], a[128:131], 0
  ds_read_b64_tr_b16 v[164:165], v10 offset:24576
  v_add_f32 v243, v243, v244
  s_nop 0
  v_mfma_f32_16x16x32_bf16 v[72:75], v[172:175], a[132:135], v[72:75]
  buffer_load_dwordx4 v210, s[20:23], s43 offen offset:2048 lds
  v_mfma_f32_16x16x32_bf16 v[76:79], v[168:171], a[192:195], 0
  ds_read_b64_tr_b16 v[166:167], v10 offset:25600
  v_add_f32 v243, v243, v243 row_ror:8
  s_nop 0
  v_mfma_f32_16x16x32_bf16 v[76:79], v[172:175], a[196:199], v[76:79]
  v_add_f32 v243, v243, v243 row_ror:4
  s_nop 0
  v_mfma_f32_16x16x32_bf16 v[80:83], v[176:179], a[0:3], 0
  ds_read_b64_tr_b16 v[168:169], v11 offset:16384
  v_add_f32 v243, v243, v243 row_ror:2
  s_nop 0
  v_mfma_f32_16x16x32_bf16 v[80:83], v[180:183], a[4:7], v[80:83]
  buffer_load_dwordx4 v211, s[20:23], s43 offen offset:3072 lds
  v_mfma_f32_16x16x32_bf16 v[84:87], v[176:179], a[64:67], 0
  ds_read_b64_tr_b16 v[170:171], v11 offset:17408
  v_add_f32 v243, v243, v243 row_ror:1
  v_mfma_f32_16x16x32_bf16 v[84:87], v[180:183], a[68:71], v[84:87]
  v_mov_b32 v244, v243
  s_nop 0
  v_mfma_f32_16x16x32_bf16 v[88:91], v[176:179], a[128:131], 0
  s_add_u32 s43, s43, 32768
  s_add_u32 m0, s42, 4096
  ds_read_b64_tr_b16 v[172:173], v11 offset:24576
  v_permlane16_swap_b32 v243, v244
  v_mfma_f32_16x16x32_bf16 v[88:91], v[180:183], a[132:135], v[88:91]
  buffer_load_dwordx4 v208, s[20:23], s43 offen offset:0 lds
  v_mfma_f32_16x16x32_bf16 v[92:95], v[176:179], a[192:195], 0
  ds_read_b64_tr_b16 v[174:175], v11 offset:25600
  v_add_f32 v243, v243, v244
  v_mfma_f32_16x16x32_bf16 v[92:95], v[180:183], a[196:199], v[92:95]
  v_mul_f32 v243, 0x3b000000, v243
  v_mov_b32 v245, 0
  v_mfma_f32_16x16x32_bf16 v[96:99], v[184:187], a[0:3], 0
  ds_read_b64_tr_b16 v[176:177], v12 offset:16384
  v_mov_b32 v246, 0
  v_mfma_f32_16x16x32_bf16 v[96:99], v[188:191], a[4:7], v[96:99]
  buffer_load_dwordx4 v209, s[20:23], s43 offen offset:1024 lds
  v_mfma_f32_16x16x32_bf16 v[100:103], v[184:187], a[64:67], 0
  ds_read_b64_tr_b16 v[178:179], v12 offset:17408
  v_sub_f32 v247, v224, v243
  v_mfma_f32_16x16x32_bf16 v[100:103], v[188:191], a[68:71], v[100:103]
  v_fmac_f32 v245, v247, v247
  v_sub_f32 v247, v225, v243
  v_mfma_f32_16x16x32_bf16 v[104:107], v[184:187], a[128:131], 0
  ds_read_b64_tr_b16 v[180:181], v12 offset:24576
  v_fmac_f32 v246, v247, v247
  v_mfma_f32_16x16x32_bf16 v[104:107], v[188:191], a[132:135], v[104:107]
  buffer_load_dwordx4 v210, s[20:23], s43 offen offset:2048 lds
  v_mfma_f32_16x16x32_bf16 v[108:111], v[184:187], a[192:195], 0
  ds_read_b64_tr_b16 v[182:183], v12 offset:25600
  v_sub_f32 v247, v226, v243
  v_mfma_f32_16x16x32_bf16 v[108:111], v[188:191], a[196:199], v[108:111]
  s_waitcnt vmcnt(18)
  ds_read_b128 a[8:11], v212 offset:32768
  v_fmac_f32 v245, v247, v247
  v_mfma_f32_16x16x32_bf16 v[112:115], v[192:195], a[0:3], 0
  ds_read_b64_tr_b16 v[184:185], v13 offset:16384
  v_sub_f32 v247, v227, v243
  v_mfma_f32_16x16x32_bf16 v[112:115], v[196:199], a[4:7], v[112:115]
  ds_read_b128 a[12:15], v213 offset:32768
  v_fmac_f32 v246, v247, v247
  v_mfma_f32_16x16x32_bf16 v[116:119], v[192:195], a[64:67], 0
  ds_read_b64_tr_b16 v[186:187], v13 offset:17408
  v_sub_f32 v247, v228, v243
  v_mfma_f32_16x16x32_bf16 v[116:119], v[196:199], a[68:71], v[116:119]
  buffer_load_dwordx4 v211, s[20:23], s43 offen offset:3072 lds
  v_mfma_f32_16x16x32_bf16 v[120:123], v[192:195], a[128:131], 0
  ds_read_b64_tr_b16 v[188:189], v13 offset:24576
  v_fmac_f32 v245, v247, v247
  v_mfma_f32_16x16x32_bf16 v[120:123], v[196:199], a[132:135], v[120:123]
  ds_read_b128 a[72:75], v212 offset:34816
  v_sub_f32 v247, v229, v243
  v_mfma_f32_16x16x32_bf16 v[124:127], v[192:195], a[192:195], 0
  ds_read_b64_tr_b16 v[190:191], v13 offset:25600
  v_fmac_f32 v246, v247, v247
  v_mfma_f32_16x16x32_bf16 v[124:127], v[196:199], a[196:199], v[124:127]
  ds_read_b128 a[76:79], v213 offset:34816
  v_sub_f32 v247, v230, v243
  v_mfma_f32_16x16x32_bf16 v[128:131], v[200:203], a[0:3], 0
  ds_read_b64_tr_b16 v[192:193], v14 offset:16384
  v_fmac_f32 v245, v247, v247
  v_mfma_f32_16x16x32_bf16 v[128:131], v[204:207], a[4:7], v[128:131]
  ds_read_b128 a[136:139], v212 offset:36864
  v_sub_f32 v247, v231, v243
  v_mfma_f32_16x16x32_bf16 v[132:135], v[200:203], a[64:67], 0
  ds_read_b64_tr_b16 v[194:195], v14 offset:17408
  v_fmac_f32 v246, v247, v247
  v_mfma_f32_16x16x32_bf16 v[132:135], v[204:207], a[68:71], v[132:135]
  ds_read_b128 a[140:143], v213 offset:36864
  v_sub_f32 v247, v232, v243
  v_mfma_f32_16x16x32_bf16 v[136:139], v[200:203], a[128:131], 0
  ds_read_b64_tr_b16 v[196:197], v14 offset:24576
  v_fmac_f32 v245, v247, v247
  v_mfma_f32_16x16x32_bf16 v[136:139], v[204:207], a[132:135], v[136:139]
  ds_read_b128 a[200:203], v212 offset:38912
  v_sub_f32 v247, v233, v243
  v_mfma_f32_16x16x32_bf16 v[140:143], v[200:203], a[192:195], 0
  ds_read_b64_tr_b16 v[198:199], v14 offset:25600
  v_fmac_f32 v246, v247, v247
  v_mfma_f32_16x16x32_bf16 v[140:143], v[204:207], a[196:199], v[140:143]
  ds_read_b128 a[204:207], v213 offset:38912
  v_sub_f32 v247, v234, v243
  s_waitcnt lgkmcnt(13)
  v_mfma_f32_16x16x32_bf16 v[16:19], v[144:147], a[8:11], v[16:19]
  s_add_u32 s49, s44, 1572864
  s_add_u32 m0, s41, 114688
  ds_read_b64_tr_b16 v[200:201], v15 offset:16384
  v_fmac_f32 v245, v247, v247
  v_mfma_f32_16x16x32_bf16 v[16:19], v[148:151], a[12:15], v[16:19]
  s_waitcnt lgkmcnt(9)
  buffer_load_dwordx4 v4, s[24:27], s49 offen offset:0 lds
  v_mfma_f32_16x16x32_bf16 v[20:23], v[144:147], a[72:75], v[20:23]
  ds_read_b64_tr_b16 v[202:203], v15 offset:17408
  v_sub_f32 v247, v235, v243
  v_mfma_f32_16x16x32_bf16 v[20:23], v[148:151], a[76:79], v[20:23]
  s_waitcnt lgkmcnt(6)
  v_fmac_f32 v246, v247, v247
  v_sub_f32 v247, v236, v243
  v_mfma_f32_16x16x32_bf16 v[24:27], v[144:147], a[136:139], v[24:27]
  ds_read_b64_tr_b16 v[204:205], v15 offset:24576
  v_fmac_f32 v245, v247, v247
  v_mfma_f32_16x16x32_bf16 v[24:27], v[148:151], a[140:143], v[24:27]
  s_waitcnt lgkmcnt(3)
  buffer_load_dwordx4 v5, s[24:27], s49 offen offset:1024 lds
  v_mfma_f32_16x16x32_bf16 v[28:31], v[144:147], a[200:203], v[28:31]
  ds_read_b64_tr_b16 v[206:207], v15 offset:25600
  v_sub_f32 v247, v237, v243
  v_mfma_f32_16x16x32_bf16 v[28:31], v[148:151], a[204:207], v[28:31]
  v_fmac_f32 v246, v247, v247
  v_sub_f32 v247, v238, v243
  v_mfma_f32_16x16x32_bf16 v[32:35], v[152:155], a[8:11], v[32:35]
  s_cmp_lg_u32 s36, 0
  s_cbranch_scc1 L_nst1_0
  s_call_b64 s[52:53], L_w_b_diag_full_0
L_nst1_0:
  s_cmp_lg_u32 s36, 1
  s_cbranch_scc1 L_nst1_1
  s_call_b64 s[52:53], L_w_b_full_diag_0
L_nst1_1:
  s_cmp_lg_u32 s36, 2
  s_cbranch_scc1 L_nst1_2
  s_call_b64 s[52:53], L_w_b_None_diag_0epi
L_nst1_2:
  s_cmp_lg_u32 s36, 3
  s_cbranch_scc1 L_nst1_3
  s_call_b64 s[52:53], L_w_b_diag_None_0st
L_nst1_3:
  v_fmac_f32 v245, v247, v247
  v_sub_f32 v247, v239, v243
  v_mfma_f32_16x16x32_bf16 v[32:35], v[156:159], a[12:15], v[32:35]
  s_waitcnt vmcnt(10) lgkmcnt(0)
  s_barrier
  v_fmac_f32 v246, v247, v247
  v_add_f32 v245, v245, v246
  s_nop 0
  v_mfma_f32_16x16x32_bf16 v[36:39], v[152:155], a[72:75], v[36:39]
  ds_read_b64_tr_b16 v[144:145], v8 offset:32768
  v_add_f32 v245, v245, v245 row_ror:8
  s_nop 0
  v_mfma_f32_16x16x32_bf16 v[36:39], v[156:159], a[76:79], v[36:39]
  buffer_load_dwordx4 v6, s[24:27], s49 offen offset:2048 lds
  v_mfma_f32_16x16x32_bf16 v[40:43], v[152:155], a[136:139], v[40:43]
  ds_read_b64_tr_b16 v[146:147], v8 offset:33792
  v_add_f32 v245, v245, v245 row_ror:4
  s_nop 0
  v_mfma_f32_16x16x32_bf16 v[40:43], v[156:159], a[140:143], v[40:43]
  v_add_f32 v245, v245, v245 row_ror:2
  s_nop 0
  v_mfma_f32_16x16x32_bf16 v[44:47], v[152:155], a[200:203], v[44:47]
  ds_read_b64_tr_b16 v[148:149], v8 offset:40960
  v_add_f32 v245, v245, v245 row_ror:1
  v_mfma_f32_16x16x32_bf16 v[44:47], v[156:159], a[204:207], v[44:47]
  buffer_load_dwordx4 v7, s[24:27], s49 offen offset:3072 lds
  v_mfma_f32_16x16x32_bf16 v[48:51], v[160:163], a[8:11], v[48:51]
  ds_read_b64_tr_b16 v[150:151], v8 offset:41984
  v_mov_b32 v244, v245
  s_nop 0
  v_mfma_f32_16x16x32_bf16 v[48:51], v[164:167], a[12:15], v[48:51]
  v_permlane16_swap_b32 v245, v244
  v_mfma_f32_16x16x32_bf16 v[52:55], v[160:163], a[72:75], v[52:55]
  ds_read_b64_tr_b16 v[152:153], v9 offset:32768
  v_add_f32 v245, v245, v244
  v_mfma_f32_16x16x32_bf16 v[52:55], v[164:167], a[76:79], v[52:55]
  v_mul_f32 v245, 0x3b000000, v245
  v_cvt_pk_bf16_f32 v243, v243, v245
  v_mfma_f32_16x16x32_bf16 v[56:59], v[160:163], a[136:139], v[56:59]
  s_add_u32 s43, s40, 384
  s_add_u32 m0, s42, 32768
  ds_read_b64_tr_b16 v[154:155], v9 offset:33792
  v_and_b32 v245, 0xffff0000, v243
  v_mfma_f32_16x16x32_bf16 v[56:59], v[164:167], a[140:143], v[56:59]
  buffer_load_dwordx4 v208, s[20:23], s43 offen offset:0 lds
  v_mfma_f32_16x16x32_bf16 v[60:63], v[160:163], a[200:203], v[60:63]
  ds_read_b64_tr_b16 v[156:157], v9 offset:40960
  v_lshlrev_b32 v243, 16, v243
  v_mfma_f32_16x16x32_bf16 v[60:63], v[164:167], a[204:207], v[60:63]
  ds_read_b64_tr_b16 v[158:159], v9 offset:41984
  v_add_f32 v245, 0x3727c5ac, v245
  v_mfma_f32_16x16x32_bf16 v[64:67], v[168:171], a[8:11], v[64:67]
  ds_read_b64_tr_b16 v[160:161], v10 offset:32768
  v_cvt_pk_bf16_f32 v245, v245, v245
  v_mfma_f32_16x16x32_bf16 v[64:67], v[172:175], a[12:15], v[64:67]
  buffer_load_dwordx4 v209, s[20:23], s43 offen offset:1024 lds
  v_mfma_f32_16x16x32_bf16 v[68:71], v[168:171], a[72:75], v[68:71]
  ds_read_b64_tr_b16 v[162:163], v10 offset:33792
  v_lshlrev_b32 v245, 16, v245
  v_mfma_f32_16x16x32_bf16 v[68:71], v[172:175], a[76:79], v[68:71]
  v_sqrt_f32 v245, v245
  v_mfma_f32_16x16x32_bf16 v[72:75], v[168:171], a[136:139], v[72:75]
  ds_read_b64_tr_b16 v[164:165], v10 offset:40960
  v_cvt_pk_bf16_f32 v245, v245, v245
  v_mfma_f32_16x16x32_bf16 v[72:75], v[172:175], a[140:143], v[72:75]
  buffer_load_dwordx4 v210, s[20:23], s43 offen offset:2048 lds
  v_mfma_f32_16x16x32_bf16 v[76:79], v[168:171], a[200:203], v[76:79]
  ds_read_b64_tr_b16 v[166:167], v10 offset:41984
  v_lshlrev_b32 v245, 16, v245
  v_mfma_f32_16x16x32_bf16 v[76:79], v[172:175], a[204:207], v[76:79]
  v_rcp_f32 v245, v245
  v_mfma_f32_16x16x32_bf16 v[80:83], v[176:179], a[8:11], v[80:83]
  ds_read_b64_tr_b16 v[168:169], v11 offset:32768
  v_sub_f32 v224, v224, v243
  v_mfma_f32_16x16x32_bf16 v[80:83], v[180:183], a[12:15], v[80:83]
  buffer_load_dwordx4 v211, s[20:23], s43 offen offset:3072 lds
  v_mfma_f32_16x16x32_bf16 v[84:87], v[176:179], a[72:75], v[84:87]
  ds_read_b64_tr_b16 v[170:171], v11 offset:33792
  v_sub_f32 v225, v225, v243
  v_mfma_f32_16x16x32_bf16 v[84:87], v[180:183], a[76:79], v[84:87]
  v_sub_f32 v226, v226, v243
  v_sub_f32 v227, v227, v243
  v_mfma_f32_16x16x32_bf16 v[88:91], v[176:179], a[136:139], v[88:91]
  s_add_u32 s43, s43, 32768
  s_add_u32 m0, s42, 36864
  ds_read_b64_tr_b16 v[172:173], v11 offset:40960
  v_sub_f32 v228, v228, v243
  v_mfma_f32_16x16x32_bf16 v[88:91], v[180:183], a[140:143], v[88:91]
  buffer_load_dwordx4 v208, s[20:23], s43 offen offset:0 lds
  v_mfma_f32_16x16x32_bf16 v[92:95], v[176:179], a[200:203], v[92:95]
  ds_read_b64_tr_b16 v[174:175], v11 offset:41984
  v_sub_f32 v229, v229, v243
  v_mfma_f32_16x16x32_bf16 v[92:95], v[180:183], a[204:207], v[92:95]
  v_sub_f32 v230, v230, v243
  v_sub_f32 v231, v231, v243
  v_mfma_f32_16x16x32_bf16 v[96:99], v[184:187], a[8:11], v[96:99]
  ds_read_b64_tr_b16 v[176:177], v12 offset:32768
  v_sub_f32 v232, v232, v243
  v_mfma_f32_16x16x32_bf16 v[96:99], v[188:191], a[12:15], v[96:99]
  buffer_load_dwordx4 v209, s[20:23], s43 offen offset:1024 lds
  v_mfma_f32_16x16x32_bf16 v[100:103], v[184:187], a[72:75], v[100:103]
  ds_read_b64_tr_b16 v[178:179], v12 offset:33792
  v_sub_f32 v233, v233, v243
  v_mfma_f32_16x16x32_bf16 v[100:103], v[188:191], a[76:79], v[100:103]
  v_sub_f32 v234, v234, v243
  v_sub_f32 v235, v235, v243
  v_mfma_f32_16x16x32_bf16 v[104:107], v[184:187], a[136:139], v[104:107]
  ds_read_b64_tr_b16 v[180:181], v12 offset:40960
  v_sub_f32 v236, v236, v243
  v_mfma_f32_16x16x32_bf16 v[104:107], v[188:191], a[140:143], v[104:107]
  buffer_load_dwordx4 v210, s[20:23], s43 offen offset:2048 lds
  v_mfma_f32_16x16x32_bf16 v[108:111], v[184:187], a[200:203], v[108:111]
  ds_read_b64_tr_b16 v[182:183], v12 offset:41984
  v_sub_f32 v237, v237, v243
  v_mfma_f32_16x16x32_bf16 v[108:111], v[188:191], a[204:207], v[108:111]
  s_waitcnt vmcnt(17)
  ds_read_b128 a[16:19], v212 offset:0
  v_sub_f32 v238, v238, v243
  v_mfma_f32_16x16x32_bf16 v[112:115], v[192:195], a[8:11], v[112:115]
  ds_read_b64_tr_b16 v[184:185], v13 offset:32768
  v_sub_f32 v239, v239, v243
  v_mfma_f32_16x16x32_bf16 v[112:115], v[196:199], a[12:15], v[112:115]
  ds_read_b128 a[20:23], v213 offset:0
  v_cvt_pk_bf16_f32 v216, v224, v225
  v_mfma_f32_16x16x32_bf16 v[116:119], v[192:195], a[72:75], v[116:119]
  ds_read_b64_tr_b16 v[186:187], v13 offset:33792
  v_cvt_pk_bf16_f32 v217, v226, v227
  v_mfma_f32_16x16x32_bf16 v[116:119], v[196:199], a[76:79], v[116:119]
  buffer_load_dwordx4 v211, s[20:23], s43 offen offset:3072 lds
  v_mfma_f32_16x16x32_bf16 v[120:123], v[192:195], a[136:139], v[120:123]
  buffer_load_dword v252, v3, s[28:31], 0 offen
  ds_read_b64_tr_b16 v[188:189], v13 offset:40960
  v_cvt_pk_bf16_f32 v218, v228, v229
  v_mfma_f32_16x16x32_bf16 v[120:123], v[196:199], a[140:143], v[120:123]
  s_waitcnt vmcnt(17)
  ds_read_b128 a[80:83], v212 offset:2048
  v_cvt_pk_bf16_f32 v219, v230, v231
  v_mfma_f32_16x16x32_bf16 v[124:127], v[192:195], a[200:203], v[124:127]
  ds_read_b64_tr_b16 v[190:191], v13 offset:41984
  v_cvt_pk_bf16_f32 v220, v232, v233
  v_mfma_f32_16x16x32_bf16 v[124:127], v[196:199], a[204:207], v[124:127]
  ds_read_b128 a[84:87], v213 offset:2048
  v_cvt_pk_bf16_f32 v221, v234, v235
  v_mfma_f32_16x16x32_bf16 v[128:131], v[200:203], a[8:11], v[128:131]
  ds_read_b64_tr_b16 v[192:193], v14 offset:32768
  v_cvt_pk_bf16_f32 v222, v236, v237
  v_mfma_f32_16x16x32_bf16 v[128:131], v[204:207], a[12:15], v[128:131]
  s_waitcnt vmcnt(15)
  ds_read_b128 a[144:147], v212 offset:4096
  v_cvt_pk_bf16_f32 v223, v238, v239
  v_mfma_f32_16x16x32_bf16 v[132:135], v[200:203], a[72:75], v[132:135]
  ds_read_b64_tr_b16 v[194:195], v14 offset:33792
  v_lshlrev_b32 v224, 16, v216
  v_mfma_f32_16x16x32_bf16 v[132:135], v[204:207], a[76:79], v[132:135]
  ds_read_b128 a[148:151], v213 offset:4096
  v_and_b32 v225, 0xffff0000, v216
  v_mfma_f32_16x16x32_bf16 v[136:139], v[200:203], a[136:139], v[136:139]
  ds_read_b64_tr_b16 v[196:197], v14 offset:40960
  v_mul_f32 v224, v224, v245
  v_mfma_f32_16x16x32_bf16 v[136:139], v[204:207], a[140:143], v[136:139]
  s_waitcnt vmcnt(13)
  ds_read_b128 a[208:211], v212 offset:6144
  v_mul_f32 v225, v225, v245
  v_mfma_f32_16x16x32_bf16 v[140:143], v[200:203], a[200:203], v[140:143]
  ds_read_b64_tr_b16 v[198:199], v14 offset:41984
  v_lshlrev_b32 v226, 16, v217
  v_mfma_f32_16x16x32_bf16 v[140:143], v[204:207], a[204:207], v[140:143]
  ds_read_b128 a[212:215], v213 offset:6144
  v_and_b32 v227, 0xffff0000, v217
  s_waitcnt lgkmcnt(13)
  v_mfma_f32_16x16x32_bf16 v[16:19], v[144:147], a[16:19], v[16:19]
  s_add_u32 s49, s44, 2097152
  s_add_u32 m0, s41, 131072
  ds_read_b64_tr_b16 v[200:201], v15 offset:32768
  v_mul_f32 v226, v226, v245
  v_mfma_f32_16x16x32_bf16 v[16:19], v[148:151], a[20:23], v[16:19]
  s_waitcnt lgkmcnt(9)
  buffer_load_dwordx4 v4, s[24:27], s49 offen offset:0 lds
  v_mfma_f32_16x16x32_bf16 v[20:23], v[144:147], a[80:83], v[20:23]
  ds_read_b64_tr_b16 v[202:203], v15 offset:33792
  v_mul_f32 v227, v227, v245
  v_mfma_f32_16x16x32_bf16 v[20:23], v[148:151], a[84:87], v[20:23]
  s_waitcnt lgkmcnt(6)
  v_lshlrev_b32 v228, 16, v218
  v_and_b32 v229, 0xffff0000, v218
  v_mfma_f32_16x16x32_bf16 v[24:27], v[144:147], a[144:147], v[24:27]
  ds_read_b64_tr_b16 v[204:205], v15 offset:40960
  v_mul_f32 v228, v228, v245
  v_mfma_f32_16x16x32_bf16 v[24:27], v[148:151], a[148:151], v[24:27]
  s_waitcnt lgkmcnt(3)
  buffer_load_dwordx4 v5, s[24:27], s49 offen offset:1024 lds
  v_mfma_f32_16x16x32_bf16 v[28:31], v[144:147], a[208:211], v[28:31]
  ds_read_b64_tr_b16 v[206:207], v15 offset:41984
  v_mul_f32 v229, v229, v245
  v_mfma_f32_16x16x32_bf16 v[28:31], v[148:151], a[212:215], v[28:31]
  v_lshlrev_b32 v230, 16, v219
  v_and_b32 v231, 0xffff0000, v219
  v_mfma_f32_16x16x32_bf16 v[32:35], v[152:155], a[16:19], v[32:35]
  s_cmp_lg_u32 s36, 0
  s_cbranch_scc1 L_nst2_0
  s_call_b64 s[52:53], L_w_b_full_diag_1
L_nst2_0:
  s_cmp_lg_u32 s36, 1
  s_cbranch_scc1 L_nst2_1
  s_call_b64 s[52:53], L_w_b_full_None_0st
L_nst2_1:
  s_cmp_lg_u32 s36, 2
  s_cbranch_scc1 L_nst2_2
  s_call_b64 s[52:53], L_w_b_None_full_0lastlo
L_nst2_2:
  s_cmp_lg_u32 s36, 3
  s_cbranch_scc1 L_nst2_3
  s_call_b64 s[52:53], L_w_merge
L_nst2_3:
  v_mul_f32 v230, v230, v245
  v_mul_f32 v231, v231, v245
  v_mfma_f32_16x16x32_bf16 v[32:35], v[156:159], a[20:23], v[32:35]
  s_waitcnt vmcnt(11) lgkmcnt(0)
  s_barrier
  v_lshlrev_b32 v232, 16, v220
  v_and_b32 v233, 0xffff0000, v220
  v_mfma_f32_16x16x32_bf16 v[36:39], v[152:155], a[80:83], v[36:39]
  ds_read_b64_tr_b16 v[144:145], v8 offset:0
  v_mul_f32 v232, v232, v245
  v_mfma_f32_16x16x32_bf16 v[36:39], v[156:159], a[84:87], v[36:39]
  buffer_load_dwordx4 v6, s[24:27], s49 offen offset:2048 lds
  v_mfma_f32_16x16x32_bf16 v[40:43], v[152:155], a[144:147], v[40:43]
  ds_read_b64_tr_b16 v[146:147], v8 offset:1024
  v_mul_f32 v233, v233, v245
  v_mfma_f32_16x16x32_bf16 v[40:43], v[156:159], a[148:151], v[40:43]
  v_lshlrev_b32 v234, 16, v221
  v_and_b32 v235, 0xffff0000, v221
  v_mfma_f32_16x16x32_bf16 v[44:47], v[152:155], a[208:211], v[44:47]
  ds_read_b64_tr_b16 v[148:149], v8 offset:8192
  v_mul_f32 v234, v234, v245
  v_mfma_f32_16x16x32_bf16 v[44:47], v[156:159], a[212:215], v[44:47]
  buffer_load_dwordx4 v7, s[24:27], s49 offen offset:3072 lds
  v_mfma_f32_16x16x32_bf16 v[48:51], v[160:163], a[16:19], v[48:51]
  ds_read_b64_tr_b16 v[150:151], v8 offset:9216
  v_mul_f32 v235, v235, v245
  v_mfma_f32_16x16x32_bf16 v[48:51], v[164:167], a[20:23], v[48:51]
  v_lshlrev_b32 v236, 16, v222
  v_and_b32 v237, 0xffff0000, v222
  v_mfma_f32_16x16x32_bf16 v[52:55], v[160:163], a[80:83], v[52:55]
  ds_read_b64_tr_b16 v[152:153], v9 offset:0
  v_mul_f32 v236, v236, v245
  v_mfma_f32_16x16x32_bf16 v[52:55], v[164:167], a[84:87], v[52:55]
  v_mul_f32 v237, v237, v245
  v_lshlrev_b32 v238, 16, v223
  v_mfma_f32_16x16x32_bf16 v[56:59], v[160:163], a[144:147], v[56:59]
  s_add_u32 s43, s40, 512
  s_add_u32 m0, s42, 0
  ds_read_b64_tr_b16 v[154:155], v9 offset:1024
  v_and_b32 v239, 0xffff0000, v223
  v_mfma_f32_16x16x32_bf16 v[56:59], v[164:167], a[148:151], v[56:59]
  buffer_load_dwordx4 v208, s[20:23], s43 offen offset:0 lds
  v_mfma_f32_16x16x32_bf16 v[60:63], v[160:163], a[208:211], v[60:63]
  ds_read_b64_tr_b16 v[156:157], v9 offset:8192
  v_mul_f32 v238, v238, v245
  v_mfma_f32_16x16x32_bf16 v[60:63], v[164:167], a[212:215], v[60:63]
  ds_read_b64_tr_b16 v[158:159], v9 offset:9216
  v_mul_f32 v239, v239, v245
  v_mfma_f32_16x16x32_bf16 v[64:67], v[168:171], a[16:19], v[64:67]
  ds_read_b64_tr_b16 v[160:161], v10 offset:0
  v_cvt_pk_bf16_f32 v216, v224, v225
  v_mfma_f32_16x16x32_bf16 v[64:67], v[172:175], a[20:23], v[64:67]
  buffer_load_dwordx4 v209, s[20:23], s43 offen offset:1024 lds
  v_mfma_f32_16x16x32_bf16 v[68:71], v[168:171], a[80:83], v[68:71]
  ds_read_b64_tr_b16 v[162:163], v10 offset:1024
  v_cvt_pk_bf16_f32 v217, v226, v227
  v_mfma_f32_16x16x32_bf16 v[68:71], v[172:175], a[84:87], v[68:71]
  v_cvt_pk_bf16_f32 v218, v228, v229
  v_cvt_pk_bf16_f32 v219, v230, v231
  v_mfma_f32_16x16x32_bf16 v[72:75], v[168:171], a[144:147], v[72:75]
  ds_read_b64_tr_b16 v[164:165], v10 offset:8192
  v_cvt_pk_bf16_f32 v220, v232, v233
  v_mfma_f32_16x16x32_bf16 v[72:75], v[172:175], a[148:151], v[72:75]
  buffer_load_dwordx4 v210, s[20:23], s43 offen offset:2048 lds
  v_mfma_f32_16x16x32_bf16 v[76:79], v[168:171], a[208:211], v[76:79]
  ds_read_b64_tr_b16 v[166:167], v10 offset:9216
  v_cvt_pk_bf16_f32 v221, v234, v235
  v_mfma_f32_16x16x32_bf16 v[76:79], v[172:175], a[212:215], v[76:79]
  v_cvt_pk_bf16_f32 v222, v236, v237
  v_cvt_pk_bf16_f32 v223, v238, v239
  v_mfma_f32_16x16x32_bf16 v[80:83], v[176:179], a[16:19], v[80:83]
  ds_read_b64_tr_b16 v[168:169], v11 offset:0
  v_mfma_f32_16x16x32_bf16 v[80:83], v[180:183], a[20:23], v[80:83]
  buffer_load_dwordx4 v211, s[20:23], s43 offen offset:3072 lds
  v_mfma_f32_16x16x32_bf16 v[84:87], v[176:179], a[80:83], v[84:87]
  ds_read_b64_tr_b16 v[170:171], v11 offset:1024
  v_mfma_f32_16x16x32_bf16 v[84:87], v[180:183], a[84:87], v[84:87]
  v_mfma_f32_16x16x32_bf16 v[88:91], v[176:179], a[144:147], v[88:91]
  s_add_u32 s43, s43, 32768
  s_add_u32 m0, s42, 4096
  ds_read_b64_tr_b16 v[172:173], v11 offset:8192
  v_mfma_f32_16x16x32_bf16 v[88:91], v[180:183], a[148:151], v[88:91]
  buffer_load_dwordx4 v208, s[20:23], s43 offen offset:0 lds
  v_mfma_f32_16x16x32_bf16 v[92:95], v[176:179], a[208:211], v[92:95]
  ds_read_b64_tr_b16 v[174:175], v11 offset:9216
  v_mfma_f32_16x16x32_bf16 v[92:95], v[180:183], a[212:215], v[92:95]
  v_mfma_f32_16x16x32_bf16 v[96:99], v[184:187], a[16:19], v[96:99]
  ds_read_b64_tr_b16 v[176:177], v12 offset:0
  v_mfma_f32_16x16x32_bf16 v[96:99], v[188:191], a[20:23], v[96:99]
  buffer_load_dwordx4 v209, s[20:23], s43 offen offset:1024 lds
  v_mfma_f32_16x16x32_bf16 v[100:103], v[184:187], a[80:83], v[100:103]
  ds_read_b64_tr_b16 v[178:179], v12 offset:1024
  v_mfma_f32_16x16x32_bf16 v[100:103], v[188:191], a[84:87], v[100:103]
  v_mfma_f32_16x16x32_bf16 v[104:107], v[184:187], a[144:147], v[104:107]
  ds_read_b64_tr_b16 v[180:181], v12 offset:8192
  v_mfma_f32_16x16x32_bf16 v[104:107], v[188:191], a[148:151], v[104:107]
  buffer_load_dwordx4 v210, s[20:23], s43 offen offset:2048 lds
  v_mfma_f32_16x16x32_bf16 v[108:111], v[184:187], a[208:211], v[108:111]
  ds_read_b64_tr_b16 v[182:183], v12 offset:9216
  v_mfma_f32_16x16x32_bf16 v[108:111], v[188:191], a[212:215], v[108:111]
  s_waitcnt vmcnt(18)
  ds_read_b128 a[24:27], v212 offset:32768
  v_mfma_f32_16x16x32_bf16 v[112:115], v[192:195], a[16:19], v[112:115]
  ds_read_b64_tr_b16 v[184:185], v13 offset:0
  v_mfma_f32_16x16x32_bf16 v[112:115], v[196:199], a[20:23], v[112:115]
  ds_read_b128 a[28:31], v213 offset:32768
  v_mfma_f32_16x16x32_bf16 v[116:119], v[192:195], a[80:83], v[116:119]
  ds_read_b64_tr_b16 v[186:187], v13 offset:1024
  v_mfma_f32_16x16x32_bf16 v[116:119], v[196:199], a[84:87], v[116:119]
  buffer_load_dwordx4 v211, s[20:23], s43 offen offset:3072 lds
  v_mfma_f32_16x16x32_bf16 v[120:123], v[192:195], a[144:147], v[120:123]
  ds_read_b64_tr_b16 v[188:189], v13 offset:8192
  v_mfma_f32_16x16x32_bf16 v[120:123], v[196:199], a[148:151], v[120:123]
  s_waitcnt vmcnt(17)
  ds_read_b128 a[88:91], v212 offset:34816
  v_mfma_f32_16x16x32_bf16 v[124:127], v[192:195], a[208:211], v[124:127]
  ds_read_b64_tr_b16 v[190:191], v13 offset:9216
  v_mfma_f32_16x16x32_bf16 v[124:127], v[196:199], a[212:215], v[124:127]
  ds_read_b128 a[92:95], v213 offset:34816
  v_mfma_f32_16x16x32_bf16 v[128:131], v[200:203], a[16:19], v[128:131]
  ds_read_b64_tr_b16 v[192:193], v14 offset:0
  v_mfma_f32_16x16x32_bf16 v[128:131], v[204:207], a[20:23], v[128:131]
  s_waitcnt vmcnt(15)
  ds_read_b128 a[152:155], v212 offset:36864
  v_mfma_f32_16x16x32_bf16 v[132:135], v[200:203], a[80:83], v[132:135]
  ds_read_b64_tr_b16 v[194:195], v14 offset:1024
  v_mfma_f32_16x16x32_bf16 v[132:135], v[204:207], a[84:87], v[132:135]
  ds_read_b128 a[156:159], v213 offset:36864
  v_mfma_f32_16x16x32_bf16 v[136:139], v[200:203], a[144:147], v[136:139]
  ds_read_b64_tr_b16 v[196:197], v14 offset:8192
  v_mfma_f32_16x16x32_bf16 v[136:139], v[204:207], a[148:151], v[136:139]
  s_waitcnt vmcnt(13)
  ds_read_b128 a[216:219], v212 offset:38912
  v_mfma_f32_16x16x32_bf16 v[140:143], v[200:203], a[208:211], v[140:143]
  ds_read_b64_tr_b16 v[198:199], v14 offset:9216
  v_mfma_f32_16x16x32_bf16 v[140:143], v[204:207], a[212:215], v[140:143]
  ds_read_b128 a[220:223], v213 offset:38912
  s_waitcnt lgkmcnt(13)
  v_mfma_f32_16x16x32_bf16 v[16:19], v[144:147], a[24:27], v[16:19]
  s_add_u32 s49, s44, 2621440
  s_add_u32 m0, s41, 147456
  ds_read_b64_tr_b16 v[200:201], v15 offset:0
  v_mfma_f32_16x16x32_bf16 v[16:19], v[148:151], a[28:31], v[16:19]
  s_waitcnt lgkmcnt(9)
  buffer_load_dwordx4 v4, s[24:27], s49 offen offset:0 lds
  v_mfma_f32_16x16x32_bf16 v[20:23], v[144:147], a[88:91], v[20:23]
  ds_read_b64_tr_b16 v[202:203], v15 offset:1024
  v_mfma_f32_16x16x32_bf16 v[20:23], v[148:151], a[92:95], v[20:23]
  s_waitcnt lgkmcnt(6)
  v_mfma_f32_16x16x32_bf16 v[24:27], v[144:147], a[152:155], v[24:27]
  ds_read_b64_tr_b16 v[204:205], v15 offset:8192
  v_mfma_f32_16x16x32_bf16 v[24:27], v[148:151], a[156:159], v[24:27]
  s_waitcnt lgkmcnt(3)
  buffer_load_dwordx4 v5, s[24:27], s49 offen offset:1024 lds
  v_mfma_f32_16x16x32_bf16 v[28:31], v[144:147], a[216:219], v[28:31]
  ds_read_b64_tr_b16 v[206:207], v15 offset:9216
  v_mfma_f32_16x16x32_bf16 v[28:31], v[148:151], a[220:223], v[28:31]
  v_mfma_f32_16x16x32_bf16 v[32:35], v[152:155], a[24:27], v[32:35]
  v_mfma_f32_16x16x32_bf16 v[32:35], v[156:159], a[28:31], v[32:35]
  s_waitcnt vmcnt(10) lgkmcnt(0)
  s_barrier
  v_mfma_f32_16x16x32_bf16 v[36:39], v[152:155], a[88:91], v[36:39]
  ds_read_b64_tr_b16 v[144:145], v8 offset:16384
  v_mfma_f32_16x16x32_bf16 v[36:39], v[156:159], a[92:95], v[36:39]
  buffer_load_dwordx4 v6, s[24:27], s49 offen offset:2048 lds
  v_mfma_f32_16x16x32_bf16 v[40:43], v[152:155], a[152:155], v[40:43]
  ds_read_b64_tr_b16 v[146:147], v8 offset:17408
  v_mfma_f32_16x16x32_bf16 v[40:43], v[156:159], a[156:159], v[40:43]
  v_mfma_f32_16x16x32_bf16 v[44:47], v[152:155], a[216:219], v[44:47]
  ds_read_b64_tr_b16 v[148:149], v8 offset:24576
  v_mfma_f32_16x16x32_bf16 v[44:47], v[156:159], a[220:223], v[44:47]
  buffer_load_dwordx4 v7, s[24:27], s49 offen offset:3072 lds
  v_mfma_f32_16x16x32_bf16 v[48:51], v[160:163], a[24:27], v[48:51]
  ds_read_b64_tr_b16 v[150:151], v8 offset:25600
  v_mfma_f32_16x16x32_bf16 v[48:51], v[164:167], a[28:31], v[48:51]
  v_mfma_f32_16x16x32_bf16 v[52:55], v[160:163], a[88:91], v[52:55]
  ds_read_b64_tr_b16 v[152:153], v9 offset:16384
  v_mfma_f32_16x16x32_bf16 v[52:55], v[164:167], a[92:95], v[52:55]
  v_mfma_f32_16x16x32_bf16 v[56:59], v[160:163], a[152:155], v[56:59]
  s_add_u32 s43, s40, 640
  s_add_u32 m0, s42, 32768
  ds_read_b64_tr_b16 v[154:155], v9 offset:17408
  v_mfma_f32_16x16x32_bf16 v[56:59], v[164:167], a[156:159], v[56:59]
  buffer_load_dwordx4 v208, s[20:23], s43 offen offset:0 lds
  v_mfma_f32_16x16x32_bf16 v[60:63], v[160:163], a[216:219], v[60:63]
  ds_read_b64_tr_b16 v[156:157], v9 offset:24576
  v_mfma_f32_16x16x32_bf16 v[60:63], v[164:167], a[220:223], v[60:63]
  ds_read_b64_tr_b16 v[158:159], v9 offset:25600
  v_mfma_f32_16x16x32_bf16 v[64:67], v[168:171], a[24:27], v[64:67]
  ds_read_b64_tr_b16 v[160:161], v10 offset:16384
  v_mfma_f32_16x16x32_bf16 v[64:67], v[172:175], a[28:31], v[64:67]
  buffer_load_dwordx4 v209, s[20:23], s43 offen offset:1024 lds
  v_mfma_f32_16x16x32_bf16 v[68:71], v[168:171], a[88:91], v[68:71]
  ds_read_b64_tr_b16 v[162:163], v10 offset:17408
  v_mfma_f32_16x16x32_bf16 v[68:71], v[172:175], a[92:95], v[68:71]
  v_mfma_f32_16x16x32_bf16 v[72:75], v[168:171], a[152:155], v[72:75]
  ds_read_b64_tr_b16 v[164:165], v10 offset:24576
  v_mfma_f32_16x16x32_bf16 v[72:75], v[172:175], a[156:159], v[72:75]
  buffer_load_dwordx4 v210, s[20:23], s43 offen offset:2048 lds
  v_mfma_f32_16x16x32_bf16 v[76:79], v[168:171], a[216:219], v[76:79]
  ds_read_b64_tr_b16 v[166:167], v10 offset:25600
  v_mfma_f32_16x16x32_bf16 v[76:79], v[172:175], a[220:223], v[76:79]
  v_mfma_f32_16x16x32_bf16 v[80:83], v[176:179], a[24:27], v[80:83]
  ds_read_b64_tr_b16 v[168:169], v11 offset:16384
  v_mfma_f32_16x16x32_bf16 v[80:83], v[180:183], a[28:31], v[80:83]
  buffer_load_dwordx4 v211, s[20:23], s43 offen offset:3072 lds
  v_mfma_f32_16x16x32_bf16 v[84:87], v[176:179], a[88:91], v[84:87]
  ds_read_b64_tr_b16 v[170:171], v11 offset:17408
  v_mfma_f32_16x16x32_bf16 v[84:87], v[180:183], a[92:95], v[84:87]
  v_mfma_f32_16x16x32_bf16 v[88:91], v[176:179], a[152:155], v[88:91]
  s_add_u32 s43, s43, 32768
  s_add_u32 m0, s42, 36864
  ds_read_b64_tr_b16 v[172:173], v11 offset:24576
  v_mfma_f32_16x16x32_bf16 v[88:91], v[180:183], a[156:159], v[88:91]
  buffer_load_dwordx4 v208, s[20:23], s43 offen offset:0 lds
  v_mfma_f32_16x16x32_bf16 v[92:95], v[176:179], a[216:219], v[92:95]
  ds_read_b64_tr_b16 v[174:175], v11 offset:25600
  v_mfma_f32_16x16x32_bf16 v[92:95], v[180:183], a[220:223], v[92:95]
  v_mfma_f32_16x16x32_bf16 v[96:99], v[184:187], a[24:27], v[96:99]
  ds_read_b64_tr_b16 v[176:177], v12 offset:16384
  v_mfma_f32_16x16x32_bf16 v[96:99], v[188:191], a[28:31], v[96:99]
  buffer_load_dwordx4 v209, s[20:23], s43 offen offset:1024 lds
  v_mfma_f32_16x16x32_bf16 v[100:103], v[184:187], a[88:91], v[100:103]
  ds_read_b64_tr_b16 v[178:179], v12 offset:17408
  v_mfma_f32_16x16x32_bf16 v[100:103], v[188:191], a[92:95], v[100:103]
  v_mfma_f32_16x16x32_bf16 v[104:107], v[184:187], a[152:155], v[104:107]
  ds_read_b64_tr_b16 v[180:181], v12 offset:24576
  v_mfma_f32_16x16x32_bf16 v[104:107], v[188:191], a[156:159], v[104:107]
  buffer_load_dwordx4 v210, s[20:23], s43 offen offset:2048 lds
  v_mfma_f32_16x16x32_bf16 v[108:111], v[184:187], a[216:219], v[108:111]
  ds_read_b64_tr_b16 v[182:183], v12 offset:25600
  v_mfma_f32_16x16x32_bf16 v[108:111], v[188:191], a[220:223], v[108:111]
  s_waitcnt vmcnt(17)
  ds_read_b128 a[32:35], v212 offset:0
  v_mfma_f32_16x16x32_bf16 v[112:115], v[192:195], a[24:27], v[112:115]
  ds_read_b64_tr_b16 v[184:185], v13 offset:16384
  v_mfma_f32_16x16x32_bf16 v[112:115], v[196:199], a[28:31], v[112:115]
  ds_read_b128 a[36:39], v213 offset:0
  v_mfma_f32_16x16x32_bf16 v[116:119], v[192:195], a[88:91], v[116:119]
  ds_read_b64_tr_b16 v[186:187], v13 offset:17408
  v_mfma_f32_16x16x32_bf16 v[116:119], v[196:199], a[92:95], v[116:119]
  buffer_load_dwordx4 v211, s[20:23], s43 offen offset:3072 lds
  v_mfma_f32_16x16x32_bf16 v[120:123], v[192:195], a[152:155], v[120:123]
  ds_read_b64_tr_b16 v[188:189], v13 offset:24576
  v_mfma_f32_16x16x32_bf16 v[120:123], v[196:199], a[156:159], v[120:123]
  s_waitcnt vmcnt(16)
  ds_read_b128 a[96:99], v212 offset:2048
  v_mfma_f32_16x16x32_bf16 v[124:127], v[192:195], a[216:219], v[124:127]
  ds_read_b64_tr_b16 v[190:191], v13 offset:25600
  v_mfma_f32_16x16x32_bf16 v[124:127], v[196:199], a[220:223], v[124:127]
  ds_read_b128 a[100:103], v213 offset:2048
  v_mfma_f32_16x16x32_bf16 v[128:131], v[200:203], a[24:27], v[128:131]
  ds_read_b64_tr_b16 v[192:193], v14 offset:16384
  v_mfma_f32_16x16x32_bf16 v[128:131], v[204:207], a[28:31], v[128:131]
  s_waitcnt vmcnt(14)
  ds_read_b128 a[160:163], v212 offset:4096
  v_mfma_f32_16x16x32_bf16 v[132:135], v[200:203], a[88:91], v[132:135]
  ds_read_b64_tr_b16 v[194:195], v14 offset:17408
  v_mfma_f32_16x16x32_bf16 v[132:135], v[204:207], a[92:95], v[132:135]
  ds_read_b128 a[164:167], v213 offset:4096
  v_mfma_f32_16x16x32_bf16 v[136:139], v[200:203], a[152:155], v[136:139]
  ds_read_b64_tr_b16 v[196:197], v14 offset:24576
  v_mfma_f32_16x16x32_bf16 v[136:139], v[204:207], a[156:159], v[136:139]
  s_waitcnt vmcnt(12)
  ds_read_b128 a[224:227], v212 offset:6144
  v_mfma_f32_16x16x32_bf16 v[140:143], v[200:203], a[216:219], v[140:143]
  ds_read_b64_tr_b16 v[198:199], v14 offset:25600
  v_mfma_f32_16x16x32_bf16 v[140:143], v[204:207], a[220:223], v[140:143]
  ds_read_b128 a[228:231], v213 offset:6144
  s_waitcnt lgkmcnt(13)
  v_mfma_f32_16x16x32_bf16 v[16:19], v[144:147], a[32:35], v[16:19]
  s_add_u32 s49, s44, 3145728
  s_add_u32 m0, s41, 114688
  ds_read_b64_tr_b16 v[200:201], v15 offset:16384
  v_mfma_f32_16x16x32_bf16 v[16:19], v[148:151], a[36:39], v[16:19]
  s_waitcnt lgkmcnt(9)
  buffer_load_dwordx4 v4, s[24:27], s49 offen offset:0 lds
  v_mfma_f32_16x16x32_bf16 v[20:23], v[144:147], a[96:99], v[20:23]
  ds_read_b64_tr_b16 v[202:203], v15 offset:17408
  v_mfma_f32_16x16x32_bf16 v[20:23], v[148:151], a[100:103], v[20:23]
  s_waitcnt lgkmcnt(6)
  v_mfma_f32_16x16x32_bf16 v[24:27], v[144:147], a[160:163], v[24:27]
  ds_read_b64_tr_b16 v[204:205], v15 offset:24576
  v_mfma_f32_16x16x32_bf16 v[24:27], v[148:151], a[164:167], v[24:27]
  s_waitcnt lgkmcnt(3)
  buffer_load_dwordx4 v5, s[24:27], s49 offen offset:1024 lds
  v_mfma_f32_16x16x32_bf16 v[28:31], v[144:147], a[224:227], v[28:31]
  ds_read_b64_tr_b16 v[206:207], v15 offset:25600
  v_mfma_f32_16x16x32_bf16 v[28:31], v[148:151], a[228:231], v[28:31]
  v_mfma_f32_16x16x32_bf16 v[32:35], v[152:155], a[32:35], v[32:35]
  v_mfma_f32_16x16x32_bf16 v[32:35], v[156:159], a[36:39], v[32:35]
  s_waitcnt vmcnt(10) lgkmcnt(0)
  s_barrier
  v_mfma_f32_16x16x32_bf16 v[36:39], v[152:155], a[96:99], v[36:39]
  ds_read_b64_tr_b16 v[144:145], v8 offset:32768
  v_mfma_f32_16x16x32_bf16 v[36:39], v[156:159], a[100:103], v[36:39]
  buffer_load_dwordx4 v6, s[24:27], s49 offen offset:2048 lds
  v_mfma_f32_16x16x32_bf16 v[40:43], v[152:155], a[160:163], v[40:43]
  ds_read_b64_tr_b16 v[146:147], v8 offset:33792
  v_mfma_f32_16x16x32_bf16 v[40:43], v[156:159], a[164:167], v[40:43]
  v_mfma_f32_16x16x32_bf16 v[44:47], v[152:155], a[224:227], v[44:47]
  ds_read_b64_tr_b16 v[148:149], v8 offset:40960
  v_mfma_f32_16x16x32_bf16 v[44:47], v[156:159], a[228:231], v[44:47]
  buffer_load_dwordx4 v7, s[24:27], s49 offen offset:3072 lds
  v_mfma_f32_16x16x32_bf16 v[48:51], v[160:163], a[32:35], v[48:51]
  ds_read_b64_tr_b16 v[150:151], v8 offset:41984
  v_mfma_f32_16x16x32_bf16 v[48:51], v[164:167], a[36:39], v[48:51]
  v_mfma_f32_16x16x32_bf16 v[52:55], v[160:163], a[96:99], v[52:55]
  ds_read_b64_tr_b16 v[152:153], v9 offset:32768
  v_mfma_f32_16x16x32_bf16 v[52:55], v[164:167], a[100:103], v[52:55]
  v_mfma_f32_16x16x32_bf16 v[56:59], v[160:163], a[160:163], v[56:59]
  s_add_u32 s43, s40, 768
  s_add_u32 m0, s42, 0
  ds_read_b64_tr_b16 v[154:155], v9 offset:33792
  v_mfma_f32_16x16x32_bf16 v[56:59], v[164:167], a[164:167], v[56:59]
  buffer_load_dwordx4 v208, s[20:23], s43 offen offset:0 lds
  v_mfma_f32_16x16x32_bf16 v[60:63], v[160:163], a[224:227], v[60:63]
  ds_read_b64_tr_b16 v[156:157], v9 offset:40960
  v_mfma_f32_16x16x32_bf16 v[60:63], v[164:167], a[228:231], v[60:63]
  ds_read_b64_tr_b16 v[158:159], v9 offset:41984
  v_mfma_f32_16x16x32_bf16 v[64:67], v[168:171], a[32:35], v[64:67]
  ds_read_b64_tr_b16 v[160:161], v10 offset:32768
  v_mfma_f32_16x16x32_bf16 v[64:67], v[172:175], a[36:39], v[64:67]
  buffer_load_dwordx4 v209, s[20:23], s43 offen offset:1024 lds
  v_mfma_f32_16x16x32_bf16 v[68:71], v[168:171], a[96:99], v[68:71]
  ds_read_b64_tr_b16 v[162:163], v10 offset:33792
  v_mfma_f32_16x16x32_bf16 v[68:71], v[172:175], a[100:103], v[68:71]
  v_mfma_f32_16x16x32_bf16 v[72:75], v[168:171], a[160:163], v[72:75]
  ds_read_b64_tr_b16 v[164:165], v10 offset:40960
  v_mfma_f32_16x16x32_bf16 v[72:75], v[172:175], a[164:167], v[72:75]
  buffer_load_dwordx4 v210, s[20:23], s43 offen offset:2048 lds
  v_mfma_f32_16x16x32_bf16 v[76:79], v[168:171], a[224:227], v[76:79]
  ds_read_b64_tr_b16 v[166:167], v10 offset:41984
  v_mfma_f32_16x16x32_bf16 v[76:79], v[172:175], a[228:231], v[76:79]
  v_mfma_f32_16x16x32_bf16 v[80:83], v[176:179], a[32:35], v[80:83]
  ds_read_b64_tr_b16 v[168:169], v11 offset:32768
  v_mfma_f32_16x16x32_bf16 v[80:83], v[180:183], a[36:39], v[80:83]
  buffer_load_dwordx4 v211, s[20:23], s43 offen offset:3072 lds
  v_mfma_f32_16x16x32_bf16 v[84:87], v[176:179], a[96:99], v[84:87]
  ds_read_b64_tr_b16 v[170:171], v11 offset:33792
  v_mfma_f32_16x16x32_bf16 v[84:87], v[180:183], a[100:103], v[84:87]
  v_mfma_f32_16x16x32_bf16 v[88:91], v[176:179], a[160:163], v[88:91]
  s_add_u32 s43, s43, 32768
  s_add_u32 m0, s42, 4096
  ds_read_b64_tr_b16 v[172:173], v11 offset:40960
  v_mfma_f32_16x16x32_bf16 v[88:91], v[180:183], a[164:167], v[88:91]
  buffer_load_dwordx4 v208, s[20:23], s43 offen offset:0 lds
  v_mfma_f32_16x16x32_bf16 v[92:95], v[176:179], a[224:227], v[92:95]
  ds_read_b64_tr_b16 v[174:175], v11 offset:41984
  v_mfma_f32_16x16x32_bf16 v[92:95], v[180:183], a[228:231], v[92:95]
  v_mfma_f32_16x16x32_bf16 v[96:99], v[184:187], a[32:35], v[96:99]
  ds_read_b64_tr_b16 v[176:177], v12 offset:32768
  v_mfma_f32_16x16x32_bf16 v[96:99], v[188:191], a[36:39], v[96:99]
  buffer_load_dwordx4 v209, s[20:23], s43 offen offset:1024 lds
  v_mfma_f32_16x16x32_bf16 v[100:103], v[184:187], a[96:99], v[100:103]
  ds_read_b64_tr_b16 v[178:179], v12 offset:33792
  v_mfma_f32_16x16x32_bf16 v[100:103], v[188:191], a[100:103], v[100:103]
  v_mfma_f32_16x16x32_bf16 v[104:107], v[184:187], a[160:163], v[104:107]
  ds_read_b64_tr_b16 v[180:181], v12 offset:40960
  v_mfma_f32_16x16x32_bf16 v[104:107], v[188:191], a[164:167], v[104:107]
  buffer_load_dwordx4 v210, s[20:23], s43 offen offset:2048 lds
  v_mfma_f32_16x16x32_bf16 v[108:111], v[184:187], a[224:227], v[108:111]
  ds_read_b64_tr_b16 v[182:183], v12 offset:41984
  v_mfma_f32_16x16x32_bf16 v[108:111], v[188:191], a[228:231], v[108:111]
  s_waitcnt vmcnt(17)
  ds_read_b128 a[40:43], v212 offset:32768
  v_mfma_f32_16x16x32_bf16 v[112:115], v[192:195], a[32:35], v[112:115]
  ds_read_b64_tr_b16 v[184:185], v13 offset:32768
  v_mfma_f32_16x16x32_bf16 v[112:115], v[196:199], a[36:39], v[112:115]
  ds_read_b128 a[44:47], v213 offset:32768
  v_mfma_f32_16x16x32_bf16 v[116:119], v[192:195], a[96:99], v[116:119]
  ds_read_b64_tr_b16 v[186:187], v13 offset:33792
  v_mfma_f32_16x16x32_bf16 v[116:119], v[196:199], a[100:103], v[116:119]
  buffer_load_dwordx4 v211, s[20:23], s43 offen offset:3072 lds
  v_mfma_f32_16x16x32_bf16 v[120:123], v[192:195], a[160:163], v[120:123]
  ds_read_b64_tr_b16 v[188:189], v13 offset:40960
  v_mfma_f32_16x16x32_bf16 v[120:123], v[196:199], a[164:167], v[120:123]
  s_waitcnt vmcnt(16)
  ds_read_b128 a[104:107], v212 offset:34816
  v_mfma_f32_16x16x32_bf16 v[124:127], v[192:195], a[224:227], v[124:127]
  ds_read_b64_tr_b16 v[190:191], v13 offset:41984
  v_mfma_f32_16x16x32_bf16 v[124:127], v[196:199], a[228:231], v[124:127]
  ds_read_b128 a[108:111], v213 offset:34816
  v_mfma_f32_16x16x32_bf16 v[128:131], v[200:203], a[32:35], v[128:131]
  ds_read_b64_tr_b16 v[192:193], v14 offset:32768
  v_mfma_f32_16x16x32_bf16 v[128:131], v[204:207], a[36:39], v[128:131]
  s_waitcnt vmcnt(14)
  ds_read_b128 a[168:171], v212 offset:36864
  v_mfma_f32_16x16x32_bf16 v[132:135], v[200:203], a[96:99], v[132:135]
  ds_read_b64_tr_b16 v[194:195], v14 offset:33792
  v_mfma_f32_16x16x32_bf16 v[132:135], v[204:207], a[100:103], v[132:135]
  ds_read_b128 a[172:175], v213 offset:36864
  v_mfma_f32_16x16x32_bf16 v[136:139], v[200:203], a[160:163], v[136:139]
  ds_read_b64_tr_b16 v[196:197], v14 offset:40960
  v_mfma_f32_16x16x32_bf16 v[136:139], v[204:207], a[164:167], v[136:139]
  s_waitcnt vmcnt(12)
  ds_read_b128 a[232:235], v212 offset:38912
  v_mfma_f32_16x16x32_bf16 v[140:143], v[200:203], a[224:227], v[140:143]
  ds_read_b64_tr_b16 v[198:199], v14 offset:41984
  v_mfma_f32_16x16x32_bf16 v[140:143], v[204:207], a[228:231], v[140:143]
  ds_read_b128 a[236:239], v213 offset:38912
  s_waitcnt lgkmcnt(13)
  v_mfma_f32_16x16x32_bf16 v[16:19], v[144:147], a[40:43], v[16:19]
  s_add_u32 s49, s44, 3670016
  s_add_u32 m0, s41, 131072
  ds_read_b64_tr_b16 v[200:201], v15 offset:32768
  v_mfma_f32_16x16x32_bf16 v[16:19], v[148:151], a[44:47], v[16:19]
  s_waitcnt lgkmcnt(9)
  buffer_load_dwordx4 v4, s[24:27], s49 offen offset:0 lds
  v_mfma_f32_16x16x32_bf16 v[20:23], v[144:147], a[104:107], v[20:23]
  ds_read_b64_tr_b16 v[202:203], v15 offset:33792
  v_mfma_f32_16x16x32_bf16 v[20:23], v[148:151], a[108:111], v[20:23]
  s_waitcnt lgkmcnt(6)
  v_mfma_f32_16x16x32_bf16 v[24:27], v[144:147], a[168:171], v[24:27]
  ds_read_b64_tr_b16 v[204:205], v15 offset:40960
  v_mfma_f32_16x16x32_bf16 v[24:27], v[148:151], a[172:175], v[24:27]
  s_waitcnt lgkmcnt(3)
  buffer_load_dwordx4 v5, s[24:27], s49 offen offset:1024 lds
  v_mfma_f32_16x16x32_bf16 v[28:31], v[144:147], a[232:235], v[28:31]
  ds_read_b64_tr_b16 v[206:207], v15 offset:41984
  v_mfma_f32_16x16x32_bf16 v[28:31], v[148:151], a[236:239], v[28:31]
  v_mfma_f32_16x16x32_bf16 v[32:35], v[152:155], a[40:43], v[32:35]
  v_mfma_f32_16x16x32_bf16 v[32:35], v[156:159], a[44:47], v[32:35]
  s_waitcnt vmcnt(10) lgkmcnt(0)
  s_barrier
  v_mfma_f32_16x16x32_bf16 v[36:39], v[152:155], a[104:107], v[36:39]
  ds_read_b64_tr_b16 v[144:145], v8 offset:0
  v_mfma_f32_16x16x32_bf16 v[36:39], v[156:159], a[108:111], v[36:39]
  buffer_load_dwordx4 v6, s[24:27], s49 offen offset:2048 lds
  v_mfma_f32_16x16x32_bf16 v[40:43], v[152:155], a[168:171], v[40:43]
  ds_read_b64_tr_b16 v[146:147], v8 offset:1024
  v_mfma_f32_16x16x32_bf16 v[40:43], v[156:159], a[172:175], v[40:43]
  v_mfma_f32_16x16x32_bf16 v[44:47], v[152:155], a[232:235], v[44:47]
  ds_read_b64_tr_b16 v[148:149], v8 offset:8192
  v_mfma_f32_16x16x32_bf16 v[44:47], v[156:159], a[236:239], v[44:47]
  buffer_load_dwordx4 v7, s[24:27], s49 offen offset:3072 lds
  v_mfma_f32_16x16x32_bf16 v[48:51], v[160:163], a[40:43], v[48:51]
  ds_read_b64_tr_b16 v[150:151], v8 offset:9216
  v_mfma_f32_16x16x32_bf16 v[48:51], v[164:167], a[44:47], v[48:51]
  v_mfma_f32_16x16x32_bf16 v[52:55], v[160:163], a[104:107], v[52:55]
  ds_read_b64_tr_b16 v[152:153], v9 offset:0
  v_mfma_f32_16x16x32_bf16 v[52:55], v[164:167], a[108:111], v[52:55]
  v_mfma_f32_16x16x32_bf16 v[56:59], v[160:163], a[168:171], v[56:59]
  s_add_u32 s43, s40, 896
  s_add_u32 m0, s42, 32768
  ds_read_b64_tr_b16 v[154:155], v9 offset:1024
  v_mfma_f32_16x16x32_bf16 v[56:59], v[164:167], a[172:175], v[56:59]
  buffer_load_dwordx4 v208, s[20:23], s43 offen offset:0 lds
  v_mfma_f32_16x16x32_bf16 v[60:63], v[160:163], a[232:235], v[60:63]
  ds_read_b64_tr_b16 v[156:157], v9 offset:8192
  v_mfma_f32_16x16x32_bf16 v[60:63], v[164:167], a[236:239], v[60:63]
  ds_read_b64_tr_b16 v[158:159], v9 offset:9216
  v_mfma_f32_16x16x32_bf16 v[64:67], v[168:171], a[40:43], v[64:67]
  ds_read_b64_tr_b16 v[160:161], v10 offset:0
  v_mfma_f32_16x16x32_bf16 v[64:67], v[172:175], a[44:47], v[64:67]
  buffer_load_dwordx4 v209, s[20:23], s43 offen offset:1024 lds
  v_mfma_f32_16x16x32_bf16 v[68:71], v[168:171], a[104:107], v[68:71]
  ds_read_b64_tr_b16 v[162:163], v10 offset:1024
  v_mfma_f32_16x16x32_bf16 v[68:71], v[172:175], a[108:111], v[68:71]
  v_mfma_f32_16x16x32_bf16 v[72:75], v[168:171], a[168:171], v[72:75]
  ds_read_b64_tr_b16 v[164:165], v10 offset:8192
  v_mfma_f32_16x16x32_bf16 v[72:75], v[172:175], a[172:175], v[72:75]
  buffer_load_dwordx4 v210, s[20:23], s43 offen offset:2048 lds
  v_mfma_f32_16x16x32_bf16 v[76:79], v[168:171], a[232:235], v[76:79]
  ds_read_b64_tr_b16 v[166:167], v10 offset:9216
  v_mfma_f32_16x16x32_bf16 v[76:79], v[172:175], a[236:239], v[76:79]
  v_mfma_f32_16x16x32_bf16 v[80:83], v[176:179], a[40:43], v[80:83]
  ds_read_b64_tr_b16 v[168:169], v11 offset:0
  v_mfma_f32_16x16x32_bf16 v[80:83], v[180:183], a[44:47], v[80:83]
  buffer_load_dwordx4 v211, s[20:23], s43 offen offset:3072 lds
  v_mfma_f32_16x16x32_bf16 v[84:87], v[176:179], a[104:107], v[84:87]
  ds_read_b64_tr_b16 v[170:171], v11 offset:1024
  v_mfma_f32_16x16x32_bf16 v[84:87], v[180:183], a[108:111], v[84:87]
  v_mfma_f32_16x16x32_bf16 v[88:91], v[176:179], a[168:171], v[88:91]
  s_add_u32 s43, s43, 32768
  s_add_u32 m0, s42, 36864
  ds_read_b64_tr_b16 v[172:173], v11 offset:8192
  v_mfma_f32_16x16x32_bf16 v[88:91], v[180:183], a[172:175], v[88:91]
  buffer_load_dwordx4 v208, s[20:23], s43 offen offset:0 lds
  v_mfma_f32_16x16x32_bf16 v[92:95], v[176:179], a[232:235], v[92:95]
  ds_read_b64_tr_b16 v[174:175], v11 offset:9216
  v_mfma_f32_16x16x32_bf16 v[92:95], v[180:183], a[236:239], v[92:95]
  v_mfma_f32_16x16x32_bf16 v[96:99], v[184:187], a[40:43], v[96:99]
  ds_read_b64_tr_b16 v[176:177], v12 offset:0
  v_mfma_f32_16x16x32_bf16 v[96:99], v[188:191], a[44:47], v[96:99]
  buffer_load_dwordx4 v209, s[20:23], s43 offen offset:1024 lds
  v_mfma_f32_16x16x32_bf16 v[100:103], v[184:187], a[104:107], v[100:103]
  ds_read_b64_tr_b16 v[178:179], v12 offset:1024
  v_mfma_f32_16x16x32_bf16 v[100:103], v[188:191], a[108:111], v[100:103]
  v_mfma_f32_16x16x32_bf16 v[104:107], v[184:187], a[168:171], v[104:107]
  ds_read_b64_tr_b16 v[180:181], v12 offset:8192
  v_mfma_f32_16x16x32_bf16 v[104:107], v[188:191], a[172:175], v[104:107]
  buffer_load_dwordx4 v210, s[20:23], s43 offen offset:2048 lds
  v_mfma_f32_16x16x32_bf16 v[108:111], v[184:187], a[232:235], v[108:111]
  ds_read_b64_tr_b16 v[182:183], v12 offset:9216
  v_mfma_f32_16x16x32_bf16 v[108:111], v[188:191], a[236:239], v[108:111]
  s_waitcnt vmcnt(17)
  ds_read_b128 a[48:51], v212 offset:0
  v_mfma_f32_16x16x32_bf16 v[112:115], v[192:195], a[40:43], v[112:115]
  ds_read_b64_tr_b16 v[184:185], v13 offset:0
  v_mfma_f32_16x16x32_bf16 v[112:115], v[196:199], a[44:47], v[112:115]
  ds_read_b128 a[52:55], v213 offset:0
  v_mfma_f32_16x16x32_bf16 v[116:119], v[192:195], a[104:107], v[116:119]
  ds_read_b64_tr_b16 v[186:187], v13 offset:1024
  v_mfma_f32_16x16x32_bf16 v[116:119], v[196:199], a[108:111], v[116:119]
  buffer_load_dwordx4 v211, s[20:23], s43 offen offset:3072 lds
  v_mfma_f32_16x16x32_bf16 v[120:123], v[192:195], a[168:171], v[120:123]
  ds_read_b64_tr_b16 v[188:189], v13 offset:8192
  v_mfma_f32_16x16x32_bf16 v[120:123], v[196:199], a[172:175], v[120:123]
  s_waitcnt vmcnt(16)
  ds_read_b128 a[112:115], v212 offset:2048
  v_mfma_f32_16x16x32_bf16 v[124:127], v[192:195], a[232:235], v[124:127]
  ds_read_b64_tr_b16 v[190:191], v13 offset:9216
  v_mfma_f32_16x16x32_bf16 v[124:127], v[196:199], a[236:239], v[124:127]
  ds_read_b128 a[116:119], v213 offset:2048
  v_mfma_f32_16x16x32_bf16 v[128:131], v[200:203], a[40:43], v[128:131]
  ds_read_b64_tr_b16 v[192:193], v14 offset:0
  v_mfma_f32_16x16x32_bf16 v[128:131], v[204:207], a[44:47], v[128:131]
  s_waitcnt vmcnt(14)
  ds_read_b128 a[176:179], v212 offset:4096
  v_mfma_f32_16x16x32_bf16 v[132:135], v[200:203], a[104:107], v[132:135]
  ds_read_b64_tr_b16 v[194:195], v14 offset:1024
  v_mfma_f32_16x16x32_bf16 v[132:135], v[204:207], a[108:111], v[132:135]
  ds_read_b128 a[180:183], v213 offset:4096
  v_mfma_f32_16x16x32_bf16 v[136:139], v[200:203], a[168:171], v[136:139]
  ds_read_b64_tr_b16 v[196:197], v14 offset:8192
  v_mfma_f32_16x16x32_bf16 v[136:139], v[204:207], a[172:175], v[136:139]
  s_waitcnt vmcnt(12)
  ds_read_b128 a[240:243], v212 offset:6144
  v_mfma_f32_16x16x32_bf16 v[140:143], v[200:203], a[232:235], v[140:143]
  ds_read_b64_tr_b16 v[198:199], v14 offset:9216
  v_mfma_f32_16x16x32_bf16 v[140:143], v[204:207], a[236:239], v[140:143]
  buffer_store_dwordx4 v[216:219], v240, s[16:19], 0 offen sc1
  buffer_store_dwordx4 v[220:223], v241, s[16:19], 0 offen sc1
  v_mov_b32 v248, 0
  global_load_dword v249, v248, s[12:13] sc1
  ds_read_b128 a[244:247], v213 offset:6144
  s_waitcnt lgkmcnt(13)
  v_mfma_f32_16x16x32_bf16 v[16:19], v[144:147], a[48:51], v[16:19]
  s_add_u32 s49, s44, 0
  s_add_u32 m0, s41, 65536
  ds_read_b64_tr_b16 v[200:201], v15 offset:0
  v_mfma_f32_16x16x32_bf16 v[16:19], v[148:151], a[52:55], v[16:19]
  s_waitcnt lgkmcnt(9)
  buffer_load_dwordx4 v4, s[28:31], s49 offen offset:0 lds
  v_mfma_f32_16x16x32_bf16 v[20:23], v[144:147], a[112:115], v[20:23]
  ds_read_b64_tr_b16 v[202:203], v15 offset:1024
  v_mfma_f32_16x16x32_bf16 v[20:23], v[148:151], a[116:119], v[20:23]
  s_waitcnt lgkmcnt(6)
  v_mfma_f32_16x16x32_bf16 v[24:27], v[144:147], a[176:179], v[24:27]
  ds_read_b64_tr_b16 v[204:205], v15 offset:8192
  v_mfma_f32_16x16x32_bf16 v[24:27], v[148:151], a[180:183], v[24:27]
  s_waitcnt lgkmcnt(3)
  buffer_load_dwordx4 v5, s[28:31], s49 offen offset:1024 lds
  v_mfma_f32_16x16x32_bf16 v[28:31], v[144:147], a[240:243], v[28:31]
  ds_read_b64_tr_b16 v[206:207], v15 offset:9216
  v_mfma_f32_16x16x32_bf16 v[28:31], v[148:151], a[244:247], v[28:31]
  v_mfma_f32_16x16x32_bf16 v[32:35], v[152:155], a[48:51], v[32:35]
  v_mfma_f32_16x16x32_bf16 v[32:35], v[156:159], a[52:55], v[32:35]
  s_waitcnt vmcnt(13) lgkmcnt(0)
  s_barrier
  v_mfma_f32_16x16x32_bf16 v[36:39], v[152:155], a[112:115], v[36:39]
  ds_read_b64_tr_b16 v[144:145], v8 offset:16384
  v_mfma_f32_16x16x32_bf16 v[36:39], v[156:159], a[116:119], v[36:39]
  buffer_load_dwordx4 v6, s[28:31], s49 offen offset:2048 lds
  v_mfma_f32_16x16x32_bf16 v[40:43], v[152:155], a[176:179], v[40:43]
  ds_read_b64_tr_b16 v[146:147], v8 offset:17408
  v_mfma_f32_16x16x32_bf16 v[40:43], v[156:159], a[180:183], v[40:43]
  v_mfma_f32_16x16x32_bf16 v[44:47], v[152:155], a[240:243], v[44:47]
  ds_read_b64_tr_b16 v[148:149], v8 offset:24576
  v_mfma_f32_16x16x32_bf16 v[44:47], v[156:159], a[244:247], v[44:47]
  buffer_load_dwordx4 v7, s[28:31], s49 offen offset:3072 lds
  v_mfma_f32_16x16x32_bf16 v[48:51], v[160:163], a[48:51], v[48:51]
  ds_read_b64_tr_b16 v[150:151], v8 offset:25600
  v_mfma_f32_16x16x32_bf16 v[48:51], v[164:167], a[52:55], v[48:51]
  v_mfma_f32_16x16x32_bf16 v[52:55], v[160:163], a[112:115], v[52:55]
  ds_read_b64_tr_b16 v[152:153], v9 offset:16384
  v_mfma_f32_16x16x32_bf16 v[52:55], v[164:167], a[116:119], v[52:55]
  v_mfma_f32_16x16x32_bf16 v[56:59], v[160:163], a[176:179], v[56:59]
  s_add_u32 s49, s44, 524288
  s_add_u32 m0, s41, 81920
  ds_read_b64_tr_b16 v[154:155], v9 offset:17408
  v_mfma_f32_16x16x32_bf16 v[56:59], v[164:167], a[180:183], v[56:59]
  buffer_load_dwordx4 v4, s[28:31], s49 offen offset:0 lds
  v_mfma_f32_16x16x32_bf16 v[60:63], v[160:163], a[240:243], v[60:63]
  ds_read_b64_tr_b16 v[156:157], v9 offset:24576
  v_mfma_f32_16x16x32_bf16 v[60:63], v[164:167], a[244:247], v[60:63]
  ds_read_b64_tr_b16 v[158:159], v9 offset:25600
  v_mfma_f32_16x16x32_bf16 v[64:67], v[168:171], a[48:51], v[64:67]
  ds_read_b64_tr_b16 v[160:161], v10 offset:16384
  v_mfma_f32_16x16x32_bf16 v[64:67], v[172:175], a[52:55], v[64:67]
  buffer_load_dwordx4 v5, s[28:31], s49 offen offset:1024 lds
  v_mfma_f32_16x16x32_bf16 v[68:71], v[168:171], a[112:115], v[68:71]
  ds_read_b64_tr_b16 v[162:163], v10 offset:17408
  v_mfma_f32_16x16x32_bf16 v[68:71], v[172:175], a[116:119], v[68:71]
  v_mfma_f32_16x16x32_bf16 v[72:75], v[168:171], a[176:179], v[72:75]
  ds_read_b64_tr_b16 v[164:165], v10 offset:24576
  v_mfma_f32_16x16x32_bf16 v[72:75], v[172:175], a[180:183], v[72:75]
  buffer_load_dwordx4 v6, s[28:31], s49 offen offset:2048 lds
  v_mfma_f32_16x16x32_bf16 v[76:79], v[168:171], a[240:243], v[76:79]
  ds_read_b64_tr_b16 v[166:167], v10 offset:25600
  v_mfma_f32_16x16x32_bf16 v[76:79], v[172:175], a[244:247], v[76:79]
  v_mfma_f32_16x16x32_bf16 v[80:83], v[176:179], a[48:51], v[80:83]
  ds_read_b64_tr_b16 v[168:169], v11 offset:16384
  v_mfma_f32_16x16x32_bf16 v[80:83], v[180:183], a[52:55], v[80:83]
  buffer_load_dwordx4 v7, s[28:31], s49 offen offset:3072 lds
  v_mfma_f32_16x16x32_bf16 v[84:87], v[176:179], a[112:115], v[84:87]
  ds_read_b64_tr_b16 v[170:171], v11 offset:17408
  v_mfma_f32_16x16x32_bf16 v[84:87], v[180:183], a[116:119], v[84:87]
  v_mfma_f32_16x16x32_bf16 v[88:91], v[176:179], a[176:179], v[88:91]
  s_add_u32 s49, s44, 1048576
  s_add_u32 m0, s41, 98304
  ds_read_b64_tr_b16 v[172:173], v11 offset:24576
  v_mfma_f32_16x16x32_bf16 v[88:91], v[180:183], a[180:183], v[88:91]
  buffer_load_dwordx4 v4, s[28:31], s49 offen offset:0 lds
  v_mfma_f32_16x16x32_bf16 v[92:95], v[176:179], a[240:243], v[92:95]
  ds_read_b64_tr_b16 v[174:175], v11 offset:25600
  v_mfma_f32_16x16x32_bf16 v[92:95], v[180:183], a[244:247], v[92:95]
  v_mfma_f32_16x16x32_bf16 v[96:99], v[184:187], a[48:51], v[96:99]
  ds_read_b64_tr_b16 v[176:177], v12 offset:16384
  v_mfma_f32_16x16x32_bf16 v[96:99], v[188:191], a[52:55], v[96:99]
  buffer_load_dwordx4 v5, s[28:31], s49 offen offset:1024 lds
  v_mfma_f32_16x16x32_bf16 v[100:103], v[184:187], a[112:115], v[100:103]
  ds_read_b64_tr_b16 v[178:179], v12 offset:17408
  v_mfma_f32_16x16x32_bf16 v[100:103], v[188:191], a[116:119], v[100:103]
  v_mfma_f32_16x16x32_bf16 v[104:107], v[184:187], a[176:179], v[104:107]
  ds_read_b64_tr_b16 v[180:181], v12 offset:24576
  v_mfma_f32_16x16x32_bf16 v[104:107], v[188:191], a[180:183], v[104:107]
  buffer_load_dwordx4 v6, s[28:31], s49 offen offset:2048 lds
  v_mfma_f32_16x16x32_bf16 v[108:111], v[184:187], a[240:243], v[108:111]
  ds_read_b64_tr_b16 v[182:183], v12 offset:25600
  v_mfma_f32_16x16x32_bf16 v[108:111], v[188:191], a[244:247], v[108:111]
  s_waitcnt vmcnt(20)
  ds_read_b128 a[56:59], v212 offset:32768
  v_mfma_f32_16x16x32_bf16 v[112:115], v[192:195], a[48:51], v[112:115]
  ds_read_b64_tr_b16 v[184:185], v13 offset:16384
  v_mfma_f32_16x16x32_bf16 v[112:115], v[196:199], a[52:55], v[112:115]
  ds_read_b128 a[60:63], v213 offset:32768
  v_mfma_f32_16x16x32_bf16 v[116:119], v[192:195], a[112:115], v[116:119]
  ds_read_b64_tr_b16 v[186:187], v13 offset:17408
  v_mfma_f32_16x16x32_bf16 v[116:119], v[196:199], a[116:119], v[116:119]
  buffer_load_dwordx4 v7, s[28:31], s49 offen offset:3072 lds
  v_mfma_f32_16x16x32_bf16 v[120:123], v[192:195], a[176:179], v[120:123]
  ds_read_b64_tr_b16 v[188:189], v13 offset:24576
  v_mfma_f32_16x16x32_bf16 v[120:123], v[196:199], a[180:183], v[120:123]
  s_waitcnt vmcnt(19)
  ds_read_b128 a[120:123], v212 offset:34816
  v_mfma_f32_16x16x32_bf16 v[124:127], v[192:195], a[240:243], v[124:127]
  ds_read_b64_tr_b16 v[190:191], v13 offset:25600
  v_mfma_f32_16x16x32_bf16 v[124:127], v[196:199], a[244:247], v[124:127]
  ds_read_b128 a[124:127], v213 offset:34816
  v_mfma_f32_16x16x32_bf16 v[128:131], v[200:203], a[48:51], v[128:131]
  ds_read_b64_tr_b16 v[192:193], v14 offset:16384
  v_mfma_f32_16x16x32_bf16 v[128:131], v[204:207], a[52:55], v[128:131]
  s_waitcnt vmcnt(17)
  ds_read_b128 a[184:187], v212 offset:36864
  v_mfma_f32_16x16x32_bf16 v[132:135], v[200:203], a[112:115], v[132:135]
  ds_read_b64_tr_b16 v[194:195], v14 offset:17408
  v_mfma_f32_16x16x32_bf16 v[132:135], v[204:207], a[116:119], v[132:135]
  ds_read_b128 a[188:191], v213 offset:36864
  v_mfma_f32_16x16x32_bf16 v[136:139], v[200:203], a[176:179], v[136:139]
  ds_read_b64_tr_b16 v[196:197], v14 offset:24576
  v_mfma_f32_16x16x32_bf16 v[136:139], v[204:207], a[180:183], v[136:139]
  s_waitcnt vmcnt(15)
  ds_read_b128 a[248:251], v212 offset:38912
  v_mfma_f32_16x16x32_bf16 v[140:143], v[200:203], a[240:243], v[140:143]
  ds_read_b64_tr_b16 v[198:199], v14 offset:25600
  v_mfma_f32_16x16x32_bf16 v[140:143], v[204:207], a[244:247], v[140:143]
  ds_read_b128 a[252:255], v213 offset:38912
  s_waitcnt lgkmcnt(13)
  v_mfma_f32_16x16x32_bf16 v[16:19], v[144:147], a[56:59], v[16:19]
  s_add_u32 s49, s44, 1572864
  s_add_u32 m0, s41, 0
  ds_read_b64_tr_b16 v[200:201], v15 offset:16384
  v_mfma_f32_16x16x32_bf16 v[16:19], v[148:151], a[60:63], v[16:19]
  s_waitcnt lgkmcnt(9)
  buffer_load_dwordx4 v4, s[28:31], s49 offen offset:0 lds
  v_mfma_f32_16x16x32_bf16 v[20:23], v[144:147], a[120:123], v[20:23]
  ds_read_b64_tr_b16 v[202:203], v15 offset:17408
  v_mfma_f32_16x16x32_bf16 v[20:23], v[148:151], a[124:127], v[20:23]
  s_waitcnt lgkmcnt(6)
  v_mfma_f32_16x16x32_bf16 v[24:27], v[144:147], a[184:187], v[24:27]
  ds_read_b64_tr_b16 v[204:205], v15 offset:24576
  v_mfma_f32_16x16x32_bf16 v[24:27], v[148:151], a[188:191], v[24:27]
  s_waitcnt lgkmcnt(3)
  buffer_load_dwordx4 v5, s[28:31], s49 offen offset:1024 lds
  v_mfma_f32_16x16x32_bf16 v[28:31], v[144:147], a[248:251], v[28:31]
  ds_read_b64_tr_b16 v[206:207], v15 offset:25600
  v_mfma_f32_16x16x32_bf16 v[28:31], v[148:151], a[252:255], v[28:31]
  v_mfma_f32_16x16x32_bf16 v[32:35], v[152:155], a[56:59], v[32:35]
  v_subrev_u32 v240, 114688, v8
  v_subrev_u32 v241, 49152, v8
  v_subrev_u32 v242, 114688, v9
  v_subrev_u32 v243, 49152, v9
  s_mov_b32 s52, 1040356334
  v_mfma_f32_16x16x32_bf16 v[32:35], v[156:159], a[60:63], v[32:35]
  s_waitcnt vmcnt(6) lgkmcnt(0)
  s_barrier
  v_mfma_f32_16x16x32_bf16 v[36:39], v[152:155], a[120:123], v[36:39]
  s_mov_b32 s47, 0
L_npoll:
  v_readfirstlane_b32 s3, v249
  s_nop 0
  s_cmp_lg_u32 s3, 0
  s_cbranch_scc1 L_npollok
  s_add_u32 s47, s47, 1
  s_cmp_gt_u32 s47, 0x80000
  s_cbranch_scc1 L_npollok
  s_sleep 2
  global_load_dword v249, v248, s[12:13] sc1
  s_waitcnt vmcnt(0)
  s_branch L_npoll
L_npollok:
  s_add_u32 s45, s45, s3
  s_lshl_b32 s47, s2, 2
  s_add_u32 s47, s47, s36
  s_lshl_b32 s47, s47, 7
  s_add_u32 s47, s47, 96468992
  v_mov_b32 v249, s45
  v_lshlrev_b32 v248, 2, v1
  s_mov_b32 exec_hi, 0
  buffer_store_dword v249, v248, s[16:19], s47 offen sc1
  s_mov_b64 exec, -1
  v_mfma_f32_16x16x32_bf16 v[36:39], v[156:159], a[124:127], v[36:39]
  buffer_load_dwordx4 v6, s[28:31], s49 offen offset:2048 lds
  v_mfma_f32_16x16x32_bf16 v[40:43], v[152:155], a[184:187], v[40:43]
  v_mfma_f32_16x16x32_bf16 v[40:43], v[156:159], a[188:191], v[40:43]
  v_mfma_f32_16x16x32_bf16 v[44:47], v[152:155], a[248:251], v[44:47]
  v_mfma_f32_16x16x32_bf16 v[44:47], v[156:159], a[252:255], v[44:47]
  buffer_load_dwordx4 v7, s[28:31], s49 offen offset:3072 lds
  v_mfma_f32_16x16x32_bf16 v[48:51], v[160:163], a[56:59], v[48:51]
  ds_read_b64_tr_b16 v[144:145], v241 offset:0
  v_mfma_f32_16x16x32_bf16 v[48:51], v[164:167], a[60:63], v[48:51]
  v_mfma_f32_16x16x32_bf16 v[52:55], v[160:163], a[120:123], v[52:55]
  ds_read_b64_tr_b16 v[146:147], v241 offset:1024
  v_mul_f32 v16, s52, v16
  v_mfma_f32_16x16x32_bf16 v[52:55], v[164:167], a[124:127], v[52:55]
  v_mul_f32 v17, s52, v17
  v_mul_f32 v18, s52, v18
  v_mfma_f32_16x16x32_bf16 v[56:59], v[160:163], a[184:187], v[56:59]
  s_add_u32 s49, s44, 2097152
  s_add_u32 m0, s41, 16384
  ds_read_b64_tr_b16 v[148:149], v241 offset:8192
  v_mul_f32 v19, s52, v19
  v_mfma_f32_16x16x32_bf16 v[56:59], v[164:167], a[188:191], v[56:59]
  buffer_load_dwordx4 v4, s[28:31], s49 offen offset:0 lds
  v_mfma_f32_16x16x32_bf16 v[60:63], v[160:163], a[248:251], v[60:63]
  ds_read_b64_tr_b16 v[150:151], v241 offset:9216
  v_mul_f32 v32, s52, v32
  v_mfma_f32_16x16x32_bf16 v[60:63], v[164:167], a[252:255], v[60:63]
  ds_read_b64_tr_b16 v[152:153], v241 offset:16384
  v_mul_f32 v33, s52, v33
  v_mfma_f32_16x16x32_bf16 v[64:67], v[168:171], a[56:59], v[64:67]
  ds_read_b64_tr_b16 v[154:155], v241 offset:17408
  v_mul_f32 v34, s52, v34
  v_mfma_f32_16x16x32_bf16 v[64:67], v[172:175], a[60:63], v[64:67]
  ds_read_b64_tr_b16 v[156:157], v241 offset:24576
  v_mul_f32 v35, s52, v35
  v_mfma_f32_16x16x32_bf16 v[68:71], v[168:171], a[120:123], v[68:71]
  ds_read_b64_tr_b16 v[158:159], v241 offset:25600
  v_mul_f32 v20, s52, v20
  v_mfma_f32_16x16x32_bf16 v[68:71], v[172:175], a[124:127], v[68:71]
  buffer_load_dwordx4 v5, s[28:31], s49 offen offset:1024 lds
  v_mfma_f32_16x16x32_bf16 v[72:75], v[168:171], a[184:187], v[72:75]
  v_mul_f32 v21, s52, v21
  v_mul_f32 v22, s52, v22
  v_mfma_f32_16x16x32_bf16 v[72:75], v[172:175], a[188:191], v[72:75]
  v_mul_f32 v23, s52, v23
  v_mul_f32 v36, s52, v36
  v_mfma_f32_16x16x32_bf16 v[76:79], v[168:171], a[248:251], v[76:79]
  v_mul_f32 v37, s52, v37
  v_mul_f32 v38, s52, v38
  v_mfma_f32_16x16x32_bf16 v[76:79], v[172:175], a[252:255], v[76:79]
  buffer_load_dwordx4 v6, s[28:31], s49 offen offset:2048 lds
  v_mfma_f32_16x16x32_bf16 v[80:83], v[176:179], a[56:59], v[80:83]
  ds_read_b64_tr_b16 v[160:161], v243 offset:0
  v_mul_f32 v39, s52, v39
  v_mfma_f32_16x16x32_bf16 v[80:83], v[180:183], a[60:63], v[80:83]
  v_mul_f32 v24, s52, v24
  v_mul_f32 v25, s52, v25
  v_mfma_f32_16x16x32_bf16 v[84:87], v[176:179], a[120:123], v[84:87]
  ds_read_b64_tr_b16 v[162:163], v243 offset:1024
  v_mul_f32 v26, s52, v26
  v_mfma_f32_16x16x32_bf16 v[84:87], v[180:183], a[124:127], v[84:87]
  v_mul_f32 v27, s52, v27
  v_mul_f32 v40, s52, v40
  v_mfma_f32_16x16x32_bf16 v[88:91], v[176:179], a[184:187], v[88:91]
  ds_read_b64_tr_b16 v[164:165], v243 offset:8192
  v_mul_f32 v41, s52, v41
  v_mfma_f32_16x16x32_bf16 v[88:91], v[180:183], a[188:191], v[88:91]
  buffer_load_dwordx4 v7, s[28:31], s49 offen offset:3072 lds
  v_mfma_f32_16x16x32_bf16 v[92:95], v[176:179], a[248:251], v[92:95]
  ds_read_b64_tr_b16 v[166:167], v243 offset:9216
  v_mul_f32 v42, s52, v42
  v_mfma_f32_16x16x32_bf16 v[92:95], v[180:183], a[252:255], v[92:95]
  ds_read_b64_tr_b16 v[168:169], v243 offset:16384
  v_mul_f32 v43, s52, v43
  v_mfma_f32_16x16x32_bf16 v[96:99], v[184:187], a[56:59], v[96:99]
  ds_read_b64_tr_b16 v[170:171], v243 offset:17408
  v_mul_f32 v28, s52, v28
  v_mfma_f32_16x16x32_bf16 v[96:99], v[188:191], a[60:63], v[96:99]
  ds_read_b64_tr_b16 v[172:173], v243 offset:24576
  v_mul_f32 v29, s52, v29
  v_mfma_f32_16x16x32_bf16 v[100:103], v[184:187], a[120:123], v[100:103]
  s_add_u32 s49, s44, 2621440
  s_add_u32 m0, s41, 114688
  ds_read_b64_tr_b16 v[174:175], v243 offset:25600
  v_mul_f32 v30, s52, v30
  v_mfma_f32_16x16x32_bf16 v[100:103], v[188:191], a[124:127], v[100:103]
  buffer_load_dwordx4 v4, s[28:31], s49 offen offset:0 lds
  v_mfma_f32_16x16x32_bf16 v[104:107], v[184:187], a[184:187], v[104:107]
  v_mul_f32 v31, s52, v31
  v_mul_f32 v44, s52, v44
  v_mfma_f32_16x16x32_bf16 v[104:107], v[188:191], a[188:191], v[104:107]
  v_mul_f32 v45, s52, v45
  v_mul_f32 v46, s52, v46
  v_mfma_f32_16x16x32_bf16 v[108:111], v[184:187], a[248:251], v[108:111]
  v_mul_f32 v47, s52, v47
  v_mul_f32 v48, s52, v48
  v_mfma_f32_16x16x32_bf16 v[108:111], v[188:191], a[252:255], v[108:111]
  v_mul_f32 v49, s52, v49
  v_mul_f32 v50, s52, v50
  v_mfma_f32_16x16x32_bf16 v[112:115], v[192:195], a[56:59], v[112:115]
  v_mul_f32 v51, s52, v51
  v_mul_f32 v64, s52, v64
  v_mfma_f32_16x16x32_bf16 v[112:115], v[196:199], a[60:63], v[112:115]
  buffer_load_dwordx4 v5, s[28:31], s49 offen offset:1024 lds
  v_mfma_f32_16x16x32_bf16 v[116:119], v[192:195], a[120:123], v[116:119]
  v_mul_f32 v65, s52, v65
  v_mul_f32 v66, s52, v66
  v_mfma_f32_16x16x32_bf16 v[116:119], v[196:199], a[124:127], v[116:119]
  v_mul_f32 v67, s52, v67
  v_mul_f32 v52, s52, v52
  v_mfma_f32_16x16x32_bf16 v[120:123], v[192:195], a[184:187], v[120:123]
  v_mul_f32 v53, s52, v53
  v_mul_f32 v54, s52, v54
  v_mfma_f32_16x16x32_bf16 v[120:123], v[196:199], a[188:191], v[120:123]
  v_mul_f32 v55, s52, v55
  v_mul_f32 v68, s52, v68
  v_mfma_f32_16x16x32_bf16 v[124:127], v[192:195], a[248:251], v[124:127]
  v_mul_f32 v69, s52, v69
  v_mul_f32 v70, s52, v70
  v_mfma_f32_16x16x32_bf16 v[124:127], v[196:199], a[252:255], v[124:127]
  buffer_load_dwordx4 v6, s[28:31], s49 offen offset:2048 lds
  v_mfma_f32_16x16x32_bf16 v[128:131], v[200:203], a[56:59], v[128:131]
  v_mul_f32 v71, s52, v71
  v_mul_f32 v56, s52, v56
  v_mfma_f32_16x16x32_bf16 v[128:131], v[204:207], a[60:63], v[128:131]
  v_mul_f32 v57, s52, v57
  v_mul_f32 v58, s52, v58
  v_mfma_f32_16x16x32_bf16 v[132:135], v[200:203], a[120:123], v[132:135]
  v_mul_f32 v59, s52, v59
  v_mul_f32 v72, s52, v72
  v_mfma_f32_16x16x32_bf16 v[132:135], v[204:207], a[124:127], v[132:135]
  v_mul_f32 v73, s52, v73
  v_mul_f32 v74, s52, v74
  v_mfma_f32_16x16x32_bf16 v[136:139], v[200:203], a[184:187], v[136:139]
  v_mul_f32 v75, s52, v75
  v_mul_f32 v60, s52, v60
  v_mfma_f32_16x16x32_bf16 v[136:139], v[204:207], a[188:191], v[136:139]
  buffer_load_dwordx4 v7, s[28:31], s49 offen offset:3072 lds
  v_mfma_f32_16x16x32_bf16 v[140:143], v[200:203], a[248:251], v[140:143]
  v_mul_f32 v61, s52, v61
  v_mul_f32 v62, s52, v62
  v_mfma_f32_16x16x32_bf16 v[140:143], v[204:207], a[252:255], v[140:143]
  v_mul_f32 v63, s52, v63
  v_mul_f32 v76, s52, v76
  s_waitcnt lgkmcnt(8)
  s_waitcnt vmcnt(8)
  s_barrier
  v_mfma_f32_16x16x32_bf16 v[208:211], a[0:3], v[144:147], 0
  s_add_u32 s49, s44, 3145728
  s_add_u32 m0, s41, 32768
  ds_read_b64_tr_b16 v[176:177], v241 offset:32768
  v_cvt_pk_bf16_f32 v16, v16, v17
  v_mfma_f32_16x16x32_bf16 v[208:211], a[4:7], v[148:151], v[208:211]
  buffer_load_dwordx4 v4, s[28:31], s49 offen offset:0 lds
  v_mfma_f32_16x16x32_bf16 v[208:211], a[8:11], v[152:155], v[208:211]
  ds_read_b64_tr_b16 v[178:179], v241 offset:33792
  v_cvt_pk_bf16_f32 v17, v18, v19
  v_mfma_f32_16x16x32_bf16 v[208:211], a[12:15], v[156:159], v[208:211]
  v_mul_f32 v77, s52, v77
  v_mul_f32 v78, s52, v78
  v_mfma_f32_16x16x32_bf16 v[212:215], a[64:67], v[144:147], 0
  ds_read_b64_tr_b16 v[180:181], v241 offset:40960
  v_cvt_pk_bf16_f32 v18, v32, v33
  v_mfma_f32_16x16x32_bf16 v[212:215], a[68:71], v[148:151], v[212:215]
  buffer_load_dwordx4 v5, s[28:31], s49 offen offset:1024 lds
  v_mfma_f32_16x16x32_bf16 v[212:215], a[72:75], v[152:155], v[212:215]
  ds_read_b64_tr_b16 v[182:183], v241 offset:41984
  v_cvt_pk_bf16_f32 v19, v34, v35
  v_mfma_f32_16x16x32_bf16 v[212:215], a[76:79], v[156:159], v[212:215]
  v_mul_f32 v79, s52, v79
  v_mul_f32 v80, s52, v80
  v_mfma_f32_16x16x32_bf16 v[216:219], a[128:131], v[144:147], 0
  ds_read_b64_tr_b16 v[184:185], v240 offset:0
  v_cvt_pk_bf16_f32 v20, v20, v21
  v_mfma_f32_16x16x32_bf16 v[216:219], a[132:135], v[148:151], v[216:219]
  buffer_load_dwordx4 v6, s[28:31], s49 offen offset:2048 lds
  v_mfma_f32_16x16x32_bf16 v[216:219], a[136:139], v[152:155], v[216:219]
  ds_read_b64_tr_b16 v[186:187], v240 offset:1024
  v_cvt_pk_bf16_f32 v21, v22, v23
  v_mfma_f32_16x16x32_bf16 v[216:219], a[140:143], v[156:159], v[216:219]
  v_mul_f32 v81, s52, v81
  v_mul_f32 v82, s52, v82
  v_mfma_f32_16x16x32_bf16 v[220:223], a[192:195], v[144:147], 0
  ds_read_b64_tr_b16 v[188:189], v240 offset:8192
  v_cvt_pk_bf16_f32 v22, v36, v37
  v_mfma_f32_16x16x32_bf16 v[220:223], a[196:199], v[148:151], v[220:223]
  buffer_load_dwordx4 v7, s[28:31], s49 offen offset:3072 lds
  v_mfma_f32_16x16x32_bf16 v[220:223], a[200:203], v[152:155], v[220:223]
  ds_read_b64_tr_b16 v[190:191], v240 offset:9216
  v_cvt_pk_bf16_f32 v23, v38, v39
  v_mfma_f32_16x16x32_bf16 v[220:223], a[204:207], v[156:159], v[220:223]
  s_add_u32 s47, s46, 0
  buffer_store_dwordx4 v[16:19], v2, s[16:19], s47 offen offset:0
  s_waitcnt lgkmcnt(8)
  v_mfma_f32_16x16x32_bf16 v[224:227], a[0:3], v[160:163], 0
  s_add_u32 s49, s44, 3670016
  s_add_u32 m0, s41, 49152
  ds_read_b64_tr_b16 v[192:193], v243 offset:32768
  v_cvt_pk_bf16_f32 v24, v24, v25
  v_mfma_f32_16x16x32_bf16 v[224:227], a[4:7], v[164:167], v[224:227]
  buffer_load_dwordx4 v4, s[28:31], s49 offen offset:0 lds
  v_mfma_f32_16x16x32_bf16 v[224:227], a[8:11], v[168:171], v[224:227]
  ds_read_b64_tr_b16 v[194:195], v243 offset:33792
  v_cvt_pk_bf16_f32 v25, v26, v27
  v_mfma_f32_16x16x32_bf16 v[224:227], a[12:15], v[172:175], v[224:227]
  v_mul_f32 v83, s52, v83
  v_mul_f32 v96, s52, v96
  v_mfma_f32_16x16x32_bf16 v[228:231], a[64:67], v[160:163], 0
  ds_read_b64_tr_b16 v[196:197], v243 offset:40960
  v_cvt_pk_bf16_f32 v26, v40, v41
  v_mfma_f32_16x16x32_bf16 v[228:231], a[68:71], v[164:167], v[228:231]
  buffer_load_dwordx4 v5, s[28:31], s49 offen offset:1024 lds
  v_mfma_f32_16x16x32_bf16 v[228:231], a[72:75], v[168:171], v[228:231]
  ds_read_b64_tr_b16 v[198:199], v243 offset:41984
  v_cvt_pk_bf16_f32 v27, v42, v43
  v_mfma_f32_16x16x32_bf16 v[228:231], a[76:79], v[172:175], v[228:231]
  v_mul_f32 v97, s52, v97
  v_mul_f32 v98, s52, v98
  v_mfma_f32_16x16x32_bf16 v[232:235], a[128:131], v[160:163], 0
  ds_read_b64_tr_b16 v[200:201], v242 offset:0
  v_cvt_pk_bf16_f32 v28, v28, v29
  v_mfma_f32_16x16x32_bf16 v[232:235], a[132:135], v[164:167], v[232:235]
  buffer_load_dwordx4 v6, s[28:31], s49 offen offset:2048 lds
  v_mfma_f32_16x16x32_bf16 v[232:235], a[136:139], v[168:171], v[232:235]
  ds_read_b64_tr_b16 v[202:203], v242 offset:1024
  v_cvt_pk_bf16_f32 v29, v30, v31
  v_mfma_f32_16x16x32_bf16 v[232:235], a[140:143], v[172:175], v[232:235]
  v_mul_f32 v99, s52, v99
  v_mul_f32 v84, s52, v84
  v_mfma_f32_16x16x32_bf16 v[236:239], a[192:195], v[160:163], 0
  ds_read_b64_tr_b16 v[204:205], v242 offset:8192
  v_cvt_pk_bf16_f32 v30, v44, v45
  v_mfma_f32_16x16x32_bf16 v[236:239], a[196:199], v[164:167], v[236:239]
  buffer_load_dwordx4 v7, s[28:31], s49 offen offset:3072 lds
  v_mfma_f32_16x16x32_bf16 v[236:239], a[200:203], v[168:171], v[236:239]
  ds_read_b64_tr_b16 v[206:207], v242 offset:9216
  v_cvt_pk_bf16_f32 v31, v46, v47
  v_mfma_f32_16x16x32_bf16 v[236:239], a[204:207], v[172:175], v[236:239]
  s_add_u32 s47, s46, 4096
  buffer_store_dwordx4 v[20:23], v2, s[16:19], s47 offen offset:0
  s_waitcnt lgkmcnt(8)
  s_waitcnt vmcnt(10)
  s_barrier
  v_mfma_f32_16x16x32_bf16 v[208:211], a[16:19], v[176:179], v[208:211]
  ds_read_b64_tr_b16 v[144:145], v240 offset:16384
  v_cvt_pk_bf16_f32 v48, v48, v49
  v_mfma_f32_16x16x32_bf16 v[208:211], a[20:23], v[180:183], v[208:211]
  v_mul_f32 v85, s52, v85
  v_mul_f32 v86, s52, v86
  v_mfma_f32_16x16x32_bf16 v[208:211], a[24:27], v[184:187], v[208:211]
  ds_read_b64_tr_b16 v[146:147], v240 offset:17408
  v_cvt_pk_bf16_f32 v49, v50, v51
  v_mfma_f32_16x16x32_bf16 v[208:211], a[28:31], v[188:191], v[208:211]
  v_mul_f32 v87, s52, v87
  v_mul_f32 v100, s52, v100
  v_mfma_f32_16x16x32_bf16 v[212:215], a[80:83], v[176:179], v[212:215]
  s_load_dwordx2 s[4:5], s[0:1], 16
  ds_read_b64_tr_b16 v[148:149], v240 offset:24576
  v_cvt_pk_bf16_f32 v50, v64, v65
  v_mfma_f32_16x16x32_bf16 v[212:215], a[84:87], v[180:183], v[212:215]
  s_load_dwordx4 s[8:11], s[0:1], 56
  v_mul_f32 v101, s52, v101
  v_mul_f32 v102, s52, v102
  v_mfma_f32_16x16x32_bf16 v[212:215], a[88:91], v[184:187], v[212:215]
  s_lshl_b32 s49, s38, 1
  ds_read_b64_tr_b16 v[150:151], v240 offset:25600
  v_cvt_pk_bf16_f32 v51, v66, v67
  v_mfma_f32_16x16x32_bf16 v[212:215], a[92:95], v[188:191], v[212:215]
  v_mul_f32 v103, s52, v103
  v_mul_f32 v88, s52, v88
  v_mfma_f32_16x16x32_bf16 v[216:219], a[144:147], v[176:179], v[216:219]
  s_lshr_b32 s48, s36, 1
  ds_read_b64_tr_b16 v[152:153], v241 offset:49152
  v_cvt_pk_bf16_f32 v52, v52, v53
  v_mfma_f32_16x16x32_bf16 v[216:219], a[148:151], v[180:183], v[216:219]
  s_lshl_b32 s48, s48, 16
  v_mul_f32 v89, s52, v89
  v_mul_f32 v90, s52, v90
  v_mfma_f32_16x16x32_bf16 v[216:219], a[152:155], v[184:187], v[216:219]
  s_and_b32 s50, s36, 1
  ds_read_b64_tr_b16 v[154:155], v241 offset:50176
  v_cvt_pk_bf16_f32 v53, v54, v55
  v_mfma_f32_16x16x32_bf16 v[216:219], a[156:159], v[188:191], v[216:219]
  s_lshl_b32 s50, s50, 2
  v_mul_f32 v91, s52, v91
  v_mul_f32 v104, s52, v104
  v_mfma_f32_16x16x32_bf16 v[220:223], a[208:211], v[176:179], v[220:223]
  s_lshr_b32 s51, s36, 1
  ds_read_b64_tr_b16 v[156:157], v241 offset:57344
  v_cvt_pk_bf16_f32 v54, v68, v69
  v_mfma_f32_16x16x32_bf16 v[220:223], a[212:215], v[180:183], v[220:223]
  s_xor_b32 s51, s51, s36
  v_mul_f32 v105, s52, v105
  v_mul_f32 v106, s52, v106
  v_mfma_f32_16x16x32_bf16 v[220:223], a[216:219], v[184:187], v[220:223]
  s_and_b32 s51, s51, 1
  s_lshl_b32 s51, s51, 2
  s_sub_u32 s57, 15, s38
  ds_read_b64_tr_b16 v[158:159], v241 offset:58368
  v_cvt_pk_bf16_f32 v55, v70, v71
  v_mfma_f32_16x16x32_bf16 v[220:223], a[220:223], v[188:191], v[220:223]
  s_add_u32 s47, s46, 8192
  buffer_store_dwordx4 v[24:27], v2, s[16:19], s47 offen offset:0
  s_waitcnt lgkmcnt(8)
  v_mfma_f32_16x16x32_bf16 v[224:227], a[16:19], v[192:195], v[224:227]
  s_lshl_b32 s57, s57, 3
  ds_read_b64_tr_b16 v[160:161], v242 offset:16384
  v_cvt_pk_bf16_f32 v56, v56, v57
  v_mfma_f32_16x16x32_bf16 v[224:227], a[20:23], v[196:199], v[224:227]
  s_add_u32 s57, s57, s51
  v_mul_f32 v107, s52, v107
  v_mul_f32 v92, s52, v92
  v_mfma_f32_16x16x32_bf16 v[224:227], a[24:27], v[200:203], v[224:227]
  s_lshl_b32 s56, s38, 3
  ds_read_b64_tr_b16 v[162:163], v242 offset:17408
  v_cvt_pk_bf16_f32 v57, v58, v59
  v_mfma_f32_16x16x32_bf16 v[224:227], a[28:31], v[204:207], v[224:227]
  s_add_u32 s56, s56, s50
  v_mul_f32 v93, s52, v93
  v_mul_f32 v94, s52, v94
  v_mfma_f32_16x16x32_bf16 v[228:231], a[80:83], v[192:195], v[228:231]
  s_cmp_lt_u32 s36, 2
  ds_read_b64_tr_b16 v[164:165], v242 offset:24576
  v_cvt_pk_bf16_f32 v58, v72, v73
  v_mfma_f32_16x16x32_bf16 v[228:231], a[84:87], v[196:199], v[228:231]
  s_cselect_b32 s56, s57, s56
  v_mul_f32 v95, s52, v95
  v_mul_f32 v108, s52, v108
  v_mfma_f32_16x16x32_bf16 v[228:231], a[88:91], v[200:203], v[228:231]
  ds_read_b64_tr_b16 v[166:167], v242 offset:25600
  v_cvt_pk_bf16_f32 v59, v74, v75
  v_mfma_f32_16x16x32_bf16 v[228:231], a[92:95], v[204:207], v[228:231]
  v_mul_f32 v109, s52, v109
  v_mul_f32 v110, s52, v110
  v_mfma_f32_16x16x32_bf16 v[232:235], a[144:147], v[192:195], v[232:235]
  s_lshl_b32 s40, s37, 20
  ds_read_b64_tr_b16 v[168:169], v243 offset:49152
  v_cvt_pk_bf16_f32 v60, v60, v61
  v_mfma_f32_16x16x32_bf16 v[232:235], a[148:151], v[196:199], v[232:235]
  s_add_u32 s40, s40, s41
  v_mul_f32 v111, s52, v111
  v_mul_f32 v112, s52, v112
  v_mfma_f32_16x16x32_bf16 v[232:235], a[152:155], v[200:203], v[232:235]
  s_add_u32 s40, s40, 2097152
  ds_read_b64_tr_b16 v[170:171], v243 offset:50176
  v_cvt_pk_bf16_f32 v61, v62, v63
  v_mfma_f32_16x16x32_bf16 v[232:235], a[156:159], v[204:207], v[232:235]
  s_and_b32 s7, s37, 1
  v_mul_f32 v113, s52, v113
  v_mul_f32 v114, s52, v114
  v_mfma_f32_16x16x32_bf16 v[236:239], a[208:211], v[192:195], v[236:239]
  s_lshl_b32 s6, s7, 5
  ds_read_b64_tr_b16 v[172:173], v243 offset:57344
  v_cvt_pk_bf16_f32 v62, v76, v77
  v_mfma_f32_16x16x32_bf16 v[236:239], a[212:215], v[196:199], v[236:239]
  s_lshl_b32 s7, s7, 1
  v_mul_f32 v115, s52, v115
  v_mul_f32 v128, s52, v128
  v_mfma_f32_16x16x32_bf16 v[236:239], a[216:219], v[200:203], v[236:239]
  ds_read_b64_tr_b16 v[174:175], v243 offset:58368
  v_cvt_pk_bf16_f32 v63, v78, v79
  v_mfma_f32_16x16x32_bf16 v[236:239], a[220:223], v[204:207], v[236:239]
  s_add_u32 s47, s46, 12288
  buffer_store_dwordx4 v[28:31], v2, s[16:19], s47 offen offset:0
  s_waitcnt lgkmcnt(8)
  v_mfma_f32_16x16x32_bf16 v[208:211], a[32:35], v[144:147], v[208:211]
  s_mul_i32 s32, s37, 96
  v_cvt_pk_bf16_f32 v80, v80, v81
  v_mfma_f32_16x16x32_bf16 v[208:211], a[36:39], v[148:151], v[208:211]
  s_mul_i32 s33, s36, 44032
  v_mul_f32 v129, s52, v129
  v_mul_f32 v130, s52, v130
  v_subrev_u32 v244, 114688, v10
  v_mfma_f32_16x16x32_bf16 v[208:211], a[40:43], v[152:155], v[208:211]
  s_add_u32 s33, s33, s32
  v_cvt_pk_bf16_f32 v81, v82, v83
  v_mfma_f32_16x16x32_bf16 v[208:211], a[44:47], v[156:159], v[208:211]
  s_lshl_b32 s34, s56, 14
  v_mul_f32 v131, s52, v131
  v_mul_f32 v116, s52, v116
  v_subrev_u32 v245, 49152, v10
  v_mfma_f32_16x16x32_bf16 v[212:215], a[96:99], v[144:147], v[212:215]
  s_add_u32 s34, s34, 0
  v_cvt_pk_bf16_f32 v82, v96, v97
  v_mfma_f32_16x16x32_bf16 v[212:215], a[100:103], v[148:151], v[212:215]
  s_mul_i32 s35, s36, 2304
  v_mul_f32 v117, s52, v117
  v_mul_f32 v118, s52, v118
  v_subrev_u32 v246, 114688, v11
  v_mfma_f32_16x16x32_bf16 v[212:215], a[104:107], v[152:155], v[212:215]
  v_cvt_pk_bf16_f32 v83, v98, v99
  v_mfma_f32_16x16x32_bf16 v[212:215], a[108:111], v[156:159], v[212:215]
  v_mul_f32 v119, s52, v119
  v_mul_f32 v132, s52, v132
  v_mfma_f32_16x16x32_bf16 v[216:219], a[160:163], v[144:147], v[216:219]
  s_add_u32 s53, s32, s6
  v_cvt_pk_bf16_f32 v84, v84, v85
  v_mfma_f32_16x16x32_bf16 v[216:219], a[164:167], v[148:151], v[216:219]
  s_lshl_b32 s6, s6, 1
  v_mul_f32 v133, s52, v133
  v_mul_f32 v134, s52, v134
  v_subrev_u32 v247, 49152, v11
  v_mfma_f32_16x16x32_bf16 v[216:219], a[168:171], v[152:155], v[216:219]
  s_sub_u32 s54, s32, s6
  v_cvt_pk_bf16_f32 v85, v86, v87
  v_mfma_f32_16x16x32_bf16 v[216:219], a[172:175], v[156:159], v[216:219]
  v_mul_f32 v135, s52, v135
  v_mul_f32 v120, s52, v120
  v_mfma_f32_16x16x32_bf16 v[220:223], a[224:227], v[144:147], v[220:223]
  v_cvt_pk_bf16_f32 v86, v100, v101
  v_mfma_f32_16x16x32_bf16 v[220:223], a[228:231], v[148:151], v[220:223]
  v_mul_f32 v121, s52, v121
  v_mul_f32 v122, s52, v122
  v_mfma_f32_16x16x32_bf16 v[220:223], a[232:235], v[152:155], v[220:223]
  v_cvt_pk_bf16_f32 v87, v102, v103
  v_mfma_f32_16x16x32_bf16 v[220:223], a[236:239], v[156:159], v[220:223]
  s_add_u32 s47, s46, 0
  buffer_store_dwordx4 v[48:51], v2, s[16:19], s47 offen offset:1024
  s_waitcnt lgkmcnt(0)
  s_waitcnt vmcnt(4)
  s_barrier
  v_mfma_f32_16x16x32_bf16 v[224:227], a[32:35], v[160:163], v[224:227]
  ds_read_b64_tr_b16 v[176:177], v240 offset:32768
  ds_read_b64_tr_b16 v[178:179], v240 offset:33792
  v_cvt_pk_bf16_f32 v88, v88, v89
  v_mfma_f32_16x16x32_bf16 v[224:227], a[36:39], v[164:167], v[224:227]
  ds_read_b64_tr_b16 v[180:181], v240 offset:40960
  v_mul_u32_u24 v20, 43, v1
  global_load_dword v252, v3, s[68:69]
  v_mfma_f32_16x16x32_bf16 v[224:227], a[40:43], v[168:171], v[224:227]
  ds_read_b64_tr_b16 v[182:183], v240 offset:41984
  v_cvt_pk_bf16_f32 v89, v90, v91
  v_mfma_f32_16x16x32_bf16 v[224:227], a[44:47], v[172:175], v[224:227]
  ds_read_b64_tr_b16 v[184:185], v240 offset:49152
  v_lshrrev_b32 v20, 8, v20
  v_mul_f32 v123, s52, v123
  v_mul_f32 v136, s52, v136
  v_mfma_f32_16x16x32_bf16 v[228:231], a[96:99], v[160:163], v[228:231]
  ds_read_b64_tr_b16 v[186:187], v240 offset:50176
  v_cvt_pk_bf16_f32 v90, v104, v105
  v_mfma_f32_16x16x32_bf16 v[228:231], a[100:103], v[164:167], v[228:231]
  ds_read_b64_tr_b16 v[188:189], v240 offset:57344
  v_mul_u32_u24 v21, 6, v20
  v_sub_u32 v21, v1, v21
  global_load_dword v253, v250, s[64:65]
  v_mfma_f32_16x16x32_bf16 v[228:231], a[104:107], v[168:171], v[228:231]
  ds_read_b64_tr_b16 v[190:191], v240 offset:58368
  v_cvt_pk_bf16_f32 v91, v106, v107
  v_mfma_f32_16x16x32_bf16 v[228:231], a[108:111], v[172:175], v[228:231]
  ds_read_b64_tr_b16 v[192:193], v242 offset:32768
  v_mul_f32 v137, s52, v137
  v_mul_f32 v138, s52, v138
  v_mfma_f32_16x16x32_bf16 v[232:235], a[160:163], v[160:163], v[232:235]
  ds_read_b64_tr_b16 v[194:195], v242 offset:33792
  v_cvt_pk_bf16_f32 v92, v92, v93
  v_mfma_f32_16x16x32_bf16 v[232:235], a[164:167], v[164:167], v[232:235]
  ds_read_b64_tr_b16 v[196:197], v242 offset:40960
  v_add_u32 v21, s7, v21
  v_subrev_u32 v22, 6, v21
  v_mul_f32 v139, s52, v139
  v_mul_f32 v124, s52, v124
  v_mfma_f32_16x16x32_bf16 v[232:235], a[168:171], v[168:171], v[232:235]
  ds_read_b64_tr_b16 v[198:199], v242 offset:41984
  v_cvt_pk_bf16_f32 v93, v94, v95
  v_mfma_f32_16x16x32_bf16 v[232:235], a[172:175], v[172:175], v[232:235]
  ds_read_b64_tr_b16 v[200:201], v242 offset:49152
  v_min_u32 v21, v21, v22
  v_mul_u32_u24 v16, 2752, v20
  v_mul_f32 v125, s52, v125
  v_mul_f32 v126, s52, v126
  v_mfma_f32_16x16x32_bf16 v[236:239], a[224:227], v[160:163], v[236:239]
  ds_read_b64_tr_b16 v[202:203], v242 offset:50176
  v_cvt_pk_bf16_f32 v94, v108, v109
  v_mfma_f32_16x16x32_bf16 v[236:239], a[228:231], v[164:167], v[236:239]
  ds_read_b64_tr_b16 v[204:205], v242 offset:57344
  v_lshl_add_u32 v16, v21, 4, v16
  v_cmp_gt_u32 vcc, 48, v1
  v_mul_f32 v127, s52, v127
  v_mul_f32 v140, s52, v140
  v_mfma_f32_16x16x32_bf16 v[236:239], a[232:235], v[168:171], v[236:239]
  ds_read_b64_tr_b16 v[206:207], v242 offset:58368
  v_cvt_pk_bf16_f32 v95, v110, v111
  v_mfma_f32_16x16x32_bf16 v[236:239], a[236:239], v[172:175], v[236:239]
  s_waitcnt lgkmcnt(0)
  s_add_u32 s47, s46, 4096
  buffer_store_dwordx4 v[52:55], v2, s[16:19], s47 offen offset:1024
  v_mfma_f32_16x16x32_bf16 v[208:211], a[48:51], v[176:179], v[208:211]
  s_mov_b32 s20, s4
  ds_read_b64_tr_b16 v[144:145], v245 offset:0
  ds_read_b64_tr_b16 v[146:147], v245 offset:1024
  v_cvt_pk_bf16_f32 v112, v112, v113
  v_mfma_f32_16x16x32_bf16 v[208:211], a[52:55], v[180:183], v[208:211]
  s_mov_b32 s21, s5
  ds_read_b64_tr_b16 v[148:149], v245 offset:8192
  v_mov_b32 v20, 1073741824
  v_mul_f32 v141, s52, v141
  v_mul_f32 v142, s52, v142
  v_mfma_f32_16x16x32_bf16 v[208:211], a[56:59], v[184:187], v[208:211]
  s_mov_b32 s22, 4194304
  ds_read_b64_tr_b16 v[150:151], v245 offset:9216
  v_cvt_pk_bf16_f32 v113, v114, v115
  v_mfma_f32_16x16x32_bf16 v[208:211], a[60:63], v[188:191], v[208:211]
  s_mov_b32 s23, 0x20000
  ds_read_b64_tr_b16 v[152:153], v245 offset:16384
  v_lshrrev_b32 v21, 4, v1
  v_mul_f32 v143, s52, v143
  v_mfma_f32_16x16x32_bf16 v[212:215], a[112:115], v[176:179], v[212:215]
  s_mov_b32 s24, s8
  ds_read_b64_tr_b16 v[154:155], v245 offset:17408
  v_cvt_pk_bf16_f32 v114, v128, v129
  v_mfma_f32_16x16x32_bf16 v[212:215], a[116:119], v[180:183], v[212:215]
  s_mov_b32 s25, s9
  ds_read_b64_tr_b16 v[156:157], v245 offset:24576
  v_cndmask_b32 v16, v20, v16, vcc
  v_add_u32 v17, 20864, v16
  v_mfma_f32_16x16x32_bf16 v[212:215], a[120:123], v[184:187], v[212:215]
  s_mov_b32 s26, 1409024
  ds_read_b64_tr_b16 v[158:159], v245 offset:25600
  v_cvt_pk_bf16_f32 v115, v130, v131
  v_mfma_f32_16x16x32_bf16 v[212:215], a[124:127], v[188:191], v[212:215]
  s_mov_b32 s27, 0x20000
  ds_read_b64_tr_b16 v[160:161], v247 offset:0
  v_mfma_f32_16x16x32_bf16 v[216:219], a[176:179], v[176:179], v[216:219]
  s_mov_b32 s28, s10
  ds_read_b64_tr_b16 v[162:163], v247 offset:1024
  v_cvt_pk_bf16_f32 v116, v116, v117
  v_mfma_f32_16x16x32_bf16 v[216:219], a[180:183], v[180:183], v[216:219]
  s_mov_b32 s29, s11
  ds_read_b64_tr_b16 v[164:165], v247 offset:8192
  v_mul_u32_u24 v18, 1152, v21
  v_bfe_u32 v22, v1, 2, 2
  v_mfma_f32_16x16x32_bf16 v[216:219], a[184:187], v[184:187], v[216:219]
  s_mov_b32 s30, 2752
  ds_read_b64_tr_b16 v[166:167], v247 offset:9216
  v_cvt_pk_bf16_f32 v117, v118, v119
  v_mfma_f32_16x16x32_bf16 v[216:219], a[188:191], v[188:191], v[216:219]
  s_mov_b32 s31, 0x20000
  ds_read_b64_tr_b16 v[168:169], v247 offset:16384
  v_mul_u32_u24 v22, 96, v22
  v_add_u32 v18, v18, v22
  v_mfma_f32_16x16x32_bf16 v[220:223], a[240:243], v[176:179], v[220:223]
  ds_read_b64_tr_b16 v[170:171], v247 offset:17408
  v_cvt_pk_bf16_f32 v118, v132, v133
  v_mfma_f32_16x16x32_bf16 v[220:223], a[244:247], v[180:183], v[220:223]
  ds_read_b64_tr_b16 v[172:173], v247 offset:24576
  v_and_b32 v22, 3, v1
  v_lshl_add_u32 v18, v22, 3, v18
  v_mfma_f32_16x16x32_bf16 v[220:223], a[248:251], v[184:187], v[220:223]
  ds_read_b64_tr_b16 v[174:175], v247 offset:25600
  v_cvt_pk_bf16_f32 v119, v134, v135
  v_mfma_f32_16x16x32_bf16 v[220:223], a[252:255], v[188:191], v[220:223]
  s_add_u32 s47, s46, 8192
  buffer_store_dwordx4 v[56:59], v2, s[16:19], s47 offen offset:1024
  v_mfma_f32_16x16x32_bf16 v[224:227], a[48:51], v[192:195], v[224:227]
  ds_read_b64_tr_b16 v[176:177], v245 offset:32768
  v_cvt_pk_bf16_f32 v120, v120, v121
  v_mfma_f32_16x16x32_bf16 v[224:227], a[52:55], v[196:199], v[224:227]
  v_add_u32 v18, 103424, v18
  v_mfma_f32_16x16x32_bf16 v[224:227], a[56:59], v[200:203], v[224:227]
  ds_read_b64_tr_b16 v[178:179], v245 offset:33792
  v_cvt_pk_bf16_f32 v121, v122, v123
  v_mfma_f32_16x16x32_bf16 v[224:227], a[60:63], v[204:207], v[224:227]
  v_lshlrev_b32 v19, 3, v21
  v_mfma_f32_16x16x32_bf16 v[228:231], a[112:115], v[192:195], v[228:231]
  ds_read_b64_tr_b16 v[180:181], v245 offset:40960
  v_cvt_pk_bf16_f32 v122, v136, v137
  v_mfma_f32_16x16x32_bf16 v[228:231], a[116:119], v[196:199], v[228:231]
  v_and_b32 v24, 31, v1
  v_lshlrev_b32 v24, 7, v24
  v_mfma_f32_16x16x32_bf16 v[228:231], a[120:123], v[200:203], v[228:231]
  ds_read_b64_tr_b16 v[182:183], v245 offset:41984
  v_cvt_pk_bf16_f32 v123, v138, v139
  v_mfma_f32_16x16x32_bf16 v[228:231], a[124:127], v[204:207], v[228:231]
  v_mfma_f32_16x16x32_bf16 v[232:235], a[176:179], v[192:195], v[232:235]
  ds_read_b64_tr_b16 v[184:185], v244 offset:0
  v_cvt_pk_bf16_f32 v124, v124, v125
  v_mfma_f32_16x16x32_bf16 v[232:235], a[180:183], v[196:199], v[232:235]
  v_mfma_f32_16x16x32_bf16 v[232:235], a[184:187], v[200:203], v[232:235]
  ds_read_b64_tr_b16 v[186:187], v244 offset:1024
  v_cvt_pk_bf16_f32 v125, v126, v127
  v_mfma_f32_16x16x32_bf16 v[232:235], a[188:191], v[204:207], v[232:235]
  v_mfma_f32_16x16x32_bf16 v[236:239], a[240:243], v[192:195], v[236:239]
  ds_read_b64_tr_b16 v[188:189], v244 offset:8192
  v_cvt_pk_bf16_f32 v126, v140, v141
  v_mfma_f32_16x16x32_bf16 v[236:239], a[244:247], v[196:199], v[236:239]
  v_mfma_f32_16x16x32_bf16 v[236:239], a[248:251], v[200:203], v[236:239]
  ds_read_b64_tr_b16 v[190:191], v244 offset:9216
  v_cvt_pk_bf16_f32 v127, v142, v143
  v_mfma_f32_16x16x32_bf16 v[236:239], a[252:255], v[204:207], v[236:239]
  s_add_u32 s47, s46, 12288
  buffer_store_dwordx4 v[60:63], v2, s[16:19], s47 offen offset:1024
  s_waitcnt lgkmcnt(15)
  v_mfma_f32_16x16x32_bf16 v[128:131], a[0:3], v[144:147], 0
  ds_read_b64_tr_b16 v[192:193], v247 offset:32768
  v_mfma_f32_16x16x32_bf16 v[128:131], a[4:7], v[148:151], v[128:131]
  s_lshl_b32 s50, s56, 10
  s_add_u32 s50, s50, 96468992
  v_mfma_f32_16x16x32_bf16 v[128:131], a[8:11], v[152:155], v[128:131]
  ds_read_b64_tr_b16 v[194:195], v247 offset:33792
  v_mfma_f32_16x16x32_bf16 v[128:131], a[12:15], v[156:159], v[128:131]
  v_add_u32 v24, s50, v24
  v_mfma_f32_16x16x32_bf16 v[132:135], a[64:67], v[144:147], 0
  ds_read_b64_tr_b16 v[196:197], v247 offset:40960
  v_mfma_f32_16x16x32_bf16 v[132:135], a[68:71], v[148:151], v[132:135]
  v_mfma_f32_16x16x32_bf16 v[132:135], a[72:75], v[152:155], v[132:135]
  ds_read_b64_tr_b16 v[198:199], v247 offset:41984
  v_mfma_f32_16x16x32_bf16 v[132:135], a[76:79], v[156:159], v[132:135]
  buffer_load_dwordx2 v[26:27], v19, s[28:31], s53 offen offset:0
  v_mfma_f32_16x16x32_bf16 v[136:139], a[128:131], v[144:147], 0
  ds_read_b64_tr_b16 v[200:201], v246 offset:0
  v_mfma_f32_16x16x32_bf16 v[136:139], a[132:135], v[148:151], v[136:139]
  buffer_load_dwordx2 v[28:29], v19, s[28:31], s53 offen offset:32
  v_mfma_f32_16x16x32_bf16 v[136:139], a[136:139], v[152:155], v[136:139]
  ds_read_b64_tr_b16 v[202:203], v246 offset:1024
  v_mfma_f32_16x16x32_bf16 v[136:139], a[140:143], v[156:159], v[136:139]
  s_add_u32 s47, s46, 0
  buffer_store_dwordx4 v[80:83], v2, s[16:19], s47 offen offset:2048
  buffer_load_dwordx2 v[30:31], v19, s[28:31], s54 offen offset:64
  v_mfma_f32_16x16x32_bf16 v[140:143], a[192:195], v[144:147], 0
  ds_read_b64_tr_b16 v[204:205], v246 offset:8192
  v_mfma_f32_16x16x32_bf16 v[140:143], a[196:199], v[148:151], v[140:143]
  v_mfma_f32_16x16x32_bf16 v[140:143], a[200:203], v[152:155], v[140:143]
  ds_read_b64_tr_b16 v[206:207], v246 offset:9216
  v_mfma_f32_16x16x32_bf16 v[140:143], a[204:207], v[156:159], v[140:143]
  s_waitcnt lgkmcnt(15)
  v_mfma_f32_16x16x32_bf16 v[96:99], a[0:3], v[160:163], 0
  ds_read_b64_tr_b16 v[144:145], v244 offset:16384
  v_cvt_pk_bf16_f32 v208, v208, v209
  v_mfma_f32_16x16x32_bf16 v[96:99], a[4:7], v[164:167], v[96:99]
  s_lshr_b32 s50, s2, 3
  s_lshl_b32 s50, s50, 2
  s_add_u32 s50, s50, s36
  v_mfma_f32_16x16x32_bf16 v[96:99], a[8:11], v[168:171], v[96:99]
  ds_read_b64_tr_b16 v[146:147], v244 offset:17408
  v_cvt_pk_bf16_f32 v209, v210, v211
  v_mfma_f32_16x16x32_bf16 v[96:99], a[12:15], v[172:175], v[96:99]
  s_lshl_b32 s50, s50, 10
  s_and_b32 s50, s50, 32767
  s_add_u32 s50, s50, 32768
  s_min_u32 s50, s50, L_codeend-L_pcbase-1024
  v_mfma_f32_16x16x32_bf16 v[100:103], a[64:67], v[160:163], 0
  ds_read_b64_tr_b16 v[148:149], v244 offset:24576
  v_cvt_pk_bf16_f32 v210, v212, v213
  v_mfma_f32_16x16x32_bf16 v[100:103], a[68:71], v[164:167], v[100:103]
  v_add_u32 v32, s50, v2
  v_mfma_f32_16x16x32_bf16 v[100:103], a[72:75], v[168:171], v[100:103]
  ds_read_b64_tr_b16 v[150:151], v244 offset:25600
  v_cvt_pk_bf16_f32 v211, v214, v215
  v_mfma_f32_16x16x32_bf16 v[100:103], a[76:79], v[172:175], v[100:103]
  global_load_dwordx4 v[44:47], v32, s[62:63]
  v_mfma_f32_16x16x32_bf16 v[104:107], a[128:131], v[160:163], 0
  ds_read_b64_tr_b16 v[152:153], v245 offset:49152
  v_mfma_f32_16x16x32_bf16 v[104:107], a[132:135], v[164:167], v[104:107]
  v_mfma_f32_16x16x32_bf16 v[104:107], a[136:139], v[168:171], v[104:107]
  ds_read_b64_tr_b16 v[154:155], v245 offset:50176
  v_mfma_f32_16x16x32_bf16 v[104:107], a[140:143], v[172:175], v[104:107]
  s_add_u32 s47, s46, 16384
  buffer_store_dwordx4 v[208:211], v2, s[16:19], s47 offen offset:0
  v_add_u32 v33, 0x7c00, v32
  v_mfma_f32_16x16x32_bf16 v[108:111], a[192:195], v[160:163], 0
  ds_read_b64_tr_b16 v[156:157], v245 offset:57344
  v_mfma_f32_16x16x32_bf16 v[108:111], a[196:199], v[164:167], v[108:111]
  global_load_dwordx4 v[44:47], v33, s[62:63]
  v_mfma_f32_16x16x32_bf16 v[108:111], a[200:203], v[168:171], v[108:111]
  ds_read_b64_tr_b16 v[158:159], v245 offset:58368
  v_mfma_f32_16x16x32_bf16 v[108:111], a[204:207], v[172:175], v[108:111]
  s_waitcnt lgkmcnt(15)
  v_mfma_f32_16x16x32_bf16 v[128:131], a[16:19], v[176:179], v[128:131]
  ds_read_b64_tr_b16 v[160:161], v246 offset:16384
  v_mfma_f32_16x16x32_bf16 v[128:131], a[20:23], v[180:183], v[128:131]
  v_mfma_f32_16x16x32_bf16 v[128:131], a[24:27], v[184:187], v[128:131]
  ds_read_b64_tr_b16 v[162:163], v246 offset:17408
  v_mfma_f32_16x16x32_bf16 v[128:131], a[28:31], v[188:191], v[128:131]
  v_mfma_f32_16x16x32_bf16 v[132:135], a[80:83], v[176:179], v[132:135]
  ds_read_b64_tr_b16 v[164:165], v246 offset:24576
  v_mfma_f32_16x16x32_bf16 v[132:135], a[84:87], v[180:183], v[132:135]
  v_mfma_f32_16x16x32_bf16 v[132:135], a[88:91], v[184:187], v[132:135]
  ds_read_b64_tr_b16 v[166:167], v246 offset:25600
  v_mfma_f32_16x16x32_bf16 v[132:135], a[92:95], v[188:191], v[132:135]
  v_mfma_f32_16x16x32_bf16 v[136:139], a[144:147], v[176:179], v[136:139]
  ds_read_b64_tr_b16 v[168:169], v247 offset:49152
  v_mfma_f32_16x16x32_bf16 v[136:139], a[148:151], v[180:183], v[136:139]
  v_mfma_f32_16x16x32_bf16 v[136:139], a[152:155], v[184:187], v[136:139]
  ds_read_b64_tr_b16 v[170:171], v247 offset:50176
  v_mfma_f32_16x16x32_bf16 v[136:139], a[156:159], v[188:191], v[136:139]
  s_add_u32 s47, s46, 4096
  buffer_store_dwordx4 v[84:87], v2, s[16:19], s47 offen offset:2048
  v_mfma_f32_16x16x32_bf16 v[140:143], a[208:211], v[176:179], v[140:143]
  ds_read_b64_tr_b16 v[172:173], v247 offset:57344
  v_mfma_f32_16x16x32_bf16 v[140:143], a[212:215], v[180:183], v[140:143]
  buffer_load_dword v25, v24, s[16:19], 0 offen sc1
  v_mfma_f32_16x16x32_bf16 v[140:143], a[216:219], v[184:187], v[140:143]
  ds_read_b64_tr_b16 v[174:175], v247 offset:58368
  v_mfma_f32_16x16x32_bf16 v[140:143], a[220:223], v[188:191], v[140:143]
  s_waitcnt lgkmcnt(15)
  v_mfma_f32_16x16x32_bf16 v[96:99], a[16:19], v[192:195], v[96:99]
  ds_read_b64_tr_b16 v[176:177], v244 offset:32768
  v_cvt_pk_bf16_f32 v216, v216, v217
  v_mfma_f32_16x16x32_bf16 v[96:99], a[20:23], v[196:199], v[96:99]
  v_mfma_f32_16x16x32_bf16 v[96:99], a[24:27], v[200:203], v[96:99]
  ds_read_b64_tr_b16 v[178:179], v244 offset:33792
  v_cvt_pk_bf16_f32 v217, v218, v219
  v_mfma_f32_16x16x32_bf16 v[96:99], a[28:31], v[204:207], v[96:99]
  v_mfma_f32_16x16x32_bf16 v[100:103], a[80:83], v[192:195], v[100:103]
  ds_read_b64_tr_b16 v[180:181], v244 offset:40960
  v_cvt_pk_bf16_f32 v218, v220, v221
  v_mfma_f32_16x16x32_bf16 v[100:103], a[84:87], v[196:199], v[100:103]
  v_mfma_f32_16x16x32_bf16 v[100:103], a[88:91], v[200:203], v[100:103]
  ds_read_b64_tr_b16 v[182:183], v244 offset:41984
  v_cvt_pk_bf16_f32 v219, v222, v223
  v_mfma_f32_16x16x32_bf16 v[100:103], a[92:95], v[204:207], v[100:103]
  v_mfma_f32_16x16x32_bf16 v[104:107], a[144:147], v[192:195], v[104:107]
  ds_read_b64_tr_b16 v[184:185], v244 offset:49152
  v_mfma_f32_16x16x32_bf16 v[104:107], a[148:151], v[196:199], v[104:107]
  v_mfma_f32_16x16x32_bf16 v[104:107], a[152:155], v[200:203], v[104:107]
  ds_read_b64_tr_b16 v[186:187], v244 offset:50176
  v_mfma_f32_16x16x32_bf16 v[104:107], a[156:159], v[204:207], v[104:107]
  s_add_u32 s47, s46, 24576
  buffer_store_dwordx4 v[216:219], v2, s[16:19], s47 offen offset:0
  v_mfma_f32_16x16x32_bf16 v[108:111], a[208:211], v[192:195], v[108:111]
  ds_read_b64_tr_b16 v[188:189], v244 offset:57344
  v_mfma_f32_16x16x32_bf16 v[108:111], a[212:215], v[196:199], v[108:111]
  v_mfma_f32_16x16x32_bf16 v[108:111], a[216:219], v[200:203], v[108:111]
  ds_read_b64_tr_b16 v[190:191], v244 offset:58368
  v_mfma_f32_16x16x32_bf16 v[108:111], a[220:223], v[204:207], v[108:111]
  s_waitcnt lgkmcnt(15)
  v_mfma_f32_16x16x32_bf16 v[128:131], a[32:35], v[144:147], v[128:131]
  ds_read_b64_tr_b16 v[192:193], v246 offset:32768
  v_mfma_f32_16x16x32_bf16 v[128:131], a[36:39], v[148:151], v[128:131]
  v_subrev_u32 v240, 114688, v12
  v_mfma_f32_16x16x32_bf16 v[128:131], a[40:43], v[152:155], v[128:131]
  ds_read_b64_tr_b16 v[194:195], v246 offset:33792
  v_mfma_f32_16x16x32_bf16 v[128:131], a[44:47], v[156:159], v[128:131]
  v_subrev_u32 v241, 49152, v12
  v_mfma_f32_16x16x32_bf16 v[132:135], a[96:99], v[144:147], v[132:135]
  ds_read_b64_tr_b16 v[196:197], v246 offset:40960
  v_mfma_f32_16x16x32_bf16 v[132:135], a[100:103], v[148:151], v[132:135]
  v_subrev_u32 v242, 114688, v13
  v_mfma_f32_16x16x32_bf16 v[132:135], a[104:107], v[152:155], v[132:135]
  ds_read_b64_tr_b16 v[198:199], v246 offset:41984
  v_mfma_f32_16x16x32_bf16 v[132:135], a[108:111], v[156:159], v[132:135]
  v_mfma_f32_16x16x32_bf16 v[136:139], a[160:163], v[144:147], v[136:139]
  ds_read_b64_tr_b16 v[200:201], v246 offset:49152
  v_mfma_f32_16x16x32_bf16 v[136:139], a[164:167], v[148:151], v[136:139]
  v_subrev_u32 v243, 49152, v13
  v_mfma_f32_16x16x32_bf16 v[136:139], a[168:171], v[152:155], v[136:139]
  ds_read_b64_tr_b16 v[202:203], v246 offset:50176
  v_mfma_f32_16x16x32_bf16 v[136:139], a[172:175], v[156:159], v[136:139]
  s_add_u32 s47, s46, 8192
  buffer_store_dwordx4 v[88:91], v2, s[16:19], s47 offen offset:2048
  v_mfma_f32_16x16x32_bf16 v[140:143], a[224:227], v[144:147], v[140:143]
  ds_read_b64_tr_b16 v[204:205], v246 offset:57344
  v_mfma_f32_16x16x32_bf16 v[140:143], a[228:231], v[148:151], v[140:143]
  v_mfma_f32_16x16x32_bf16 v[140:143], a[232:235], v[152:155], v[140:143]
  ds_read_b64_tr_b16 v[206:207], v246 offset:58368
  v_mfma_f32_16x16x32_bf16 v[140:143], a[236:239], v[156:159], v[140:143]
  s_waitcnt lgkmcnt(15)
  s_waitcnt vmcnt(2)
  s_mov_b32 s50, 0
L_poll0:
  v_and_b32 v23, 0xffffff00, v25
  v_cmp_ne_u32 vcc, s3, v23
  s_cbranch_vccz L_pollok0
  s_add_u32 s50, s50, 1
  s_cmp_gt_u32 s50, 0x80000
  s_cbranch_scc1 L_pollok0
  buffer_load_dword v25, v24, s[16:19], 0 offen sc1
  s_waitcnt vmcnt(0)
  s_branch L_poll0
L_pollok0:
  v_lshlrev_b32 v32, 16, v26
  v_and_b32 v33, 0xffff0000, v26
  v_lshlrev_b32 v34, 16, v27
  v_and_b32 v35, 0xffff0000, v27
  v_lshlrev_b32 v36, 16, v28
  v_and_b32 v37, 0xffff0000, v28
  v_lshlrev_b32 v38, 16, v29
  v_and_b32 v39, 0xffff0000, v29
  v_lshlrev_b32 v40, 16, v30
  v_and_b32 v41, 0xffff0000, v30
  v_lshlrev_b32 v42, 16, v31
  v_and_b32 v43, 0xffff0000, v31
  v_mov_b32 v20, v32
  v_mov_b32 v21, v33
  v_mov_b32 v22, v34
  v_mov_b32 v23, v35
  v_mov_b32 v24, v36
  v_mov_b32 v25, v37
  v_mov_b32 v26, v38
  v_mov_b32 v27, v39
  v_mov_b32 v28, v40
  v_mov_b32 v29, v41
  v_mov_b32 v30, v42
  v_mov_b32 v31, v43
  v_mfma_f32_16x16x32_bf16 v[96:99], a[32:35], v[160:163], v[96:99]
  ds_read_b64_tr_b16 v[144:145], v241 offset:0
  v_cvt_pk_bf16_f32 v224, v224, v225
  v_mfma_f32_16x16x32_bf16 v[96:99], a[36:39], v[164:167], v[96:99]
  v_mfma_f32_16x16x32_bf16 v[96:99], a[40:43], v[168:171], v[96:99]
  ds_read_b64_tr_b16 v[146:147], v241 offset:1024
  v_cvt_pk_bf16_f32 v225, v226, v227
  v_mfma_f32_16x16x32_bf16 v[96:99], a[44:47], v[172:175], v[96:99]
  v_mfma_f32_16x16x32_bf16 v[100:103], a[96:99], v[160:163], v[100:103]
  ds_read_b64_tr_b16 v[148:149], v241 offset:8192
  v_cvt_pk_bf16_f32 v226, v228, v229
  v_mfma_f32_16x16x32_bf16 v[100:103], a[100:103], v[164:167], v[100:103]
  v_mfma_f32_16x16x32_bf16 v[100:103], a[104:107], v[168:171], v[100:103]
  s_add_u32 s51, s34, 0
  ds_read_b64_tr_b16 v[150:151], v241 offset:9216
  v_cvt_pk_bf16_f32 v227, v230, v231
  v_mfma_f32_16x16x32_bf16 v[100:103], a[108:111], v[172:175], v[100:103]
  buffer_load_dwordx4 v[64:67], v2, s[16:19], s51 offen offset:0 sc1
  v_mfma_f32_16x16x32_bf16 v[104:107], a[160:163], v[160:163], v[104:107]
  ds_read_b64_tr_b16 v[152:153], v241 offset:16384
  v_mfma_f32_16x16x32_bf16 v[104:107], a[164:167], v[164:167], v[104:107]
  v_mfma_f32_16x16x32_bf16 v[104:107], a[168:171], v[168:171], v[104:107]
  ds_read_b64_tr_b16 v[154:155], v241 offset:17408
  v_mfma_f32_16x16x32_bf16 v[104:107], a[172:175], v[172:175], v[104:107]
  s_add_u32 s47, s46, 16384
  buffer_store_dwordx4 v[224:227], v2, s[16:19], s47 offen offset:1024
  v_mfma_f32_16x16x32_bf16 v[108:111], a[224:227], v[160:163], v[108:111]
  ds_read_b64_tr_b16 v[156:157], v241 offset:24576
  v_mfma_f32_16x16x32_bf16 v[108:111], a[228:231], v[164:167], v[108:111]
  v_mfma_f32_16x16x32_bf16 v[108:111], a[232:235], v[168:171], v[108:111]
  ds_read_b64_tr_b16 v[158:159], v241 offset:25600
  v_mfma_f32_16x16x32_bf16 v[108:111], a[236:239], v[172:175], v[108:111]
  buffer_load_dwordx4 v[68:71], v2, s[16:19], s51 offen offset:1024 sc1
  s_waitcnt lgkmcnt(15)
  v_mfma_f32_16x16x32_bf16 v[128:131], a[48:51], v[176:179], v[128:131]
  ds_read_b64_tr_b16 v[160:161], v243 offset:0
  v_mfma_f32_16x16x32_bf16 v[128:131], a[52:55], v[180:183], v[128:131]
  v_mfma_f32_16x16x32_bf16 v[128:131], a[56:59], v[184:187], v[128:131]
  ds_read_b64_tr_b16 v[162:163], v243 offset:1024
  v_mfma_f32_16x16x32_bf16 v[128:131], a[60:63], v[188:191], v[128:131]
  v_mfma_f32_16x16x32_bf16 v[132:135], a[112:115], v[176:179], v[132:135]
  ds_read_b64_tr_b16 v[164:165], v243 offset:8192
  v_mfma_f32_16x16x32_bf16 v[132:135], a[116:119], v[180:183], v[132:135]
  v_mfma_f32_16x16x32_bf16 v[132:135], a[120:123], v[184:187], v[132:135]
  s_add_u32 s51, s51, 16384
  ds_read_b64_tr_b16 v[166:167], v243 offset:9216
  v_mfma_f32_16x16x32_bf16 v[132:135], a[124:127], v[188:191], v[132:135]
  buffer_load_dwordx4 v[72:75], v2, s[16:19], s51 offen offset:0 sc1
  v_mfma_f32_16x16x32_bf16 v[136:139], a[176:179], v[176:179], v[136:139]
  ds_read_b64_tr_b16 v[168:169], v243 offset:16384
  v_mfma_f32_16x16x32_bf16 v[136:139], a[180:183], v[180:183], v[136:139]
  v_mfma_f32_16x16x32_bf16 v[136:139], a[184:187], v[184:187], v[136:139]
  ds_read_b64_tr_b16 v[170:171], v243 offset:17408
  v_mfma_f32_16x16x32_bf16 v[136:139], a[188:191], v[188:191], v[136:139]
  s_add_u32 s47, s46, 12288
  buffer_store_dwordx4 v[92:95], v2, s[16:19], s47 offen offset:2048
  v_mfma_f32_16x16x32_bf16 v[140:143], a[240:243], v[176:179], v[140:143]
  ds_read_b64_tr_b16 v[172:173], v243 offset:24576
  v_mfma_f32_16x16x32_bf16 v[140:143], a[244:247], v[180:183], v[140:143]
  v_mfma_f32_16x16x32_bf16 v[140:143], a[248:251], v[184:187], v[140:143]
  ds_read_b64_tr_b16 v[174:175], v243 offset:25600
  v_mfma_f32_16x16x32_bf16 v[140:143], a[252:255], v[188:191], v[140:143]
  buffer_load_dwordx4 v[76:79], v2, s[16:19], s51 offen offset:1024 sc1
  s_waitcnt lgkmcnt(15)
  v_mfma_f32_16x16x32_bf16 v[96:99], a[48:51], v[192:195], v[96:99]
  ds_read_b64_tr_b16 v[176:177], v241 offset:32768
  v_cvt_pk_bf16_f32 v232, v232, v233
  v_mfma_f32_16x16x32_bf16 v[96:99], a[52:55], v[196:199], v[96:99]
  v_mfma_f32_16x16x32_bf16 v[96:99], a[56:59], v[200:203], v[96:99]
  ds_read_b64_tr_b16 v[178:179], v241 offset:33792
  v_cvt_pk_bf16_f32 v233, v234, v235
  v_mfma_f32_16x16x32_bf16 v[96:99], a[60:63], v[204:207], v[96:99]
  v_mfma_f32_16x16x32_bf16 v[100:103], a[112:115], v[192:195], v[100:103]
  ds_read_b64_tr_b16 v[180:181], v241 offset:40960
  v_cvt_pk_bf16_f32 v234, v236, v237
  v_mfma_f32_16x16x32_bf16 v[100:103], a[116:119], v[196:199], v[100:103]
  v_mfma_f32_16x16x32_bf16 v[100:103], a[120:123], v[200:203], v[100:103]
  s_add_u32 s51, s51, 16384
  ds_read_b64_tr_b16 v[182:183], v241 offset:41984
  v_cvt_pk_bf16_f32 v235, v238, v239
  v_mfma_f32_16x16x32_bf16 v[100:103], a[124:127], v[204:207], v[100:103]
  buffer_load_dwordx4 v[48:51], v2, s[16:19], s51 offen offset:0 sc1
  v_mfma_f32_16x16x32_bf16 v[104:107], a[176:179], v[192:195], v[104:107]
  ds_read_b64_tr_b16 v[184:185], v240 offset:0
  v_mfma_f32_16x16x32_bf16 v[104:107], a[180:183], v[196:199], v[104:107]
  v_mfma_f32_16x16x32_bf16 v[104:107], a[184:187], v[200:203], v[104:107]
  ds_read_b64_tr_b16 v[186:187], v240 offset:1024
  v_mfma_f32_16x16x32_bf16 v[104:107], a[188:191], v[204:207], v[104:107]
  s_add_u32 s47, s46, 24576
  buffer_store_dwordx4 v[232:235], v2, s[16:19], s47 offen offset:1024
  v_mfma_f32_16x16x32_bf16 v[108:111], a[240:243], v[192:195], v[108:111]
  ds_read_b64_tr_b16 v[188:189], v240 offset:8192
  v_mfma_f32_16x16x32_bf16 v[108:111], a[244:247], v[196:199], v[108:111]
  v_mfma_f32_16x16x32_bf16 v[108:111], a[248:251], v[200:203], v[108:111]
  ds_read_b64_tr_b16 v[190:191], v240 offset:9216
  v_mfma_f32_16x16x32_bf16 v[108:111], a[252:255], v[204:207], v[108:111]
  buffer_load_dwordx4 v[52:55], v2, s[16:19], s51 offen offset:1024 sc1
  s_waitcnt lgkmcnt(15)
  v_mfma_f32_16x16x32_bf16 v[208:211], a[0:3], v[144:147], 0
  ds_read_b64_tr_b16 v[192:193], v243 offset:32768
  v_mfma_f32_16x16x32_bf16 v[208:211], a[4:7], v[148:151], v[208:211]
  v_mfma_f32_16x16x32_bf16 v[208:211], a[8:11], v[152:155], v[208:211]
  ds_read_b64_tr_b16 v[194:195], v243 offset:33792
  v_mfma_f32_16x16x32_bf16 v[208:211], a[12:15], v[156:159], v[208:211]
  v_mfma_f32_16x16x32_bf16 v[212:215], a[64:67], v[144:147], 0
  ds_read_b64_tr_b16 v[196:197], v243 offset:40960
  v_mfma_f32_16x16x32_bf16 v[212:215], a[68:71], v[148:151], v[212:215]
  v_mfma_f32_16x16x32_bf16 v[212:215], a[72:75], v[152:155], v[212:215]
  s_add_u32 s51, s51, 16384
  ds_read_b64_tr_b16 v[198:199], v243 offset:41984
  v_mfma_f32_16x16x32_bf16 v[212:215], a[76:79], v[156:159], v[212:215]
  buffer_load_dwordx4 v[56:59], v2, s[16:19], s51 offen offset:0 sc1
  v_mfma_f32_16x16x32_bf16 v[216:219], a[128:131], v[144:147], 0
  ds_read_b64_tr_b16 v[200:201], v242 offset:0
  v_mfma_f32_16x16x32_bf16 v[216:219], a[132:135], v[148:151], v[216:219]
  v_mfma_f32_16x16x32_bf16 v[216:219], a[136:139], v[152:155], v[216:219]
  ds_read_b64_tr_b16 v[202:203], v242 offset:1024
  v_mfma_f32_16x16x32_bf16 v[216:219], a[140:143], v[156:159], v[216:219]
  s_add_u32 s47, s46, 0
  buffer_store_dwordx4 v[112:115], v2, s[16:19], s47 offen offset:3072
  v_mfma_f32_16x16x32_bf16 v[220:223], a[192:195], v[144:147], 0
  ds_read_b64_tr_b16 v[204:205], v242 offset:8192
  v_mfma_f32_16x16x32_bf16 v[220:223], a[196:199], v[148:151], v[220:223]
  v_mfma_f32_16x16x32_bf16 v[220:223], a[200:203], v[152:155], v[220:223]
  ds_read_b64_tr_b16 v[206:207], v242 offset:9216
  v_mfma_f32_16x16x32_bf16 v[220:223], a[204:207], v[156:159], v[220:223]
  buffer_load_dwordx4 v[60:63], v2, s[16:19], s51 offen offset:1024 sc1
  s_waitcnt lgkmcnt(15)
  v_mfma_f32_16x16x32_bf16 v[224:227], a[0:3], v[160:163], 0
  ds_read_b64_tr_b16 v[144:145], v240 offset:16384
  v_cvt_pk_bf16_f32 v128, v128, v129
  v_mfma_f32_16x16x32_bf16 v[224:227], a[4:7], v[164:167], v[224:227]
  v_mfma_f32_16x16x32_bf16 v[224:227], a[8:11], v[168:171], v[224:227]
  ds_read_b64_tr_b16 v[146:147], v240 offset:17408
  v_cvt_pk_bf16_f32 v129, v130, v131
  v_mfma_f32_16x16x32_bf16 v[224:227], a[12:15], v[172:175], v[224:227]
  v_mfma_f32_16x16x32_bf16 v[228:231], a[64:67], v[160:163], 0
  ds_read_b64_tr_b16 v[148:149], v240 offset:24576
  v_cvt_pk_bf16_f32 v130, v132, v133
  v_mfma_f32_16x16x32_bf16 v[228:231], a[68:71], v[164:167], v[228:231]
  v_mfma_f32_16x16x32_bf16 v[228:231], a[72:75], v[168:171], v[228:231]
  s_add_u32 s51, s34, 2048
  ds_read_b64_tr_b16 v[150:151], v240 offset:25600
  v_cvt_pk_bf16_f32 v131, v134, v135
  v_mfma_f32_16x16x32_bf16 v[228:231], a[76:79], v[172:175], v[228:231]
  buffer_load_dwordx4 v[32:35], v2, s[16:19], s51 offen offset:0 sc1
  v_mfma_f32_16x16x32_bf16 v[232:235], a[128:131], v[160:163], 0
  ds_read_b64_tr_b16 v[152:153], v241 offset:49152
  v_mfma_f32_16x16x32_bf16 v[232:235], a[132:135], v[164:167], v[232:235]
  v_mfma_f32_16x16x32_bf16 v[232:235], a[136:139], v[168:171], v[232:235]
  ds_read_b64_tr_b16 v[154:155], v241 offset:50176
  v_mfma_f32_16x16x32_bf16 v[232:235], a[140:143], v[172:175], v[232:235]
  s_add_u32 s47, s46, 16384
  buffer_store_dwordx4 v[128:131], v2, s[16:19], s47 offen offset:2048
  v_mfma_f32_16x16x32_bf16 v[236:239], a[192:195], v[160:163], 0
  ds_read_b64_tr_b16 v[156:157], v241 offset:57344
  v_mfma_f32_16x16x32_bf16 v[236:239], a[196:199], v[164:167], v[236:239]
  v_mfma_f32_16x16x32_bf16 v[236:239], a[200:203], v[168:171], v[236:239]
  ds_read_b64_tr_b16 v[158:159], v241 offset:58368
  v_mfma_f32_16x16x32_bf16 v[236:239], a[204:207], v[172:175], v[236:239]
  buffer_load_dwordx4 v[36:39], v2, s[16:19], s51 offen offset:1024 sc1
  s_waitcnt lgkmcnt(15)
  v_mfma_f32_16x16x32_bf16 v[208:211], a[16:19], v[176:179], v[208:211]
  ds_read_b64_tr_b16 v[160:161], v242 offset:16384
  v_mfma_f32_16x16x32_bf16 v[208:211], a[20:23], v[180:183], v[208:211]
  v_mfma_f32_16x16x32_bf16 v[208:211], a[24:27], v[184:187], v[208:211]
  ds_read_b64_tr_b16 v[162:163], v242 offset:17408
  v_mfma_f32_16x16x32_bf16 v[208:211], a[28:31], v[188:191], v[208:211]
  v_mfma_f32_16x16x32_bf16 v[212:215], a[80:83], v[176:179], v[212:215]
  ds_read_b64_tr_b16 v[164:165], v242 offset:24576
  v_mfma_f32_16x16x32_bf16 v[212:215], a[84:87], v[180:183], v[212:215]
  v_mfma_f32_16x16x32_bf16 v[212:215], a[88:91], v[184:187], v[212:215]
  s_add_u32 s51, s51, 16384
  ds_read_b64_tr_b16 v[166:167], v242 offset:25600
  v_mfma_f32_16x16x32_bf16 v[212:215], a[92:95], v[188:191], v[212:215]
  buffer_load_dwordx4 v[40:43], v2, s[16:19], s51 offen offset:0 sc1
  v_mfma_f32_16x16x32_bf16 v[216:219], a[144:147], v[176:179], v[216:219]
  ds_read_b64_tr_b16 v[168:169], v243 offset:49152
  v_mfma_f32_16x16x32_bf16 v[216:219], a[148:151], v[180:183], v[216:219]
  v_mfma_f32_16x16x32_bf16 v[216:219], a[152:155], v[184:187], v[216:219]
  ds_read_b64_tr_b16 v[170:171], v243 offset:50176
  v_mfma_f32_16x16x32_bf16 v[216:219], a[156:159], v[188:191], v[216:219]
  s_add_u32 s47, s46, 4096
  buffer_store_dwordx4 v[116:119], v2, s[16:19], s47 offen offset:3072
  v_mfma_f32_16x16x32_bf16 v[220:223], a[208:211], v[176:179], v[220:223]
  ds_read_b64_tr_b16 v[172:173], v243 offset:57344
  v_mfma_f32_16x16x32_bf16 v[220:223], a[212:215], v[180:183], v[220:223]
  v_mfma_f32_16x16x32_bf16 v[220:223], a[216:219], v[184:187], v[220:223]
  ds_read_b64_tr_b16 v[174:175], v243 offset:58368
  v_mfma_f32_16x16x32_bf16 v[220:223], a[220:223], v[188:191], v[220:223]
  buffer_load_dwordx4 v[44:47], v2, s[16:19], s51 offen offset:1024 sc1
  s_waitcnt lgkmcnt(15)
  v_mfma_f32_16x16x32_bf16 v[224:227], a[16:19], v[192:195], v[224:227]
  ds_read_b64_tr_b16 v[176:177], v240 offset:32768
  v_cvt_pk_bf16_f32 v136, v136, v137
  v_mfma_f32_16x16x32_bf16 v[224:227], a[20:23], v[196:199], v[224:227]
  v_mfma_f32_16x16x32_bf16 v[224:227], a[24:27], v[200:203], v[224:227]
  ds_read_b64_tr_b16 v[178:179], v240 offset:33792
  v_cvt_pk_bf16_f32 v137, v138, v139
  v_mfma_f32_16x16x32_bf16 v[224:227], a[28:31], v[204:207], v[224:227]
  v_mfma_f32_16x16x32_bf16 v[228:231], a[80:83], v[192:195], v[228:231]
  ds_read_b64_tr_b16 v[180:181], v240 offset:40960
  v_cvt_pk_bf16_f32 v138, v140, v141
  v_mfma_f32_16x16x32_bf16 v[228:231], a[84:87], v[196:199], v[228:231]
  v_mfma_f32_16x16x32_bf16 v[228:231], a[88:91], v[200:203], v[228:231]
  s_add_u32 s51, s51, 16384
  ds_read_b64_tr_b16 v[182:183], v240 offset:41984
  v_cvt_pk_bf16_f32 v139, v142, v143
  v_mfma_f32_16x16x32_bf16 v[228:231], a[92:95], v[204:207], v[228:231]
  buffer_load_dwordx4 v[80:83], v2, s[16:19], s51 offen offset:0 sc1
  v_mfma_f32_16x16x32_bf16 v[232:235], a[144:147], v[192:195], v[232:235]
  ds_read_b64_tr_b16 v[184:185], v240 offset:49152
  v_mfma_f32_16x16x32_bf16 v[232:235], a[148:151], v[196:199], v[232:235]
  v_mfma_f32_16x16x32_bf16 v[232:235], a[152:155], v[200:203], v[232:235]
  ds_read_b64_tr_b16 v[186:187], v240 offset:50176
  v_mfma_f32_16x16x32_bf16 v[232:235], a[156:159], v[204:207], v[232:235]
  s_add_u32 s47, s46, 24576
  buffer_store_dwordx4 v[136:139], v2, s[16:19], s47 offen offset:2048
  v_mfma_f32_16x16x32_bf16 v[236:239], a[208:211], v[192:195], v[236:239]
  ds_read_b64_tr_b16 v[188:189], v240 offset:57344
  v_mfma_f32_16x16x32_bf16 v[236:239], a[212:215], v[196:199], v[236:239]
  v_mfma_f32_16x16x32_bf16 v[236:239], a[216:219], v[200:203], v[236:239]
  ds_read_b64_tr_b16 v[190:191], v240 offset:58368
  v_mfma_f32_16x16x32_bf16 v[236:239], a[220:223], v[204:207], v[236:239]
  buffer_load_dwordx4 v[84:87], v2, s[16:19], s51 offen offset:1024 sc1
  s_waitcnt lgkmcnt(15)
  v_mfma_f32_16x16x32_bf16 v[208:211], a[32:35], v[144:147], v[208:211]
  ds_read_b64_tr_b16 v[192:193], v242 offset:32768
  v_mfma_f32_16x16x32_bf16 v[208:211], a[36:39], v[148:151], v[208:211]
  v_subrev_u32 v244, 114688, v14
  v_mfma_f32_16x16x32_bf16 v[208:211], a[40:43], v[152:155], v[208:211]
  ds_read_b64_tr_b16 v[194:195], v242 offset:33792
  v_mfma_f32_16x16x32_bf16 v[208:211], a[44:47], v[156:159], v[208:211]
  v_subrev_u32 v245, 49152, v14
  v_mfma_f32_16x16x32_bf16 v[212:215], a[96:99], v[144:147], v[212:215]
  ds_read_b64_tr_b16 v[196:197], v242 offset:40960
  v_mfma_f32_16x16x32_bf16 v[212:215], a[100:103], v[148:151], v[212:215]
  v_subrev_u32 v246, 114688, v15
  v_mfma_f32_16x16x32_bf16 v[212:215], a[104:107], v[152:155], v[212:215]
  s_add_u32 s51, s51, 16384
  ds_read_b64_tr_b16 v[198:199], v242 offset:41984
  v_mfma_f32_16x16x32_bf16 v[212:215], a[108:111], v[156:159], v[212:215]
  buffer_load_dwordx4 v[88:91], v2, s[16:19], s51 offen offset:0 sc1
  v_mfma_f32_16x16x32_bf16 v[216:219], a[160:163], v[144:147], v[216:219]
  ds_read_b64_tr_b16 v[200:201], v242 offset:49152
  v_mfma_f32_16x16x32_bf16 v[216:219], a[164:167], v[148:151], v[216:219]
  v_subrev_u32 v247, 49152, v15
  v_mfma_f32_16x16x32_bf16 v[216:219], a[168:171], v[152:155], v[216:219]
  ds_read_b64_tr_b16 v[202:203], v242 offset:50176
  v_mfma_f32_16x16x32_bf16 v[216:219], a[172:175], v[156:159], v[216:219]
  s_add_u32 s47, s46, 8192
  buffer_store_dwordx4 v[120:123], v2, s[16:19], s47 offen offset:3072
  v_mfma_f32_16x16x32_bf16 v[220:223], a[224:227], v[144:147], v[220:223]
  ds_read_b64_tr_b16 v[204:205], v242 offset:57344
  v_mfma_f32_16x16x32_bf16 v[220:223], a[228:231], v[148:151], v[220:223]
  v_mfma_f32_16x16x32_bf16 v[220:223], a[232:235], v[152:155], v[220:223]
  ds_read_b64_tr_b16 v[206:207], v242 offset:58368
  v_mfma_f32_16x16x32_bf16 v[220:223], a[236:239], v[156:159], v[220:223]
  buffer_load_dwordx4 v[92:95], v2, s[16:19], s51 offen offset:1024 sc1
  s_waitcnt lgkmcnt(15)
  v_mfma_f32_16x16x32_bf16 v[224:227], a[32:35], v[160:163], v[224:227]
  ds_read_b64_tr_b16 v[144:145], v245 offset:0
  v_cvt_pk_bf16_f32 v96, v96, v97
  v_mfma_f32_16x16x32_bf16 v[224:227], a[36:39], v[164:167], v[224:227]
  v_mfma_f32_16x16x32_bf16 v[224:227], a[40:43], v[168:171], v[224:227]
  ds_read_b64_tr_b16 v[146:147], v245 offset:1024
  v_cvt_pk_bf16_f32 v97, v98, v99
  v_mfma_f32_16x16x32_bf16 v[224:227], a[44:47], v[172:175], v[224:227]
  v_mfma_f32_16x16x32_bf16 v[228:231], a[96:99], v[160:163], v[228:231]
  ds_read_b64_tr_b16 v[148:149], v245 offset:8192
  v_cvt_pk_bf16_f32 v98, v100, v101
  v_mfma_f32_16x16x32_bf16 v[228:231], a[100:103], v[164:167], v[228:231]
  v_mfma_f32_16x16x32_bf16 v[228:231], a[104:107], v[168:171], v[228:231]
  ds_read_b64_tr_b16 v[150:151], v245 offset:9216
  v_cvt_pk_bf16_f32 v99, v102, v103
  v_mfma_f32_16x16x32_bf16 v[228:231], a[108:111], v[172:175], v[228:231]
  v_mfma_f32_16x16x32_bf16 v[232:235], a[160:163], v[160:163], v[232:235]
  ds_read_b64_tr_b16 v[152:153], v245 offset:16384
  v_mfma_f32_16x16x32_bf16 v[232:235], a[164:167], v[164:167], v[232:235]
  v_mfma_f32_16x16x32_bf16 v[232:235], a[168:171], v[168:171], v[232:235]
  ds_read_b64_tr_b16 v[154:155], v245 offset:17408
  v_mfma_f32_16x16x32_bf16 v[232:235], a[172:175], v[172:175], v[232:235]
  s_add_u32 s47, s46, 16384
  buffer_store_dwordx4 v[96:99], v2, s[16:19], s47 offen offset:3072
  v_mfma_f32_16x16x32_bf16 v[236:239], a[224:227], v[160:163], v[236:239]
  ds_read_b64_tr_b16 v[156:157], v245 offset:24576
  v_mfma_f32_16x16x32_bf16 v[236:239], a[228:231], v[164:167], v[236:239]
  v_mfma_f32_16x16x32_bf16 v[236:239], a[232:235], v[168:171], v[236:239]
  ds_read_b64_tr_b16 v[158:159], v245 offset:25600
  v_mfma_f32_16x16x32_bf16 v[236:239], a[236:239], v[172:175], v[236:239]
  s_waitcnt lgkmcnt(15)
  v_mfma_f32_16x16x32_bf16 v[208:211], a[48:51], v[176:179], v[208:211]
  ds_read_b64_tr_b16 v[160:161], v247 offset:0
  v_mfma_f32_16x16x32_bf16 v[208:211], a[52:55], v[180:183], v[208:211]
  v_mfma_f32_16x16x32_bf16 v[208:211], a[56:59], v[184:187], v[208:211]
  s_add_u32 s50, s44, 0
  s_add_u32 m0, s41, 138240
  ds_read_b64_tr_b16 v[162:163], v247 offset:1024
  v_mfma_f32_16x16x32_bf16 v[208:211], a[60:63], v[188:191], v[208:211]
  buffer_load_dwordx4 v4, s[20:23], s50 offen lds
  v_mfma_f32_16x16x32_bf16 v[212:215], a[112:115], v[176:179], v[212:215]
  ds_read_b64_tr_b16 v[164:165], v247 offset:8192
  v_mfma_f32_16x16x32_bf16 v[212:215], a[116:119], v[180:183], v[212:215]
  v_mfma_f32_16x16x32_bf16 v[212:215], a[120:123], v[184:187], v[212:215]
  ds_read_b64_tr_b16 v[166:167], v247 offset:9216
  v_mfma_f32_16x16x32_bf16 v[212:215], a[124:127], v[188:191], v[212:215]
  v_mfma_f32_16x16x32_bf16 v[216:219], a[176:179], v[176:179], v[216:219]
  ds_read_b64_tr_b16 v[168:169], v247 offset:16384
  v_mfma_f32_16x16x32_bf16 v[216:219], a[180:183], v[180:183], v[216:219]
  buffer_load_dwordx4 v5, s[20:23], s50 offen offset:1024 lds
  v_mfma_f32_16x16x32_bf16 v[216:219], a[184:187], v[184:187], v[216:219]
  ds_read_b64_tr_b16 v[170:171], v247 offset:17408
  v_mfma_f32_16x16x32_bf16 v[216:219], a[188:191], v[188:191], v[216:219]
  s_add_u32 s47, s46, 12288
  buffer_store_dwordx4 v[124:127], v2, s[16:19], s47 offen offset:3072
  v_mfma_f32_16x16x32_bf16 v[220:223], a[240:243], v[176:179], v[220:223]
  ds_read_b64_tr_b16 v[172:173], v247 offset:24576
  v_mfma_f32_16x16x32_bf16 v[220:223], a[244:247], v[180:183], v[220:223]
  v_mfma_f32_16x16x32_bf16 v[220:223], a[248:251], v[184:187], v[220:223]
  ds_read_b64_tr_b16 v[174:175], v247 offset:25600
  v_mfma_f32_16x16x32_bf16 v[220:223], a[252:255], v[188:191], v[220:223]
  buffer_load_dwordx4 v6, s[20:23], s50 offen offset:2048 lds
  s_waitcnt lgkmcnt(15)
  v_mfma_f32_16x16x32_bf16 v[224:227], a[48:51], v[192:195], v[224:227]
  ds_read_b64_tr_b16 v[176:177], v245 offset:32768
  v_cvt_pk_bf16_f32 v104, v104, v105
  v_mfma_f32_16x16x32_bf16 v[224:227], a[52:55], v[196:199], v[224:227]
  v_subrev_u32 v8, 27648, v8
  v_mfma_f32_16x16x32_bf16 v[224:227], a[56:59], v[200:203], v[224:227]
  ds_read_b64_tr_b16 v[178:179], v245 offset:33792
  v_cvt_pk_bf16_f32 v105, v106, v107
  v_mfma_f32_16x16x32_bf16 v[224:227], a[60:63], v[204:207], v[224:227]
  v_subrev_u32 v9, 27648, v9
  v_mfma_f32_16x16x32_bf16 v[228:231], a[112:115], v[192:195], v[228:231]
  ds_read_b64_tr_b16 v[180:181], v245 offset:40960
  v_cvt_pk_bf16_f32 v106, v108, v109
  v_mfma_f32_16x16x32_bf16 v[228:231], a[116:119], v[196:199], v[228:231]
  buffer_load_dwordx4 v7, s[20:23], s50 offen offset:3072 lds
  v_subrev_u32 v10, 27648, v10
  v_mfma_f32_16x16x32_bf16 v[228:231], a[120:123], v[200:203], v[228:231]
  ds_read_b64_tr_b16 v[182:183], v245 offset:41984
  v_cvt_pk_bf16_f32 v107, v110, v111
  v_mfma_f32_16x16x32_bf16 v[228:231], a[124:127], v[204:207], v[228:231]
  v_subrev_u32 v11, 27648, v11
  v_mfma_f32_16x16x32_bf16 v[232:235], a[176:179], v[192:195], v[232:235]
  ds_read_b64_tr_b16 v[184:185], v244 offset:0
  v_mfma_f32_16x16x32_bf16 v[232:235], a[180:183], v[196:199], v[232:235]
  v_subrev_u32 v12, 27648, v12
  v_mfma_f32_16x16x32_bf16 v[232:235], a[184:187], v[200:203], v[232:235]
  s_add_u32 s50, s33, 0
  s_add_u32 m0, s35, 154624
  ds_read_b64_tr_b16 v[186:187], v244 offset:1024
  v_mfma_f32_16x16x32_bf16 v[232:235], a[188:191], v[204:207], v[232:235]
  s_add_u32 s47, s46, 24576
  buffer_store_dwordx4 v[104:107], v2, s[16:19], s47 offen offset:3072
  buffer_load_dwordx4 v16, s[24:27], s50 offen lds
  v_subrev_u32 v13, 27648, v13
  v_mfma_f32_16x16x32_bf16 v[236:239], a[240:243], v[192:195], v[236:239]
  ds_read_b64_tr_b16 v[188:189], v244 offset:8192
  v_mfma_f32_16x16x32_bf16 v[236:239], a[244:247], v[196:199], v[236:239]
  v_subrev_u32 v14, 27648, v14
  v_mfma_f32_16x16x32_bf16 v[236:239], a[248:251], v[200:203], v[236:239]
  ds_read_b64_tr_b16 v[190:191], v244 offset:9216
  v_mfma_f32_16x16x32_bf16 v[236:239], a[252:255], v[204:207], v[236:239]
  v_subrev_u32 v15, 27648, v15
  s_waitcnt lgkmcnt(15)
  v_mfma_f32_16x16x32_bf16 v[128:131], a[0:3], v[144:147], 0
  ds_read_b64_tr_b16 v[192:193], v247 offset:32768
  v_cvt_pk_bf16_f32 v208, v208, v209
  v_mfma_f32_16x16x32_bf16 v[128:131], a[4:7], v[148:151], v[128:131]
  buffer_load_dwordx4 v17, s[24:27], s50 offen offset:1152 lds
  v_mfma_f32_16x16x32_bf16 v[128:131], a[8:11], v[152:155], v[128:131]
  ds_read_b64_tr_b16 v[194:195], v247 offset:33792
  v_cvt_pk_bf16_f32 v209, v210, v211
  v_mfma_f32_16x16x32_bf16 v[128:131], a[12:15], v[156:159], v[128:131]
  v_mfma_f32_16x16x32_bf16 v[132:135], a[64:67], v[144:147], 0
  ds_read_b64_tr_b16 v[196:197], v247 offset:40960
  v_cvt_pk_bf16_f32 v210, v212, v213
  v_mfma_f32_16x16x32_bf16 v[132:135], a[68:71], v[148:151], v[132:135]
  v_mfma_f32_16x16x32_bf16 v[132:135], a[72:75], v[152:155], v[132:135]
  ds_read_b64_tr_b16 v[198:199], v247 offset:41984
  v_cvt_pk_bf16_f32 v211, v214, v215
  v_mfma_f32_16x16x32_bf16 v[132:135], a[76:79], v[156:159], v[132:135]
  v_mfma_f32_16x16x32_bf16 v[136:139], a[128:131], v[144:147], 0
  ds_read_b64_tr_b16 v[200:201], v246 offset:0
  v_mfma_f32_16x16x32_bf16 v[136:139], a[132:135], v[148:151], v[136:139]
  v_mfma_f32_16x16x32_bf16 v[136:139], a[136:139], v[152:155], v[136:139]
  ds_read_b64_tr_b16 v[202:203], v246 offset:1024
  v_mfma_f32_16x16x32_bf16 v[136:139], a[140:143], v[156:159], v[136:139]
  s_add_u32 s47, s46, 20480
  buffer_store_dwordx4 v[208:211], v2, s[16:19], s47 offen offset:0
  v_mfma_f32_16x16x32_bf16 v[140:143], a[192:195], v[144:147], 0
  ds_read_b64_tr_b16 v[204:205], v246 offset:8192
  v_mfma_f32_16x16x32_bf16 v[140:143], a[196:199], v[148:151], v[140:143]
  v_mfma_f32_16x16x32_bf16 v[140:143], a[200:203], v[152:155], v[140:143]
  ds_read_b64_tr_b16 v[206:207], v246 offset:9216
  v_mfma_f32_16x16x32_bf16 v[140:143], a[204:207], v[156:159], v[140:143]
  s_waitcnt lgkmcnt(15)
  v_mfma_f32_16x16x32_bf16 v[96:99], a[0:3], v[160:163], 0
  ds_read_b64_tr_b16 v[144:145], v244 offset:16384
  v_cvt_pk_bf16_f32 v216, v216, v217
  v_mfma_f32_16x16x32_bf16 v[96:99], a[4:7], v[164:167], v[96:99]
  v_mfma_f32_16x16x32_bf16 v[96:99], a[8:11], v[168:171], v[96:99]
  ds_read_b64_tr_b16 v[146:147], v244 offset:17408
  v_cvt_pk_bf16_f32 v217, v218, v219
  v_mfma_f32_16x16x32_bf16 v[96:99], a[12:15], v[172:175], v[96:99]
  v_mfma_f32_16x16x32_bf16 v[100:103], a[64:67], v[160:163], 0
  ds_read_b64_tr_b16 v[148:149], v244 offset:24576
  v_cvt_pk_bf16_f32 v218, v220, v221
  v_mfma_f32_16x16x32_bf16 v[100:103], a[68:71], v[164:167], v[100:103]
  v_mfma_f32_16x16x32_bf16 v[100:103], a[72:75], v[168:171], v[100:103]
  ds_read_b64_tr_b16 v[150:151], v244 offset:25600
  v_cvt_pk_bf16_f32 v219, v222, v223
  v_mfma_f32_16x16x32_bf16 v[100:103], a[76:79], v[172:175], v[100:103]
  v_mfma_f32_16x16x32_bf16 v[104:107], a[128:131], v[160:163], 0
  ds_read_b64_tr_b16 v[152:153], v245 offset:49152
  v_mfma_f32_16x16x32_bf16 v[104:107], a[132:135], v[164:167], v[104:107]
  v_mfma_f32_16x16x32_bf16 v[104:107], a[136:139], v[168:171], v[104:107]
  ds_read_b64_tr_b16 v[154:155], v245 offset:50176
  v_mfma_f32_16x16x32_bf16 v[104:107], a[140:143], v[172:175], v[104:107]
  s_add_u32 s47, s46, 28672
  buffer_store_dwordx4 v[216:219], v2, s[16:19], s47 offen offset:0
  v_mfma_f32_16x16x32_bf16 v[108:111], a[192:195], v[160:163], 0
  ds_read_b64_tr_b16 v[156:157], v245 offset:57344
  v_mfma_f32_16x16x32_bf16 v[108:111], a[196:199], v[164:167], v[108:111]
  v_mfma_f32_16x16x32_bf16 v[108:111], a[200:203], v[168:171], v[108:111]
  ds_read_b64_tr_b16 v[158:159], v245 offset:58368
  v_mfma_f32_16x16x32_bf16 v[108:111], a[204:207], v[172:175], v[108:111]
  s_waitcnt lgkmcnt(15)
  v_mfma_f32_16x16x32_bf16 v[128:131], a[16:19], v[176:179], v[128:131]
  ds_read_b64_tr_b16 v[160:161], v246 offset:16384
  v_cvt_pk_bf16_f32 v224, v224, v225
  v_mfma_f32_16x16x32_bf16 v[128:131], a[20:23], v[180:183], v[128:131]
  v_mfma_f32_16x16x32_bf16 v[128:131], a[24:27], v[184:187], v[128:131]
  ds_read_b64_tr_b16 v[162:163], v246 offset:17408
  v_cvt_pk_bf16_f32 v225, v226, v227
  v_mfma_f32_16x16x32_bf16 v[128:131], a[28:31], v[188:191], v[128:131]
  v_mfma_f32_16x16x32_bf16 v[132:135], a[80:83], v[176:179], v[132:135]
  ds_read_b64_tr_b16 v[164:165], v246 offset:24576
  v_cvt_pk_bf16_f32 v226, v228, v229
  v_mfma_f32_16x16x32_bf16 v[132:135], a[84:87], v[180:183], v[132:135]
  v_mfma_f32_16x16x32_bf16 v[132:135], a[88:91], v[184:187], v[132:135]
  ds_read_b64_tr_b16 v[166:167], v246 offset:25600
  v_cvt_pk_bf16_f32 v227, v230, v231
  v_mfma_f32_16x16x32_bf16 v[132:135], a[92:95], v[188:191], v[132:135]
  v_mfma_f32_16x16x32_bf16 v[136:139], a[144:147], v[176:179], v[136:139]
  ds_read_b64_tr_b16 v[168:169], v247 offset:49152
  v_mfma_f32_16x16x32_bf16 v[136:139], a[148:151], v[180:183], v[136:139]
  v_mfma_f32_16x16x32_bf16 v[136:139], a[152:155], v[184:187], v[136:139]
  ds_read_b64_tr_b16 v[170:171], v247 offset:50176
  v_mfma_f32_16x16x32_bf16 v[136:139], a[156:159], v[188:191], v[136:139]
  s_add_u32 s47, s46, 20480
  buffer_store_dwordx4 v[224:227], v2, s[16:19], s47 offen offset:1024
  v_mfma_f32_16x16x32_bf16 v[140:143], a[208:211], v[176:179], v[140:143]
  ds_read_b64_tr_b16 v[172:173], v247 offset:57344
  v_mfma_f32_16x16x32_bf16 v[140:143], a[212:215], v[180:183], v[140:143]
  v_mfma_f32_16x16x32_bf16 v[140:143], a[216:219], v[184:187], v[140:143]
  ds_read_b64_tr_b16 v[174:175], v247 offset:58368
  v_mfma_f32_16x16x32_bf16 v[140:143], a[220:223], v[188:191], v[140:143]
  s_waitcnt lgkmcnt(15)
  v_mfma_f32_16x16x32_bf16 v[96:99], a[16:19], v[192:195], v[96:99]
  s_waitcnt vmcnt(12)
  ds_read_b64_tr_b16 v[176:177], v244 offset:32768
  v_cvt_pk_bf16_f32 v232, v232, v233
  v_mfma_f32_16x16x32_bf16 v[96:99], a[20:23], v[196:199], v[96:99]
  v_accvgpr_write_b32 a0, v64
  v_accvgpr_write_b32 a1, v65
  v_mfma_f32_16x16x32_bf16 v[96:99], a[24:27], v[200:203], v[96:99]
  ds_read_b64_tr_b16 v[178:179], v244 offset:33792
  v_cvt_pk_bf16_f32 v233, v234, v235
  v_mfma_f32_16x16x32_bf16 v[96:99], a[28:31], v[204:207], v[96:99]
  v_accvgpr_write_b32 a2, v66
  v_accvgpr_write_b32 a3, v67
  v_mfma_f32_16x16x32_bf16 v[100:103], a[80:83], v[192:195], v[100:103]
  ds_read_b64_tr_b16 v[180:181], v244 offset:40960
  v_cvt_pk_bf16_f32 v234, v236, v237
  v_mfma_f32_16x16x32_bf16 v[100:103], a[84:87], v[196:199], v[100:103]
  v_accvgpr_write_b32 a4, v68
  v_accvgpr_write_b32 a5, v69
  v_mfma_f32_16x16x32_bf16 v[100:103], a[88:91], v[200:203], v[100:103]
  ds_read_b64_tr_b16 v[182:183], v244 offset:41984
  v_cvt_pk_bf16_f32 v235, v238, v239
  v_mfma_f32_16x16x32_bf16 v[100:103], a[92:95], v[204:207], v[100:103]
  v_accvgpr_write_b32 a6, v70
  v_accvgpr_write_b32 a7, v71
  v_mfma_f32_16x16x32_bf16 v[104:107], a[144:147], v[192:195], v[104:107]
  ds_read_b64_tr_b16 v[184:185], v244 offset:49152
  v_mfma_f32_16x16x32_bf16 v[104:107], a[148:151], v[196:199], v[104:107]
  v_accvgpr_write_b32 a64, v72
  v_accvgpr_write_b32 a65, v73
  v_mfma_f32_16x16x32_bf16 v[104:107], a[152:155], v[200:203], v[104:107]
  ds_read_b64_tr_b16 v[186:187], v244 offset:50176
  v_mfma_f32_16x16x32_bf16 v[104:107], a[156:159], v[204:207], v[104:107]
  s_add_u32 s47, s46, 28672
  buffer_store_dwordx4 v[232:235], v2, s[16:19], s47 offen offset:1024
  v_accvgpr_write_b32 a66, v74
  v_accvgpr_write_b32 a67, v75
  v_mfma_f32_16x16x32_bf16 v[108:111], a[208:211], v[192:195], v[108:111]
  ds_read_b64_tr_b16 v[188:189], v244 offset:57344
  v_mfma_f32_16x16x32_bf16 v[108:111], a[212:215], v[196:199], v[108:111]
  v_accvgpr_write_b32 a68, v76
  v_accvgpr_write_b32 a69, v77
  v_mfma_f32_16x16x32_bf16 v[108:111], a[216:219], v[200:203], v[108:111]
  ds_read_b64_tr_b16 v[190:191], v244 offset:58368
  v_mfma_f32_16x16x32_bf16 v[108:111], a[220:223], v[204:207], v[108:111]
  v_accvgpr_write_b32 a70, v78
  v_accvgpr_write_b32 a71, v79
  s_waitcnt lgkmcnt(15)
  s_waitcnt vmcnt(4)
  s_barrier
  v_mfma_f32_16x16x32_bf16 v[128:131], a[32:35], v[144:147], v[128:131]
  ds_read_b64_tr_b16 v[192:193], v246 offset:32768
  v_mfma_f32_16x16x32_bf16 v[128:131], a[36:39], v[148:151], v[128:131]
  v_accvgpr_write_b32 a128, v48
  v_accvgpr_write_b32 a129, v49
  v_mfma_f32_16x16x32_bf16 v[128:131], a[40:43], v[152:155], v[128:131]
  s_add_u32 s50, s44, 524288
  s_add_u32 m0, s41, 87040
  ds_read_b64_tr_b16 v[194:195], v246 offset:33792
  v_mfma_f32_16x16x32_bf16 v[128:131], a[44:47], v[156:159], v[128:131]
  v_accvgpr_write_b32 a130, v50
  v_accvgpr_write_b32 a131, v51
  buffer_load_dwordx4 v4, s[20:23], s50 offen lds
  v_mfma_f32_16x16x32_bf16 v[132:135], a[96:99], v[144:147], v[132:135]
  ds_read_b64_tr_b16 v[196:197], v246 offset:40960
  v_mfma_f32_16x16x32_bf16 v[132:135], a[100:103], v[148:151], v[132:135]
  v_accvgpr_write_b32 a132, v52
  v_accvgpr_write_b32 a133, v53
  v_mfma_f32_16x16x32_bf16 v[132:135], a[104:107], v[152:155], v[132:135]
  ds_read_b64_tr_b16 v[198:199], v246 offset:41984
  v_mfma_f32_16x16x32_bf16 v[132:135], a[108:111], v[156:159], v[132:135]
  v_accvgpr_write_b32 a134, v54
  v_accvgpr_write_b32 a135, v55
  buffer_load_dwordx4 v5, s[20:23], s50 offen offset:1024 lds
  v_mfma_f32_16x16x32_bf16 v[136:139], a[160:163], v[144:147], v[136:139]
  ds_read_b64_tr_b16 v[200:201], v246 offset:49152
  v_mfma_f32_16x16x32_bf16 v[136:139], a[164:167], v[148:151], v[136:139]
  v_accvgpr_write_b32 a192, v56
  v_accvgpr_write_b32 a193, v57
  v_mfma_f32_16x16x32_bf16 v[136:139], a[168:171], v[152:155], v[136:139]
  ds_read_b64_tr_b16 v[202:203], v246 offset:50176
  v_mfma_f32_16x16x32_bf16 v[136:139], a[172:175], v[156:159], v[136:139]
  v_accvgpr_write_b32 a194, v58
  v_accvgpr_write_b32 a195, v59
  buffer_load_dwordx4 v6, s[20:23], s50 offen offset:2048 lds
  v_mfma_f32_16x16x32_bf16 v[140:143], a[224:227], v[144:147], v[140:143]
  ds_read_b64_tr_b16 v[204:205], v246 offset:57344
  v_mfma_f32_16x16x32_bf16 v[140:143], a[228:231], v[148:151], v[140:143]
  v_accvgpr_write_b32 a196, v60
  v_accvgpr_write_b32 a197, v61
  v_mfma_f32_16x16x32_bf16 v[140:143], a[232:235], v[152:155], v[140:143]
  ds_read_b64_tr_b16 v[206:207], v246 offset:58368
  v_mfma_f32_16x16x32_bf16 v[140:143], a[236:239], v[156:159], v[140:143]
  v_accvgpr_write_b32 a198, v62
  v_accvgpr_write_b32 a199, v63
  buffer_load_dwordx4 v7, s[20:23], s50 offen offset:3072 lds
  s_waitcnt lgkmcnt(15)
  v_mfma_f32_16x16x32_bf16 v[96:99], a[32:35], v[160:163], v[96:99]
  ds_read_b64_tr_b16 v[208:209], v8 offset:51200
  v_mfma_f32_16x16x32_bf16 v[96:99], a[36:39], v[164:167], v[96:99]
  v_accvgpr_write_b32 a8, v32
  v_accvgpr_write_b32 a9, v33
  v_mfma_f32_16x16x32_bf16 v[96:99], a[40:43], v[168:171], v[96:99]
  s_add_u32 s50, s33, 176128
  s_add_u32 m0, s35, 103424
  ds_read_b64_tr_b16 v[210:211], v8 offset:52224
  v_mfma_f32_16x16x32_bf16 v[96:99], a[44:47], v[172:175], v[96:99]
  v_accvgpr_write_b32 a10, v34
  v_accvgpr_write_b32 a11, v35
  buffer_load_dwordx4 v16, s[24:27], s50 offen lds
  v_mfma_f32_16x16x32_bf16 v[100:103], a[96:99], v[160:163], v[100:103]
  ds_read_b64_tr_b16 v[212:213], v8 offset:59392
  v_mfma_f32_16x16x32_bf16 v[100:103], a[100:103], v[164:167], v[100:103]
  v_accvgpr_write_b32 a12, v36
  v_accvgpr_write_b32 a13, v37
  v_mfma_f32_16x16x32_bf16 v[100:103], a[104:107], v[168:171], v[100:103]
  ds_read_b64_tr_b16 v[214:215], v8 offset:60416
  v_mfma_f32_16x16x32_bf16 v[100:103], a[108:111], v[172:175], v[100:103]
  v_accvgpr_write_b32 a14, v38
  v_accvgpr_write_b32 a15, v39
  buffer_load_dwordx4 v17, s[24:27], s50 offen offset:1152 lds
  v_mfma_f32_16x16x32_bf16 v[104:107], a[160:163], v[160:163], v[104:107]
  ds_read_b64_tr_b16 v[216:217], v9 offset:51200
  v_mfma_f32_16x16x32_bf16 v[104:107], a[164:167], v[164:167], v[104:107]
  v_accvgpr_write_b32 a72, v40
  v_accvgpr_write_b32 a73, v41
  v_mfma_f32_16x16x32_bf16 v[104:107], a[168:171], v[168:171], v[104:107]
  ds_read_b64_tr_b16 v[218:219], v9 offset:52224
  v_mfma_f32_16x16x32_bf16 v[104:107], a[172:175], v[172:175], v[104:107]
  v_accvgpr_write_b32 a74, v42
  v_accvgpr_write_b32 a75, v43
  v_mfma_f32_16x16x32_bf16 v[108:111], a[224:227], v[160:163], v[108:111]
  ds_read_b64_tr_b16 v[220:221], v9 offset:59392
  v_mfma_f32_16x16x32_bf16 v[108:111], a[228:231], v[164:167], v[108:111]
  v_accvgpr_write_b32 a76, v44
  v_accvgpr_write_b32 a77, v45
  v_mfma_f32_16x16x32_bf16 v[108:111], a[232:235], v[168:171], v[108:111]
  ds_read_b64_tr_b16 v[222:223], v9 offset:60416
  v_mfma_f32_16x16x32_bf16 v[108:111], a[236:239], v[172:175], v[108:111]
  v_accvgpr_write_b32 a78, v46
  v_accvgpr_write_b32 a79, v47
  s_waitcnt lgkmcnt(15)
  v_mfma_f32_16x16x32_bf16 v[128:131], a[48:51], v[176:179], v[128:131]
  s_add_u32 s51, s34, 4096
  ds_read_b64_tr_b16 v[224:225], v10 offset:51200
  v_mfma_f32_16x16x32_bf16 v[128:131], a[52:55], v[180:183], v[128:131]
  v_accvgpr_write_b32 a136, v80
  v_accvgpr_write_b32 a137, v81
  buffer_load_dwordx4 a[16:19], v2, s[16:19], s51 offen offset:0 sc1
  v_mfma_f32_16x16x32_bf16 v[128:131], a[56:59], v[184:187], v[128:131]
  ds_read_b64_tr_b16 v[226:227], v10 offset:52224
  v_mfma_f32_16x16x32_bf16 v[128:131], a[60:63], v[188:191], v[128:131]
  v_accvgpr_write_b32 a138, v82
  v_accvgpr_write_b32 a139, v83
  v_mfma_f32_16x16x32_bf16 v[132:135], a[112:115], v[176:179], v[132:135]
  ds_read_b64_tr_b16 v[228:229], v10 offset:59392
  v_mfma_f32_16x16x32_bf16 v[132:135], a[116:119], v[180:183], v[132:135]
  v_accvgpr_write_b32 a140, v84
  v_accvgpr_write_b32 a141, v85
  buffer_load_dwordx4 a[20:23], v2, s[16:19], s51 offen offset:1024 sc1
  v_mfma_f32_16x16x32_bf16 v[132:135], a[120:123], v[184:187], v[132:135]
  ds_read_b64_tr_b16 v[230:231], v10 offset:60416
  v_mfma_f32_16x16x32_bf16 v[132:135], a[124:127], v[188:191], v[132:135]
  v_accvgpr_write_b32 a142, v86
  v_accvgpr_write_b32 a143, v87
  v_mfma_f32_16x16x32_bf16 v[136:139], a[176:179], v[176:179], v[136:139]
  s_add_u32 s51, s51, 16384
  ds_read_b64_tr_b16 v[232:233], v11 offset:51200
  v_mfma_f32_16x16x32_bf16 v[136:139], a[180:183], v[180:183], v[136:139]
  v_accvgpr_write_b32 a200, v88
  v_accvgpr_write_b32 a201, v89
  buffer_load_dwordx4 a[80:83], v2, s[16:19], s51 offen offset:0 sc1
  v_mfma_f32_16x16x32_bf16 v[136:139], a[184:187], v[184:187], v[136:139]
  ds_read_b64_tr_b16 v[234:235], v11 offset:52224
  v_mfma_f32_16x16x32_bf16 v[136:139], a[188:191], v[188:191], v[136:139]
  v_accvgpr_write_b32 a202, v90
  v_accvgpr_write_b32 a203, v91
  v_mfma_f32_16x16x32_bf16 v[140:143], a[240:243], v[176:179], v[140:143]
  ds_read_b64_tr_b16 v[236:237], v11 offset:59392
  v_mfma_f32_16x16x32_bf16 v[140:143], a[244:247], v[180:183], v[140:143]
  v_accvgpr_write_b32 a204, v92
  v_accvgpr_write_b32 a205, v93
  buffer_load_dwordx4 a[84:87], v2, s[16:19], s51 offen offset:1024 sc1
  v_mfma_f32_16x16x32_bf16 v[140:143], a[248:251], v[184:187], v[140:143]
  ds_read_b64_tr_b16 v[238:239], v11 offset:60416
  v_mfma_f32_16x16x32_bf16 v[140:143], a[252:255], v[188:191], v[140:143]
  v_accvgpr_write_b32 a206, v94
  v_accvgpr_write_b32 a207, v95
  s_waitcnt lgkmcnt(15)
  v_mfma_f32_16x16x32_bf16 v[96:99], a[48:51], v[192:195], v[96:99]
  s_add_u32 s51, s51, 16384
  ds_read_b64_tr_b16 v[240:241], v12 offset:51200
  v_mfma_f32_16x16x32_bf16 v[96:99], a[52:55], v[196:199], v[96:99]
  buffer_load_dwordx4 a[144:147], v2, s[16:19], s51 offen offset:0 sc1
  v_mfma_f32_16x16x32_bf16 v[96:99], a[56:59], v[200:203], v[96:99]
  ds_read_b64_tr_b16 v[242:243], v12 offset:52224
  v_mfma_f32_16x16x32_bf16 v[96:99], a[60:63], v[204:207], v[96:99]
  v_mfma_f32_16x16x32_bf16 v[100:103], a[112:115], v[192:195], v[100:103]
  ds_read_b64_tr_b16 v[244:245], v12 offset:59392
  v_mfma_f32_16x16x32_bf16 v[100:103], a[116:119], v[196:199], v[100:103]
  buffer_load_dwordx4 a[148:151], v2, s[16:19], s51 offen offset:1024 sc1
  v_mfma_f32_16x16x32_bf16 v[100:103], a[120:123], v[200:203], v[100:103]
  ds_read_b64_tr_b16 v[246:247], v12 offset:60416
  v_mfma_f32_16x16x32_bf16 v[100:103], a[124:127], v[204:207], v[100:103]
  v_mfma_f32_16x16x32_bf16 v[104:107], a[176:179], v[192:195], v[104:107]
  s_add_u32 s51, s51, 16384
  v_mfma_f32_16x16x32_bf16 v[104:107], a[180:183], v[196:199], v[104:107]
  buffer_load_dwordx4 a[208:211], v2, s[16:19], s51 offen offset:0 sc1
  v_mfma_f32_16x16x32_bf16 v[104:107], a[184:187], v[200:203], v[104:107]
  v_mfma_f32_16x16x32_bf16 v[104:107], a[188:191], v[204:207], v[104:107]
  v_mfma_f32_16x16x32_bf16 v[108:111], a[240:243], v[192:195], v[108:111]
  v_mfma_f32_16x16x32_bf16 v[108:111], a[244:247], v[196:199], v[108:111]
  buffer_load_dwordx4 a[212:215], v2, s[16:19], s51 offen offset:1024 sc1
  v_mfma_f32_16x16x32_bf16 v[108:111], a[248:251], v[200:203], v[108:111]
  v_mfma_f32_16x16x32_bf16 v[108:111], a[252:255], v[204:207], v[108:111]
  s_barrier
L_qgemm:
  s_and_b32 s50, s2, 31
  s_lshl_b32 s50, s50, 9
  s_add_u32 s50, s50, 96468992
  v_bfe_u32 v3, v1, 2, 3
  v_lshlrev_b32 v3, 14, v3
  v_and_b32 v19, 3, v1
  v_lshl_add_u32 v3, v19, 7, v3
  v_add_u32 v3, s50, v3
  buffer_load_dword v19, v3, s[16:19], 0 offen sc1
  s_waitcnt lgkmcnt(15)
  v_mfma_f32_16x16x32_bf16 v[32:35], v[208:211], a[0:3], 0
  s_add_u32 s50, s44, 1048576
  s_add_u32 m0, s41, 61440
  ds_read_b64_tr_b16 v[248:249], v13 offset:51200
  v_mfma_f32_16x16x32_bf16 v[32:35], v[212:215], a[4:7], v[32:35]
  buffer_load_dwordx4 v4, s[20:23], s50 offen lds
  v_mfma_f32_16x16x32_bf16 v[36:39], v[208:211], a[64:67], 0
  ds_read_b64_tr_b16 v[250:251], v13 offset:52224
  v_mfma_f32_16x16x32_bf16 v[36:39], v[212:215], a[68:71], v[36:39]
  v_mfma_f32_16x16x32_bf16 v[40:43], v[208:211], a[128:131], 0
  ds_read_b64_tr_b16 v[252:253], v13 offset:59392
  v_mfma_f32_16x16x32_bf16 v[40:43], v[212:215], a[132:135], v[40:43]
  v_mfma_f32_16x16x32_bf16 v[44:47], v[208:211], a[192:195], 0
  ds_read_b64_tr_b16 v[254:255], v13 offset:60416
  v_mfma_f32_16x16x32_bf16 v[44:47], v[212:215], a[196:199], v[44:47]
  buffer_load_dwordx4 v5, s[20:23], s50 offen offset:1024 lds
  s_waitcnt lgkmcnt(15)
  v_mfma_f32_16x16x32_bf16 v[48:51], v[216:219], a[0:3], 0
  ds_read_b64_tr_b16 v[208:209], v14 offset:51200
  v_cvt_pk_bf16_f32 v96, v96, v97
  v_mfma_f32_16x16x32_bf16 v[48:51], v[220:223], a[4:7], v[48:51]
  v_mfma_f32_16x16x32_bf16 v[52:55], v[216:219], a[64:67], 0
  ds_read_b64_tr_b16 v[210:211], v14 offset:52224
  v_cvt_pk_bf16_f32 v97, v98, v99
  v_mfma_f32_16x16x32_bf16 v[52:55], v[220:223], a[68:71], v[52:55]
  v_mfma_f32_16x16x32_bf16 v[56:59], v[216:219], a[128:131], 0
  ds_read_b64_tr_b16 v[212:213], v14 offset:59392
  v_cvt_pk_bf16_f32 v98, v100, v101
  v_mfma_f32_16x16x32_bf16 v[56:59], v[220:223], a[132:135], v[56:59]
  buffer_load_dwordx4 v6, s[20:23], s50 offen offset:2048 lds
  v_mfma_f32_16x16x32_bf16 v[60:63], v[216:219], a[192:195], 0
  ds_read_b64_tr_b16 v[214:215], v14 offset:60416
  v_cvt_pk_bf16_f32 v99, v102, v103
  v_mfma_f32_16x16x32_bf16 v[60:63], v[220:223], a[196:199], v[60:63]
  s_add_u32 s47, s46, 20480
  buffer_store_dwordx4 v[96:99], v2, s[16:19], s47 offen offset:3072
  s_waitcnt lgkmcnt(15)
  v_mfma_f32_16x16x32_bf16 v[64:67], v[224:227], a[0:3], 0
  ds_read_b64_tr_b16 v[216:217], v15 offset:51200
  v_cvt_pk_bf16_f32 v104, v104, v105
  v_mfma_f32_16x16x32_bf16 v[64:67], v[228:231], a[4:7], v[64:67]
  v_mfma_f32_16x16x32_bf16 v[68:71], v[224:227], a[64:67], 0
  ds_read_b64_tr_b16 v[218:219], v15 offset:52224
  v_cvt_pk_bf16_f32 v105, v106, v107
  v_mfma_f32_16x16x32_bf16 v[68:71], v[228:231], a[68:71], v[68:71]
  buffer_load_dwordx4 v7, s[20:23], s50 offen offset:3072 lds
  v_mfma_f32_16x16x32_bf16 v[72:75], v[224:227], a[128:131], 0
  ds_read_b64_tr_b16 v[220:221], v15 offset:59392
  v_cvt_pk_bf16_f32 v106, v108, v109
  v_mfma_f32_16x16x32_bf16 v[72:75], v[228:231], a[132:135], v[72:75]
  v_mfma_f32_16x16x32_bf16 v[76:79], v[224:227], a[192:195], 0
  ds_read_b64_tr_b16 v[222:223], v15 offset:60416
  v_cvt_pk_bf16_f32 v107, v110, v111
  v_mfma_f32_16x16x32_bf16 v[76:79], v[228:231], a[196:199], v[76:79]
  s_add_u32 s47, s46, 28672
  buffer_store_dwordx4 v[104:107], v2, s[16:19], s47 offen offset:3072
  s_waitcnt lgkmcnt(15)
  v_mfma_f32_16x16x32_bf16 v[80:83], v[232:235], a[0:3], 0
  s_add_u32 s50, s33, 352256
  s_add_u32 m0, s35, 77824
  ds_read_b64_tr_b16 v[224:225], v18 offset:51200
  v_mfma_f32_16x16x32_bf16 v[80:83], v[236:239], a[4:7], v[80:83]
  buffer_load_dwordx4 v16, s[24:27], s50 offen lds
  v_mfma_f32_16x16x32_bf16 v[84:87], v[232:235], a[64:67], 0
  ds_read_b64_tr_b16 v[226:227], v18 offset:51584
  v_mfma_f32_16x16x32_bf16 v[84:87], v[236:239], a[68:71], v[84:87]
  v_mfma_f32_16x16x32_bf16 v[88:91], v[232:235], a[128:131], 0
  ds_read_b64_tr_b16 v[228:229], v18 offset:55808
  v_mfma_f32_16x16x32_bf16 v[88:91], v[236:239], a[132:135], v[88:91]
  v_mfma_f32_16x16x32_bf16 v[92:95], v[232:235], a[192:195], 0
  ds_read_b64_tr_b16 v[230:231], v18 offset:56192
  v_mfma_f32_16x16x32_bf16 v[92:95], v[236:239], a[196:199], v[92:95]
  buffer_load_dwordx4 v17, s[24:27], s50 offen offset:1152 lds
  s_waitcnt lgkmcnt(15)
  v_mfma_f32_16x16x32_bf16 v[96:99], v[240:243], a[0:3], 0
  ds_read_b64_tr_b16 v[232:233], v18 offset:51232
  v_cvt_pk_bf16_f32 v128, v128, v129
  v_mfma_f32_16x16x32_bf16 v[96:99], v[244:247], a[4:7], v[96:99]
  v_mfma_f32_16x16x32_bf16 v[100:103], v[240:243], a[64:67], 0
  ds_read_b64_tr_b16 v[234:235], v18 offset:51616
  v_cvt_pk_bf16_f32 v129, v130, v131
  v_mfma_f32_16x16x32_bf16 v[100:103], v[244:247], a[68:71], v[100:103]
  v_mfma_f32_16x16x32_bf16 v[104:107], v[240:243], a[128:131], 0
  s_add_u32 s51, s34, 6144
  ds_read_b64_tr_b16 v[236:237], v18 offset:55840
  v_cvt_pk_bf16_f32 v130, v132, v133
  v_mfma_f32_16x16x32_bf16 v[104:107], v[244:247], a[132:135], v[104:107]
  buffer_load_dwordx4 a[24:27], v2, s[16:19], s51 offen offset:0 sc1
  v_mfma_f32_16x16x32_bf16 v[108:111], v[240:243], a[192:195], 0
  ds_read_b64_tr_b16 v[238:239], v18 offset:56224
  v_cvt_pk_bf16_f32 v131, v134, v135
  v_mfma_f32_16x16x32_bf16 v[108:111], v[244:247], a[196:199], v[108:111]
  s_add_u32 s47, s46, 20480
  buffer_store_dwordx4 v[128:131], v2, s[16:19], s47 offen offset:2048
  s_waitcnt lgkmcnt(15)
  v_mfma_f32_16x16x32_bf16 v[112:115], v[248:251], a[0:3], 0
  ds_read_b64_tr_b16 v[240:241], v18 offset:51264
  v_cvt_pk_bf16_f32 v136, v136, v137
  v_mfma_f32_16x16x32_bf16 v[112:115], v[252:255], a[4:7], v[112:115]
  v_mfma_f32_16x16x32_bf16 v[116:119], v[248:251], a[64:67], 0
  ds_read_b64_tr_b16 v[242:243], v18 offset:51648
  v_cvt_pk_bf16_f32 v137, v138, v139
  v_mfma_f32_16x16x32_bf16 v[116:119], v[252:255], a[68:71], v[116:119]
  buffer_load_dwordx4 a[28:31], v2, s[16:19], s51 offen offset:1024 sc1
  v_mfma_f32_16x16x32_bf16 v[120:123], v[248:251], a[128:131], 0
  ds_read_b64_tr_b16 v[244:245], v18 offset:55872
  v_cvt_pk_bf16_f32 v138, v140, v141
  v_mfma_f32_16x16x32_bf16 v[120:123], v[252:255], a[132:135], v[120:123]
  v_mfma_f32_16x16x32_bf16 v[124:127], v[248:251], a[192:195], 0
  ds_read_b64_tr_b16 v[246:247], v18 offset:56256
  v_cvt_pk_bf16_f32 v139, v142, v143
  v_mfma_f32_16x16x32_bf16 v[124:127], v[252:255], a[196:199], v[124:127]
  s_add_u32 s47, s46, 28672
  buffer_store_dwordx4 v[136:139], v2, s[16:19], s47 offen offset:2048
  s_waitcnt lgkmcnt(15)
  s_waitcnt vmcnt(21)
  s_barrier
  v_mfma_f32_16x16x32_bf16 v[128:131], v[208:211], a[0:3], 0
  s_add_u32 s51, s51, 16384
  ds_read_b64_tr_b16 v[248:249], v8 offset:0
  v_mfma_f32_16x16x32_bf16 v[128:131], v[212:215], a[4:7], v[128:131]
  buffer_load_dwordx4 a[88:91], v2, s[16:19], s51 offen offset:0 sc1
  v_mfma_f32_16x16x32_bf16 v[132:135], v[208:211], a[64:67], 0
  ds_read_b64_tr_b16 v[250:251], v8 offset:1024
  v_mfma_f32_16x16x32_bf16 v[132:135], v[212:215], a[68:71], v[132:135]
  v_mfma_f32_16x16x32_bf16 v[136:139], v[208:211], a[128:131], 0
  ds_read_b64_tr_b16 v[252:253], v8 offset:8192
  v_mfma_f32_16x16x32_bf16 v[136:139], v[212:215], a[132:135], v[136:139]
  v_mfma_f32_16x16x32_bf16 v[140:143], v[208:211], a[192:195], 0
  ds_read_b64_tr_b16 v[254:255], v8 offset:9216
  v_mfma_f32_16x16x32_bf16 v[140:143], v[212:215], a[196:199], v[140:143]
  buffer_load_dwordx4 a[92:95], v2, s[16:19], s51 offen offset:1024 sc1
  s_waitcnt lgkmcnt(15)
  v_mfma_f32_16x16x32_bf16 v[144:147], v[216:219], a[0:3], 0
  ds_read_b64_tr_b16 v[208:209], v9 offset:0
  v_mfma_f32_16x16x32_bf16 v[144:147], v[220:223], a[4:7], v[144:147]
  v_mfma_f32_16x16x32_bf16 v[148:151], v[216:219], a[64:67], 0
  ds_read_b64_tr_b16 v[210:211], v9 offset:1024
  v_mfma_f32_16x16x32_bf16 v[148:151], v[220:223], a[68:71], v[148:151]
  v_mfma_f32_16x16x32_bf16 v[152:155], v[216:219], a[128:131], 0
  s_add_u32 s51, s51, 16384
  ds_read_b64_tr_b16 v[212:213], v9 offset:8192
  v_mfma_f32_16x16x32_bf16 v[152:155], v[220:223], a[132:135], v[152:155]
  buffer_load_dwordx4 a[152:155], v2, s[16:19], s51 offen offset:0 sc1
  v_mfma_f32_16x16x32_bf16 v[156:159], v[216:219], a[192:195], 0
  ds_read_b64_tr_b16 v[214:215], v9 offset:9216
  v_mfma_f32_16x16x32_bf16 v[156:159], v[220:223], a[196:199], v[156:159]
  s_waitcnt lgkmcnt(15)
  v_mfma_f32_16x16x32_bf16 v[160:163], v[224:227], a[0:3], v[20:23]
  ds_read_b64_tr_b16 v[216:217], v10 offset:0
  v_mfma_f32_16x16x32_bf16 v[160:163], v[228:231], a[4:7], v[160:163]
  v_mfma_f32_16x16x32_bf16 v[164:167], v[224:227], a[64:67], v[20:23]
  ds_read_b64_tr_b16 v[218:219], v10 offset:1024
  v_mfma_f32_16x16x32_bf16 v[164:167], v[228:231], a[68:71], v[164:167]
  buffer_load_dwordx4 a[156:159], v2, s[16:19], s51 offen offset:1024 sc1
  v_mfma_f32_16x16x32_bf16 v[168:171], v[224:227], a[128:131], v[20:23]
  ds_read_b64_tr_b16 v[220:221], v10 offset:8192
  v_mfma_f32_16x16x32_bf16 v[168:171], v[228:231], a[132:135], v[168:171]
  v_mfma_f32_16x16x32_bf16 v[172:175], v[224:227], a[192:195], v[20:23]
  ds_read_b64_tr_b16 v[222:223], v10 offset:9216
  v_mfma_f32_16x16x32_bf16 v[172:175], v[228:231], a[196:199], v[172:175]
  s_waitcnt lgkmcnt(15)
  v_mfma_f32_16x16x32_bf16 v[176:179], v[232:235], a[0:3], v[24:27]
  s_add_u32 s51, s51, 16384
  ds_read_b64_tr_b16 v[224:225], v11 offset:0
  v_mfma_f32_16x16x32_bf16 v[176:179], v[236:239], a[4:7], v[176:179]
  buffer_load_dwordx4 a[216:219], v2, s[16:19], s51 offen offset:0 sc1
  v_mfma_f32_16x16x32_bf16 v[180:183], v[232:235], a[64:67], v[24:27]
  ds_read_b64_tr_b16 v[226:227], v11 offset:1024
  v_mfma_f32_16x16x32_bf16 v[180:183], v[236:239], a[68:71], v[180:183]
  v_mfma_f32_16x16x32_bf16 v[184:187], v[232:235], a[128:131], v[24:27]
  ds_read_b64_tr_b16 v[228:229], v11 offset:8192
  v_mfma_f32_16x16x32_bf16 v[184:187], v[236:239], a[132:135], v[184:187]
  v_mfma_f32_16x16x32_bf16 v[188:191], v[232:235], a[192:195], v[24:27]
  ds_read_b64_tr_b16 v[230:231], v11 offset:9216
  v_mfma_f32_16x16x32_bf16 v[188:191], v[236:239], a[196:199], v[188:191]
  buffer_load_dwordx4 a[220:223], v2, s[16:19], s51 offen offset:1024 sc1
  s_waitcnt lgkmcnt(15)
  v_mfma_f32_16x16x32_bf16 v[192:195], v[240:243], a[0:3], v[28:31]
  ds_read_b64_tr_b16 v[232:233], v12 offset:0
  v_mfma_f32_16x16x32_bf16 v[192:195], v[244:247], a[4:7], v[192:195]
  v_mfma_f32_16x16x32_bf16 v[196:199], v[240:243], a[64:67], v[28:31]
  ds_read_b64_tr_b16 v[234:235], v12 offset:1024
  v_mfma_f32_16x16x32_bf16 v[196:199], v[244:247], a[68:71], v[196:199]
  v_mfma_f32_16x16x32_bf16 v[200:203], v[240:243], a[128:131], v[28:31]
  ds_read_b64_tr_b16 v[236:237], v12 offset:8192
  v_mfma_f32_16x16x32_bf16 v[200:203], v[244:247], a[132:135], v[200:203]
  v_mfma_f32_16x16x32_bf16 v[204:207], v[240:243], a[192:195], v[28:31]
  ds_read_b64_tr_b16 v[238:239], v12 offset:9216
  v_mfma_f32_16x16x32_bf16 v[204:207], v[244:247], a[196:199], v[204:207]
  s_waitcnt lgkmcnt(15)
  v_mfma_f32_16x16x32_bf16 v[32:35], v[248:251], a[8:11], v[32:35]
  s_add_u32 s50, s44, 1572864
  s_add_u32 m0, s41, 112640
  ds_read_b64_tr_b16 v[240:241], v13 offset:0
  v_mfma_f32_16x16x32_bf16 v[32:35], v[252:255], a[12:15], v[32:35]
  buffer_load_dwordx4 v4, s[20:23], s50 offen lds
  v_mfma_f32_16x16x32_bf16 v[36:39], v[248:251], a[72:75], v[36:39]
  ds_read_b64_tr_b16 v[242:243], v13 offset:1024
  v_mfma_f32_16x16x32_bf16 v[36:39], v[252:255], a[76:79], v[36:39]
  v_mfma_f32_16x16x32_bf16 v[40:43], v[248:251], a[136:139], v[40:43]
  ds_read_b64_tr_b16 v[244:245], v13 offset:8192
  v_mfma_f32_16x16x32_bf16 v[40:43], v[252:255], a[140:143], v[40:43]
  v_mfma_f32_16x16x32_bf16 v[44:47], v[248:251], a[200:203], v[44:47]
  ds_read_b64_tr_b16 v[246:247], v13 offset:9216
  v_mfma_f32_16x16x32_bf16 v[44:47], v[252:255], a[204:207], v[44:47]
  buffer_load_dwordx4 v5, s[20:23], s50 offen offset:1024 lds
  s_waitcnt lgkmcnt(15)
  v_mfma_f32_16x16x32_bf16 v[48:51], v[208:211], a[8:11], v[48:51]
  ds_read_b64_tr_b16 v[248:249], v14 offset:0
  v_mfma_f32_16x16x32_bf16 v[48:51], v[212:215], a[12:15], v[48:51]
  v_mfma_f32_16x16x32_bf16 v[52:55], v[208:211], a[72:75], v[52:55]
  ds_read_b64_tr_b16 v[250:251], v14 offset:1024
  v_mfma_f32_16x16x32_bf16 v[52:55], v[212:215], a[76:79], v[52:55]
  v_mfma_f32_16x16x32_bf16 v[56:59], v[208:211], a[136:139], v[56:59]
  ds_read_b64_tr_b16 v[252:253], v14 offset:8192
  v_mfma_f32_16x16x32_bf16 v[56:59], v[212:215], a[140:143], v[56:59]
  buffer_load_dwordx4 v6, s[20:23], s50 offen offset:2048 lds
  v_mfma_f32_16x16x32_bf16 v[60:63], v[208:211], a[200:203], v[60:63]
  ds_read_b64_tr_b16 v[254:255], v14 offset:9216
  v_mfma_f32_16x16x32_bf16 v[60:63], v[212:215], a[204:207], v[60:63]
  s_waitcnt lgkmcnt(15)
  v_mfma_f32_16x16x32_bf16 v[64:67], v[216:219], a[8:11], v[64:67]
  ds_read_b64_tr_b16 v[208:209], v15 offset:0
  v_mfma_f32_16x16x32_bf16 v[64:67], v[220:223], a[12:15], v[64:67]
  v_mfma_f32_16x16x32_bf16 v[68:71], v[216:219], a[72:75], v[68:71]
  ds_read_b64_tr_b16 v[210:211], v15 offset:1024
  v_mfma_f32_16x16x32_bf16 v[68:71], v[220:223], a[76:79], v[68:71]
  buffer_load_dwordx4 v7, s[20:23], s50 offen offset:3072 lds
  v_mfma_f32_16x16x32_bf16 v[72:75], v[216:219], a[136:139], v[72:75]
  ds_read_b64_tr_b16 v[212:213], v15 offset:8192
  v_mfma_f32_16x16x32_bf16 v[72:75], v[220:223], a[140:143], v[72:75]
  v_mfma_f32_16x16x32_bf16 v[76:79], v[216:219], a[200:203], v[76:79]
  ds_read_b64_tr_b16 v[214:215], v15 offset:9216
  v_mfma_f32_16x16x32_bf16 v[76:79], v[220:223], a[204:207], v[76:79]
  s_waitcnt lgkmcnt(15)
  v_mfma_f32_16x16x32_bf16 v[80:83], v[224:227], a[8:11], v[80:83]
  s_add_u32 s50, s33, 528384
  s_add_u32 m0, s35, 129024
  ds_read_b64_tr_b16 v[216:217], v18 offset:0
  v_mfma_f32_16x16x32_bf16 v[80:83], v[228:231], a[12:15], v[80:83]
  buffer_load_dwordx4 v16, s[24:27], s50 offen lds
  v_mfma_f32_16x16x32_bf16 v[84:87], v[224:227], a[72:75], v[84:87]
  ds_read_b64_tr_b16 v[218:219], v18 offset:384
  v_mfma_f32_16x16x32_bf16 v[84:87], v[228:231], a[76:79], v[84:87]
  v_mfma_f32_16x16x32_bf16 v[88:91], v[224:227], a[136:139], v[88:91]
  ds_read_b64_tr_b16 v[220:221], v18 offset:4608
  v_mfma_f32_16x16x32_bf16 v[88:91], v[228:231], a[140:143], v[88:91]
  v_mfma_f32_16x16x32_bf16 v[92:95], v[224:227], a[200:203], v[92:95]
  ds_read_b64_tr_b16 v[222:223], v18 offset:4992
  v_mfma_f32_16x16x32_bf16 v[92:95], v[228:231], a[204:207], v[92:95]
  buffer_load_dwordx4 v17, s[24:27], s50 offen offset:1152 lds
  s_waitcnt lgkmcnt(15)
  v_mfma_f32_16x16x32_bf16 v[96:99], v[232:235], a[8:11], v[96:99]
  ds_read_b64_tr_b16 v[224:225], v18 offset:32
  v_mfma_f32_16x16x32_bf16 v[96:99], v[236:239], a[12:15], v[96:99]
  v_mfma_f32_16x16x32_bf16 v[100:103], v[232:235], a[72:75], v[100:103]
  ds_read_b64_tr_b16 v[226:227], v18 offset:416
  v_mfma_f32_16x16x32_bf16 v[100:103], v[236:239], a[76:79], v[100:103]
  v_mfma_f32_16x16x32_bf16 v[104:107], v[232:235], a[136:139], v[104:107]
  s_add_u32 s51, s34, 8192
  ds_read_b64_tr_b16 v[228:229], v18 offset:4640
  v_mfma_f32_16x16x32_bf16 v[104:107], v[236:239], a[140:143], v[104:107]
  buffer_load_dwordx4 a[32:35], v2, s[16:19], s51 offen offset:0 sc1
  v_mfma_f32_16x16x32_bf16 v[108:111], v[232:235], a[200:203], v[108:111]
  ds_read_b64_tr_b16 v[230:231], v18 offset:5024
  v_mfma_f32_16x16x32_bf16 v[108:111], v[236:239], a[204:207], v[108:111]
  s_waitcnt lgkmcnt(15)
  v_mfma_f32_16x16x32_bf16 v[112:115], v[240:243], a[8:11], v[112:115]
  ds_read_b64_tr_b16 v[232:233], v18 offset:64
  v_mfma_f32_16x16x32_bf16 v[112:115], v[244:247], a[12:15], v[112:115]
  v_mfma_f32_16x16x32_bf16 v[116:119], v[240:243], a[72:75], v[116:119]
  ds_read_b64_tr_b16 v[234:235], v18 offset:448
  v_mfma_f32_16x16x32_bf16 v[116:119], v[244:247], a[76:79], v[116:119]
  buffer_load_dwordx4 a[36:39], v2, s[16:19], s51 offen offset:1024 sc1
  v_mfma_f32_16x16x32_bf16 v[120:123], v[240:243], a[136:139], v[120:123]
  ds_read_b64_tr_b16 v[236:237], v18 offset:4672
  v_mfma_f32_16x16x32_bf16 v[120:123], v[244:247], a[140:143], v[120:123]
  v_mfma_f32_16x16x32_bf16 v[124:127], v[240:243], a[200:203], v[124:127]
  ds_read_b64_tr_b16 v[238:239], v18 offset:5056
  v_mfma_f32_16x16x32_bf16 v[124:127], v[244:247], a[204:207], v[124:127]
  s_waitcnt lgkmcnt(15)
  s_waitcnt vmcnt(14)
  s_barrier
  s_mov_b32 s47, 0
L_poll1:
  v_and_b32 v31, 0xffffff00, v19
  v_cmp_ne_u32 vcc, s3, v31
  s_cbranch_vccz L_pollok1
  s_add_u32 s47, s47, 1
  s_cmp_gt_u32 s47, 0x80000
  s_cbranch_scc1 L_pollok1
  buffer_load_dword v19, v3, s[16:19], 0 offen sc1
  s_waitcnt vmcnt(0)
  s_branch L_poll1
L_pollok1:
  v_cmp_ne_u32 vcc, s45, v19
  s_cbranch_vccz L_samexcd
  buffer_wbl2 sc1
  s_waitcnt vmcnt(0)
L_samexcd:
  s_lshl_b32 s47, s2, 2
  s_add_u32 s47, s47, s36
  s_lshl_b32 s47, s47, 7
  s_add_u32 s47, s47, 96731136
  v_mov_b32 v19, s3
  v_lshlrev_b32 v31, 2, v1
  s_mov_b32 exec_hi, 0
  buffer_store_dword v19, v31, s[16:19], s47 offen sc1
  s_mov_b64 exec, -1
  v_subrev_u32 v8, 25600, v8
  v_mfma_f32_16x16x32_bf16 v[128:131], v[248:251], a[8:11], v[128:131]
  s_add_u32 s51, s51, 16384
  ds_read_b64_tr_b16 v[240:241], v8 offset:0
  v_mfma_f32_16x16x32_bf16 v[128:131], v[252:255], a[12:15], v[128:131]
  buffer_load_dwordx4 a[96:99], v2, s[16:19], s51 offen offset:0 sc1
  v_mfma_f32_16x16x32_bf16 v[132:135], v[248:251], a[72:75], v[132:135]
  ds_read_b64_tr_b16 v[242:243], v8 offset:1024
  v_mfma_f32_16x16x32_bf16 v[132:135], v[252:255], a[76:79], v[132:135]
  v_mfma_f32_16x16x32_bf16 v[136:139], v[248:251], a[136:139], v[136:139]
  ds_read_b64_tr_b16 v[244:245], v8 offset:8192
  v_mfma_f32_16x16x32_bf16 v[136:139], v[252:255], a[140:143], v[136:139]
  v_mfma_f32_16x16x32_bf16 v[140:143], v[248:251], a[200:203], v[140:143]
  ds_read_b64_tr_b16 v[246:247], v8 offset:9216
  v_mfma_f32_16x16x32_bf16 v[140:143], v[252:255], a[204:207], v[140:143]
  buffer_load_dwordx4 a[100:103], v2, s[16:19], s51 offen offset:1024 sc1
  s_waitcnt lgkmcnt(15)
  v_subrev_u32 v9, 25600, v9
  v_mfma_f32_16x16x32_bf16 v[144:147], v[208:211], a[8:11], v[144:147]
  ds_read_b64_tr_b16 v[248:249], v9 offset:0
  v_mfma_f32_16x16x32_bf16 v[144:147], v[212:215], a[12:15], v[144:147]
  v_mfma_f32_16x16x32_bf16 v[148:151], v[208:211], a[72:75], v[148:151]
  ds_read_b64_tr_b16 v[250:251], v9 offset:1024
  v_mfma_f32_16x16x32_bf16 v[148:151], v[212:215], a[76:79], v[148:151]
  v_mfma_f32_16x16x32_bf16 v[152:155], v[208:211], a[136:139], v[152:155]
  s_add_u32 s51, s51, 16384
  ds_read_b64_tr_b16 v[252:253], v9 offset:8192
  v_mfma_f32_16x16x32_bf16 v[152:155], v[212:215], a[140:143], v[152:155]
  buffer_load_dwordx4 a[160:163], v2, s[16:19], s51 offen offset:0 sc1
  v_mfma_f32_16x16x32_bf16 v[156:159], v[208:211], a[200:203], v[156:159]
  ds_read_b64_tr_b16 v[254:255], v9 offset:9216
  v_mfma_f32_16x16x32_bf16 v[156:159], v[212:215], a[204:207], v[156:159]
  s_waitcnt lgkmcnt(15)
  v_subrev_u32 v10, 25600, v10
  v_mfma_f32_16x16x32_bf16 v[160:163], v[216:219], a[8:11], v[160:163]
  ds_read_b64_tr_b16 v[208:209], v10 offset:0
  v_mfma_f32_16x16x32_bf16 v[160:163], v[220:223], a[12:15], v[160:163]
  v_mfma_f32_16x16x32_bf16 v[164:167], v[216:219], a[72:75], v[164:167]
  ds_read_b64_tr_b16 v[210:211], v10 offset:1024
  v_mfma_f32_16x16x32_bf16 v[164:167], v[220:223], a[76:79], v[164:167]
  buffer_load_dwordx4 a[164:167], v2, s[16:19], s51 offen offset:1024 sc1
  v_mfma_f32_16x16x32_bf16 v[168:171], v[216:219], a[136:139], v[168:171]
  ds_read_b64_tr_b16 v[212:213], v10 offset:8192
  v_mfma_f32_16x16x32_bf16 v[168:171], v[220:223], a[140:143], v[168:171]
  v_mfma_f32_16x16x32_bf16 v[172:175], v[216:219], a[200:203], v[172:175]
  ds_read_b64_tr_b16 v[214:215], v10 offset:9216
  v_mfma_f32_16x16x32_bf16 v[172:175], v[220:223], a[204:207], v[172:175]
  s_waitcnt lgkmcnt(15)
  v_subrev_u32 v11, 25600, v11
  v_mfma_f32_16x16x32_bf16 v[176:179], v[224:227], a[8:11], v[176:179]
  s_add_u32 s51, s51, 16384
  ds_read_b64_tr_b16 v[216:217], v11 offset:0
  v_mfma_f32_16x16x32_bf16 v[176:179], v[228:231], a[12:15], v[176:179]
  buffer_load_dwordx4 a[224:227], v2, s[16:19], s51 offen offset:0 sc1
  v_mfma_f32_16x16x32_bf16 v[180:183], v[224:227], a[72:75], v[180:183]
  ds_read_b64_tr_b16 v[218:219], v11 offset:1024
  v_mfma_f32_16x16x32_bf16 v[180:183], v[228:231], a[76:79], v[180:183]
  v_mfma_f32_16x16x32_bf16 v[184:187], v[224:227], a[136:139], v[184:187]
  ds_read_b64_tr_b16 v[220:221], v11 offset:8192
  v_mfma_f32_16x16x32_bf16 v[184:187], v[228:231], a[140:143], v[184:187]
  v_mfma_f32_16x16x32_bf16 v[188:191], v[224:227], a[200:203], v[188:191]
  ds_read_b64_tr_b16 v[222:223], v11 offset:9216
  v_mfma_f32_16x16x32_bf16 v[188:191], v[228:231], a[204:207], v[188:191]
  buffer_load_dwordx4 a[228:231], v2, s[16:19], s51 offen offset:1024 sc1
  s_waitcnt lgkmcnt(15)
  v_subrev_u32 v12, 25600, v12
  v_mfma_f32_16x16x32_bf16 v[192:195], v[232:235], a[8:11], v[192:195]
  ds_read_b64_tr_b16 v[224:225], v12 offset:0
  v_mfma_f32_16x16x32_bf16 v[192:195], v[236:239], a[12:15], v[192:195]
  v_mfma_f32_16x16x32_bf16 v[196:199], v[232:235], a[72:75], v[196:199]
  ds_read_b64_tr_b16 v[226:227], v12 offset:1024
  v_mfma_f32_16x16x32_bf16 v[196:199], v[236:239], a[76:79], v[196:199]
  v_mfma_f32_16x16x32_bf16 v[200:203], v[232:235], a[136:139], v[200:203]
  ds_read_b64_tr_b16 v[228:229], v12 offset:8192
  v_mfma_f32_16x16x32_bf16 v[200:203], v[236:239], a[140:143], v[200:203]
  v_mfma_f32_16x16x32_bf16 v[204:207], v[232:235], a[200:203], v[204:207]
  ds_read_b64_tr_b16 v[230:231], v12 offset:9216
  v_mfma_f32_16x16x32_bf16 v[204:207], v[236:239], a[204:207], v[204:207]
  s_waitcnt lgkmcnt(15)
  v_subrev_u32 v13, 25600, v13
  v_mfma_f32_16x16x32_bf16 v[32:35], v[240:243], a[16:19], v[32:35]
  s_add_u32 s50, s44, 2097152
  s_add_u32 m0, s41, 138240
  ds_read_b64_tr_b16 v[232:233], v13 offset:0
  v_mfma_f32_16x16x32_bf16 v[32:35], v[244:247], a[20:23], v[32:35]
  buffer_load_dwordx4 v4, s[20:23], s50 offen lds
  v_mfma_f32_16x16x32_bf16 v[36:39], v[240:243], a[80:83], v[36:39]
  ds_read_b64_tr_b16 v[234:235], v13 offset:1024
  v_mfma_f32_16x16x32_bf16 v[36:39], v[244:247], a[84:87], v[36:39]
  v_mfma_f32_16x16x32_bf16 v[40:43], v[240:243], a[144:147], v[40:43]
  ds_read_b64_tr_b16 v[236:237], v13 offset:8192
  v_mfma_f32_16x16x32_bf16 v[40:43], v[244:247], a[148:151], v[40:43]
  v_mfma_f32_16x16x32_bf16 v[44:47], v[240:243], a[208:211], v[44:47]
  ds_read_b64_tr_b16 v[238:239], v13 offset:9216
  v_mfma_f32_16x16x32_bf16 v[44:47], v[244:247], a[212:215], v[44:47]
  buffer_load_dwordx4 v5, s[20:23], s50 offen offset:1024 lds
  s_waitcnt lgkmcnt(15)
  v_subrev_u32 v14, 25600, v14
  v_mfma_f32_16x16x32_bf16 v[48:51], v[248:251], a[16:19], v[48:51]
  ds_read_b64_tr_b16 v[240:241], v14 offset:0
  v_mfma_f32_16x16x32_bf16 v[48:51], v[252:255], a[20:23], v[48:51]
  v_mfma_f32_16x16x32_bf16 v[52:55], v[248:251], a[80:83], v[52:55]
  ds_read_b64_tr_b16 v[242:243], v14 offset:1024
  v_mfma_f32_16x16x32_bf16 v[52:55], v[252:255], a[84:87], v[52:55]
  v_mfma_f32_16x16x32_bf16 v[56:59], v[248:251], a[144:147], v[56:59]
  ds_read_b64_tr_b16 v[244:245], v14 offset:8192
  v_mfma_f32_16x16x32_bf16 v[56:59], v[252:255], a[148:151], v[56:59]
  buffer_load_dwordx4 v6, s[20:23], s50 offen offset:2048 lds
  v_mfma_f32_16x16x32_bf16 v[60:63], v[248:251], a[208:211], v[60:63]
  ds_read_b64_tr_b16 v[246:247], v14 offset:9216
  v_mfma_f32_16x16x32_bf16 v[60:63], v[252:255], a[212:215], v[60:63]
  s_waitcnt lgkmcnt(15)
  v_subrev_u32 v15, 25600, v15
  v_mfma_f32_16x16x32_bf16 v[64:67], v[208:211], a[16:19], v[64:67]
  ds_read_b64_tr_b16 v[248:249], v15 offset:0
  v_mfma_f32_16x16x32_bf16 v[64:67], v[212:215], a[20:23], v[64:67]
  v_mfma_f32_16x16x32_bf16 v[68:71], v[208:211], a[80:83], v[68:71]
  ds_read_b64_tr_b16 v[250:251], v15 offset:1024
  v_mfma_f32_16x16x32_bf16 v[68:71], v[212:215], a[84:87], v[68:71]
  buffer_load_dwordx4 v7, s[20:23], s50 offen offset:3072 lds
  v_mfma_f32_16x16x32_bf16 v[72:75], v[208:211], a[144:147], v[72:75]
  ds_read_b64_tr_b16 v[252:253], v15 offset:8192
  v_mfma_f32_16x16x32_bf16 v[72:75], v[212:215], a[148:151], v[72:75]
  v_mfma_f32_16x16x32_bf16 v[76:79], v[208:211], a[208:211], v[76:79]
  ds_read_b64_tr_b16 v[254:255], v15 offset:9216
  v_mfma_f32_16x16x32_bf16 v[76:79], v[212:215], a[212:215], v[76:79]
  s_waitcnt lgkmcnt(15)
  v_subrev_u32 v18, 25600, v18
  v_mfma_f32_16x16x32_bf16 v[80:83], v[216:219], a[16:19], v[80:83]
  s_add_u32 s50, s33, 704512
  s_add_u32 m0, s35, 154624
  ds_read_b64_tr_b16 v[208:209], v18 offset:0
  v_mfma_f32_16x16x32_bf16 v[80:83], v[220:223], a[20:23], v[80:83]
  buffer_load_dwordx4 v16, s[24:27], s50 offen lds
  v_mfma_f32_16x16x32_bf16 v[84:87], v[216:219], a[80:83], v[84:87]
  ds_read_b64_tr_b16 v[210:211], v18 offset:384
  v_mfma_f32_16x16x32_bf16 v[84:87], v[220:223], a[84:87], v[84:87]
  v_mfma_f32_16x16x32_bf16 v[88:91], v[216:219], a[144:147], v[88:91]
  ds_read_b64_tr_b16 v[212:213], v18 offset:4608
  v_mfma_f32_16x16x32_bf16 v[88:91], v[220:223], a[148:151], v[88:91]
  v_mfma_f32_16x16x32_bf16 v[92:95], v[216:219], a[208:211], v[92:95]
  ds_read_b64_tr_b16 v[214:215], v18 offset:4992
  v_mfma_f32_16x16x32_bf16 v[92:95], v[220:223], a[212:215], v[92:95]
  buffer_load_dwordx4 v17, s[24:27], s50 offen offset:1152 lds
  s_waitcnt lgkmcnt(15)
  v_mfma_f32_16x16x32_bf16 v[96:99], v[224:227], a[16:19], v[96:99]
  ds_read_b64_tr_b16 v[216:217], v18 offset:32
  v_mfma_f32_16x16x32_bf16 v[96:99], v[228:231], a[20:23], v[96:99]
  v_mfma_f32_16x16x32_bf16 v[100:103], v[224:227], a[80:83], v[100:103]
  ds_read_b64_tr_b16 v[218:219], v18 offset:416
  v_mfma_f32_16x16x32_bf16 v[100:103], v[228:231], a[84:87], v[100:103]
  v_mfma_f32_16x16x32_bf16 v[104:107], v[224:227], a[144:147], v[104:107]
  s_add_u32 s51, s34, 10240
  ds_read_b64_tr_b16 v[220:221], v18 offset:4640
  v_mfma_f32_16x16x32_bf16 v[104:107], v[228:231], a[148:151], v[104:107]
  buffer_load_dwordx4 a[40:43], v2, s[16:19], s51 offen offset:0 sc1
  v_mfma_f32_16x16x32_bf16 v[108:111], v[224:227], a[208:211], v[108:111]
  ds_read_b64_tr_b16 v[222:223], v18 offset:5024
  v_mfma_f32_16x16x32_bf16 v[108:111], v[228:231], a[212:215], v[108:111]
  s_waitcnt lgkmcnt(15)
  v_mfma_f32_16x16x32_bf16 v[112:115], v[232:235], a[16:19], v[112:115]
  ds_read_b64_tr_b16 v[224:225], v18 offset:64
  v_mfma_f32_16x16x32_bf16 v[112:115], v[236:239], a[20:23], v[112:115]
  v_mfma_f32_16x16x32_bf16 v[116:119], v[232:235], a[80:83], v[116:119]
  ds_read_b64_tr_b16 v[226:227], v18 offset:448
  v_mfma_f32_16x16x32_bf16 v[116:119], v[236:239], a[84:87], v[116:119]
  buffer_load_dwordx4 a[44:47], v2, s[16:19], s51 offen offset:1024 sc1
  v_mfma_f32_16x16x32_bf16 v[120:123], v[232:235], a[144:147], v[120:123]
  ds_read_b64_tr_b16 v[228:229], v18 offset:4672
  v_mfma_f32_16x16x32_bf16 v[120:123], v[236:239], a[148:151], v[120:123]
  v_mfma_f32_16x16x32_bf16 v[124:127], v[232:235], a[208:211], v[124:127]
  ds_read_b64_tr_b16 v[230:231], v18 offset:5056
  v_mfma_f32_16x16x32_bf16 v[124:127], v[236:239], a[212:215], v[124:127]
  s_waitcnt lgkmcnt(15)
  s_waitcnt vmcnt(17)
  s_barrier
  v_add_u32 v8, 25600, v8
  v_mfma_f32_16x16x32_bf16 v[128:131], v[240:243], a[16:19], v[128:131]
  s_add_u32 s51, s51, 16384
  ds_read_b64_tr_b16 v[232:233], v8 offset:25600
  v_mfma_f32_16x16x32_bf16 v[128:131], v[244:247], a[20:23], v[128:131]
  buffer_load_dwordx4 a[104:107], v2, s[16:19], s51 offen offset:0 sc1
  v_mfma_f32_16x16x32_bf16 v[132:135], v[240:243], a[80:83], v[132:135]
  ds_read_b64_tr_b16 v[234:235], v8 offset:26624
  v_mfma_f32_16x16x32_bf16 v[132:135], v[244:247], a[84:87], v[132:135]
  v_mfma_f32_16x16x32_bf16 v[136:139], v[240:243], a[144:147], v[136:139]
  ds_read_b64_tr_b16 v[236:237], v8 offset:33792
  v_mfma_f32_16x16x32_bf16 v[136:139], v[244:247], a[148:151], v[136:139]
  v_mfma_f32_16x16x32_bf16 v[140:143], v[240:243], a[208:211], v[140:143]
  ds_read_b64_tr_b16 v[238:239], v8 offset:34816
  v_mfma_f32_16x16x32_bf16 v[140:143], v[244:247], a[212:215], v[140:143]
  buffer_load_dwordx4 a[108:111], v2, s[16:19], s51 offen offset:1024 sc1
  s_waitcnt lgkmcnt(15)
  v_add_u32 v9, 25600, v9
  v_mfma_f32_16x16x32_bf16 v[144:147], v[248:251], a[16:19], v[144:147]
  ds_read_b64_tr_b16 v[240:241], v9 offset:25600
  v_mfma_f32_16x16x32_bf16 v[144:147], v[252:255], a[20:23], v[144:147]
  v_mfma_f32_16x16x32_bf16 v[148:151], v[248:251], a[80:83], v[148:151]
  ds_read_b64_tr_b16 v[242:243], v9 offset:26624
  v_mfma_f32_16x16x32_bf16 v[148:151], v[252:255], a[84:87], v[148:151]
  v_mfma_f32_16x16x32_bf16 v[152:155], v[248:251], a[144:147], v[152:155]
  s_add_u32 s51, s51, 16384
  ds_read_b64_tr_b16 v[244:245], v9 offset:33792
  v_mfma_f32_16x16x32_bf16 v[152:155], v[252:255], a[148:151], v[152:155]
  buffer_load_dwordx4 a[168:171], v2, s[16:19], s51 offen offset:0 sc1
  v_mfma_f32_16x16x32_bf16 v[156:159], v[248:251], a[208:211], v[156:159]
  ds_read_b64_tr_b16 v[246:247], v9 offset:34816
  v_mfma_f32_16x16x32_bf16 v[156:159], v[252:255], a[212:215], v[156:159]
  s_waitcnt lgkmcnt(15)
  v_add_u32 v10, 25600, v10
  v_mfma_f32_16x16x32_bf16 v[160:163], v[208:211], a[16:19], v[160:163]
  ds_read_b64_tr_b16 v[248:249], v10 offset:25600
  v_mfma_f32_16x16x32_bf16 v[160:163], v[212:215], a[20:23], v[160:163]
  v_mfma_f32_16x16x32_bf16 v[164:167], v[208:211], a[80:83], v[164:167]
  ds_read_b64_tr_b16 v[250:251], v10 offset:26624
  v_mfma_f32_16x16x32_bf16 v[164:167], v[212:215], a[84:87], v[164:167]
  buffer_load_dwordx4 a[172:175], v2, s[16:19], s51 offen offset:1024 sc1
  v_mfma_f32_16x16x32_bf16 v[168:171], v[208:211], a[144:147], v[168:171]
  ds_read_b64_tr_b16 v[252:253], v10 offset:33792
  v_mfma_f32_16x16x32_bf16 v[168:171], v[212:215], a[148:151], v[168:171]
  v_mfma_f32_16x16x32_bf16 v[172:175], v[208:211], a[208:211], v[172:175]
  ds_read_b64_tr_b16 v[254:255], v10 offset:34816
  v_mfma_f32_16x16x32_bf16 v[172:175], v[212:215], a[212:215], v[172:175]
  s_waitcnt lgkmcnt(15)
  v_add_u32 v11, 25600, v11
  v_mfma_f32_16x16x32_bf16 v[176:179], v[216:219], a[16:19], v[176:179]
  s_add_u32 s51, s51, 16384
  ds_read_b64_tr_b16 v[208:209], v11 offset:25600
  v_mfma_f32_16x16x32_bf16 v[176:179], v[220:223], a[20:23], v[176:179]
  buffer_load_dwordx4 a[232:235], v2, s[16:19], s51 offen offset:0 sc1
  v_mfma_f32_16x16x32_bf16 v[180:183], v[216:219], a[80:83], v[180:183]
  ds_read_b64_tr_b16 v[210:211], v11 offset:26624
  v_mfma_f32_16x16x32_bf16 v[180:183], v[220:223], a[84:87], v[180:183]
  v_mfma_f32_16x16x32_bf16 v[184:187], v[216:219], a[144:147], v[184:187]
  ds_read_b64_tr_b16 v[212:213], v11 offset:33792
  v_mfma_f32_16x16x32_bf16 v[184:187], v[220:223], a[148:151], v[184:187]
  v_mfma_f32_16x16x32_bf16 v[188:191], v[216:219], a[208:211], v[188:191]
  ds_read_b64_tr_b16 v[214:215], v11 offset:34816
  v_mfma_f32_16x16x32_bf16 v[188:191], v[220:223], a[212:215], v[188:191]
  buffer_load_dwordx4 a[236:239], v2, s[16:19], s51 offen offset:1024 sc1
  s_waitcnt lgkmcnt(15)
  v_add_u32 v12, 25600, v12
  v_mfma_f32_16x16x32_bf16 v[192:195], v[224:227], a[16:19], v[192:195]
  ds_read_b64_tr_b16 v[216:217], v12 offset:25600
  v_mfma_f32_16x16x32_bf16 v[192:195], v[228:231], a[20:23], v[192:195]
  v_mfma_f32_16x16x32_bf16 v[196:199], v[224:227], a[80:83], v[196:199]
  ds_read_b64_tr_b16 v[218:219], v12 offset:26624
  v_mfma_f32_16x16x32_bf16 v[196:199], v[228:231], a[84:87], v[196:199]
  v_mfma_f32_16x16x32_bf16 v[200:203], v[224:227], a[144:147], v[200:203]
  ds_read_b64_tr_b16 v[220:221], v12 offset:33792
  v_mfma_f32_16x16x32_bf16 v[200:203], v[228:231], a[148:151], v[200:203]
  v_mfma_f32_16x16x32_bf16 v[204:207], v[224:227], a[208:211], v[204:207]
  ds_read_b64_tr_b16 v[222:223], v12 offset:34816
  v_mfma_f32_16x16x32_bf16 v[204:207], v[228:231], a[212:215], v[204:207]
  v_add_u32 v3, 262144, v3
  buffer_load_dword v19, v3, s[16:19], 0 offen sc1
  s_waitcnt lgkmcnt(15)
  v_add_u32 v13, 25600, v13
  v_mfma_f32_16x16x32_bf16 v[32:35], v[232:235], a[24:27], v[32:35]
  s_add_u32 s50, s44, 2621440
  s_add_u32 m0, s41, 87040
  ds_read_b64_tr_b16 v[224:225], v13 offset:25600
  v_mfma_f32_16x16x32_bf16 v[32:35], v[236:239], a[28:31], v[32:35]
  buffer_load_dwordx4 v4, s[20:23], s50 offen lds
  v_mfma_f32_16x16x32_bf16 v[36:39], v[232:235], a[88:91], v[36:39]
  ds_read_b64_tr_b16 v[226:227], v13 offset:26624
  v_mfma_f32_16x16x32_bf16 v[36:39], v[236:239], a[92:95], v[36:39]
  v_mfma_f32_16x16x32_bf16 v[40:43], v[232:235], a[152:155], v[40:43]
  ds_read_b64_tr_b16 v[228:229], v13 offset:33792
  v_mfma_f32_16x16x32_bf16 v[40:43], v[236:239], a[156:159], v[40:43]
  v_mfma_f32_16x16x32_bf16 v[44:47], v[232:235], a[216:219], v[44:47]
  ds_read_b64_tr_b16 v[230:231], v13 offset:34816
  v_mfma_f32_16x16x32_bf16 v[44:47], v[236:239], a[220:223], v[44:47]
  buffer_load_dwordx4 v5, s[20:23], s50 offen offset:1024 lds
  s_waitcnt lgkmcnt(15)
  v_add_u32 v14, 25600, v14
  v_mfma_f32_16x16x32_bf16 v[48:51], v[240:243], a[24:27], v[48:51]
  ds_read_b64_tr_b16 v[232:233], v14 offset:25600
  v_mfma_f32_16x16x32_bf16 v[48:51], v[244:247], a[28:31], v[48:51]
  v_mfma_f32_16x16x32_bf16 v[52:55], v[240:243], a[88:91], v[52:55]
  ds_read_b64_tr_b16 v[234:235], v14 offset:26624
  v_mfma_f32_16x16x32_bf16 v[52:55], v[244:247], a[92:95], v[52:55]
  v_mfma_f32_16x16x32_bf16 v[56:59], v[240:243], a[152:155], v[56:59]
  ds_read_b64_tr_b16 v[236:237], v14 offset:33792
  v_mfma_f32_16x16x32_bf16 v[56:59], v[244:247], a[156:159], v[56:59]
  buffer_load_dwordx4 v6, s[20:23], s50 offen offset:2048 lds
  v_mfma_f32_16x16x32_bf16 v[60:63], v[240:243], a[216:219], v[60:63]
  ds_read_b64_tr_b16 v[238:239], v14 offset:34816
  v_mfma_f32_16x16x32_bf16 v[60:63], v[244:247], a[220:223], v[60:63]
  s_waitcnt lgkmcnt(15)
  v_add_u32 v15, 25600, v15
  v_mfma_f32_16x16x32_bf16 v[64:67], v[248:251], a[24:27], v[64:67]
  ds_read_b64_tr_b16 v[240:241], v15 offset:25600
  v_mfma_f32_16x16x32_bf16 v[64:67], v[252:255], a[28:31], v[64:67]
  v_mfma_f32_16x16x32_bf16 v[68:71], v[248:251], a[88:91], v[68:71]
  ds_read_b64_tr_b16 v[242:243], v15 offset:26624
  v_mfma_f32_16x16x32_bf16 v[68:71], v[252:255], a[92:95], v[68:71]
  buffer_load_dwordx4 v7, s[20:23], s50 offen offset:3072 lds
  v_mfma_f32_16x16x32_bf16 v[72:75], v[248:251], a[152:155], v[72:75]
  ds_read_b64_tr_b16 v[244:245], v15 offset:33792
  v_mfma_f32_16x16x32_bf16 v[72:75], v[252:255], a[156:159], v[72:75]
  v_mfma_f32_16x16x32_bf16 v[76:79], v[248:251], a[216:219], v[76:79]
  ds_read_b64_tr_b16 v[246:247], v15 offset:34816
  v_mfma_f32_16x16x32_bf16 v[76:79], v[252:255], a[220:223], v[76:79]
  s_waitcnt lgkmcnt(15)
  v_add_u32 v18, 25600, v18
  v_mfma_f32_16x16x32_bf16 v[80:83], v[208:211], a[24:27], v[80:83]
  s_add_u32 s50, s33, 880640
  s_add_u32 m0, s35, 103424
  ds_read_b64_tr_b16 v[248:249], v18 offset:25600
  v_mfma_f32_16x16x32_bf16 v[80:83], v[212:215], a[28:31], v[80:83]
  buffer_load_dwordx4 v16, s[24:27], s50 offen lds
  v_mfma_f32_16x16x32_bf16 v[84:87], v[208:211], a[88:91], v[84:87]
  ds_read_b64_tr_b16 v[250:251], v18 offset:25984
  v_mfma_f32_16x16x32_bf16 v[84:87], v[212:215], a[92:95], v[84:87]
  v_mfma_f32_16x16x32_bf16 v[88:91], v[208:211], a[152:155], v[88:91]
  ds_read_b64_tr_b16 v[252:253], v18 offset:30208
  v_mfma_f32_16x16x32_bf16 v[88:91], v[212:215], a[156:159], v[88:91]
  v_mfma_f32_16x16x32_bf16 v[92:95], v[208:211], a[216:219], v[92:95]
  ds_read_b64_tr_b16 v[254:255], v18 offset:30592
  v_mfma_f32_16x16x32_bf16 v[92:95], v[212:215], a[220:223], v[92:95]
  buffer_load_dwordx4 v17, s[24:27], s50 offen offset:1152 lds
  s_waitcnt lgkmcnt(15)
  v_mfma_f32_16x16x32_bf16 v[96:99], v[216:219], a[24:27], v[96:99]
  ds_read_b64_tr_b16 v[208:209], v18 offset:25632
  v_mfma_f32_16x16x32_bf16 v[96:99], v[220:223], a[28:31], v[96:99]
  v_mfma_f32_16x16x32_bf16 v[100:103], v[216:219], a[88:91], v[100:103]
  ds_read_b64_tr_b16 v[210:211], v18 offset:26016
  v_mfma_f32_16x16x32_bf16 v[100:103], v[220:223], a[92:95], v[100:103]
  v_mfma_f32_16x16x32_bf16 v[104:107], v[216:219], a[152:155], v[104:107]
  s_add_u32 s51, s34, 12288
  ds_read_b64_tr_b16 v[212:213], v18 offset:30240
  v_mfma_f32_16x16x32_bf16 v[104:107], v[220:223], a[156:159], v[104:107]
  buffer_load_dwordx4 a[48:51], v2, s[16:19], s51 offen offset:0 sc1
  v_mfma_f32_16x16x32_bf16 v[108:111], v[216:219], a[216:219], v[108:111]
  ds_read_b64_tr_b16 v[214:215], v18 offset:30624
  v_mfma_f32_16x16x32_bf16 v[108:111], v[220:223], a[220:223], v[108:111]
  s_waitcnt lgkmcnt(15)
  v_mfma_f32_16x16x32_bf16 v[112:115], v[224:227], a[24:27], v[112:115]
  ds_read_b64_tr_b16 v[216:217], v18 offset:25664
  v_mfma_f32_16x16x32_bf16 v[112:115], v[228:231], a[28:31], v[112:115]
  v_mfma_f32_16x16x32_bf16 v[116:119], v[224:227], a[88:91], v[116:119]
  ds_read_b64_tr_b16 v[218:219], v18 offset:26048
  v_mfma_f32_16x16x32_bf16 v[116:119], v[228:231], a[92:95], v[116:119]
  buffer_load_dwordx4 a[52:55], v2, s[16:19], s51 offen offset:1024 sc1
  v_mfma_f32_16x16x32_bf16 v[120:123], v[224:227], a[152:155], v[120:123]
  ds_read_b64_tr_b16 v[220:221], v18 offset:30272
  v_mfma_f32_16x16x32_bf16 v[120:123], v[228:231], a[156:159], v[120:123]
  v_mfma_f32_16x16x32_bf16 v[124:127], v[224:227], a[216:219], v[124:127]
  ds_read_b64_tr_b16 v[222:223], v18 offset:30656
  v_mfma_f32_16x16x32_bf16 v[124:127], v[228:231], a[220:223], v[124:127]
  s_waitcnt lgkmcnt(15)
  s_waitcnt vmcnt(17)
  s_barrier
  v_mfma_f32_16x16x32_bf16 v[128:131], v[232:235], a[24:27], v[128:131]
  s_add_u32 s51, s51, 16384
  ds_read_b64_tr_b16 v[224:225], v8 offset:51200
  v_mfma_f32_16x16x32_bf16 v[128:131], v[236:239], a[28:31], v[128:131]
  buffer_load_dwordx4 a[112:115], v2, s[16:19], s51 offen offset:0 sc1
  v_mfma_f32_16x16x32_bf16 v[132:135], v[232:235], a[88:91], v[132:135]
  ds_read_b64_tr_b16 v[226:227], v8 offset:52224
  v_mfma_f32_16x16x32_bf16 v[132:135], v[236:239], a[92:95], v[132:135]
  v_mfma_f32_16x16x32_bf16 v[136:139], v[232:235], a[152:155], v[136:139]
  ds_read_b64_tr_b16 v[228:229], v8 offset:59392
  v_mfma_f32_16x16x32_bf16 v[136:139], v[236:239], a[156:159], v[136:139]
  v_mfma_f32_16x16x32_bf16 v[140:143], v[232:235], a[216:219], v[140:143]
  ds_read_b64_tr_b16 v[230:231], v8 offset:60416
  v_mfma_f32_16x16x32_bf16 v[140:143], v[236:239], a[220:223], v[140:143]
  buffer_load_dwordx4 a[116:119], v2, s[16:19], s51 offen offset:1024 sc1
  s_waitcnt lgkmcnt(15)
  v_mfma_f32_16x16x32_bf16 v[144:147], v[240:243], a[24:27], v[144:147]
  ds_read_b64_tr_b16 v[232:233], v9 offset:51200
  v_mfma_f32_16x16x32_bf16 v[144:147], v[244:247], a[28:31], v[144:147]
  v_mfma_f32_16x16x32_bf16 v[148:151], v[240:243], a[88:91], v[148:151]
  ds_read_b64_tr_b16 v[234:235], v9 offset:52224
  v_mfma_f32_16x16x32_bf16 v[148:151], v[244:247], a[92:95], v[148:151]
  v_mfma_f32_16x16x32_bf16 v[152:155], v[240:243], a[152:155], v[152:155]
  s_add_u32 s51, s51, 16384
  ds_read_b64_tr_b16 v[236:237], v9 offset:59392
  v_mfma_f32_16x16x32_bf16 v[152:155], v[244:247], a[156:159], v[152:155]
  buffer_load_dwordx4 a[176:179], v2, s[16:19], s51 offen offset:0 sc1
  v_mfma_f32_16x16x32_bf16 v[156:159], v[240:243], a[216:219], v[156:159]
  ds_read_b64_tr_b16 v[238:239], v9 offset:60416
  v_mfma_f32_16x16x32_bf16 v[156:159], v[244:247], a[220:223], v[156:159]
  s_waitcnt lgkmcnt(15)
  v_mfma_f32_16x16x32_bf16 v[160:163], v[248:251], a[24:27], v[160:163]
  ds_read_b64_tr_b16 v[240:241], v10 offset:51200
  v_mfma_f32_16x16x32_bf16 v[160:163], v[252:255], a[28:31], v[160:163]
  v_mfma_f32_16x16x32_bf16 v[164:167], v[248:251], a[88:91], v[164:167]
  ds_read_b64_tr_b16 v[242:243], v10 offset:52224
  v_mfma_f32_16x16x32_bf16 v[164:167], v[252:255], a[92:95], v[164:167]
  buffer_load_dwordx4 a[180:183], v2, s[16:19], s51 offen offset:1024 sc1
  v_mfma_f32_16x16x32_bf16 v[168:171], v[248:251], a[152:155], v[168:171]
  ds_read_b64_tr_b16 v[244:245], v10 offset:59392
  v_mfma_f32_16x16x32_bf16 v[168:171], v[252:255], a[156:159], v[168:171]
  v_mfma_f32_16x16x32_bf16 v[172:175], v[248:251], a[216:219], v[172:175]
  ds_read_b64_tr_b16 v[246:247], v10 offset:60416
  v_mfma_f32_16x16x32_bf16 v[172:175], v[252:255], a[220:223], v[172:175]
  s_waitcnt lgkmcnt(15)
  v_mfma_f32_16x16x32_bf16 v[176:179], v[208:211], a[24:27], v[176:179]
  s_add_u32 s51, s51, 16384
  ds_read_b64_tr_b16 v[248:249], v11 offset:51200
  v_mfma_f32_16x16x32_bf16 v[176:179], v[212:215], a[28:31], v[176:179]
  buffer_load_dwordx4 a[240:243], v2, s[16:19], s51 offen offset:0 sc1
  v_mfma_f32_16x16x32_bf16 v[180:183], v[208:211], a[88:91], v[180:183]
  ds_read_b64_tr_b16 v[250:251], v11 offset:52224
  v_mfma_f32_16x16x32_bf16 v[180:183], v[212:215], a[92:95], v[180:183]
  v_mfma_f32_16x16x32_bf16 v[184:187], v[208:211], a[152:155], v[184:187]
  ds_read_b64_tr_b16 v[252:253], v11 offset:59392
  v_mfma_f32_16x16x32_bf16 v[184:187], v[212:215], a[156:159], v[184:187]
  v_mfma_f32_16x16x32_bf16 v[188:191], v[208:211], a[216:219], v[188:191]
  ds_read_b64_tr_b16 v[254:255], v11 offset:60416
  v_mfma_f32_16x16x32_bf16 v[188:191], v[212:215], a[220:223], v[188:191]
  buffer_load_dwordx4 a[244:247], v2, s[16:19], s51 offen offset:1024 sc1
  s_waitcnt lgkmcnt(15)
  v_mfma_f32_16x16x32_bf16 v[192:195], v[216:219], a[24:27], v[192:195]
  ds_read_b64_tr_b16 v[208:209], v12 offset:51200
  v_mfma_f32_16x16x32_bf16 v[192:195], v[220:223], a[28:31], v[192:195]
  v_mfma_f32_16x16x32_bf16 v[196:199], v[216:219], a[88:91], v[196:199]
  ds_read_b64_tr_b16 v[210:211], v12 offset:52224
  v_mfma_f32_16x16x32_bf16 v[196:199], v[220:223], a[92:95], v[196:199]
  v_mfma_f32_16x16x32_bf16 v[200:203], v[216:219], a[152:155], v[200:203]
  ds_read_b64_tr_b16 v[212:213], v12 offset:59392
  v_mfma_f32_16x16x32_bf16 v[200:203], v[220:223], a[156:159], v[200:203]
  v_mfma_f32_16x16x32_bf16 v[204:207], v[216:219], a[216:219], v[204:207]
  ds_read_b64_tr_b16 v[214:215], v12 offset:60416
  v_mfma_f32_16x16x32_bf16 v[204:207], v[220:223], a[220:223], v[204:207]
  s_waitcnt vmcnt(14)
  s_mov_b32 s47, 0
L_poll2:
  v_cmp_ne_u32 vcc, s3, v19
  s_cbranch_vccz L_pollok2
  s_add_u32 s47, s47, 1
  s_cmp_gt_u32 s47, 0x80000
  s_cbranch_scc1 L_pollok2
  buffer_load_dword v19, v3, s[16:19], 0 offen sc1
  s_waitcnt vmcnt(0)
  s_branch L_poll2
L_pollok2:
  s_waitcnt lgkmcnt(15)
  v_mfma_f32_16x16x32_bf16 v[32:35], v[224:227], a[32:35], v[32:35]
  s_add_u32 s50, s44, 3145728
  s_add_u32 m0, s41, 61440
  ds_read_b64_tr_b16 v[216:217], v13 offset:51200
  v_mfma_f32_16x16x32_bf16 v[32:35], v[228:231], a[36:39], v[32:35]
  buffer_load_dwordx4 v4, s[20:23], s50 offen lds
  v_mfma_f32_16x16x32_bf16 v[36:39], v[224:227], a[96:99], v[36:39]
  ds_read_b64_tr_b16 v[218:219], v13 offset:52224
  v_mfma_f32_16x16x32_bf16 v[36:39], v[228:231], a[100:103], v[36:39]
  v_mfma_f32_16x16x32_bf16 v[40:43], v[224:227], a[160:163], v[40:43]
  ds_read_b64_tr_b16 v[220:221], v13 offset:59392
  v_mfma_f32_16x16x32_bf16 v[40:43], v[228:231], a[164:167], v[40:43]
  v_mfma_f32_16x16x32_bf16 v[44:47], v[224:227], a[224:227], v[44:47]
  ds_read_b64_tr_b16 v[222:223], v13 offset:60416
  v_mfma_f32_16x16x32_bf16 v[44:47], v[228:231], a[228:231], v[44:47]
  buffer_load_dwordx4 v5, s[20:23], s50 offen offset:1024 lds
  s_waitcnt lgkmcnt(15)
  v_mfma_f32_16x16x32_bf16 v[48:51], v[232:235], a[32:35], v[48:51]
  ds_read_b64_tr_b16 v[224:225], v14 offset:51200
  v_mfma_f32_16x16x32_bf16 v[48:51], v[236:239], a[36:39], v[48:51]
  v_mfma_f32_16x16x32_bf16 v[52:55], v[232:235], a[96:99], v[52:55]
  ds_read_b64_tr_b16 v[226:227], v14 offset:52224
  v_mfma_f32_16x16x32_bf16 v[52:55], v[236:239], a[100:103], v[52:55]
  v_mfma_f32_16x16x32_bf16 v[56:59], v[232:235], a[160:163], v[56:59]
  ds_read_b64_tr_b16 v[228:229], v14 offset:59392
  v_mfma_f32_16x16x32_bf16 v[56:59], v[236:239], a[164:167], v[56:59]
  buffer_load_dwordx4 v6, s[20:23], s50 offen offset:2048 lds
  v_mfma_f32_16x16x32_bf16 v[60:63], v[232:235], a[224:227], v[60:63]
  ds_read_b64_tr_b16 v[230:231], v14 offset:60416
  v_mfma_f32_16x16x32_bf16 v[60:63], v[236:239], a[228:231], v[60:63]
  s_waitcnt lgkmcnt(15)
  v_mfma_f32_16x16x32_bf16 v[64:67], v[240:243], a[32:35], v[64:67]
  ds_read_b64_tr_b16 v[232:233], v15 offset:51200
  v_mfma_f32_16x16x32_bf16 v[64:67], v[244:247], a[36:39], v[64:67]
  v_mfma_f32_16x16x32_bf16 v[68:71], v[240:243], a[96:99], v[68:71]
  ds_read_b64_tr_b16 v[234:235], v15 offset:52224
  v_mfma_f32_16x16x32_bf16 v[68:71], v[244:247], a[100:103], v[68:71]
  buffer_load_dwordx4 v7, s[20:23], s50 offen offset:3072 lds
  v_mfma_f32_16x16x32_bf16 v[72:75], v[240:243], a[160:163], v[72:75]
  ds_read_b64_tr_b16 v[236:237], v15 offset:59392
  v_mfma_f32_16x16x32_bf16 v[72:75], v[244:247], a[164:167], v[72:75]
  v_mfma_f32_16x16x32_bf16 v[76:79], v[240:243], a[224:227], v[76:79]
  ds_read_b64_tr_b16 v[238:239], v15 offset:60416
  v_mfma_f32_16x16x32_bf16 v[76:79], v[244:247], a[228:231], v[76:79]
  s_waitcnt lgkmcnt(15)
  v_mfma_f32_16x16x32_bf16 v[80:83], v[248:251], a[32:35], v[80:83]
  s_add_u32 s50, s33, 1056768
  s_add_u32 m0, s35, 77824
  ds_read_b64_tr_b16 v[240:241], v18 offset:51200
  v_mfma_f32_16x16x32_bf16 v[80:83], v[252:255], a[36:39], v[80:83]
  buffer_load_dwordx4 v16, s[24:27], s50 offen lds
  v_mfma_f32_16x16x32_bf16 v[84:87], v[248:251], a[96:99], v[84:87]
  ds_read_b64_tr_b16 v[242:243], v18 offset:51584
  v_mfma_f32_16x16x32_bf16 v[84:87], v[252:255], a[100:103], v[84:87]
  v_mfma_f32_16x16x32_bf16 v[88:91], v[248:251], a[160:163], v[88:91]
  ds_read_b64_tr_b16 v[244:245], v18 offset:55808
  v_mfma_f32_16x16x32_bf16 v[88:91], v[252:255], a[164:167], v[88:91]
  v_mfma_f32_16x16x32_bf16 v[92:95], v[248:251], a[224:227], v[92:95]
  ds_read_b64_tr_b16 v[246:247], v18 offset:56192
  v_mfma_f32_16x16x32_bf16 v[92:95], v[252:255], a[228:231], v[92:95]
  buffer_load_dwordx4 v17, s[24:27], s50 offen offset:1152 lds
  s_waitcnt lgkmcnt(15)
  v_mfma_f32_16x16x32_bf16 v[96:99], v[208:211], a[32:35], v[96:99]
  ds_read_b64_tr_b16 v[248:249], v18 offset:51232
  v_mfma_f32_16x16x32_bf16 v[96:99], v[212:215], a[36:39], v[96:99]
  v_mfma_f32_16x16x32_bf16 v[100:103], v[208:211], a[96:99], v[100:103]
  ds_read_b64_tr_b16 v[250:251], v18 offset:51616
  v_mfma_f32_16x16x32_bf16 v[100:103], v[212:215], a[100:103], v[100:103]
  v_mfma_f32_16x16x32_bf16 v[104:107], v[208:211], a[160:163], v[104:107]
  s_add_u32 s51, s34, 14336
  ds_read_b64_tr_b16 v[252:253], v18 offset:55840
  v_mfma_f32_16x16x32_bf16 v[104:107], v[212:215], a[164:167], v[104:107]
  buffer_load_dwordx4 a[56:59], v2, s[16:19], s51 offen offset:0 sc1
  v_mfma_f32_16x16x32_bf16 v[108:111], v[208:211], a[224:227], v[108:111]
  ds_read_b64_tr_b16 v[254:255], v18 offset:56224
  v_mfma_f32_16x16x32_bf16 v[108:111], v[212:215], a[228:231], v[108:111]
  s_waitcnt lgkmcnt(15)
  v_mfma_f32_16x16x32_bf16 v[112:115], v[216:219], a[32:35], v[112:115]
  ds_read_b64_tr_b16 v[208:209], v18 offset:51264
  v_mfma_f32_16x16x32_bf16 v[112:115], v[220:223], a[36:39], v[112:115]
  v_mfma_f32_16x16x32_bf16 v[116:119], v[216:219], a[96:99], v[116:119]
  ds_read_b64_tr_b16 v[210:211], v18 offset:51648
  v_mfma_f32_16x16x32_bf16 v[116:119], v[220:223], a[100:103], v[116:119]
  buffer_load_dwordx4 a[60:63], v2, s[16:19], s51 offen offset:1024 sc1
  v_mfma_f32_16x16x32_bf16 v[120:123], v[216:219], a[160:163], v[120:123]
  ds_read_b64_tr_b16 v[212:213], v18 offset:55872
  v_mfma_f32_16x16x32_bf16 v[120:123], v[220:223], a[164:167], v[120:123]
  v_mfma_f32_16x16x32_bf16 v[124:127], v[216:219], a[224:227], v[124:127]
  ds_read_b64_tr_b16 v[214:215], v18 offset:56256
  v_mfma_f32_16x16x32_bf16 v[124:127], v[220:223], a[228:231], v[124:127]
  s_waitcnt lgkmcnt(15)
  s_waitcnt vmcnt(16)
  s_barrier
  v_mfma_f32_16x16x32_bf16 v[128:131], v[224:227], a[32:35], v[128:131]
  s_add_u32 s51, s51, 16384
  ds_read_b64_tr_b16 v[216:217], v8 offset:0
  v_mfma_f32_16x16x32_bf16 v[128:131], v[228:231], a[36:39], v[128:131]
  buffer_load_dwordx4 a[120:123], v2, s[16:19], s51 offen offset:0 sc1
  v_mfma_f32_16x16x32_bf16 v[132:135], v[224:227], a[96:99], v[132:135]
  ds_read_b64_tr_b16 v[218:219], v8 offset:1024
  v_mfma_f32_16x16x32_bf16 v[132:135], v[228:231], a[100:103], v[132:135]
  v_mfma_f32_16x16x32_bf16 v[136:139], v[224:227], a[160:163], v[136:139]
  ds_read_b64_tr_b16 v[220:221], v8 offset:8192
  v_mfma_f32_16x16x32_bf16 v[136:139], v[228:231], a[164:167], v[136:139]
  v_mfma_f32_16x16x32_bf16 v[140:143], v[224:227], a[224:227], v[140:143]
  ds_read_b64_tr_b16 v[222:223], v8 offset:9216
  v_mfma_f32_16x16x32_bf16 v[140:143], v[228:231], a[228:231], v[140:143]
  buffer_load_dwordx4 a[124:127], v2, s[16:19], s51 offen offset:1024 sc1
  s_waitcnt lgkmcnt(15)
  v_mfma_f32_16x16x32_bf16 v[144:147], v[232:235], a[32:35], v[144:147]
  ds_read_b64_tr_b16 v[224:225], v9 offset:0
  v_mfma_f32_16x16x32_bf16 v[144:147], v[236:239], a[36:39], v[144:147]
  v_mfma_f32_16x16x32_bf16 v[148:151], v[232:235], a[96:99], v[148:151]
  ds_read_b64_tr_b16 v[226:227], v9 offset:1024
  v_mfma_f32_16x16x32_bf16 v[148:151], v[236:239], a[100:103], v[148:151]
  v_mfma_f32_16x16x32_bf16 v[152:155], v[232:235], a[160:163], v[152:155]
  s_add_u32 s51, s51, 16384
  ds_read_b64_tr_b16 v[228:229], v9 offset:8192
  v_mfma_f32_16x16x32_bf16 v[152:155], v[236:239], a[164:167], v[152:155]
  buffer_load_dwordx4 a[184:187], v2, s[16:19], s51 offen offset:0 sc1
  v_mfma_f32_16x16x32_bf16 v[156:159], v[232:235], a[224:227], v[156:159]
  ds_read_b64_tr_b16 v[230:231], v9 offset:9216
  v_mfma_f32_16x16x32_bf16 v[156:159], v[236:239], a[228:231], v[156:159]
  s_waitcnt lgkmcnt(15)
  v_mfma_f32_16x16x32_bf16 v[160:163], v[240:243], a[32:35], v[160:163]
  ds_read_b64_tr_b16 v[232:233], v10 offset:0
  v_mfma_f32_16x16x32_bf16 v[160:163], v[244:247], a[36:39], v[160:163]
  v_mfma_f32_16x16x32_bf16 v[164:167], v[240:243], a[96:99], v[164:167]
  ds_read_b64_tr_b16 v[234:235], v10 offset:1024
  v_mfma_f32_16x16x32_bf16 v[164:167], v[244:247], a[100:103], v[164:167]
  buffer_load_dwordx4 a[188:191], v2, s[16:19], s51 offen offset:1024 sc1
  v_mfma_f32_16x16x32_bf16 v[168:171], v[240:243], a[160:163], v[168:171]
  ds_read_b64_tr_b16 v[236:237], v10 offset:8192
  v_mfma_f32_16x16x32_bf16 v[168:171], v[244:247], a[164:167], v[168:171]
  v_mfma_f32_16x16x32_bf16 v[172:175], v[240:243], a[224:227], v[172:175]
  ds_read_b64_tr_b16 v[238:239], v10 offset:9216
  v_mfma_f32_16x16x32_bf16 v[172:175], v[244:247], a[228:231], v[172:175]
  s_waitcnt lgkmcnt(15)
  v_mfma_f32_16x16x32_bf16 v[176:179], v[248:251], a[32:35], v[176:179]
  s_add_u32 s51, s51, 16384
  ds_read_b64_tr_b16 v[240:241], v11 offset:0
  v_mfma_f32_16x16x32_bf16 v[176:179], v[252:255], a[36:39], v[176:179]
  buffer_load_dwordx4 a[248:251], v2, s[16:19], s51 offen offset:0 sc1
  v_mfma_f32_16x16x32_bf16 v[180:183], v[248:251], a[96:99], v[180:183]
  ds_read_b64_tr_b16 v[242:243], v11 offset:1024
  v_mfma_f32_16x16x32_bf16 v[180:183], v[252:255], a[100:103], v[180:183]
  v_mfma_f32_16x16x32_bf16 v[184:187], v[248:251], a[160:163], v[184:187]
  ds_read_b64_tr_b16 v[244:245], v11 offset:8192
  v_mfma_f32_16x16x32_bf16 v[184:187], v[252:255], a[164:167], v[184:187]
  v_mfma_f32_16x16x32_bf16 v[188:191], v[248:251], a[224:227], v[188:191]
  ds_read_b64_tr_b16 v[246:247], v11 offset:9216
  v_mfma_f32_16x16x32_bf16 v[188:191], v[252:255], a[228:231], v[188:191]
  buffer_load_dwordx4 a[252:255], v2, s[16:19], s51 offen offset:1024 sc1
  s_waitcnt lgkmcnt(15)
  v_mfma_f32_16x16x32_bf16 v[192:195], v[208:211], a[32:35], v[192:195]
  ds_read_b64_tr_b16 v[248:249], v12 offset:0
  v_mfma_f32_16x16x32_bf16 v[192:195], v[212:215], a[36:39], v[192:195]
  v_mfma_f32_16x16x32_bf16 v[196:199], v[208:211], a[96:99], v[196:199]
  ds_read_b64_tr_b16 v[250:251], v12 offset:1024
  v_mfma_f32_16x16x32_bf16 v[196:199], v[212:215], a[100:103], v[196:199]
  v_mfma_f32_16x16x32_bf16 v[200:203], v[208:211], a[160:163], v[200:203]
  ds_read_b64_tr_b16 v[252:253], v12 offset:8192
  v_mfma_f32_16x16x32_bf16 v[200:203], v[212:215], a[164:167], v[200:203]
  v_mfma_f32_16x16x32_bf16 v[204:207], v[208:211], a[224:227], v[204:207]
  ds_read_b64_tr_b16 v[254:255], v12 offset:9216
  v_mfma_f32_16x16x32_bf16 v[204:207], v[212:215], a[228:231], v[204:207]
  s_lshr_b32 s50, s2, 3
  s_lshl_b32 s50, s50, 2
  s_add_u32 s50, s50, s36
  s_lshl_b32 s50, s50, 10
  s_and_b32 s50, s50, 65535
  s_add_u32 s50, s50, 34816
  s_min_u32 s50, s50, L_codeend-L_pcbase-1024
  v_add_u32 v3, s50, v2
  global_load_dwordx4 v[20:23], v3, s[62:63]
  v_accvgpr_write_b32 a0, -1
  v_accvgpr_write_b32 a1, -1
  v_accvgpr_write_b32 a2, -1
  v_accvgpr_write_b32 a3, -1
  s_lshl_b32 s64, s2, 2
  s_add_u32 s64, s64, s36
  s_lshl_b32 s64, s64, 13
  s_add_u32 s64, s64, 58720256
  s_add_u32 s65, s64, 4096
  s_waitcnt lgkmcnt(15)
  v_mfma_f32_16x16x32_bf16 v[32:35], v[216:219], a[40:43], v[32:35]
  s_add_u32 s50, s44, 3670016
  s_add_u32 m0, s41, 112640
  ds_read_b64_tr_b16 v[208:209], v13 offset:0
  v_mfma_f32_16x16x32_bf16 v[32:35], v[220:223], a[44:47], v[32:35]
  buffer_load_dwordx4 v4, s[20:23], s50 offen lds
  v_mfma_f32_16x16x32_bf16 v[36:39], v[216:219], a[104:107], v[36:39]
  ds_read_b64_tr_b16 v[210:211], v13 offset:1024
  v_mfma_f32_16x16x32_bf16 v[36:39], v[220:223], a[108:111], v[36:39]
  v_mfma_f32_16x16x32_bf16 v[40:43], v[216:219], a[168:171], v[40:43]
  ds_read_b64_tr_b16 v[212:213], v13 offset:8192
  v_mfma_f32_16x16x32_bf16 v[40:43], v[220:223], a[172:175], v[40:43]
  v_mfma_f32_16x16x32_bf16 v[44:47], v[216:219], a[232:235], v[44:47]
  ds_read_b64_tr_b16 v[214:215], v13 offset:9216
  v_mfma_f32_16x16x32_bf16 v[44:47], v[220:223], a[236:239], v[44:47]
  buffer_load_dwordx4 v5, s[20:23], s50 offen offset:1024 lds
  s_waitcnt lgkmcnt(15)
  v_mfma_f32_16x16x32_bf16 v[48:51], v[224:227], a[40:43], v[48:51]
  ds_read_b64_tr_b16 v[216:217], v14 offset:0
  v_mfma_f32_16x16x32_bf16 v[48:51], v[228:231], a[44:47], v[48:51]
  v_mfma_f32_16x16x32_bf16 v[52:55], v[224:227], a[104:107], v[52:55]
  ds_read_b64_tr_b16 v[218:219], v14 offset:1024
  v_mfma_f32_16x16x32_bf16 v[52:55], v[228:231], a[108:111], v[52:55]
  v_mfma_f32_16x16x32_bf16 v[56:59], v[224:227], a[168:171], v[56:59]
  ds_read_b64_tr_b16 v[220:221], v14 offset:8192
  v_mfma_f32_16x16x32_bf16 v[56:59], v[228:231], a[172:175], v[56:59]
  buffer_load_dwordx4 v6, s[20:23], s50 offen offset:2048 lds
  v_mfma_f32_16x16x32_bf16 v[60:63], v[224:227], a[232:235], v[60:63]
  ds_read_b64_tr_b16 v[222:223], v14 offset:9216
  v_mfma_f32_16x16x32_bf16 v[60:63], v[228:231], a[236:239], v[60:63]
  s_waitcnt lgkmcnt(15)
  v_mfma_f32_16x16x32_bf16 v[64:67], v[232:235], a[40:43], v[64:67]
  ds_read_b64_tr_b16 v[224:225], v15 offset:0
  v_mfma_f32_16x16x32_bf16 v[64:67], v[236:239], a[44:47], v[64:67]
  v_mfma_f32_16x16x32_bf16 v[68:71], v[232:235], a[104:107], v[68:71]
  ds_read_b64_tr_b16 v[226:227], v15 offset:1024
  v_mfma_f32_16x16x32_bf16 v[68:71], v[236:239], a[108:111], v[68:71]
  buffer_load_dwordx4 v7, s[20:23], s50 offen offset:3072 lds
  buffer_store_dwordx4 a[0:3], v2, s[16:19], s64 offen offset:0 sc1
  v_mfma_f32_16x16x32_bf16 v[72:75], v[232:235], a[168:171], v[72:75]
  ds_read_b64_tr_b16 v[228:229], v15 offset:8192
  v_mfma_f32_16x16x32_bf16 v[72:75], v[236:239], a[172:175], v[72:75]
  v_mfma_f32_16x16x32_bf16 v[76:79], v[232:235], a[232:235], v[76:79]
  ds_read_b64_tr_b16 v[230:231], v15 offset:9216
  v_mfma_f32_16x16x32_bf16 v[76:79], v[236:239], a[236:239], v[76:79]
  s_waitcnt lgkmcnt(15)
  v_mfma_f32_16x16x32_bf16 v[80:83], v[240:243], a[40:43], v[80:83]
  s_add_u32 s50, s33, 1232896
  s_add_u32 m0, s35, 129024
  ds_read_b64_tr_b16 v[232:233], v18 offset:0
  v_mfma_f32_16x16x32_bf16 v[80:83], v[244:247], a[44:47], v[80:83]
  buffer_load_dwordx4 v16, s[24:27], s50 offen lds
  v_mfma_f32_16x16x32_bf16 v[84:87], v[240:243], a[104:107], v[84:87]
  ds_read_b64_tr_b16 v[234:235], v18 offset:384
  v_mfma_f32_16x16x32_bf16 v[84:87], v[244:247], a[108:111], v[84:87]
  v_mfma_f32_16x16x32_bf16 v[88:91], v[240:243], a[168:171], v[88:91]
  ds_read_b64_tr_b16 v[236:237], v18 offset:4608
  v_mfma_f32_16x16x32_bf16 v[88:91], v[244:247], a[172:175], v[88:91]
  v_mfma_f32_16x16x32_bf16 v[92:95], v[240:243], a[232:235], v[92:95]
  ds_read_b64_tr_b16 v[238:239], v18 offset:4992
  v_mfma_f32_16x16x32_bf16 v[92:95], v[244:247], a[236:239], v[92:95]
  buffer_load_dwordx4 v17, s[24:27], s50 offen offset:1152 lds
  s_waitcnt lgkmcnt(15)
  v_mfma_f32_16x16x32_bf16 v[96:99], v[248:251], a[40:43], v[96:99]
  ds_read_b64_tr_b16 v[240:241], v18 offset:32
  v_mfma_f32_16x16x32_bf16 v[96:99], v[252:255], a[44:47], v[96:99]
  v_mfma_f32_16x16x32_bf16 v[100:103], v[248:251], a[104:107], v[100:103]
  ds_read_b64_tr_b16 v[242:243], v18 offset:416
  v_mfma_f32_16x16x32_bf16 v[100:103], v[252:255], a[108:111], v[100:103]
  v_mfma_f32_16x16x32_bf16 v[104:107], v[248:251], a[168:171], v[104:107]
  s_add_u32 s50, s40, 0
  s_add_u32 m0, s41, 0
  ds_read_b64_tr_b16 v[244:245], v18 offset:4640
  v_mfma_f32_16x16x32_bf16 v[104:107], v[252:255], a[172:175], v[104:107]
  buffer_load_dwordx4 v2, s[16:19], s50 offen offset:0 sc1 lds
  v_mfma_f32_16x16x32_bf16 v[108:111], v[248:251], a[232:235], v[108:111]
  ds_read_b64_tr_b16 v[246:247], v18 offset:5024
  v_mfma_f32_16x16x32_bf16 v[108:111], v[252:255], a[236:239], v[108:111]
  s_waitcnt lgkmcnt(15)
  v_mfma_f32_16x16x32_bf16 v[112:115], v[208:211], a[40:43], v[112:115]
  ds_read_b64_tr_b16 v[248:249], v18 offset:64
  v_mfma_f32_16x16x32_bf16 v[112:115], v[212:215], a[44:47], v[112:115]
  v_mfma_f32_16x16x32_bf16 v[116:119], v[208:211], a[104:107], v[116:119]
  ds_read_b64_tr_b16 v[250:251], v18 offset:448
  v_mfma_f32_16x16x32_bf16 v[116:119], v[212:215], a[108:111], v[116:119]
  buffer_load_dwordx4 v2, s[16:19], s50 offen offset:1024 sc1 lds
  buffer_store_dwordx4 a[0:3], v2, s[16:19], s64 offen offset:1024 sc1
  v_mfma_f32_16x16x32_bf16 v[120:123], v[208:211], a[168:171], v[120:123]
  ds_read_b64_tr_b16 v[252:253], v18 offset:4672
  v_mfma_f32_16x16x32_bf16 v[120:123], v[212:215], a[172:175], v[120:123]
  v_mfma_f32_16x16x32_bf16 v[124:127], v[208:211], a[232:235], v[124:127]
  ds_read_b64_tr_b16 v[254:255], v18 offset:5056
  v_mfma_f32_16x16x32_bf16 v[124:127], v[212:215], a[236:239], v[124:127]
  s_waitcnt lgkmcnt(15)
  s_waitcnt vmcnt(19)
  s_barrier
  v_subrev_u32 v8, 25600, v8
  v_mfma_f32_16x16x32_bf16 v[128:131], v[216:219], a[40:43], v[128:131]
  ds_read_b64_tr_b16 v[208:209], v8 offset:0
  v_mfma_f32_16x16x32_bf16 v[128:131], v[220:223], a[44:47], v[128:131]
  buffer_load_dwordx4 v2, s[16:19], s50 offen offset:2048 sc1 lds
  v_mfma_f32_16x16x32_bf16 v[132:135], v[216:219], a[104:107], v[132:135]
  ds_read_b64_tr_b16 v[210:211], v8 offset:1024
  v_mfma_f32_16x16x32_bf16 v[132:135], v[220:223], a[108:111], v[132:135]
  v_mfma_f32_16x16x32_bf16 v[136:139], v[216:219], a[168:171], v[136:139]
  ds_read_b64_tr_b16 v[212:213], v8 offset:8192
  v_mfma_f32_16x16x32_bf16 v[136:139], v[220:223], a[172:175], v[136:139]
  v_mfma_f32_16x16x32_bf16 v[140:143], v[216:219], a[232:235], v[140:143]
  ds_read_b64_tr_b16 v[214:215], v8 offset:9216
  v_mfma_f32_16x16x32_bf16 v[140:143], v[220:223], a[236:239], v[140:143]
  buffer_load_dwordx4 v2, s[16:19], s50 offen offset:3072 sc1 lds
  s_waitcnt lgkmcnt(15)
  v_subrev_u32 v9, 25600, v9
  v_mfma_f32_16x16x32_bf16 v[144:147], v[224:227], a[40:43], v[144:147]
  ds_read_b64_tr_b16 v[216:217], v9 offset:0
  v_mfma_f32_16x16x32_bf16 v[144:147], v[228:231], a[44:47], v[144:147]
  v_mfma_f32_16x16x32_bf16 v[148:151], v[224:227], a[104:107], v[148:151]
  ds_read_b64_tr_b16 v[218:219], v9 offset:1024
  v_mfma_f32_16x16x32_bf16 v[148:151], v[228:231], a[108:111], v[148:151]
  v_mfma_f32_16x16x32_bf16 v[152:155], v[224:227], a[168:171], v[152:155]
  s_add_u32 s50, s40, 32768
  s_add_u32 m0, s41, 16384
  ds_read_b64_tr_b16 v[220:221], v9 offset:8192
  v_mfma_f32_16x16x32_bf16 v[152:155], v[228:231], a[172:175], v[152:155]
  buffer_load_dwordx4 v2, s[16:19], s50 offen offset:0 sc1 lds
  v_mfma_f32_16x16x32_bf16 v[156:159], v[224:227], a[232:235], v[156:159]
  ds_read_b64_tr_b16 v[222:223], v9 offset:9216
  v_mfma_f32_16x16x32_bf16 v[156:159], v[228:231], a[236:239], v[156:159]
  s_waitcnt lgkmcnt(15)
  v_subrev_u32 v10, 25600, v10
  v_mfma_f32_16x16x32_bf16 v[160:163], v[232:235], a[40:43], v[160:163]
  ds_read_b64_tr_b16 v[224:225], v10 offset:0
  v_mfma_f32_16x16x32_bf16 v[160:163], v[236:239], a[44:47], v[160:163]
  v_mfma_f32_16x16x32_bf16 v[164:167], v[232:235], a[104:107], v[164:167]
  ds_read_b64_tr_b16 v[226:227], v10 offset:1024
  v_mfma_f32_16x16x32_bf16 v[164:167], v[236:239], a[108:111], v[164:167]
  buffer_load_dwordx4 v2, s[16:19], s50 offen offset:1024 sc1 lds
  buffer_store_dwordx4 a[0:3], v2, s[16:19], s64 offen offset:2048 sc1
  v_mfma_f32_16x16x32_bf16 v[168:171], v[232:235], a[168:171], v[168:171]
  ds_read_b64_tr_b16 v[228:229], v10 offset:8192
  v_mfma_f32_16x16x32_bf16 v[168:171], v[236:239], a[172:175], v[168:171]
  v_mfma_f32_16x16x32_bf16 v[172:175], v[232:235], a[232:235], v[172:175]
  ds_read_b64_tr_b16 v[230:231], v10 offset:9216
  v_mfma_f32_16x16x32_bf16 v[172:175], v[236:239], a[236:239], v[172:175]
  s_waitcnt lgkmcnt(15)
  v_subrev_u32 v11, 25600, v11
  v_mfma_f32_16x16x32_bf16 v[176:179], v[240:243], a[40:43], v[176:179]
  ds_read_b64_tr_b16 v[232:233], v11 offset:0
  v_mfma_f32_16x16x32_bf16 v[176:179], v[244:247], a[44:47], v[176:179]
  buffer_load_dwordx4 v2, s[16:19], s50 offen offset:2048 sc1 lds
  v_mfma_f32_16x16x32_bf16 v[180:183], v[240:243], a[104:107], v[180:183]
  ds_read_b64_tr_b16 v[234:235], v11 offset:1024
  v_mfma_f32_16x16x32_bf16 v[180:183], v[244:247], a[108:111], v[180:183]
  v_mfma_f32_16x16x32_bf16 v[184:187], v[240:243], a[168:171], v[184:187]
  ds_read_b64_tr_b16 v[236:237], v11 offset:8192
  v_mfma_f32_16x16x32_bf16 v[184:187], v[244:247], a[172:175], v[184:187]
  v_mfma_f32_16x16x32_bf16 v[188:191], v[240:243], a[232:235], v[188:191]
  ds_read_b64_tr_b16 v[238:239], v11 offset:9216
  v_mfma_f32_16x16x32_bf16 v[188:191], v[244:247], a[236:239], v[188:191]
  buffer_load_dwordx4 v2, s[16:19], s50 offen offset:3072 sc1 lds
  s_waitcnt lgkmcnt(15)
  v_subrev_u32 v12, 25600, v12
  v_mfma_f32_16x16x32_bf16 v[192:195], v[248:251], a[40:43], v[192:195]
  ds_read_b64_tr_b16 v[240:241], v12 offset:0
  v_mfma_f32_16x16x32_bf16 v[192:195], v[252:255], a[44:47], v[192:195]
  v_mfma_f32_16x16x32_bf16 v[196:199], v[248:251], a[104:107], v[196:199]
  ds_read_b64_tr_b16 v[242:243], v12 offset:1024
  v_mfma_f32_16x16x32_bf16 v[196:199], v[252:255], a[108:111], v[196:199]
  v_mfma_f32_16x16x32_bf16 v[200:203], v[248:251], a[168:171], v[200:203]
  ds_read_b64_tr_b16 v[244:245], v12 offset:8192
  v_mfma_f32_16x16x32_bf16 v[200:203], v[252:255], a[172:175], v[200:203]
  v_mfma_f32_16x16x32_bf16 v[204:207], v[248:251], a[232:235], v[204:207]
  ds_read_b64_tr_b16 v[246:247], v12 offset:9216
  v_mfma_f32_16x16x32_bf16 v[204:207], v[252:255], a[236:239], v[204:207]
  s_mov_b32 s32, 3184710632
  s_mov_b32 s33, 3222493025
  v_mov_b32 v28, s33
  s_mul_i32 s34, s56, 49152
  s_add_u32 s34, s34, 35651584
  s_mul_i32 s47, s37, 3
  s_add_u32 s35, s47, 1
  s_lshr_b32 s35, s35, 1
  s_lshl_b32 s35, s35, 10
  v_add_u32 v29, s35, v2
  s_and_b32 s47, s37, 1
  s_mul_i32 s47, s47, -2040
  s_add_u32 s47, s47, 1024
  v_add_u32 v30, s47, v29
  s_lshl_b32 s61, s2, 1
  s_lshr_b32 s47, s36, 1
  s_xor_b32 s47, s47, s36
  s_and_b32 s47, s47, 1
  s_add_u32 s61, s61, s47
  s_lshl_b32 s61, s61, 10
  s_add_u32 s61, s61, 98025472
  s_lshl_b32 s47, s47, 14
  s_add_u32 s47, s47, 131072
  v_add_u32 v31, s47, v2
  s_cmp_lt_u32 s36, 2
  s_cselect_b32 s47, s47, 0x10000
  v_add_u32 v27, s47, v2
  s_waitcnt lgkmcnt(15)
  v_subrev_u32 v13, 25600, v13
  v_mfma_f32_16x16x32_bf16 v[32:35], v[208:211], a[48:51], v[32:35]
  s_add_u32 s50, s40, 16384
  s_add_u32 m0, s41, 32768
  ds_read_b64_tr_b16 v[248:249], v13 offset:0
  v_mfma_f32_16x16x32_bf16 v[32:35], v[212:215], a[52:55], v[32:35]
  buffer_load_dwordx4 v2, s[16:19], s50 offen offset:0 sc1 lds
  v_mfma_f32_16x16x32_bf16 v[36:39], v[208:211], a[112:115], v[36:39]
  ds_read_b64_tr_b16 v[250:251], v13 offset:1024
  v_mfma_f32_16x16x32_bf16 v[36:39], v[212:215], a[116:119], v[36:39]
  buffer_store_dwordx4 a[0:3], v2, s[16:19], s64 offen offset:3072 sc1
  v_mfma_f32_16x16x32_bf16 v[40:43], v[208:211], a[176:179], v[40:43]
  ds_read_b64_tr_b16 v[252:253], v13 offset:8192
  v_mfma_f32_16x16x32_bf16 v[40:43], v[212:215], a[180:183], v[40:43]
  v_mfma_f32_16x16x32_bf16 v[44:47], v[208:211], a[240:243], v[44:47]
  ds_read_b64_tr_b16 v[254:255], v13 offset:9216
  v_mfma_f32_16x16x32_bf16 v[44:47], v[212:215], a[244:247], v[44:47]
  buffer_load_dwordx4 v2, s[16:19], s50 offen offset:1024 sc1 lds
  s_waitcnt lgkmcnt(15)
  v_subrev_u32 v14, 25600, v14
  v_mfma_f32_16x16x32_bf16 v[48:51], v[216:219], a[48:51], v[48:51]
  ds_read_b64_tr_b16 v[208:209], v14 offset:0
  v_mfma_f32_16x16x32_bf16 v[48:51], v[220:223], a[52:55], v[48:51]
  v_mfma_f32_16x16x32_bf16 v[52:55], v[216:219], a[112:115], v[52:55]
  ds_read_b64_tr_b16 v[210:211], v14 offset:1024
  v_mfma_f32_16x16x32_bf16 v[52:55], v[220:223], a[116:119], v[52:55]
  v_mfma_f32_16x16x32_bf16 v[56:59], v[216:219], a[176:179], v[56:59]
  ds_read_b64_tr_b16 v[212:213], v14 offset:8192
  v_mfma_f32_16x16x32_bf16 v[56:59], v[220:223], a[180:183], v[56:59]
  buffer_load_dwordx4 v2, s[16:19], s50 offen offset:2048 sc1 lds
  v_mfma_f32_16x16x32_bf16 v[60:63], v[216:219], a[240:243], v[60:63]
  ds_read_b64_tr_b16 v[214:215], v14 offset:9216
  v_mfma_f32_16x16x32_bf16 v[60:63], v[220:223], a[244:247], v[60:63]
  s_waitcnt lgkmcnt(15)
  v_subrev_u32 v15, 25600, v15
  v_mfma_f32_16x16x32_bf16 v[64:67], v[224:227], a[48:51], v[64:67]
  ds_read_b64_tr_b16 v[216:217], v15 offset:0
  s_mov_b32 s39, -1
  v_and_b32 v24, 15, v1
  v_mfma_f32_16x16x32_bf16 v[64:67], v[228:231], a[52:55], v[64:67]
  s_add_u32 s4, s49, 2
  v_lshrrev_b32 v25, 4, v1
  v_lshlrev_b32 v25, 2, v25
  v_mfma_f32_16x16x32_bf16 v[68:71], v[224:227], a[112:115], v[68:71]
  ds_read_b64_tr_b16 v[218:219], v15 offset:1024
  s_add_u32 s5, s49, 4
  v_add_u32 v26, 0, v25
  v_mfma_f32_16x16x32_bf16 v[68:71], v[228:231], a[116:119], v[68:71]
  buffer_load_dwordx4 v2, s[16:19], s50 offen offset:3072 sc1 lds
  s_sub_u32 s6, 30, s49
  v_cmp_le_u32 s[8:9], v26, v24
  v_add_u32 v26, 1, v25
  v_mfma_f32_16x16x32_bf16 v[72:75], v[224:227], a[176:179], v[72:75]
  ds_read_b64_tr_b16 v[220:221], v15 offset:8192
  s_mov_b32 s55, 0
  v_cmp_le_u32 s[10:11], v26, v24
  v_mfma_f32_16x16x32_bf16 v[72:75], v[228:231], a[180:183], v[72:75]
  s_add_u32 s50, s39, 3
  v_add_u32 v26, 2, v25
  v_cmp_le_u32 s[12:13], v26, v24
  v_mfma_f32_16x16x32_bf16 v[76:79], v[224:227], a[240:243], v[76:79]
  ds_read_b64_tr_b16 v[222:223], v15 offset:9216
  s_lshl_b32 s51, s50, 1
  v_add_u32 v26, 3, v25
  v_mfma_f32_16x16x32_bf16 v[76:79], v[228:231], a[244:247], v[76:79]
  s_sub_u32 s51, s51, s5
  v_cmp_le_u32 s[14:15], v26, v24
  v_and_b32 v24, 3, v1
  s_waitcnt lgkmcnt(15)
  v_subrev_u32 v18, 25600, v18
  v_mfma_f32_16x16x32_bf16 v[80:83], v[232:235], a[48:51], v[80:83]
  ds_read_b64_tr_b16 v[224:225], v18 offset:0
  s_cmp_eq_u32 s50, s4
  v_cmp_eq_u32 vcc, 0, v24
  v_mfma_f32_16x16x32_bf16 v[80:83], v[236:239], a[52:55], v[80:83]
  s_cselect_b32 s51, s6, s51
  v_mov_b32 v25, 0x3f803f80
  v_nop
  v_mfma_f32_16x16x32_bf16 v[84:87], v[232:235], a[112:115], v[84:87]
  ds_read_b64_tr_b16 v[226:227], v18 offset:384
  s_cmp_lt_u32 s50, s4
  v_cndmask_b32 v24, 0, v25, vcc
  v_mfma_f32_16x16x32_bf16 v[84:87], v[236:239], a[116:119], v[84:87]
  buffer_store_dwordx4 a[0:3], v2, s[16:19], s65 offen offset:0 sc1
  s_cselect_b32 s51, s50, s51
  v_mfma_f32_16x16x32_bf16 v[88:91], v[232:235], a[176:179], v[88:91]
  ds_read_b64_tr_b16 v[228:229], v18 offset:4608
  s_cmp_gt_u32 s50, 16
  v_accvgpr_write_b32 a208, v24
  v_mfma_f32_16x16x32_bf16 v[88:91], v[236:239], a[180:183], v[88:91]
  s_cselect_b32 s51, 0x8000, s51
  v_accvgpr_write_b32 a209, v24
  v_accvgpr_write_b32 a210, v24
  v_mfma_f32_16x16x32_bf16 v[92:95], v[232:235], a[240:243], v[92:95]
  ds_read_b64_tr_b16 v[230:231], v18 offset:4992
  s_lshl_b32 s51, s51, 15
  v_accvgpr_write_b32 a211, v24
  v_mfma_f32_16x16x32_bf16 v[92:95], v[236:239], a[244:247], v[92:95]
  s_add_u32 s42, s51, s40
  s_waitcnt lgkmcnt(15)
  v_mfma_f32_16x16x32_bf16 v[96:99], v[240:243], a[48:51], v[96:99]
  ds_read_b64_tr_b16 v[232:233], v18 offset:32
  s_add_u32 s50, s39, 2
  v_mfma_f32_16x16x32_bf16 v[96:99], v[244:247], a[52:55], v[96:99]
  s_lshl_b32 s51, s50, 1
  v_mfma_f32_16x16x32_bf16 v[100:103], v[240:243], a[112:115], v[100:103]
  ds_read_b64_tr_b16 v[234:235], v18 offset:416
  s_sub_u32 s51, s51, s5
  v_mfma_f32_16x16x32_bf16 v[100:103], v[244:247], a[116:119], v[100:103]
  s_cmp_eq_u32 s50, s4
  v_mfma_f32_16x16x32_bf16 v[104:107], v[240:243], a[176:179], v[104:107]
  ds_read_b64_tr_b16 v[236:237], v18 offset:4640
  s_cselect_b32 s51, s6, s51
  v_mfma_f32_16x16x32_bf16 v[104:107], v[244:247], a[180:183], v[104:107]
  s_cmp_lt_u32 s50, s4
  v_mfma_f32_16x16x32_bf16 v[108:111], v[240:243], a[240:243], v[108:111]
  ds_read_b64_tr_b16 v[238:239], v18 offset:5024
  s_cselect_b32 s51, s50, s51
  v_mfma_f32_16x16x32_bf16 v[108:111], v[244:247], a[244:247], v[108:111]
  s_cmp_gt_u32 s50, 16
  s_waitcnt lgkmcnt(15)
  v_mfma_f32_16x16x32_bf16 v[112:115], v[248:251], a[48:51], v[112:115]
  ds_read_b64_tr_b16 v[240:241], v18 offset:64
  s_cselect_b32 s51, 0x8000, s51
  v_mfma_f32_16x16x32_bf16 v[112:115], v[252:255], a[52:55], v[112:115]
  s_lshl_b32 s51, s51, 15
  v_mfma_f32_16x16x32_bf16 v[116:119], v[248:251], a[112:115], v[116:119]
  ds_read_b64_tr_b16 v[242:243], v18 offset:448
  s_add_u32 s43, s51, s40
  v_mfma_f32_16x16x32_bf16 v[116:119], v[252:255], a[116:119], v[116:119]
  s_add_u32 s43, s43, 16384
  v_mfma_f32_16x16x32_bf16 v[120:123], v[248:251], a[176:179], v[120:123]
  ds_read_b64_tr_b16 v[244:245], v18 offset:4672
  s_and_b32 s50, s39, 1
  v_mfma_f32_16x16x32_bf16 v[120:123], v[252:255], a[180:183], v[120:123]
  s_lshl_b32 s50, s50, 14
  v_mfma_f32_16x16x32_bf16 v[124:127], v[248:251], a[240:243], v[124:127]
  ds_read_b64_tr_b16 v[246:247], v18 offset:5056
  s_add_u32 s51, s39, 2
  v_mfma_f32_16x16x32_bf16 v[124:127], v[252:255], a[244:247], v[124:127]
  s_sub_u32 s51, s51, s49
  s_waitcnt lgkmcnt(15)
  s_waitcnt vmcnt(16)
  s_barrier
  v_add_u32 v18, 25600, v18
  v_mfma_f32_16x16x32_bf16 v[128:131], v[208:211], a[48:51], v[128:131]
  ds_read_b64_tr_b16 v[248:249], v18 offset:25600
  s_cmp_ge_i32 s51, 2
  v_mfma_f32_16x16x32_bf16 v[128:131], v[212:215], a[52:55], v[128:131]
  s_cselect_b32 s46, s48, 0
  v_mfma_f32_16x16x32_bf16 v[132:135], v[208:211], a[112:115], v[132:135]
  ds_read_b64_tr_b16 v[250:251], v18 offset:25984
  s_add_u32 s46, s46, s50
  v_mfma_f32_16x16x32_bf16 v[132:135], v[212:215], a[116:119], v[132:135]
  buffer_store_dwordx4 a[0:3], v2, s[16:19], s65 offen offset:1024 sc1
  s_cmp_ge_i32 s51, 3
  v_mfma_f32_16x16x32_bf16 v[136:139], v[208:211], a[176:179], v[136:139]
  ds_read_b64_tr_b16 v[252:253], v18 offset:30208
  s_cselect_b32 s47, s48, 0
  v_mfma_f32_16x16x32_bf16 v[136:139], v[212:215], a[180:183], v[136:139]
  s_xor_b32 s51, s50, 0x4000
  v_mfma_f32_16x16x32_bf16 v[140:143], v[208:211], a[240:243], v[140:143]
  ds_read_b64_tr_b16 v[254:255], v18 offset:30592
  s_add_u32 s47, s47, s51
  v_mfma_f32_16x16x32_bf16 v[140:143], v[212:215], a[244:247], v[140:143]
  s_add_u32 s47, s47, 0x8000
  s_waitcnt lgkmcnt(15)
  v_mfma_f32_16x16x32_bf16 v[144:147], v[216:219], a[48:51], v[144:147]
  ds_read_b64_tr_b16 v[208:209], v18 offset:25632
  s_add_u32 s58, s51, s41
  v_mfma_f32_16x16x32_bf16 v[144:147], v[220:223], a[52:55], v[144:147]
  s_add_u32 s59, s50, s41
  v_mfma_f32_16x16x32_bf16 v[148:151], v[216:219], a[112:115], v[148:151]
  ds_read_b64_tr_b16 v[210:211], v18 offset:26016
  s_add_u32 s59, s59, 0x8000
  v_mfma_f32_16x16x32_bf16 v[148:151], v[220:223], a[116:119], v[148:151]
  s_add_u32 s50, s39, 3
  v_mfma_f32_16x16x32_bf16 v[152:155], v[216:219], a[176:179], v[152:155]
  ds_read_b64_tr_b16 v[212:213], v18 offset:30240
  s_lshl_b32 s51, s50, 1
  v_mfma_f32_16x16x32_bf16 v[152:155], v[220:223], a[180:183], v[152:155]
  s_sub_u32 s51, s51, s5
  v_mfma_f32_16x16x32_bf16 v[156:159], v[216:219], a[240:243], v[156:159]
  ds_read_b64_tr_b16 v[214:215], v18 offset:30624
  s_cmp_eq_u32 s50, s4
  v_mfma_f32_16x16x32_bf16 v[156:159], v[220:223], a[244:247], v[156:159]
  s_cselect_b32 s51, s6, s51
  s_waitcnt lgkmcnt(15)
  v_mfma_f32_16x16x32_bf16 v[160:163], v[224:227], a[48:51], v[160:163]
  ds_read_b64_tr_b16 v[216:217], v18 offset:25664
  s_add_u32 s51, s51, 1
  v_mfma_f32_16x16x32_bf16 v[160:163], v[228:231], a[52:55], v[160:163]
  s_cmp_lt_u32 s50, s4
  v_mfma_f32_16x16x32_bf16 v[164:167], v[224:227], a[112:115], v[164:167]
  ds_read_b64_tr_b16 v[218:219], v18 offset:26048
  s_cselect_b32 s51, 0x8000, s51
  v_mfma_f32_16x16x32_bf16 v[164:167], v[228:231], a[116:119], v[164:167]
  s_cmp_gt_u32 s50, 16
  v_mfma_f32_16x16x32_bf16 v[168:171], v[224:227], a[176:179], v[168:171]
  ds_read_b64_tr_b16 v[220:221], v18 offset:30272
  s_cselect_b32 s51, 0x8000, s51
  v_mfma_f32_16x16x32_bf16 v[168:171], v[228:231], a[180:183], v[168:171]
  s_lshl_b32 s51, s51, 15
  v_mfma_f32_16x16x32_bf16 v[172:175], v[224:227], a[240:243], v[172:175]
  ds_read_b64_tr_b16 v[222:223], v18 offset:30656
  s_add_u32 s44, s51, s40
  v_mfma_f32_16x16x32_bf16 v[172:175], v[228:231], a[244:247], v[172:175]
  s_add_u32 s50, s39, 2
  s_waitcnt lgkmcnt(15)
  v_add_u32 v8, 25600, v8
  v_mfma_f32_16x16x32_bf16 v[176:179], v[232:235], a[48:51], v[176:179]
  ds_read_b64_tr_b16 v[224:225], v8 offset:25600
  s_lshl_b32 s51, s50, 1
  v_mfma_f32_16x16x32_bf16 v[176:179], v[236:239], a[52:55], v[176:179]
  s_sub_u32 s51, s51, s5
  v_mfma_f32_16x16x32_bf16 v[180:183], v[232:235], a[112:115], v[180:183]
  ds_read_b64_tr_b16 v[226:227], v8 offset:26624
  s_cmp_eq_u32 s50, s4
  v_mfma_f32_16x16x32_bf16 v[180:183], v[236:239], a[116:119], v[180:183]
  buffer_store_dwordx4 a[0:3], v2, s[16:19], s65 offen offset:2048 sc1
  s_cselect_b32 s51, s6, s51
  v_mfma_f32_16x16x32_bf16 v[184:187], v[232:235], a[176:179], v[184:187]
  ds_read_b64_tr_b16 v[228:229], v8 offset:33792
  s_add_u32 s51, s51, 1
  v_mfma_f32_16x16x32_bf16 v[184:187], v[236:239], a[180:183], v[184:187]
  s_cmp_lt_u32 s50, s4
  v_mfma_f32_16x16x32_bf16 v[188:191], v[232:235], a[240:243], v[188:191]
  ds_read_b64_tr_b16 v[230:231], v8 offset:34816
  s_cselect_b32 s51, 0x8000, s51
  v_mfma_f32_16x16x32_bf16 v[188:191], v[236:239], a[244:247], v[188:191]
  s_cmp_gt_u32 s50, 16
  s_waitcnt lgkmcnt(15)
  v_add_u32 v9, 25600, v9
  v_mfma_f32_16x16x32_bf16 v[192:195], v[240:243], a[48:51], v[192:195]
  ds_read_b64_tr_b16 v[232:233], v9 offset:25600
  s_cselect_b32 s51, 0x8000, s51
  v_mfma_f32_16x16x32_bf16 v[192:195], v[244:247], a[52:55], v[192:195]
  s_lshl_b32 s51, s51, 15
  v_mfma_f32_16x16x32_bf16 v[196:199], v[240:243], a[112:115], v[196:199]
  ds_read_b64_tr_b16 v[234:235], v9 offset:26624
  s_add_u32 s45, s51, s40
  v_mfma_f32_16x16x32_bf16 v[196:199], v[244:247], a[116:119], v[196:199]
  s_add_u32 s45, s45, 16384
  v_mfma_f32_16x16x32_bf16 v[200:203], v[240:243], a[176:179], v[200:203]
  ds_read_b64_tr_b16 v[236:237], v9 offset:33792
  s_mov_b32 s39, 0
  v_mfma_f32_16x16x32_bf16 v[200:203], v[244:247], a[180:183], v[200:203]
  v_mfma_f32_16x16x32_bf16 v[204:207], v[240:243], a[240:243], v[204:207]
  ds_read_b64_tr_b16 v[238:239], v9 offset:34816
  v_mfma_f32_16x16x32_bf16 v[204:207], v[244:247], a[244:247], v[204:207]
  s_waitcnt lgkmcnt(15)
  v_add_u32 v10, 25600, v10
  v_mfma_f32_16x16x32_bf16 v[160:163], v[248:251], a[56:59], v[160:163]
  ds_read_b64_tr_b16 v[240:241], v10 offset:25600
  v_mfma_f32_16x16x32_bf16 v[160:163], v[252:255], a[60:63], v[160:163]
  v_mfma_f32_16x16x32_bf16 v[164:167], v[248:251], a[120:123], v[164:167]
  ds_read_b64_tr_b16 v[242:243], v10 offset:26624
  v_mfma_f32_16x16x32_bf16 v[164:167], v[252:255], a[124:127], v[164:167]
  v_mfma_f32_16x16x32_bf16 v[168:171], v[248:251], a[184:187], v[168:171]
  ds_read_b64_tr_b16 v[244:245], v10 offset:33792
  v_mfma_f32_16x16x32_bf16 v[168:171], v[252:255], a[188:191], v[168:171]
  v_mfma_f32_16x16x32_bf16 v[172:175], v[248:251], a[248:251], v[172:175]
  ds_read_b64_tr_b16 v[246:247], v10 offset:34816
  v_mfma_f32_16x16x32_bf16 v[172:175], v[252:255], a[252:255], v[172:175]
  s_waitcnt lgkmcnt(15)
  v_add_u32 v11, 25600, v11
  v_mfma_f32_16x16x32_bf16 v[176:179], v[208:211], a[56:59], v[176:179]
  ds_read_b64_tr_b16 v[248:249], v11 offset:25600
  v_mfma_f32_16x16x32_bf16 v[176:179], v[212:215], a[60:63], v[176:179]
  v_mfma_f32_16x16x32_bf16 v[180:183], v[208:211], a[120:123], v[180:183]
  ds_read_b64_tr_b16 v[250:251], v11 offset:26624
  v_mfma_f32_16x16x32_bf16 v[180:183], v[212:215], a[124:127], v[180:183]
  buffer_store_dwordx4 a[0:3], v2, s[16:19], s65 offen offset:3072 sc1
  v_mfma_f32_16x16x32_bf16 v[184:187], v[208:211], a[184:187], v[184:187]
  ds_read_b64_tr_b16 v[252:253], v11 offset:33792
  v_mfma_f32_16x16x32_bf16 v[184:187], v[212:215], a[188:191], v[184:187]
  v_mfma_f32_16x16x32_bf16 v[188:191], v[208:211], a[248:251], v[188:191]
  ds_read_b64_tr_b16 v[254:255], v11 offset:34816
  v_mfma_f32_16x16x32_bf16 v[188:191], v[212:215], a[252:255], v[188:191]
  s_waitcnt lgkmcnt(15)
  v_add_u32 v12, 25600, v12
  v_mfma_f32_16x16x32_bf16 v[192:195], v[216:219], a[56:59], v[192:195]
  ds_read_b64_tr_b16 v[208:209], v12 offset:25600
  v_mfma_f32_16x16x32_bf16 v[192:195], v[220:223], a[60:63], v[192:195]
  v_mfma_f32_16x16x32_bf16 v[196:199], v[216:219], a[120:123], v[196:199]
  ds_read_b64_tr_b16 v[210:211], v12 offset:26624
  v_mfma_f32_16x16x32_bf16 v[196:199], v[220:223], a[124:127], v[196:199]
  v_mfma_f32_16x16x32_bf16 v[200:203], v[216:219], a[184:187], v[200:203]
  ds_read_b64_tr_b16 v[212:213], v12 offset:33792
  v_mfma_f32_16x16x32_bf16 v[200:203], v[220:223], a[188:191], v[200:203]
  v_mfma_f32_16x16x32_bf16 v[204:207], v[216:219], a[248:251], v[204:207]
  ds_read_b64_tr_b16 v[214:215], v12 offset:34816
  v_mfma_f32_16x16x32_bf16 v[204:207], v[220:223], a[252:255], v[204:207]
  s_waitcnt lgkmcnt(15)
  v_add_u32 v13, 25600, v13
  v_mfma_f32_16x16x32_bf16 v[32:35], v[224:227], a[56:59], v[32:35]
  ds_read_b64_tr_b16 v[216:217], v13 offset:25600
  v_mfma_f32_16x16x32_bf16 v[32:35], v[228:231], a[60:63], v[32:35]
  v_mfma_f32_16x16x32_bf16 v[36:39], v[224:227], a[120:123], v[36:39]
  ds_read_b64_tr_b16 v[218:219], v13 offset:26624
  v_mfma_f32_16x16x32_bf16 v[36:39], v[228:231], a[124:127], v[36:39]
  v_mfma_f32_16x16x32_bf16 v[40:43], v[224:227], a[184:187], v[40:43]
  ds_read_b64_tr_b16 v[220:221], v13 offset:33792
  v_mfma_f32_16x16x32_bf16 v[40:43], v[228:231], a[188:191], v[40:43]
  v_mfma_f32_16x16x32_bf16 v[44:47], v[224:227], a[248:251], v[44:47]
  ds_read_b64_tr_b16 v[222:223], v13 offset:34816
  v_mfma_f32_16x16x32_bf16 v[44:47], v[228:231], a[252:255], v[44:47]
  s_waitcnt vmcnt(4)
  s_barrier
  v_mov_b32 v3, v2
  s_waitcnt lgkmcnt(15)
  v_add_u32 v14, 25600, v14
  v_mfma_f32_16x16x32_bf16 v[48:51], v[232:235], a[56:59], v[48:51]
  ds_read_b64_tr_b16 v[224:225], v14 offset:25600
  v_mul_f32 v20, v160, v160
  v_mfma_f32_16x16x32_bf16 v[48:51], v[236:239], a[60:63], v[48:51]
  v_mul_f32 v21, v161, v161
  v_mul_f32 v22, v162, v162
  v_mfma_f32_16x16x32_bf16 v[52:55], v[232:235], a[120:123], v[52:55]
  ds_read_b64_tr_b16 v[226:227], v14 offset:26624
  v_mul_f32 v23, v163, v163
  v_mfma_f32_16x16x32_bf16 v[52:55], v[236:239], a[124:127], v[52:55]
  v_fma_f32 v20, v20, s32, v28
  v_fma_f32 v21, v21, s32, v28
  v_mfma_f32_16x16x32_bf16 v[56:59], v[232:235], a[184:187], v[56:59]
  ds_read_b64_tr_b16 v[228:229], v14 offset:33792
  v_fma_f32 v22, v22, s32, v28
  v_mfma_f32_16x16x32_bf16 v[56:59], v[236:239], a[188:191], v[56:59]
  v_fma_f32 v23, v23, s32, v28
  v_mul_f32 v20, v20, v160
  v_mfma_f32_16x16x32_bf16 v[60:63], v[232:235], a[248:251], v[60:63]
  ds_read_b64_tr_b16 v[230:231], v14 offset:34816
  v_mul_f32 v21, v21, v161
  v_mfma_f32_16x16x32_bf16 v[60:63], v[236:239], a[252:255], v[60:63]
  v_mul_f32 v22, v22, v162
  v_mul_f32 v23, v23, v163
  s_waitcnt lgkmcnt(15)
  v_add_u32 v15, 25600, v15
  v_mfma_f32_16x16x32_bf16 v[64:67], v[240:243], a[56:59], v[64:67]
  ds_read_b64_tr_b16 v[232:233], v15 offset:25600
  v_mfma_f32_16x16x32_bf16 v[64:67], v[244:247], a[60:63], v[64:67]
  v_exp_f32 v20, v20
  v_mfma_f32_16x16x32_bf16 v[68:71], v[240:243], a[120:123], v[68:71]
  ds_read_b64_tr_b16 v[234:235], v15 offset:26624
  v_mfma_f32_16x16x32_bf16 v[68:71], v[244:247], a[124:127], v[68:71]
  v_exp_f32 v21, v21
  v_mfma_f32_16x16x32_bf16 v[72:75], v[240:243], a[184:187], v[72:75]
  ds_read_b64_tr_b16 v[236:237], v15 offset:33792
  v_mfma_f32_16x16x32_bf16 v[72:75], v[244:247], a[188:191], v[72:75]
  v_exp_f32 v22, v22
  v_mfma_f32_16x16x32_bf16 v[76:79], v[240:243], a[248:251], v[76:79]
  ds_read_b64_tr_b16 v[238:239], v15 offset:34816
  v_mfma_f32_16x16x32_bf16 v[76:79], v[244:247], a[252:255], v[76:79]
  v_exp_f32 v23, v23
  s_waitcnt lgkmcnt(15)
  v_mfma_f32_16x16x32_bf16 v[80:83], v[248:251], a[56:59], v[80:83]
  ds_read_b128 a[144:147], v3 offset:0
  v_cvt_pk_bf16_f32 v32, v32, v33
  v_mfma_f32_16x16x32_bf16 v[80:83], v[252:255], a[60:63], v[80:83]
  v_cvt_pk_bf16_f32 v33, v34, v35
  v_cvt_pk_bf16_f32 v34, v48, v49
  v_mfma_f32_16x16x32_bf16 v[84:87], v[248:251], a[120:123], v[84:87]
  ds_read_b128 a[148:151], v3 offset:1024
  v_cvt_pk_bf16_f32 v35, v50, v51
  v_mfma_f32_16x16x32_bf16 v[84:87], v[252:255], a[124:127], v[84:87]
  ds_write_b128 v27, v[32:35] offset:0
  v_mfma_f32_16x16x32_bf16 v[88:91], v[248:251], a[184:187], v[88:91]
  ds_read_b128 a[152:155], v3 offset:2048
  v_cvt_pk_bf16_f32 v36, v36, v37
  v_mfma_f32_16x16x32_bf16 v[88:91], v[252:255], a[188:191], v[88:91]
  v_cvt_pk_bf16_f32 v37, v38, v39
  v_cvt_pk_bf16_f32 v38, v52, v53
  v_mfma_f32_16x16x32_bf16 v[92:95], v[248:251], a[248:251], v[92:95]
  ds_read_b128 a[156:159], v3 offset:3072
  v_cvt_pk_bf16_f32 v39, v54, v55
  v_mfma_f32_16x16x32_bf16 v[92:95], v[252:255], a[252:255], v[92:95]
  ds_write_b128 v27, v[36:39] offset:4096
  s_waitcnt lgkmcnt(15)
  v_mfma_f32_16x16x32_bf16 v[96:99], v[208:211], a[56:59], v[96:99]
  ds_read_b128 a[128:131], v3 offset:4096
  v_cvt_pk_bf16_f32 v40, v40, v41
  v_mfma_f32_16x16x32_bf16 v[96:99], v[212:215], a[60:63], v[96:99]
  v_cvt_pk_bf16_f32 v41, v42, v43
  v_cvt_pk_bf16_f32 v42, v56, v57
  v_mfma_f32_16x16x32_bf16 v[100:103], v[208:211], a[120:123], v[100:103]
  ds_read_b128 a[132:135], v3 offset:5120
  v_cvt_pk_bf16_f32 v43, v58, v59
  v_mfma_f32_16x16x32_bf16 v[100:103], v[212:215], a[124:127], v[100:103]
  ds_write_b128 v27, v[40:43] offset:8192
  v_mfma_f32_16x16x32_bf16 v[104:107], v[208:211], a[184:187], v[104:107]
  ds_read_b128 a[136:139], v3 offset:6144
  v_cvt_pk_bf16_f32 v44, v44, v45
  v_mfma_f32_16x16x32_bf16 v[104:107], v[212:215], a[188:191], v[104:107]
  v_cvt_pk_bf16_f32 v45, v46, v47
  v_cvt_pk_bf16_f32 v46, v60, v61
  v_mfma_f32_16x16x32_bf16 v[108:111], v[208:211], a[248:251], v[108:111]
  ds_read_b128 a[140:143], v3 offset:7168
  v_cvt_pk_bf16_f32 v47, v62, v63
  v_mfma_f32_16x16x32_bf16 v[108:111], v[212:215], a[252:255], v[108:111]
  ds_write_b128 v27, v[44:47] offset:12288
  s_waitcnt lgkmcnt(15)
  v_mfma_f32_16x16x32_bf16 v[112:115], v[216:219], a[56:59], v[112:115]
  ds_read_b128 a[160:163], v3 offset:8192
  v_cvt_pk_bf16_f32 v64, v64, v65
  v_mfma_f32_16x16x32_bf16 v[112:115], v[220:223], a[60:63], v[112:115]
  v_cvt_pk_bf16_f32 v65, v66, v67
  v_cvt_pk_bf16_f32 v66, v80, v81
  v_mfma_f32_16x16x32_bf16 v[116:119], v[216:219], a[120:123], v[116:119]
  ds_read_b128 a[164:167], v3 offset:9216
  v_cvt_pk_bf16_f32 v67, v82, v83
  v_mfma_f32_16x16x32_bf16 v[116:119], v[220:223], a[124:127], v[116:119]
  ds_write_b128 v27, v[64:67] offset:1024
  v_mfma_f32_16x16x32_bf16 v[120:123], v[216:219], a[184:187], v[120:123]
  ds_read_b128 a[168:171], v3 offset:10240
  v_cvt_pk_bf16_f32 v68, v68, v69
  v_mfma_f32_16x16x32_bf16 v[120:123], v[220:223], a[188:191], v[120:123]
  v_cvt_pk_bf16_f32 v69, v70, v71
  v_cvt_pk_bf16_f32 v70, v84, v85
  v_mfma_f32_16x16x32_bf16 v[124:127], v[216:219], a[248:251], v[124:127]
  ds_read_b128 a[172:175], v3 offset:11264
  v_cvt_pk_bf16_f32 v71, v86, v87
  v_mfma_f32_16x16x32_bf16 v[124:127], v[220:223], a[252:255], v[124:127]
  ds_write_b128 v27, v[68:71] offset:5120
  s_waitcnt lgkmcnt(15)
  v_mfma_f32_16x16x32_bf16 v[128:131], v[224:227], a[56:59], v[128:131]
  v_cvt_pk_bf16_f32 v72, v72, v73
  v_cvt_pk_bf16_f32 v73, v74, v75
  v_mfma_f32_16x16x32_bf16 v[128:131], v[228:231], a[60:63], v[128:131]
  v_cvt_pk_bf16_f32 v74, v88, v89
  v_cvt_pk_bf16_f32 v75, v90, v91
  v_mfma_f32_16x16x32_bf16 v[132:135], v[224:227], a[120:123], v[132:135]
  ds_write_b128 v27, v[72:75] offset:9216
  v_mfma_f32_16x16x32_bf16 v[132:135], v[228:231], a[124:127], v[132:135]
  v_cvt_pk_bf16_f32 v76, v76, v77
  v_cvt_pk_bf16_f32 v77, v78, v79
  v_mfma_f32_16x16x32_bf16 v[136:139], v[224:227], a[184:187], v[136:139]
  v_cvt_pk_bf16_f32 v78, v92, v93
  v_cvt_pk_bf16_f32 v79, v94, v95
  v_mfma_f32_16x16x32_bf16 v[136:139], v[228:231], a[188:191], v[136:139]
  ds_write_b128 v27, v[76:79] offset:13312
  v_mfma_f32_16x16x32_bf16 v[140:143], v[224:227], a[248:251], v[140:143]
  v_add_f32 v20, 1.0, v20
  v_add_f32 v21, 1.0, v21
  v_mfma_f32_16x16x32_bf16 v[140:143], v[228:231], a[252:255], v[140:143]
  v_add_f32 v22, 1.0, v22
  v_add_f32 v23, 1.0, v23
  s_waitcnt lgkmcnt(15)
  v_mfma_f32_16x16x32_bf16 v[144:147], v[232:235], a[56:59], v[144:147]
  v_cvt_pk_bf16_f32 v96, v96, v97
  v_cvt_pk_bf16_f32 v97, v98, v99
  v_mfma_f32_16x16x32_bf16 v[144:147], v[236:239], a[60:63], v[144:147]
  v_cvt_pk_bf16_f32 v98, v112, v113
  v_cvt_pk_bf16_f32 v99, v114, v115
  v_mfma_f32_16x16x32_bf16 v[148:151], v[232:235], a[120:123], v[148:151]
  ds_write_b128 v27, v[96:99] offset:2048
  v_mfma_f32_16x16x32_bf16 v[148:151], v[236:239], a[124:127], v[148:151]
  v_cvt_pk_bf16_f32 v100, v100, v101
  v_cvt_pk_bf16_f32 v101, v102, v103
  v_mfma_f32_16x16x32_bf16 v[152:155], v[232:235], a[184:187], v[152:155]
  v_cvt_pk_bf16_f32 v102, v116, v117
  v_cvt_pk_bf16_f32 v103, v118, v119
  v_mfma_f32_16x16x32_bf16 v[152:155], v[236:239], a[188:191], v[152:155]
  ds_write_b128 v27, v[100:103] offset:6144
  v_mfma_f32_16x16x32_bf16 v[156:159], v[232:235], a[248:251], v[156:159]
  v_cvt_pk_bf16_f32 v104, v104, v105
  v_cvt_pk_bf16_f32 v105, v106, v107
  v_mfma_f32_16x16x32_bf16 v[156:159], v[236:239], a[252:255], v[156:159]
  v_cvt_pk_bf16_f32 v106, v120, v121
  v_cvt_pk_bf16_f32 v107, v122, v123
  ds_read_b128 a[176:179], v3 offset:12288
  ds_read_b128 a[180:183], v3 offset:13312
  ds_read_b128 a[184:187], v3 offset:14336
  ds_read_b128 a[188:191], v3 offset:15360
  ds_write_b128 v27, v[104:107] offset:10240
  v_cvt_pk_bf16_f32 v108, v108, v109
  v_cvt_pk_bf16_f32 v109, v110, v111
  v_cvt_pk_bf16_f32 v110, v124, v125
  v_cvt_pk_bf16_f32 v111, v126, v127
  ds_write_b128 v27, v[108:111] offset:14336
  v_cvt_pk_bf16_f32 v128, v128, v129
  v_cvt_pk_bf16_f32 v129, v130, v131
  v_cvt_pk_bf16_f32 v130, v144, v145
  v_cvt_pk_bf16_f32 v131, v146, v147
  ds_write_b128 v27, v[128:131] offset:3072
  v_cvt_pk_bf16_f32 v132, v132, v133
  v_cvt_pk_bf16_f32 v133, v134, v135
  v_cvt_pk_bf16_f32 v134, v148, v149
  v_cvt_pk_bf16_f32 v135, v150, v151
  ds_write_b128 v27, v[132:135] offset:7168
  v_cvt_pk_bf16_f32 v136, v136, v137
  v_cvt_pk_bf16_f32 v137, v138, v139
  v_cvt_pk_bf16_f32 v138, v152, v153
  v_cvt_pk_bf16_f32 v139, v154, v155
  ds_write_b128 v27, v[136:139] offset:11264
  v_cvt_pk_bf16_f32 v140, v140, v141
  v_cvt_pk_bf16_f32 v141, v142, v143
  v_cvt_pk_bf16_f32 v142, v156, v157
  v_cvt_pk_bf16_f32 v143, v158, v159
  ds_write_b128 v27, v[140:143] offset:15360
  s_cmp_lg_u32 s60, 0
  s_cbranch_scc1 L_nomaxpass
  s_call_b64 s[52:53], L_maxpass
L_nomaxpass:
  s_waitcnt lgkmcnt(15)
  v_mfma_f32_16x16x32_bf16 v[48:51], a[144:147], v[32:35], 0
  v_rcp_f32 v20, v20
  v_mfma_f32_16x16x32_bf16 v[48:51], a[148:151], v[64:67], v[48:51]
  v_rcp_f32 v21, v21
  v_mfma_f32_16x16x32_bf16 v[48:51], a[152:155], v[96:99], v[48:51]
  v_rcp_f32 v22, v22
  v_mfma_f32_16x16x32_bf16 v[48:51], a[156:159], v[128:131], v[48:51]
  v_rcp_f32 v23, v23
  v_mfma_f32_16x16x32_bf16 v[52:55], a[144:147], v[36:39], 0
  v_mul_f32 v160, v160, v20
  v_mul_f32 v161, v161, v21
  v_mfma_f32_16x16x32_bf16 v[52:55], a[148:151], v[68:71], v[52:55]
  v_mul_f32 v162, v162, v22
  v_mul_f32 v163, v163, v23
  v_mfma_f32_16x16x32_bf16 v[52:55], a[152:155], v[100:103], v[52:55]
  v_cvt_pk_bf16_f32 v160, v160, v161
  v_cvt_pk_bf16_f32 v161, v162, v163
  v_mfma_f32_16x16x32_bf16 v[52:55], a[156:159], v[132:135], v[52:55]
  v_mul_f32 v20, v176, v176
  v_mul_f32 v21, v177, v177
  v_mfma_f32_16x16x32_bf16 v[56:59], a[144:147], v[40:43], 0
  v_mul_f32 v22, v178, v178
  v_mul_f32 v23, v179, v179
  v_mfma_f32_16x16x32_bf16 v[56:59], a[148:151], v[72:75], v[56:59]
  v_fma_f32 v20, v20, s32, v28
  v_fma_f32 v21, v21, s32, v28
  v_mfma_f32_16x16x32_bf16 v[56:59], a[152:155], v[104:107], v[56:59]
  v_fma_f32 v22, v22, s32, v28
  v_fma_f32 v23, v23, s32, v28
  v_mfma_f32_16x16x32_bf16 v[56:59], a[156:159], v[136:139], v[56:59]
  v_mul_f32 v20, v20, v176
  v_mul_f32 v21, v21, v177
  v_mfma_f32_16x16x32_bf16 v[60:63], a[144:147], v[44:47], 0
  v_mul_f32 v22, v22, v178
  v_mul_f32 v23, v23, v179
  v_mfma_f32_16x16x32_bf16 v[60:63], a[148:151], v[76:79], v[60:63]
  v_exp_f32 v20, v20
  v_mfma_f32_16x16x32_bf16 v[60:63], a[152:155], v[108:111], v[60:63]
  v_exp_f32 v21, v21
  v_mfma_f32_16x16x32_bf16 v[60:63], a[156:159], v[140:143], v[60:63]
  v_exp_f32 v22, v22
  v_exp_f32 v23, v23
  v_add_f32 v20, 1.0, v20
  v_add_f32 v21, 1.0, v21
  v_add_f32 v22, 1.0, v22
  v_add_f32 v23, 1.0, v23
  v_rcp_f32 v20, v20
  s_cmp_lg_u32 s56, 0
  s_cbranch_scc1 L_nodiag0
  v_mov_b32 v8, 0xff7fffff
  v_cndmask_b32 v48, v8, v48, s[8:9]
  v_cndmask_b32 v49, v8, v49, s[10:11]
  v_cndmask_b32 v50, v8, v50, s[12:13]
  v_cndmask_b32 v51, v8, v51, s[14:15]
L_nodiag0:
  v_max3_f32 v240, v48, v49, v50
  v_max3_f32 v244, v52, v53, v54
  v_max3_f32 v248, v56, v57, v58
  v_max3_f32 v252, v60, v61, v62
  v_max_f32 v240, v240, v51
  v_max_f32 v244, v244, v55
  v_max_f32 v248, v248, v59
  v_max_f32 v252, v252, v63
  s_cmp_lg_u32 s60, 0
  s_cbranch_scc1 L_fastmax
  v_mov_b32 v240, v12
  v_mov_b32 v244, v13
  v_mov_b32 v248, v14
  v_mov_b32 v252, v15
L_fastmax:
  v_mov_b32 v241, v240
  v_mov_b32 v245, v244
  v_mov_b32 v249, v248
  v_mov_b32 v253, v252
  s_nop 0
  v_permlane16_swap_b32 v240, v241
  v_permlane16_swap_b32 v244, v245
  v_permlane16_swap_b32 v248, v249
  v_permlane16_swap_b32 v252, v253
  s_nop 0
  v_max_f32 v240, v240, v241
  v_max_f32 v244, v244, v245
  v_max_f32 v248, v248, v249
  v_max_f32 v252, v252, v253
  v_mov_b32 v241, v240
  v_mov_b32 v245, v244
  v_mov_b32 v249, v248
  v_mov_b32 v253, v252
  s_nop 0
  v_permlane32_swap_b32 v240, v241
  v_permlane32_swap_b32 v244, v245
  v_permlane32_swap_b32 v248, v249
  v_permlane32_swap_b32 v252, v253
  s_nop 0
  v_max_f32 v240, v240, v241
  v_max_f32 v244, v244, v245
  v_max_f32 v248, v248, v249
  v_max_f32 v252, v252, v253
  v_sub_f32 v240, 0, v240
  v_sub_f32 v244, 0, v244
  v_sub_f32 v248, 0, v248
  v_sub_f32 v252, 0, v252
  v_mov_b32 v241, v240
  v_mov_b32 v242, v240
  v_mov_b32 v243, v240
  v_mov_b32 v245, v244
  v_mov_b32 v246, v244
  v_mov_b32 v247, v244
  v_mov_b32 v249, v248
  v_mov_b32 v250, v248
  v_mov_b32 v251, v248
  v_mov_b32 v253, v252
  v_mov_b32 v254, v252
  v_mov_b32 v255, v252
  s_nop 0
  s_waitcnt lgkmcnt(15)
  v_mfma_f32_16x16x32_bf16 v[80:83], a[128:131], v[32:35], v[240:243]
  v_add_f32 v48, v48, v240
  v_add_f32 v49, v49, v240
  v_mfma_f32_16x16x32_bf16 v[80:83], a[132:135], v[64:67], v[80:83]
  v_add_f32 v50, v50, v240
  v_add_f32 v51, v51, v240
  v_mfma_f32_16x16x32_bf16 v[80:83], a[136:139], v[96:99], v[80:83]
  v_add_f32 v52, v52, v244
  v_add_f32 v53, v53, v244
  v_mfma_f32_16x16x32_bf16 v[80:83], a[140:143], v[128:131], v[80:83]
  v_add_f32 v54, v54, v244
  v_add_f32 v55, v55, v244
  v_mfma_f32_16x16x32_bf16 v[84:87], a[128:131], v[36:39], v[244:247]
  v_add_f32 v56, v56, v248
  v_add_f32 v57, v57, v248
  v_mfma_f32_16x16x32_bf16 v[84:87], a[132:135], v[68:71], v[84:87]
  v_add_f32 v58, v58, v248
  v_add_f32 v59, v59, v248
  v_mfma_f32_16x16x32_bf16 v[84:87], a[136:139], v[100:103], v[84:87]
  v_add_f32 v60, v60, v252
  v_add_f32 v61, v61, v252
  v_mfma_f32_16x16x32_bf16 v[84:87], a[140:143], v[132:135], v[84:87]
  v_add_f32 v62, v62, v252
  v_add_f32 v63, v63, v252
  v_mfma_f32_16x16x32_bf16 v[88:91], a[128:131], v[40:43], v[248:251]
  v_exp_f32 v48, v48
  v_mfma_f32_16x16x32_bf16 v[88:91], a[132:135], v[72:75], v[88:91]
  v_exp_f32 v49, v49
  v_mfma_f32_16x16x32_bf16 v[88:91], a[136:139], v[104:107], v[88:91]
  v_exp_f32 v50, v50
  v_mfma_f32_16x16x32_bf16 v[88:91], a[140:143], v[136:139], v[88:91]
  v_exp_f32 v51, v51
  v_mfma_f32_16x16x32_bf16 v[92:95], a[128:131], v[44:47], v[252:255]
  v_exp_f32 v52, v52
  v_mfma_f32_16x16x32_bf16 v[92:95], a[132:135], v[76:79], v[92:95]
  v_exp_f32 v53, v53
  v_mfma_f32_16x16x32_bf16 v[92:95], a[136:139], v[108:111], v[92:95]
  v_exp_f32 v54, v54
  v_mfma_f32_16x16x32_bf16 v[92:95], a[140:143], v[140:143], v[92:95]
  v_exp_f32 v55, v55
  s_waitcnt lgkmcnt(9)
  v_mfma_f32_16x16x32_bf16 v[112:115], a[160:163], v[32:35], v[240:243]
  v_exp_f32 v56, v56
  v_mfma_f32_16x16x32_bf16 v[112:115], a[164:167], v[64:67], v[112:115]
  v_exp_f32 v57, v57
  v_mfma_f32_16x16x32_bf16 v[112:115], a[168:171], v[96:99], v[112:115]
  v_exp_f32 v58, v58
  v_mfma_f32_16x16x32_bf16 v[112:115], a[172:175], v[128:131], v[112:115]
  v_exp_f32 v59, v59
  v_mfma_f32_16x16x32_bf16 v[116:119], a[160:163], v[36:39], v[244:247]
  v_exp_f32 v60, v60
  v_mfma_f32_16x16x32_bf16 v[116:119], a[164:167], v[68:71], v[116:119]
  v_exp_f32 v61, v61
  v_mfma_f32_16x16x32_bf16 v[116:119], a[168:171], v[100:103], v[116:119]
  v_exp_f32 v62, v62
  v_mfma_f32_16x16x32_bf16 v[116:119], a[172:175], v[132:135], v[116:119]
  v_exp_f32 v63, v63
  v_mfma_f32_16x16x32_bf16 v[120:123], a[160:163], v[40:43], v[248:251]
  v_rcp_f32 v21, v21
  v_mfma_f32_16x16x32_bf16 v[120:123], a[164:167], v[72:75], v[120:123]
  v_rcp_f32 v22, v22
  v_mfma_f32_16x16x32_bf16 v[120:123], a[168:171], v[104:107], v[120:123]
  v_rcp_f32 v23, v23
  v_mfma_f32_16x16x32_bf16 v[120:123], a[172:175], v[136:139], v[120:123]
  v_mul_f32 v176, v176, v20
  v_mul_f32 v177, v177, v21
  v_mfma_f32_16x16x32_bf16 v[124:127], a[160:163], v[44:47], v[252:255]
  v_mul_f32 v178, v178, v22
  v_mul_f32 v179, v179, v23
  v_mfma_f32_16x16x32_bf16 v[124:127], a[164:167], v[76:79], v[124:127]
  v_cvt_pk_bf16_f32 v162, v176, v177
  v_cvt_pk_bf16_f32 v163, v178, v179
  v_mfma_f32_16x16x32_bf16 v[124:127], a[168:171], v[108:111], v[124:127]
  s_add_u32 s35, s34, 0
  buffer_store_dwordx4 v[160:163], v29, s[16:19], s35 offen sc1
  v_mfma_f32_16x16x32_bf16 v[124:127], a[172:175], v[140:143], v[124:127]
  v_mul_f32 v20, v192, v192
  v_mul_f32 v21, v193, v193
  s_waitcnt lgkmcnt(0)
  v_mfma_f32_16x16x32_bf16 v[144:147], a[176:179], v[32:35], v[240:243]
  v_exp_f32 v80, v80
  v_mfma_f32_16x16x32_bf16 v[144:147], a[180:183], v[64:67], v[144:147]
  v_exp_f32 v81, v81
  v_mfma_f32_16x16x32_bf16 v[144:147], a[184:187], v[96:99], v[144:147]
  v_exp_f32 v82, v82
  v_mfma_f32_16x16x32_bf16 v[144:147], a[188:191], v[128:131], v[144:147]
  v_exp_f32 v83, v83
  v_mfma_f32_16x16x32_bf16 v[148:151], a[176:179], v[36:39], v[244:247]
  v_exp_f32 v84, v84
  v_mfma_f32_16x16x32_bf16 v[148:151], a[180:183], v[68:71], v[148:151]
  v_exp_f32 v85, v85
  v_mfma_f32_16x16x32_bf16 v[148:151], a[184:187], v[100:103], v[148:151]
  v_exp_f32 v86, v86
  v_mfma_f32_16x16x32_bf16 v[148:151], a[188:191], v[132:135], v[148:151]
  v_exp_f32 v87, v87
  v_mfma_f32_16x16x32_bf16 v[152:155], a[176:179], v[40:43], v[248:251]
  v_exp_f32 v88, v88
  v_mfma_f32_16x16x32_bf16 v[152:155], a[180:183], v[72:75], v[152:155]
  v_exp_f32 v89, v89
  v_mfma_f32_16x16x32_bf16 v[152:155], a[184:187], v[104:107], v[152:155]
  v_exp_f32 v90, v90
  v_mfma_f32_16x16x32_bf16 v[152:155], a[188:191], v[136:139], v[152:155]
  v_exp_f32 v91, v91
  v_mfma_f32_16x16x32_bf16 v[156:159], a[176:179], v[44:47], v[252:255]
  v_exp_f32 v92, v92
  v_mfma_f32_16x16x32_bf16 v[156:159], a[180:183], v[76:79], v[156:159]
  v_exp_f32 v93, v93
  v_mfma_f32_16x16x32_bf16 v[156:159], a[184:187], v[108:111], v[156:159]
  v_exp_f32 v94, v94
  v_mfma_f32_16x16x32_bf16 v[156:159], a[188:191], v[140:143], v[156:159]
  v_exp_f32 v95, v95
  s_barrier
  v_add_u32 v3, s46, v2
  v_add_u32 v19, s47, v2
  s_mov_b32 m0, s58
  s_lshl_b32 s7, s2, 2
  s_add_u32 s7, s7, s36
  v_and_b32 v18, 31, v1
  buffer_load_dwordx4 v2, s[16:19], s42 offen offset:0 sc1 lds
  v_lshlrev_b32 v18, 7, v18
  v_min_u32 v17, 0x500, v18
  s_lshl_b32 s33, s7, 12
  buffer_load_dwordx4 v2, s[16:19], s42 offen offset:1024 sc1 lds
  v_add_u32 v18, s33, v18
  s_mul_i32 s7, s7, 1408
  v_add_u32 v17, s7, v17
  buffer_load_dwordx4 v2, s[16:19], s42 offen offset:2048 sc1 lds
  v_min_u32 v17, 1409020, v17
  v_mul_f32 v22, v194, v194
  v_mul_f32 v23, v195, v195
  buffer_load_dwordx4 v2, s[16:19], s42 offen offset:3072 sc1 lds
  v_fma_f32 v20, v20, s32, v28
  v_fma_f32 v21, v21, s32, v28
  v_fma_f32 v22, v22, s32, v28
  s_mov_b32 m0, s59
  v_fma_f32 v23, v23, s32, v28
  v_mul_f32 v20, v20, v192
  v_mul_f32 v21, v21, v193
  buffer_load_dwordx4 v2, s[16:19], s43 offen offset:0 sc1 lds
  v_mul_f32 v22, v22, v194
  v_mul_f32 v23, v23, v195
  v_exp_f32 v20, v20
  buffer_load_dwordx4 v2, s[16:19], s43 offen offset:1024 sc1 lds
  v_exp_f32 v21, v21
  v_exp_f32 v22, v22
  v_exp_f32 v23, v23
  buffer_load_dwordx4 v2, s[16:19], s43 offen offset:2048 sc1 lds
  v_add_f32 v20, 1.0, v20
  v_add_f32 v21, 1.0, v21
  v_add_f32 v22, 1.0, v22
  buffer_load_dwordx4 v2, s[16:19], s43 offen offset:3072 sc1 lds
  v_add_f32 v23, 1.0, v23
  v_rcp_f32 v20, v20
  v_rcp_f32 v21, v21
  ds_read_b128 a[128:131], v19 offset:0
  v_rcp_f32 v22, v22
  v_rcp_f32 v23, v23
  v_mul_f32 v192, v192, v20
  ds_read_b128 a[132:135], v19 offset:1024
  v_mul_f32 v193, v193, v21
  v_mul_f32 v194, v194, v22
  v_mul_f32 v195, v195, v23
  ds_read_b128 a[136:139], v19 offset:2048
  v_cvt_pk_bf16_f32 v192, v192, v193
  v_cvt_pk_bf16_f32 v193, v194, v195
  buffer_store_dwordx2 v[192:193], v30, s[16:19], s35 offen sc1
  ds_read_b128 a[140:143], v19 offset:3072
  v_mov_b32 v8, 1.0
  v_mov_b32 v9, 1.0
  v_mov_b32 v10, v28
  ds_read_b128 a[144:147], v3 offset:0
  v_mov_b32 v11, v28
  s_mov_b32 s33, s32
  v_pk_mul_f32 v[20:21], v[164:165], v[164:165]
  ds_read_b128 a[148:151], v3 offset:1024
  v_pk_mul_f32 v[22:23], v[166:167], v[166:167]
  v_pk_fma_f32 v[20:21], v[20:21], s[32:33], v[10:11]
  v_pk_fma_f32 v[22:23], v[22:23], s[32:33], v[10:11]
  ds_read_b128 a[152:155], v3 offset:2048
  v_pk_mul_f32 v[20:21], v[20:21], v[164:165]
  v_pk_mul_f32 v[22:23], v[22:23], v[166:167]
  v_exp_f32 v20, v20
  ds_read_b128 a[156:159], v3 offset:3072
  v_exp_f32 v21, v21
  v_exp_f32 v22, v22
  v_exp_f32 v23, v23
  ds_read_b128 a[160:163], v19 offset:4096
  v_pk_add_f32 v[20:21], v[20:21], v[8:9]
  v_pk_add_f32 v[22:23], v[22:23], v[8:9]
  v_rcp_f32 v20, v20
  ds_read_b128 a[164:167], v19 offset:5120
  v_rcp_f32 v21, v21
  v_rcp_f32 v22, v22
  v_rcp_f32 v23, v23
  ds_read_b128 a[168:171], v19 offset:6144
  v_pk_mul_f32 v[164:165], v[164:165], v[20:21]
  v_pk_mul_f32 v[166:167], v[166:167], v[22:23]
  v_cvt_pk_bf16_f32 v164, v164, v165
  ds_read_b128 a[172:175], v19 offset:7168
  v_cvt_pk_bf16_f32 v165, v166, v167
  v_pk_mul_f32 v[12:13], v[180:181], v[180:181]
  v_pk_mul_f32 v[14:15], v[182:183], v[182:183]
  v_pk_fma_f32 v[12:13], v[12:13], s[32:33], v[10:11]
  v_pk_fma_f32 v[14:15], v[14:15], s[32:33], v[10:11]
  v_pk_mul_f32 v[12:13], v[12:13], v[180:181]
  v_pk_mul_f32 v[14:15], v[14:15], v[182:183]
  v_exp_f32 v12, v12
  v_exp_f32 v13, v13
  v_exp_f32 v14, v14
  v_exp_f32 v15, v15
  v_pk_add_f32 v[12:13], v[12:13], v[8:9]
  v_pk_add_f32 v[14:15], v[14:15], v[8:9]
  v_rcp_f32 v12, v12
  v_rcp_f32 v13, v13
  v_rcp_f32 v14, v14
  v_rcp_f32 v15, v15
  v_pk_mul_f32 v[180:181], v[180:181], v[12:13]
  v_pk_mul_f32 v[182:183], v[182:183], v[14:15]
  v_cvt_pk_bf16_f32 v166, v180, v181
  v_cvt_pk_bf16_f32 v167, v182, v183
  s_add_u32 s35, s34, 49152
  buffer_store_dwordx4 v[164:167], v29, s[16:19], s35 offen sc1
  v_pk_mul_f32 v[20:21], v[196:197], v[196:197]
  v_pk_mul_f32 v[22:23], v[198:199], v[198:199]
  v_pk_fma_f32 v[20:21], v[20:21], s[32:33], v[10:11]
  v_pk_fma_f32 v[22:23], v[22:23], s[32:33], v[10:11]
  v_pk_mul_f32 v[20:21], v[20:21], v[196:197]
  v_pk_mul_f32 v[22:23], v[22:23], v[198:199]
  v_exp_f32 v20, v20
  v_exp_f32 v21, v21
  v_exp_f32 v22, v22
  v_exp_f32 v23, v23
  v_pk_add_f32 v[20:21], v[20:21], v[8:9]
  v_pk_add_f32 v[22:23], v[22:23], v[8:9]
  v_rcp_f32 v20, v20
  v_rcp_f32 v21, v21
  v_rcp_f32 v22, v22
  v_rcp_f32 v23, v23
  v_pk_mul_f32 v[196:197], v[196:197], v[20:21]
  v_pk_mul_f32 v[198:199], v[198:199], v[22:23]
  v_cvt_pk_bf16_f32 v196, v196, v197
  v_cvt_pk_bf16_f32 v197, v198, v199
  buffer_store_dwordx2 v[196:197], v30, s[16:19], s35 offen sc1
  v_pk_mul_f32 v[12:13], v[168:169], v[168:169]
  v_pk_mul_f32 v[14:15], v[170:171], v[170:171]
  v_pk_fma_f32 v[12:13], v[12:13], s[32:33], v[10:11]
  v_pk_fma_f32 v[14:15], v[14:15], s[32:33], v[10:11]
  v_pk_mul_f32 v[12:13], v[12:13], v[168:169]
  v_pk_mul_f32 v[14:15], v[14:15], v[170:171]
  v_exp_f32 v12, v12
  v_exp_f32 v13, v13
  v_exp_f32 v14, v14
  v_exp_f32 v15, v15
  v_pk_add_f32 v[12:13], v[12:13], v[8:9]
  v_pk_add_f32 v[14:15], v[14:15], v[8:9]
  v_rcp_f32 v12, v12
  v_rcp_f32 v13, v13
  v_rcp_f32 v14, v14
  v_rcp_f32 v15, v15
  v_pk_mul_f32 v[168:169], v[168:169], v[12:13]
  v_pk_mul_f32 v[170:171], v[170:171], v[14:15]
  v_cvt_pk_bf16_f32 v168, v168, v169
  v_cvt_pk_bf16_f32 v169, v170, v171
  v_pk_mul_f32 v[20:21], v[184:185], v[184:185]
  v_pk_mul_f32 v[22:23], v[186:187], v[186:187]
  v_pk_fma_f32 v[20:21], v[20:21], s[32:33], v[10:11]
  v_pk_fma_f32 v[22:23], v[22:23], s[32:33], v[10:11]
  v_pk_mul_f32 v[20:21], v[20:21], v[184:185]
  v_pk_mul_f32 v[22:23], v[22:23], v[186:187]
  v_exp_f32 v20, v20
  v_exp_f32 v21, v21
  v_exp_f32 v22, v22
  v_exp_f32 v23, v23
  v_pk_add_f32 v[20:21], v[20:21], v[8:9]
  v_pk_add_f32 v[22:23], v[22:23], v[8:9]
  v_rcp_f32 v20, v20
  v_rcp_f32 v21, v21
  v_rcp_f32 v22, v22
  v_rcp_f32 v23, v23
  v_pk_mul_f32 v[184:185], v[184:185], v[20:21]
  v_pk_mul_f32 v[186:187], v[186:187], v[22:23]
  v_cvt_pk_bf16_f32 v170, v184, v185
  v_cvt_pk_bf16_f32 v171, v186, v187
  s_add_u32 s35, s34, 98304
  buffer_store_dwordx4 v[168:171], v29, s[16:19], s35 offen sc1
  v_pk_mul_f32 v[12:13], v[200:201], v[200:201]
  v_pk_mul_f32 v[14:15], v[202:203], v[202:203]
  v_pk_fma_f32 v[12:13], v[12:13], s[32:33], v[10:11]
  v_pk_fma_f32 v[14:15], v[14:15], s[32:33], v[10:11]
  v_pk_mul_f32 v[12:13], v[12:13], v[200:201]
  v_pk_mul_f32 v[14:15], v[14:15], v[202:203]
  v_exp_f32 v12, v12
  v_exp_f32 v13, v13
  v_exp_f32 v14, v14
  v_exp_f32 v15, v15
  v_pk_add_f32 v[12:13], v[12:13], v[8:9]
  v_pk_add_f32 v[14:15], v[14:15], v[8:9]
  v_rcp_f32 v12, v12
  v_rcp_f32 v13, v13
  v_rcp_f32 v14, v14
  v_rcp_f32 v15, v15
  v_pk_mul_f32 v[200:201], v[200:201], v[12:13]
  v_pk_mul_f32 v[202:203], v[202:203], v[14:15]
  v_cvt_pk_bf16_f32 v200, v200, v201
  v_cvt_pk_bf16_f32 v201, v202, v203
  buffer_store_dwordx2 v[200:201], v30, s[16:19], s35 offen sc1
  v_pk_mul_f32 v[20:21], v[172:173], v[172:173]
  v_pk_mul_f32 v[22:23], v[174:175], v[174:175]
  v_pk_fma_f32 v[20:21], v[20:21], s[32:33], v[10:11]
  v_pk_fma_f32 v[22:23], v[22:23], s[32:33], v[10:11]
  v_pk_mul_f32 v[20:21], v[20:21], v[172:173]
  v_pk_mul_f32 v[22:23], v[22:23], v[174:175]
  v_exp_f32 v20, v20
  v_exp_f32 v21, v21
  v_exp_f32 v22, v22
  v_exp_f32 v23, v23
  v_pk_add_f32 v[20:21], v[20:21], v[8:9]
  v_pk_add_f32 v[22:23], v[22:23], v[8:9]
  v_rcp_f32 v20, v20
  v_rcp_f32 v21, v21
  v_rcp_f32 v22, v22
  v_rcp_f32 v23, v23
  v_pk_mul_f32 v[172:173], v[172:173], v[20:21]
  v_pk_mul_f32 v[174:175], v[174:175], v[22:23]
  v_cvt_pk_bf16_f32 v172, v172, v173
  v_cvt_pk_bf16_f32 v173, v174, v175
  v_pk_mul_f32 v[12:13], v[188:189], v[188:189]
  v_pk_mul_f32 v[14:15], v[190:191], v[190:191]
  v_pk_fma_f32 v[12:13], v[12:13], s[32:33], v[10:11]
  v_pk_fma_f32 v[14:15], v[14:15], s[32:33], v[10:11]
  v_pk_mul_f32 v[12:13], v[12:13], v[188:189]
  v_pk_mul_f32 v[14:15], v[14:15], v[190:191]
  v_exp_f32 v12, v12
  v_exp_f32 v13, v13
  v_exp_f32 v14, v14
  v_exp_f32 v15, v15
  v_pk_add_f32 v[12:13], v[12:13], v[8:9]
  v_pk_add_f32 v[14:15], v[14:15], v[8:9]
  v_rcp_f32 v12, v12
  v_rcp_f32 v13, v13
  v_rcp_f32 v14, v14
  v_rcp_f32 v15, v15
  v_pk_mul_f32 v[188:189], v[188:189], v[12:13]
  v_pk_mul_f32 v[190:191], v[190:191], v[14:15]
  v_cvt_pk_bf16_f32 v174, v188, v189
  v_cvt_pk_bf16_f32 v175, v190, v191
  s_add_u32 s35, s34, 147456
  buffer_store_dwordx4 v[172:175], v29, s[16:19], s35 offen sc1
  v_pk_mul_f32 v[20:21], v[204:205], v[204:205]
  v_pk_mul_f32 v[22:23], v[206:207], v[206:207]
  v_pk_fma_f32 v[20:21], v[20:21], s[32:33], v[10:11]
  v_pk_fma_f32 v[22:23], v[22:23], s[32:33], v[10:11]
  v_pk_mul_f32 v[20:21], v[20:21], v[204:205]
  v_pk_mul_f32 v[22:23], v[22:23], v[206:207]
  v_exp_f32 v20, v20
  v_exp_f32 v21, v21
  v_exp_f32 v22, v22
  v_exp_f32 v23, v23
  v_pk_add_f32 v[20:21], v[20:21], v[8:9]
  v_pk_add_f32 v[22:23], v[22:23], v[8:9]
  v_rcp_f32 v20, v20
  v_rcp_f32 v21, v21
  v_rcp_f32 v22, v22
  v_rcp_f32 v23, v23
  v_pk_mul_f32 v[204:205], v[204:205], v[20:21]
  v_pk_mul_f32 v[206:207], v[206:207], v[22:23]
  v_cvt_pk_bf16_f32 v204, v204, v205
  v_cvt_pk_bf16_f32 v205, v206, v207
  buffer_store_dwordx2 v[204:205], v30, s[16:19], s35 offen sc1
  s_cmp_ge_u32 s36, 2
  s_cbranch_scc1 L_nostash2
  v_mov_b32 v8, v240
  v_mov_b32 v9, v244
  v_mov_b32 v10, v248
  v_mov_b32 v11, v252
  s_add_u32 s50, s61, 16384
  buffer_store_dwordx4 v[8:11], v2, s[16:19], s50 offen
L_nostash2:
  s_cmp_lg_u32 s56, 0
  s_cbranch_scc1 L_nodiag1
  v_mov_b32 v80, 0
  v_cndmask_b32 v84, 0, v84, s[8:9]
  v_mov_b32 v81, 0
  v_cndmask_b32 v85, 0, v85, s[10:11]
  v_mov_b32 v82, 0
  v_cndmask_b32 v86, 0, v86, s[12:13]
  v_mov_b32 v83, 0
  v_cndmask_b32 v87, 0, v87, s[14:15]
L_nodiag1:
  v_cvt_pk_bf16_f32 v208, v48, v49
  v_cvt_pk_bf16_f32 v209, v50, v51
  v_cvt_pk_bf16_f32 v210, v80, v81
  v_cvt_pk_bf16_f32 v211, v82, v83
  v_cvt_pk_bf16_f32 v212, v52, v53
  v_cvt_pk_bf16_f32 v213, v54, v55
  v_cvt_pk_bf16_f32 v214, v84, v85
  v_cvt_pk_bf16_f32 v215, v86, v87
  v_cvt_pk_bf16_f32 v216, v56, v57
  v_cvt_pk_bf16_f32 v217, v58, v59
  v_cvt_pk_bf16_f32 v218, v88, v89
  v_cvt_pk_bf16_f32 v219, v90, v91
  v_cvt_pk_bf16_f32 v220, v60, v61
  v_cvt_pk_bf16_f32 v221, v62, v63
  v_cvt_pk_bf16_f32 v222, v92, v93
  v_cvt_pk_bf16_f32 v223, v94, v95
  s_lshr_b32 s32, s2, 3
  s_lshl_b32 s32, s32, 2
  s_add_u32 s32, s32, s36
  s_and_b32 s32, s32, 63
  s_lshl_b32 s32, s32, 10
  s_add_u32 s32, s32, 34816
  s_min_u32 s32, s32, L_codeend-L_pcbase-1024
  v_add_u32 v16, s32, v2
  s_nop 1
  s_sub_u32 s32, s49, 1
  s_sub_u32 s33, s49, 2
  s_cmp_eq_u32 s36, 2
  s_cbranch_scc1 L_role2
  s_cmp_eq_u32 s36, 3
  s_cbranch_scc1 L_role3
  s_cmp_eq_u32 s38, 0
  s_cbranch_scc1 L_r01_t0
  s_call_b64 s[52:53], L_b_full_full_1fd
  s_branch L_r01_c
L_r01_t0:
  s_call_b64 s[52:53], L_b_full_full_1t0
L_r01_c:
  s_mov_b32 s54, s32
  s_cmp_gt_i32 s39, s54
  s_cbranch_scc1 L_skip_r01d
  s_call_b64 s[52:53], L_main_d
L_skip_r01d:
  s_cmp_eq_u32 s36, 0
  s_cbranch_scc1 L_role0
  s_mov_b32 s54, 15
  s_cmp_gt_i32 s39, s54
  s_cbranch_scc1 L_skip_r1s
  s_call_b64 s[52:53], L_main_s
L_skip_r1s:
  s_lshl_b32 s34, s2, 2
  s_add_u32 s34, s34, s36
  s_lshl_b32 s34, s34, 7
  s_add_u32 s34, s34, 96993280
  v_mov_b32 v205, s3
  v_lshlrev_b32 v204, 2, v1
  s_mov_b32 exec_hi, 0
  buffer_store_dword v205, v204, s[16:19], s34 offen sc1
  s_mov_b64 exec, -1
  s_call_b64 s[52:53], L_maddr
  s_call_b64 s[52:53], L_b_None_full_0lastlo
  s_branch L_merge
L_w_role0:
  s_setpc_b64 s[52:53]
L_role0:
  s_mov_b32 s54, s49
  s_cmp_gt_i32 s39, s54
  s_cbranch_scc1 L_skip_r0s
  s_call_b64 s[52:53], L_main_s
L_skip_r0s:
  s_call_b64 s[52:53], L_b_diag_full_0
  s_cmp_eq_u32 s38, 7
  s_cbranch_scc1 L_role0_t7
  s_call_b64 s[52:53], L_b_full_diag_0
  s_mov_b32 s54, 15
  s_cmp_gt_i32 s39, s54
  s_cbranch_scc1 L_skip_r0s2
  s_call_b64 s[52:53], L_main_s
L_skip_r0s2:
  s_lshl_b32 s34, s2, 2
  s_add_u32 s34, s34, s36
  s_lshl_b32 s34, s34, 7
  s_add_u32 s34, s34, 96993280
  v_mov_b32 v205, s3
  v_lshlrev_b32 v204, 2, v1
  s_mov_b32 exec_hi, 0
  buffer_store_dword v205, v204, s[16:19], s34 offen sc1
  s_mov_b64 exec, -1
  s_call_b64 s[52:53], L_maddr
  s_call_b64 s[52:53], L_b_None_full_0lastlo
  s_branch L_merge
L_role0_t7:
  s_lshl_b32 s34, s2, 2
  s_add_u32 s34, s34, s36
  s_lshl_b32 s34, s34, 7
  s_add_u32 s34, s34, 96993280
  v_mov_b32 v205, s3
  v_lshlrev_b32 v204, 2, v1
  s_mov_b32 exec_hi, 0
  buffer_store_dword v205, v204, s[16:19], s34 offen sc1
  s_mov_b64 exec, -1
  s_call_b64 s[52:53], L_maddr
  s_call_b64 s[52:53], L_b_None_diag_0lastlo
  s_branch L_merge
L_w_role2:
  s_setpc_b64 s[52:53]
L_role2:
  s_cmp_eq_u32 s38, 0
  s_cbranch_scc1 L_role2_t0
  s_call_b64 s[52:53], L_b_full_full_1fd
  s_mov_b32 s54, s33
  s_cmp_gt_i32 s39, s54
  s_cbranch_scc1 L_skip_r2d
  s_call_b64 s[52:53], L_main_d
L_skip_r2d:
  s_call_b64 s[52:53], L_b_diag_full_0
  s_call_b64 s[52:53], L_b_None_diag_0epi
  s_branch L_role2_b
L_role2_t0:
  s_call_b64 s[52:53], L_b_None_diag_1epi
L_role2_b:
  s_waitcnt vmcnt(16)
  s_nop 3
  v_mov_b32 v240, v200
  v_mov_b32 v241, v200
  v_mov_b32 v242, v200
  v_mov_b32 v243, v200
  v_mov_b32 v244, v201
  v_mov_b32 v245, v201
  v_mov_b32 v246, v201
  v_mov_b32 v247, v201
  v_mov_b32 v248, v202
  v_mov_b32 v249, v202
  v_mov_b32 v250, v202
  v_mov_b32 v251, v202
  v_mov_b32 v252, v203
  v_mov_b32 v253, v203
  v_mov_b32 v254, v203
  v_mov_b32 v255, v203
  s_nop 1
  s_call_b64 s[52:53], L_b_diag_None_0st
  s_cmp_eq_u32 s38, 7
  s_cbranch_scc1 L_role2_t7
  s_call_b64 s[52:53], L_b_full_diag_1
  s_and_b32 s34, s55, s60
  s_cbranch_scc1 L_nf5256
  s_lshl_b32 s34, s2, 2
  s_add_u32 s34, s34, s36
  s_lshl_b32 s34, s34, 7
  s_add_u32 s34, s34, 97255424
  v_mov_b32 v205, s3
  v_lshlrev_b32 v204, 2, v1
  s_mov_b32 exec_hi, 0
  buffer_store_dword v205, v204, s[16:19], s34 offen sc1
  s_mov_b64 exec, -1
L_nf5256:
  s_mov_b32 s54, 15
  s_cmp_gt_i32 s39, s54
  s_cbranch_scc1 L_skip_r2s
  s_call_b64 s[52:53], L_main_s
L_skip_r2s:
  s_lshl_b32 s34, s2, 2
  s_add_u32 s34, s34, s36
  s_lshl_b32 s34, s34, 7
  s_add_u32 s34, s34, 96993280
  v_mov_b32 v205, s3
  v_lshlrev_b32 v204, 2, v1
  s_mov_b32 exec_hi, 0
  buffer_store_dword v205, v204, s[16:19], s34 offen sc1
  s_mov_b64 exec, -1
  s_call_b64 s[52:53], L_maddr
  s_call_b64 s[52:53], L_b_None_full_0lasthi
  s_branch L_merge
L_role2_t7:
  s_lshl_b32 s34, s2, 2
  s_add_u32 s34, s34, s36
  s_lshl_b32 s34, s34, 7
  s_add_u32 s34, s34, 96993280
  v_mov_b32 v205, s3
  v_lshlrev_b32 v204, 2, v1
  s_mov_b32 exec_hi, 0
  buffer_store_dword v205, v204, s[16:19], s34 offen sc1
  s_mov_b64 exec, -1
  s_call_b64 s[52:53], L_maddr
  s_call_b64 s[52:53], L_b_None_diag_1lasthi
  s_and_b32 s34, s55, s60
  s_cbranch_scc1 L_nf5297
  s_lshl_b32 s34, s2, 2
  s_add_u32 s34, s34, s36
  s_lshl_b32 s34, s34, 7
  s_add_u32 s34, s34, 97255424
  v_mov_b32 v205, s3
  v_lshlrev_b32 v204, 2, v1
  s_mov_b32 exec_hi, 0
  buffer_store_dword v205, v204, s[16:19], s34 offen sc1
  s_mov_b64 exec, -1
L_nf5297:
  s_branch L_merge
L_w_role3:
  s_setpc_b64 s[52:53]
L_role3:
  s_cmp_eq_u32 s38, 0
  s_cbranch_scc1 L_role3_t0
  s_call_b64 s[52:53], L_b_full_full_1fd
  s_mov_b32 s54, s32
  s_cmp_gt_i32 s39, s54
  s_cbranch_scc1 L_skip_r3d
  s_call_b64 s[52:53], L_main_d
L_skip_r3d:
  s_call_b64 s[52:53], L_b_diag_full_0
  s_branch L_role3_b
L_role3_t0:
  s_call_b64 s[52:53], L_b_diag_full_1
L_role3_b:
  s_call_b64 s[52:53], L_b_None_diag_0epi
  s_waitcnt vmcnt(16)
  s_nop 3
  v_mov_b32 v240, v200
  v_mov_b32 v241, v200
  v_mov_b32 v242, v200
  v_mov_b32 v243, v200
  v_mov_b32 v244, v201
  v_mov_b32 v245, v201
  v_mov_b32 v246, v201
  v_mov_b32 v247, v201
  v_mov_b32 v248, v202
  v_mov_b32 v249, v202
  v_mov_b32 v250, v202
  v_mov_b32 v251, v202
  v_mov_b32 v252, v203
  v_mov_b32 v253, v203
  v_mov_b32 v254, v203
  v_mov_b32 v255, v203
  s_nop 1
  s_cmp_eq_u32 s38, 7
  s_cbranch_scc1 L_role3_t7
  s_call_b64 s[52:53], L_b_full_None_0st
  s_call_b64 s[52:53], L_b_full_full_1
  s_and_b32 s34, s55, s60
  s_cbranch_scc1 L_nf5350
  s_lshl_b32 s34, s2, 2
  s_add_u32 s34, s34, s36
  s_lshl_b32 s34, s34, 7
  s_add_u32 s34, s34, 97255424
  v_mov_b32 v205, s3
  v_lshlrev_b32 v204, 2, v1
  s_mov_b32 exec_hi, 0
  buffer_store_dword v205, v204, s[16:19], s34 offen sc1
  s_mov_b64 exec, -1
L_nf5350:
  s_mov_b32 s54, 15
  s_cmp_gt_i32 s39, s54
  s_cbranch_scc1 L_skip_r3s
  s_call_b64 s[52:53], L_main_s
L_skip_r3s:
  s_lshl_b32 s34, s2, 2
  s_add_u32 s34, s34, s36
  s_lshl_b32 s34, s34, 7
  s_add_u32 s34, s34, 96993280
  v_mov_b32 v205, s3
  v_lshlrev_b32 v204, 2, v1
  s_mov_b32 exec_hi, 0
  buffer_store_dword v205, v204, s[16:19], s34 offen sc1
  s_mov_b64 exec, -1
  s_call_b64 s[52:53], L_maddr
  s_call_b64 s[52:53], L_b_None_full_0lasthi
  s_branch L_merge
L_role3_t7:
  s_lshl_b32 s34, s2, 2
  s_add_u32 s34, s34, s36
  s_lshl_b32 s34, s34, 7
  s_add_u32 s34, s34, 96993280
  v_mov_b32 v205, s3
  v_lshlrev_b32 v204, 2, v1
  s_mov_b32 exec_hi, 0
  buffer_store_dword v205, v204, s[16:19], s34 offen sc1
  s_mov_b64 exec, -1
  s_call_b64 s[52:53], L_maddr
  s_call_b64 s[52:53], L_b_None_None_0lastst
  v_mov_b32 v128, 0
  v_mov_b32 v129, 0
  v_mov_b32 v130, 0
  v_mov_b32 v131, 0
  v_mov_b32 v132, 0
  v_mov_b32 v133, 0
  v_mov_b32 v134, 0
  v_mov_b32 v135, 0
  v_mov_b32 v136, 0
  v_mov_b32 v137, 0
  v_mov_b32 v138, 0
  v_mov_b32 v139, 0
  v_mov_b32 v140, 0
  v_mov_b32 v141, 0
  v_mov_b32 v142, 0
  v_mov_b32 v143, 0
  v_mov_b32 v144, 0
  v_mov_b32 v145, 0
  v_mov_b32 v146, 0
  v_mov_b32 v147, 0
  v_mov_b32 v148, 0
  v_mov_b32 v149, 0
  v_mov_b32 v150, 0
  v_mov_b32 v151, 0
  v_mov_b32 v152, 0
  v_mov_b32 v153, 0
  v_mov_b32 v154, 0
  v_mov_b32 v155, 0
  v_mov_b32 v156, 0
  v_mov_b32 v157, 0
  v_mov_b32 v158, 0
  v_mov_b32 v159, 0
  v_mov_b32 v160, 0
  v_mov_b32 v161, 0
  v_mov_b32 v162, 0
  v_mov_b32 v163, 0
  v_mov_b32 v164, 0
  v_mov_b32 v165, 0
  v_mov_b32 v166, 0
  v_mov_b32 v167, 0
  v_mov_b32 v168, 0
  v_mov_b32 v169, 0
  v_mov_b32 v170, 0
  v_mov_b32 v171, 0
  v_mov_b32 v172, 0
  v_mov_b32 v173, 0
  v_mov_b32 v174, 0
  v_mov_b32 v175, 0
  v_mov_b32 v176, 0
  v_mov_b32 v177, 0
  v_mov_b32 v178, 0
  v_mov_b32 v179, 0
  v_mov_b32 v180, 0
  v_mov_b32 v181, 0
  v_mov_b32 v182, 0
  v_mov_b32 v183, 0
  v_mov_b32 v184, 0
  v_mov_b32 v185, 0
  v_mov_b32 v186, 0
  v_mov_b32 v187, 0
  v_mov_b32 v188, 0
  v_mov_b32 v189, 0
  v_mov_b32 v190, 0
  v_mov_b32_e64 v191, 0
  v_accvgpr_write_b32 a192, 0
  v_accvgpr_write_b32 a193, 0
  v_accvgpr_write_b32 a194, 0
  v_accvgpr_write_b32 a195, 0
  v_accvgpr_write_b32 a196, 0
  v_accvgpr_write_b32 a197, 0
  v_accvgpr_write_b32 a198, 0
  v_accvgpr_write_b32 a199, 0
  v_accvgpr_write_b32 a200, 0
  v_accvgpr_write_b32 a201, 0
  v_accvgpr_write_b32 a202, 0
  v_accvgpr_write_b32 a203, 0
  v_accvgpr_write_b32 a204, 0
  v_accvgpr_write_b32 a205, 0
  v_accvgpr_write_b32 a206, 0
  v_accvgpr_write_b32 a207, 0
  ds_write_b128 v197, v[128:131] offset:0
  ds_write_b128 v197, v[128:131] offset:1024
  ds_write_b128 v197, v[128:131] offset:2048
  ds_write_b128 v197, v[128:131] offset:3072
  ds_write_b128 v197, v[128:131] offset:4096
  ds_write_b128 v197, v[128:131] offset:5120
  ds_write_b128 v197, v[128:131] offset:6144
  ds_write_b128 v197, v[128:131] offset:7168
  ds_write_b128 v197, v[128:131] offset:8192
  ds_write_b128 v197, v[128:131] offset:9216
  ds_write_b128 v197, v[128:131] offset:10240
  ds_write_b128 v197, v[128:131] offset:11264
  ds_write_b128 v197, v[128:131] offset:12288
  ds_write_b128 v197, v[128:131] offset:13312
  ds_write_b128 v197, v[128:131] offset:14336
  ds_write_b128 v197, v[128:131] offset:15360
  s_and_b32 s34, s55, s60
  s_cbranch_scc1 L_nf5487
  s_lshl_b32 s34, s2, 2
  s_add_u32 s34, s34, s36
  s_lshl_b32 s34, s34, 7
  s_add_u32 s34, s34, 97255424
  v_mov_b32 v205, s3
  v_lshlrev_b32 v204, 2, v1
  s_mov_b32 exec_hi, 0
  buffer_store_dword v205, v204, s[16:19], s34 offen sc1
  s_mov_b64 exec, -1
L_nf5487:
  s_branch L_merge
L_w_merge:
  s_setpc_b64 s[52:53]
L_merge:
  v_accvgpr_read_b32 v192, a192
  v_accvgpr_read_b32 v193, a196
  v_accvgpr_read_b32 v194, a200
  v_accvgpr_read_b32 v195, a204
  v_mov_b32 v196, 1585446912
  v_cmp_nle_f32 vcc, v192, v196
  s_or_b32 s55, s55, vcc_lo
  s_or_b32 s55, s55, vcc_hi
  v_cmp_nle_f32 vcc, v193, v196
  s_or_b32 s55, s55, vcc_lo
  s_or_b32 s55, s55, vcc_hi
  v_cmp_nle_f32 vcc, v194, v196
  s_or_b32 s55, s55, vcc_lo
  s_or_b32 s55, s55, vcc_hi
  v_cmp_nle_f32 vcc, v195, v196
  s_or_b32 s55, s55, vcc_lo
  s_or_b32 s55, s55, vcc_hi
  v_mov_b32 v202, s55
  ds_write_b128 v199, v[192:195]
  ds_write_b32 v201, v202
  s_cmp_ge_u32 s36, 2
  s_cbranch_scc1 L_mhi
  s_waitcnt lgkmcnt(0)
  s_barrier
  v_mov_b32 v201, 135168
  ds_read_b128 v[204:207], v201
  ds_read_b128 v[208:211], v200
  ds_read_b128 v[64:67], v198 offset:0
  ds_read_b128 v[68:71], v198 offset:1024
  ds_read_b128 v[72:75], v198 offset:2048
  ds_read_b128 v[76:79], v198 offset:3072
  ds_read_b128 v[80:83], v198 offset:4096
  ds_read_b128 v[84:87], v198 offset:5120
  ds_read_b128 v[88:91], v198 offset:6144
  ds_read_b128 v[92:95], v198 offset:7168
  ds_read_b128 v[96:99], v198 offset:8192
  ds_read_b128 v[100:103], v198 offset:9216
  ds_read_b128 v[104:107], v198 offset:10240
  ds_read_b128 v[108:111], v198 offset:11264
  ds_read_b128 v[112:115], v198 offset:12288
  ds_read_b128 v[116:119], v198 offset:13312
  ds_read_b128 v[120:123], v198 offset:14336
  ds_read_b128 v[124:127], v198 offset:15360
  s_lshl_b32 s32, s57, 5
  s_add_u32 s32, s32, s37
  s_lshl_b32 s32, s32, 12
  s_add_u32 s32, s32, 41943040
  s_waitcnt lgkmcnt(15)
  v_or_b32 v204, v204, v205
  v_or3_b32 v204, v204, v206, v207
  v_add_f32 v192, v192, v208
  v_add_f32 v193, v193, v209
  v_readfirstlane_b32 s55, v204
  v_rcp_f32 v192, v192
  v_rcp_f32 v193, v193
  s_add_u32 s33, s32, 0
  s_waitcnt lgkmcnt(14)
  v_pk_add_f32 v[128:129], v[128:129], v[64:65]
  v_pk_add_f32 v[130:131], v[130:131], v[66:67]
  v_pk_add_f32 v[132:133], v[132:133], v[68:69]
  v_pk_add_f32 v[134:135], v[134:135], v[70:71]
  v_pk_mul_f32 v[128:129], v[128:129], v[192:193] op_sel:[0,0] op_sel_hi:[1,0]
  v_pk_mul_f32 v[130:131], v[130:131], v[192:193] op_sel:[0,0] op_sel_hi:[1,0]
  v_pk_mul_f32 v[132:133], v[132:133], v[192:193] op_sel:[0,0] op_sel_hi:[1,0]
  v_pk_mul_f32 v[134:135], v[134:135], v[192:193] op_sel:[0,0] op_sel_hi:[1,0]
  v_cvt_pk_bf16_f32 v128, v128, v129
  v_cvt_pk_bf16_f32 v129, v130, v131
  v_cvt_pk_bf16_f32 v130, v132, v133
  v_cvt_pk_bf16_f32 v131, v134, v135
  buffer_store_dwordx4 v[128:131], v2, s[16:19], s33 offen offset:0 sc1
  s_waitcnt lgkmcnt(12)
  s_nop 0
  v_pk_add_f32 v[136:137], v[136:137], v[72:73]
  v_pk_add_f32 v[138:139], v[138:139], v[74:75]
  v_pk_add_f32 v[140:141], v[140:141], v[76:77]
  v_pk_add_f32 v[142:143], v[142:143], v[78:79]
  v_pk_mul_f32 v[136:137], v[136:137], v[192:193] op_sel:[0,0] op_sel_hi:[1,0]
  v_pk_mul_f32 v[138:139], v[138:139], v[192:193] op_sel:[0,0] op_sel_hi:[1,0]
  v_pk_mul_f32 v[140:141], v[140:141], v[192:193] op_sel:[0,0] op_sel_hi:[1,0]
  v_pk_mul_f32 v[142:143], v[142:143], v[192:193] op_sel:[0,0] op_sel_hi:[1,0]
  v_cvt_pk_bf16_f32 v136, v136, v137
  v_cvt_pk_bf16_f32 v137, v138, v139
  v_cvt_pk_bf16_f32 v138, v140, v141
  v_cvt_pk_bf16_f32 v139, v142, v143
  buffer_store_dwordx4 v[136:139], v2, s[16:19], s33 offen offset:1024 sc1
  s_waitcnt lgkmcnt(10)
  s_nop 0
  v_pk_add_f32 v[144:145], v[144:145], v[80:81]
  v_pk_add_f32 v[146:147], v[146:147], v[82:83]
  v_pk_add_f32 v[148:149], v[148:149], v[84:85]
  v_pk_add_f32 v[150:151], v[150:151], v[86:87]
  v_pk_mul_f32 v[144:145], v[144:145], v[192:193] op_sel:[0,0] op_sel_hi:[1,0]
  v_pk_mul_f32 v[146:147], v[146:147], v[192:193] op_sel:[0,0] op_sel_hi:[1,0]
  v_pk_mul_f32 v[148:149], v[148:149], v[192:193] op_sel:[0,0] op_sel_hi:[1,0]
  v_pk_mul_f32 v[150:151], v[150:151], v[192:193] op_sel:[0,0] op_sel_hi:[1,0]
  v_cvt_pk_bf16_f32 v144, v144, v145
  v_cvt_pk_bf16_f32 v145, v146, v147
  v_cvt_pk_bf16_f32 v146, v148, v149
  v_cvt_pk_bf16_f32 v147, v150, v151
  buffer_store_dwordx4 v[144:147], v2, s[16:19], s33 offen offset:2048 sc1
  s_waitcnt lgkmcnt(8)
  s_nop 0
  v_pk_add_f32 v[152:153], v[152:153], v[88:89]
  v_pk_add_f32 v[154:155], v[154:155], v[90:91]
  v_pk_add_f32 v[156:157], v[156:157], v[92:93]
  v_pk_add_f32 v[158:159], v[158:159], v[94:95]
  v_pk_mul_f32 v[152:153], v[152:153], v[192:193] op_sel:[0,0] op_sel_hi:[1,0]
  v_pk_mul_f32 v[154:155], v[154:155], v[192:193] op_sel:[0,0] op_sel_hi:[1,0]
  v_pk_mul_f32 v[156:157], v[156:157], v[192:193] op_sel:[0,0] op_sel_hi:[1,0]
  v_pk_mul_f32 v[158:159], v[158:159], v[192:193] op_sel:[0,0] op_sel_hi:[1,0]
  v_cvt_pk_bf16_f32 v152, v152, v153
  v_cvt_pk_bf16_f32 v153, v154, v155
  v_cvt_pk_bf16_f32 v154, v156, v157
  v_cvt_pk_bf16_f32 v155, v158, v159
  buffer_store_dwordx4 v[152:155], v2, s[16:19], s33 offen offset:3072 sc1
  s_add_u32 s33, s32, 131072
  s_waitcnt lgkmcnt(6)
  s_nop 0
  v_pk_add_f32 v[160:161], v[160:161], v[96:97]
  v_pk_add_f32 v[162:163], v[162:163], v[98:99]
  v_pk_add_f32 v[164:165], v[164:165], v[100:101]
  v_pk_add_f32 v[166:167], v[166:167], v[102:103]
  v_pk_mul_f32 v[160:161], v[160:161], v[192:193] op_sel:[0,1] op_sel_hi:[1,1]
  v_pk_mul_f32 v[162:163], v[162:163], v[192:193] op_sel:[0,1] op_sel_hi:[1,1]
  v_pk_mul_f32 v[164:165], v[164:165], v[192:193] op_sel:[0,1] op_sel_hi:[1,1]
  v_pk_mul_f32 v[166:167], v[166:167], v[192:193] op_sel:[0,1] op_sel_hi:[1,1]
  v_cvt_pk_bf16_f32 v160, v160, v161
  v_cvt_pk_bf16_f32 v161, v162, v163
  v_cvt_pk_bf16_f32 v162, v164, v165
  v_cvt_pk_bf16_f32 v163, v166, v167
  buffer_store_dwordx4 v[160:163], v2, s[16:19], s33 offen offset:0 sc1
  s_waitcnt lgkmcnt(4)
  s_nop 0
  v_pk_add_f32 v[168:169], v[168:169], v[104:105]
  v_pk_add_f32 v[170:171], v[170:171], v[106:107]
  v_pk_add_f32 v[172:173], v[172:173], v[108:109]
  v_pk_add_f32 v[174:175], v[174:175], v[110:111]
  v_pk_mul_f32 v[168:169], v[168:169], v[192:193] op_sel:[0,1] op_sel_hi:[1,1]
  v_pk_mul_f32 v[170:171], v[170:171], v[192:193] op_sel:[0,1] op_sel_hi:[1,1]
  v_pk_mul_f32 v[172:173], v[172:173], v[192:193] op_sel:[0,1] op_sel_hi:[1,1]
  v_pk_mul_f32 v[174:175], v[174:175], v[192:193] op_sel:[0,1] op_sel_hi:[1,1]
  v_cvt_pk_bf16_f32 v168, v168, v169
  v_cvt_pk_bf16_f32 v169, v170, v171
  v_cvt_pk_bf16_f32 v170, v172, v173
  v_cvt_pk_bf16_f32 v171, v174, v175
  buffer_store_dwordx4 v[168:171], v2, s[16:19], s33 offen offset:1024 sc1
  s_waitcnt lgkmcnt(2)
  s_nop 0
  v_pk_add_f32 v[176:177], v[176:177], v[112:113]
  v_pk_add_f32 v[178:179], v[178:179], v[114:115]
  v_pk_add_f32 v[180:181], v[180:181], v[116:117]
  v_pk_add_f32 v[182:183], v[182:183], v[118:119]
  v_pk_mul_f32 v[176:177], v[176:177], v[192:193] op_sel:[0,1] op_sel_hi:[1,1]
  v_pk_mul_f32 v[178:179], v[178:179], v[192:193] op_sel:[0,1] op_sel_hi:[1,1]
  v_pk_mul_f32 v[180:181], v[180:181], v[192:193] op_sel:[0,1] op_sel_hi:[1,1]
  v_pk_mul_f32 v[182:183], v[182:183], v[192:193] op_sel:[0,1] op_sel_hi:[1,1]
  v_cvt_pk_bf16_f32 v176, v176, v177
  v_cvt_pk_bf16_f32 v177, v178, v179
  v_cvt_pk_bf16_f32 v178, v180, v181
  v_cvt_pk_bf16_f32 v179, v182, v183
  buffer_store_dwordx4 v[176:179], v2, s[16:19], s33 offen offset:2048 sc1
  s_waitcnt lgkmcnt(0)
  s_nop 0
  v_pk_add_f32 v[184:185], v[184:185], v[120:121]
  v_pk_add_f32 v[186:187], v[186:187], v[122:123]
  v_pk_add_f32 v[188:189], v[188:189], v[124:125]
  v_pk_add_f32 v[190:191], v[190:191], v[126:127]
  v_pk_mul_f32 v[184:185], v[184:185], v[192:193] op_sel:[0,1] op_sel_hi:[1,1]
  v_pk_mul_f32 v[186:187], v[186:187], v[192:193] op_sel:[0,1] op_sel_hi:[1,1]
  v_pk_mul_f32 v[188:189], v[188:189], v[192:193] op_sel:[0,1] op_sel_hi:[1,1]
  v_pk_mul_f32 v[190:191], v[190:191], v[192:193] op_sel:[0,1] op_sel_hi:[1,1]
  v_cvt_pk_bf16_f32 v184, v184, v185
  v_cvt_pk_bf16_f32 v185, v186, v187
  v_cvt_pk_bf16_f32 v186, v188, v189
  v_cvt_pk_bf16_f32 v187, v190, v191
  buffer_store_dwordx4 v[184:187], v2, s[16:19], s33 offen offset:3072 sc1
  s_branch L_done
L_w_mhi:
  s_setpc_b64 s[52:53]
L_mhi:
  s_waitcnt lgkmcnt(0)
  s_barrier
  v_mov_b32 v201, 135168
  ds_read_b128 v[204:207], v201
  ds_read_b128 v[208:211], v200
  ds_read_b128 v[64:67], v198 offset:0
  ds_read_b128 v[68:71], v198 offset:1024
  ds_read_b128 v[72:75], v198 offset:2048
  ds_read_b128 v[76:79], v198 offset:3072
  ds_read_b128 v[80:83], v198 offset:4096
  ds_read_b128 v[84:87], v198 offset:5120
  ds_read_b128 v[88:91], v198 offset:6144
  ds_read_b128 v[92:95], v198 offset:7168
  ds_read_b128 v[96:99], v198 offset:8192
  ds_read_b128 v[100:103], v198 offset:9216
  ds_read_b128 v[104:107], v198 offset:10240
  ds_read_b128 v[108:111], v198 offset:11264
  ds_read_b128 v[112:115], v198 offset:12288
  ds_read_b128 v[116:119], v198 offset:13312
  ds_read_b128 v[120:123], v198 offset:14336
  ds_read_b128 v[124:127], v198 offset:15360
  s_lshl_b32 s32, s57, 5
  s_add_u32 s32, s32, s37
  s_lshl_b32 s32, s32, 12
  s_add_u32 s32, s32, 41943040
  s_waitcnt lgkmcnt(15)
  v_or_b32 v204, v204, v205
  v_or3_b32 v204, v204, v206, v207
  v_add_f32 v194, v194, v210
  v_add_f32 v195, v195, v211
  v_readfirstlane_b32 s55, v204
  v_rcp_f32 v194, v194
  v_rcp_f32 v195, v195
  s_add_u32 s33, s32, 262144
  s_waitcnt lgkmcnt(14)
  s_nop 0
  v_pk_add_f32 v[128:129], v[128:129], v[64:65]
  v_pk_add_f32 v[130:131], v[130:131], v[66:67]
  v_pk_add_f32 v[132:133], v[132:133], v[68:69]
  v_pk_add_f32 v[134:135], v[134:135], v[70:71]
  v_pk_mul_f32 v[128:129], v[128:129], v[194:195] op_sel:[0,0] op_sel_hi:[1,0]
  v_pk_mul_f32 v[130:131], v[130:131], v[194:195] op_sel:[0,0] op_sel_hi:[1,0]
  v_pk_mul_f32 v[132:133], v[132:133], v[194:195] op_sel:[0,0] op_sel_hi:[1,0]
  v_pk_mul_f32 v[134:135], v[134:135], v[194:195] op_sel:[0,0] op_sel_hi:[1,0]
  v_cvt_pk_bf16_f32 v128, v128, v129
  v_cvt_pk_bf16_f32 v129, v130, v131
  v_cvt_pk_bf16_f32 v130, v132, v133
  v_cvt_pk_bf16_f32 v131, v134, v135
  buffer_store_dwordx4 v[128:131], v2, s[16:19], s33 offen offset:0 sc1
  s_waitcnt lgkmcnt(12)
  s_nop 0
  v_pk_add_f32 v[136:137], v[136:137], v[72:73]
  v_pk_add_f32 v[138:139], v[138:139], v[74:75]
  v_pk_add_f32 v[140:141], v[140:141], v[76:77]
  v_pk_add_f32 v[142:143], v[142:143], v[78:79]
  v_pk_mul_f32 v[136:137], v[136:137], v[194:195] op_sel:[0,0] op_sel_hi:[1,0]
  v_pk_mul_f32 v[138:139], v[138:139], v[194:195] op_sel:[0,0] op_sel_hi:[1,0]
  v_pk_mul_f32 v[140:141], v[140:141], v[194:195] op_sel:[0,0] op_sel_hi:[1,0]
  v_pk_mul_f32 v[142:143], v[142:143], v[194:195] op_sel:[0,0] op_sel_hi:[1,0]
  v_cvt_pk_bf16_f32 v136, v136, v137
  v_cvt_pk_bf16_f32 v137, v138, v139
  v_cvt_pk_bf16_f32 v138, v140, v141
  v_cvt_pk_bf16_f32 v139, v142, v143
  buffer_store_dwordx4 v[136:139], v2, s[16:19], s33 offen offset:1024 sc1
  s_waitcnt lgkmcnt(10)
  s_nop 0
  v_pk_add_f32 v[144:145], v[144:145], v[80:81]
  v_pk_add_f32 v[146:147], v[146:147], v[82:83]
  v_pk_add_f32 v[148:149], v[148:149], v[84:85]
  v_pk_add_f32 v[150:151], v[150:151], v[86:87]
  v_pk_mul_f32 v[144:145], v[144:145], v[194:195] op_sel:[0,0] op_sel_hi:[1,0]
  v_pk_mul_f32 v[146:147], v[146:147], v[194:195] op_sel:[0,0] op_sel_hi:[1,0]
  v_pk_mul_f32 v[148:149], v[148:149], v[194:195] op_sel:[0,0] op_sel_hi:[1,0]
  v_pk_mul_f32 v[150:151], v[150:151], v[194:195] op_sel:[0,0] op_sel_hi:[1,0]
  v_cvt_pk_bf16_f32 v144, v144, v145
  v_cvt_pk_bf16_f32 v145, v146, v147
  v_cvt_pk_bf16_f32 v146, v148, v149
  v_cvt_pk_bf16_f32 v147, v150, v151
  buffer_store_dwordx4 v[144:147], v2, s[16:19], s33 offen offset:2048 sc1
  s_waitcnt lgkmcnt(8)
  s_nop 0
  v_pk_add_f32 v[152:153], v[152:153], v[88:89]
  v_pk_add_f32 v[154:155], v[154:155], v[90:91]
  v_pk_add_f32 v[156:157], v[156:157], v[92:93]
  v_pk_add_f32 v[158:159], v[158:159], v[94:95]
  v_pk_mul_f32 v[152:153], v[152:153], v[194:195] op_sel:[0,0] op_sel_hi:[1,0]
  v_pk_mul_f32 v[154:155], v[154:155], v[194:195] op_sel:[0,0] op_sel_hi:[1,0]
  v_pk_mul_f32 v[156:157], v[156:157], v[194:195] op_sel:[0,0] op_sel_hi:[1,0]
  v_pk_mul_f32 v[158:159], v[158:159], v[194:195] op_sel:[0,0] op_sel_hi:[1,0]
  v_cvt_pk_bf16_f32 v152, v152, v153
  v_cvt_pk_bf16_f32 v153, v154, v155
  v_cvt_pk_bf16_f32 v154, v156, v157
  v_cvt_pk_bf16_f32 v155, v158, v159
  buffer_store_dwordx4 v[152:155], v2, s[16:19], s33 offen offset:3072 sc1
  s_add_u32 s33, s32, 393216
  s_waitcnt lgkmcnt(6)
  s_nop 0
  v_pk_add_f32 v[160:161], v[160:161], v[96:97]
  v_pk_add_f32 v[162:163], v[162:163], v[98:99]
  v_pk_add_f32 v[164:165], v[164:165], v[100:101]
  v_pk_add_f32 v[166:167], v[166:167], v[102:103]
  v_pk_mul_f32 v[160:161], v[160:161], v[194:195] op_sel:[0,1] op_sel_hi:[1,1]
  v_pk_mul_f32 v[162:163], v[162:163], v[194:195] op_sel:[0,1] op_sel_hi:[1,1]
  v_pk_mul_f32 v[164:165], v[164:165], v[194:195] op_sel:[0,1] op_sel_hi:[1,1]
  v_pk_mul_f32 v[166:167], v[166:167], v[194:195] op_sel:[0,1] op_sel_hi:[1,1]
  v_cvt_pk_bf16_f32 v160, v160, v161
  v_cvt_pk_bf16_f32 v161, v162, v163
  v_cvt_pk_bf16_f32 v162, v164, v165
  v_cvt_pk_bf16_f32 v163, v166, v167
  buffer_store_dwordx4 v[160:163], v2, s[16:19], s33 offen offset:0 sc1
  s_waitcnt lgkmcnt(4)
  s_nop 0
  v_pk_add_f32 v[168:169], v[168:169], v[104:105]
  v_pk_add_f32 v[170:171], v[170:171], v[106:107]
  v_pk_add_f32 v[172:173], v[172:173], v[108:109]
  v_pk_add_f32 v[174:175], v[174:175], v[110:111]
  v_pk_mul_f32 v[168:169], v[168:169], v[194:195] op_sel:[0,1] op_sel_hi:[1,1]
  v_pk_mul_f32 v[170:171], v[170:171], v[194:195] op_sel:[0,1] op_sel_hi:[1,1]
  v_pk_mul_f32 v[172:173], v[172:173], v[194:195] op_sel:[0,1] op_sel_hi:[1,1]
  v_pk_mul_f32 v[174:175], v[174:175], v[194:195] op_sel:[0,1] op_sel_hi:[1,1]
  v_cvt_pk_bf16_f32 v168, v168, v169
  v_cvt_pk_bf16_f32 v169, v170, v171
  v_cvt_pk_bf16_f32 v170, v172, v173
  v_cvt_pk_bf16_f32 v171, v174, v175
  buffer_store_dwordx4 v[168:171], v2, s[16:19], s33 offen offset:1024 sc1
  s_waitcnt lgkmcnt(2)
  s_nop 0
  v_pk_add_f32 v[176:177], v[176:177], v[112:113]
  v_pk_add_f32 v[178:179], v[178:179], v[114:115]
  v_pk_add_f32 v[180:181], v[180:181], v[116:117]
  v_pk_add_f32 v[182:183], v[182:183], v[118:119]
  v_pk_mul_f32 v[176:177], v[176:177], v[194:195] op_sel:[0,1] op_sel_hi:[1,1]
  v_pk_mul_f32 v[178:179], v[178:179], v[194:195] op_sel:[0,1] op_sel_hi:[1,1]
  v_pk_mul_f32 v[180:181], v[180:181], v[194:195] op_sel:[0,1] op_sel_hi:[1,1]
  v_pk_mul_f32 v[182:183], v[182:183], v[194:195] op_sel:[0,1] op_sel_hi:[1,1]
  v_cvt_pk_bf16_f32 v176, v176, v177
  v_cvt_pk_bf16_f32 v177, v178, v179
  v_cvt_pk_bf16_f32 v178, v180, v181
  v_cvt_pk_bf16_f32 v179, v182, v183
  buffer_store_dwordx4 v[176:179], v2, s[16:19], s33 offen offset:2048 sc1
  s_waitcnt lgkmcnt(0)
  s_nop 0
  v_pk_add_f32 v[184:185], v[184:185], v[120:121]
  v_pk_add_f32 v[186:187], v[186:187], v[122:123]
  v_pk_add_f32 v[188:189], v[188:189], v[124:125]
  v_pk_add_f32 v[190:191], v[190:191], v[126:127]
  v_pk_mul_f32 v[184:185], v[184:185], v[194:195] op_sel:[0,1] op_sel_hi:[1,1]
  v_pk_mul_f32 v[186:187], v[186:187], v[194:195] op_sel:[0,1] op_sel_hi:[1,1]
  v_pk_mul_f32 v[188:189], v[188:189], v[194:195] op_sel:[0,1] op_sel_hi:[1,1]
  v_pk_mul_f32 v[190:191], v[190:191], v[194:195] op_sel:[0,1] op_sel_hi:[1,1]
  v_cvt_pk_bf16_f32 v184, v184, v185
  v_cvt_pk_bf16_f32 v185, v186, v187
  v_cvt_pk_bf16_f32 v186, v188, v189
  v_cvt_pk_bf16_f32 v187, v190, v191
  buffer_store_dwordx4 v[184:187], v2, s[16:19], s33 offen offset:3072 sc1
L_done:
  s_and_b32 s34, s55, s60
  s_cbranch_scc1 L_saferestart
  s_load_dwordx2 s[8:9], s[0:1], 40
  s_load_dwordx4 s[12:15], s[0:1], 72
  s_load_dwordx2 s[24:25], s[0:1], 0
  s_load_dwordx2 s[28:29], s[0:1], 88
  s_and_b32 s64, s2, 3
  s_lshr_b32 s6, s2, 3
  s_and_b32 s66, s6, 3
  s_lshr_b32 s65, s6, 2
  s_and_b32 s7, s2, 4
  s_lshl_b32 s7, s7, 1
  s_add_u32 s65, s65, s7
  s_and_b32 s67, s36, 1
  s_lshr_b32 s68, s36, 1
  s_lshl_b32 s6, s64, 1
  s_add_u32 s6, s6, s68
  s_cmp_eq_u32 s6, 5
  s_cselect_b32 s71, 18, 22
  s_sub_u32 s7, 22, s68
  s_cmp_eq_u32 s64, 3
  s_cselect_b32 s71, s7, s71
  s_cselect_b32 s6, s68, s6
  s_mov_b32 s35, 131072
  s_cselect_b32 s70, 49152, s35
  s_mov_b32 s35, 41943040
  s_cselect_b32 s69, 35651584, s35
  s_mul_i32 s6, s6, 22
  s_lshl_b32 s7, s65, 3
  s_lshl_b32 s35, s67, 2
  s_add_u32 s7, s7, s35
  s_lshl_b32 s35, s68, 1
  s_add_u32 s7, s7, s35
  s_lshl_b32 s49, s7, 14
  s_mul_i32 s48, s68, -4
  s_add_i32 s48, s48, 1
  s_mul_i32 s48, s48, s70
  s_mul_i32 s7, s7, s70
  s_add_u32 s69, s69, s7
  s_lshl_b32 s7, s6, 10
  s_add_u32 s69, s69, s7
  s_add_u32 s6, s6, s67
  s_lshl_b32 s4, s6, 15
  s_lshl_b32 s7, s66, 8
  s_add_u32 s4, s4, s7
  s_lshl_b32 s5, s68, 16
  s_lshl_b32 s7, s67, 13
  s_add_u32 s5, s5, s7
  v_and_b32 v16, 15, v1
  v_lshrrev_b32 v17, 4, v1
  v_lshrrev_b32 v18, 1, v16
  v_xor_b32 v18, v18, v17
  v_and_b32 v19, 1, v16
  v_lshlrev_b32 v19, 4, v19
  v_lshl_add_u32 v19, v17, 10, v19
  v_lshl_add_u32 v4, v18, 5, v19
  v_xor_b32 v18, 4, v18
  v_lshl_add_u32 v5, v18, 5, v19
  v_add_u32 v6, 6144, v4
  v_add_u32 v7, 9216, v5
  v_add_u32 v5, 3072, v5
  s_waitcnt lgkmcnt(0)
  s_cmp_eq_u32 s64, 3
  s_cselect_b32 s20, s12, s8
  s_cselect_b32 s21, s13, s9
  s_mov_b32 s7, 4194304
  s_cselect_b32 s22, 1409024, s7
  s_mov_b32 s23, 0x20000
  s_mov_b32 s12, s14
  s_mov_b32 s13, s15
  s_nop 0
  s_mov_b32 s14, 1024
  s_mov_b32 s15, 0x20000
  s_mov_b32 s26, 2097152
  s_mov_b32 s27, 0x20000
  s_mov_b32 s30, 2097152
  s_mov_b32 s31, 0x20000
  s_lshl_b32 s7, s68, 14
  s_lshl_b32 s35, s67, 13
  s_add_u32 s7, s7, s35
  s_add_u32 s39, s7, 131072
  s_waitcnt vmcnt(0)
  s_lshl_b32 s34, s2, 2
  s_add_u32 s34, s34, s36
  s_lshl_b32 s34, s34, 7
  s_add_u32 s34, s34, 97517568
  v_mov_b32 v31, s3
  v_lshlrev_b32 v30, 2, v1
  s_mov_b32 exec_hi, 0
  buffer_store_dword v31, v30, s[16:19], s34 offen sc1
  s_mov_b64 exec, -1
  s_add_u32 s6, s4, 0
  s_add_u32 m0, s5, 32768
  s_nop 0
  s_nop 0
  buffer_load_dwordx4 v4, s[20:23], s6 offen offset:0 lds
  buffer_load_dwordx4 v5, s[20:23], s6 offen offset:1024 lds
  buffer_load_dwordx4 v6, s[20:23], s6 offen offset:2048 lds
  buffer_load_dwordx4 v7, s[20:23], s6 offen offset:3072 lds
  s_add_u32 s6, s4, 16384
  s_add_u32 m0, s5, 36864
  s_nop 0
  s_nop 0
  buffer_load_dwordx4 v4, s[20:23], s6 offen offset:0 lds
  buffer_load_dwordx4 v5, s[20:23], s6 offen offset:1024 lds
  buffer_load_dwordx4 v6, s[20:23], s6 offen offset:2048 lds
  buffer_load_dwordx4 v7, s[20:23], s6 offen offset:3072 lds
  v_bfe_u32 v16, v1, 2, 2
  v_lshl_add_u32 v18, v17, 2, v16
  v_lshlrev_b32 v18, 8, v18
  v_and_b32 v19, 3, v1
  v_lshl_add_u32 v18, v19, 3, v18
  s_lshl_b32 s7, s68, 16
  v_add_u32 v18, s7, v18
  v_and_b32 v19, 1, v17
  v_lshl_add_u32 v16, v19, 2, v16
  s_mul_i32 s7, s68, -49152
  s_add_u32 s7, s7, 131072
  v_xor_b32 v19, 0, v16
  v_lshl_add_u32 v8, v19, 5, v18
  v_add_u32 v20, s7, v8
  v_xor_b32 v19, 1, v16
  v_lshl_add_u32 v9, v19, 5, v18
  v_add_u32 v21, s7, v9
  v_xor_b32 v19, 2, v16
  v_lshl_add_u32 v10, v19, 5, v18
  v_add_u32 v22, s7, v10
  v_xor_b32 v19, 3, v16
  v_lshl_add_u32 v11, v19, 5, v18
  v_add_u32 v23, s7, v11
  v_xor_b32 v19, 4, v16
  v_lshl_add_u32 v12, v19, 5, v18
  v_add_u32 v24, s7, v12
  v_xor_b32 v19, 5, v16
  v_lshl_add_u32 v13, v19, 5, v18
  v_add_u32 v25, s7, v13
  v_xor_b32 v19, 6, v16
  v_lshl_add_u32 v14, v19, 5, v18
  v_add_u32 v26, s7, v14
  v_xor_b32 v19, 7, v16
  v_lshl_add_u32 v15, v19, 5, v18
  v_add_u32 v27, s7, v15
  s_mul_i32 s6, s64, 11
  s_add_u32 s7, s6, 10
  s_min_u32 s7, s7, 31
  s_cmp_eq_u32 s64, 3
  s_cselect_b32 s6, 0, s6
  s_cselect_b32 s7, 28, s7
  v_and_b32 v28, 31, v1
  v_add_u32 v28, s6, v28
  v_cmp_ge_u32 s[58:59], s7, v28
  v_min_u32 v28, s7, v28
  v_lshrrev_b32 v29, 2, v28
  v_and_b32 v28, 3, v28
  v_lshl_add_u32 v28, v28, 3, v29
  v_lshlrev_b32 v28, 9, v28
  s_sub_u32 s6, 15, s65
  s_min_u32 s6, s6, s65
  s_lshl_b32 s6, s6, 14
  s_lshl_b32 s7, s67, 7
  s_add_u32 s6, s6, s7
  s_cmp_lt_u32 s65, 8
  s_cselect_b32 s7, 256, 0
  s_add_u32 s6, s6, s7
  s_cmp_lt_u32 s65, 8
  s_mov_b32 s7, 97517568
  s_cselect_b32 s7, 97255424, s7
  s_mul_i32 s35, s67, -256
  s_addk_i32 s35, 384
  s_cmp_lt_u32 s65, 8
  s_cselect_b32 s35, 0, s35
  s_cmp_eq_u32 s64, 3
  s_cselect_b32 s7, 96993280, s7
  s_cselect_b32 s35, 0, s35
  s_add_u32 s6, s6, s7
  v_add_u32 v28, s6, v28
  v_lshrrev_b32 v29, 5, v1
  v_mul_u32_u24 v29, s35, v29
  v_add_u32 v28, v28, v29
  buffer_load_dword v29, v28, s[16:19], 0 offen sc1
  s_waitcnt vmcnt(0)
  s_barrier
  s_nop 0
  ds_read_b64_tr_b16 v[192:193], v8 offset:32768
  ds_read_b64_tr_b16 v[194:195], v8 offset:36864
  ds_read_b64_tr_b16 v[196:197], v8 offset:40960
  ds_read_b64_tr_b16 v[198:199], v8 offset:45056
  ds_read_b64_tr_b16 v[200:201], v9 offset:32768
  ds_read_b64_tr_b16 v[202:203], v9 offset:36864
  ds_read_b64_tr_b16 v[204:205], v9 offset:40960
  ds_read_b64_tr_b16 v[206:207], v9 offset:45056
  ds_read_b64_tr_b16 v[208:209], v10 offset:32768
  ds_read_b64_tr_b16 v[210:211], v10 offset:36864
  ds_read_b64_tr_b16 v[212:213], v10 offset:40960
  ds_read_b64_tr_b16 v[214:215], v10 offset:45056
  ds_read_b64_tr_b16 v[216:217], v11 offset:32768
  ds_read_b64_tr_b16 v[218:219], v11 offset:36864
  ds_read_b64_tr_b16 v[220:221], v11 offset:40960
  ds_read_b64_tr_b16 v[222:223], v11 offset:45056
  ds_read_b64_tr_b16 v[224:225], v12 offset:32768
  ds_read_b64_tr_b16 v[226:227], v12 offset:36864
  ds_read_b64_tr_b16 v[228:229], v12 offset:40960
  ds_read_b64_tr_b16 v[230:231], v12 offset:45056
  ds_read_b64_tr_b16 v[232:233], v13 offset:32768
  ds_read_b64_tr_b16 v[234:235], v13 offset:36864
  ds_read_b64_tr_b16 v[236:237], v13 offset:40960
  ds_read_b64_tr_b16 v[238:239], v13 offset:45056
  ds_read_b64_tr_b16 v[240:241], v14 offset:32768
  ds_read_b64_tr_b16 v[242:243], v14 offset:36864
  ds_read_b64_tr_b16 v[244:245], v14 offset:40960
  ds_read_b64_tr_b16 v[246:247], v14 offset:45056
  v_cmp_ne_u32 vcc, s3, v29
  s_cbranch_vccnz L_late
  s_add_u32 s7, s69, 0
  buffer_load_dwordx4 a[128:131], v2, s[16:19], s7 offen offset:0 sc1
  buffer_load_dwordx4 a[132:135], v2, s[16:19], s7 offen offset:1024 sc1
  s_add_u32 s7, s7, s70
  buffer_load_dwordx4 a[136:139], v2, s[16:19], s7 offen offset:0 sc1
  buffer_load_dwordx4 a[140:143], v2, s[16:19], s7 offen offset:1024 sc1
  s_add_u32 s7, s7, s48
  buffer_load_dwordx4 a[144:147], v2, s[16:19], s7 offen offset:0 sc1
  buffer_load_dwordx4 a[148:151], v2, s[16:19], s7 offen offset:1024 sc1
  s_add_u32 s7, s7, s70
  buffer_load_dwordx4 a[152:155], v2, s[16:19], s7 offen offset:0 sc1
  buffer_load_dwordx4 a[156:159], v2, s[16:19], s7 offen offset:1024 sc1
  s_add_u32 s6, s4, 65536
  s_add_u32 m0, s39, 0
  s_nop 0
  buffer_load_dwordx4 v4, s[20:23], s6 offen offset:0 lds
  buffer_load_dwordx4 v5, s[20:23], s6 offen offset:1024 lds
  buffer_load_dwordx4 v6, s[20:23], s6 offen offset:2048 lds
  buffer_load_dwordx4 v7, s[20:23], s6 offen offset:3072 lds
  s_add_u32 s6, s4, 81920
  s_add_u32 m0, s39, 4096
  s_nop 0
  buffer_load_dwordx4 v4, s[20:23], s6 offen offset:0 lds
  buffer_load_dwordx4 v5, s[20:23], s6 offen offset:1024 lds
  buffer_load_dwordx4 v6, s[20:23], s6 offen offset:2048 lds
  buffer_load_dwordx4 v7, s[20:23], s6 offen offset:3072 lds
  s_add_u32 s6, s4, 131072
  s_add_u32 m0, s5, 0
  s_nop 0
  s_nop 0
  buffer_load_dwordx4 v4, s[20:23], s6 offen offset:0 lds
  buffer_load_dwordx4 v5, s[20:23], s6 offen offset:1024 lds
  buffer_load_dwordx4 v6, s[20:23], s6 offen offset:2048 lds
  buffer_load_dwordx4 v7, s[20:23], s6 offen offset:3072 lds
  s_add_u32 s6, s4, 147456
  s_add_u32 m0, s5, 4096
  s_nop 0
  s_nop 0
  buffer_load_dwordx4 v4, s[20:23], s6 offen offset:0 lds
  buffer_load_dwordx4 v5, s[20:23], s6 offen offset:1024 lds
  buffer_load_dwordx4 v6, s[20:23], s6 offen offset:2048 lds
  buffer_load_dwordx4 v7, s[20:23], s6 offen offset:3072 lds
  s_add_u32 s6, s4, 196608
  s_add_u32 m0, s5, 16384
  s_nop 0
  s_nop 0
  buffer_load_dwordx4 v4, s[20:23], s6 offen offset:0 lds
  buffer_load_dwordx4 v5, s[20:23], s6 offen offset:1024 lds
  buffer_load_dwordx4 v6, s[20:23], s6 offen offset:2048 lds
  buffer_load_dwordx4 v7, s[20:23], s6 offen offset:3072 lds
  s_add_u32 s6, s4, 212992
  s_add_u32 m0, s5, 20480
  s_nop 0
  s_nop 0
  buffer_load_dwordx4 v4, s[20:23], s6 offen offset:0 lds
  buffer_load_dwordx4 v5, s[20:23], s6 offen offset:1024 lds
  buffer_load_dwordx4 v6, s[20:23], s6 offen offset:2048 lds
  buffer_load_dwordx4 v7, s[20:23], s6 offen offset:3072 lds
  s_add_u32 s6, s4, 262144
  s_add_u32 m0, s5, 49152
  s_nop 0
  s_nop 0
  buffer_load_dwordx4 v4, s[20:23], s6 offen offset:0 lds
  buffer_load_dwordx4 v5, s[20:23], s6 offen offset:1024 lds
  buffer_load_dwordx4 v6, s[20:23], s6 offen offset:2048 lds
  buffer_load_dwordx4 v7, s[20:23], s6 offen offset:3072 lds
  s_add_u32 s6, s4, 278528
  s_add_u32 m0, s5, 53248
  s_nop 0
  buffer_load_dwordx4 v4, s[20:23], s6 offen offset:0 lds
  buffer_load_dwordx4 v5, s[20:23], s6 offen offset:1024 lds
  buffer_load_dwordx4 v6, s[20:23], s6 offen offset:2048 lds
  buffer_load_dwordx4 v7, s[20:23], s6 offen offset:3072 lds
  s_waitcnt vmcnt(32)
  s_branch L_haveB
L_late:
  buffer_load_dword v29, v28, s[16:19], 0 offen sc1
  s_mov_b64 exec, -1
  s_add_u32 s6, s4, 65536
  s_add_u32 m0, s39, 0
  s_nop 0
  buffer_load_dwordx4 v4, s[20:23], s6 offen offset:0 lds
  buffer_load_dwordx4 v5, s[20:23], s6 offen offset:1024 lds
  buffer_load_dwordx4 v6, s[20:23], s6 offen offset:2048 lds
  buffer_load_dwordx4 v7, s[20:23], s6 offen offset:3072 lds
  s_add_u32 s6, s4, 81920
  s_add_u32 m0, s39, 4096
  s_nop 0
  buffer_load_dwordx4 v4, s[20:23], s6 offen offset:0 lds
  buffer_load_dwordx4 v5, s[20:23], s6 offen offset:1024 lds
  buffer_load_dwordx4 v6, s[20:23], s6 offen offset:2048 lds
  buffer_load_dwordx4 v7, s[20:23], s6 offen offset:3072 lds
  s_add_u32 s6, s4, 131072
  s_add_u32 m0, s5, 0
  s_nop 0
  s_nop 0
  buffer_load_dwordx4 v4, s[20:23], s6 offen offset:0 lds
  buffer_load_dwordx4 v5, s[20:23], s6 offen offset:1024 lds
  buffer_load_dwordx4 v6, s[20:23], s6 offen offset:2048 lds
  buffer_load_dwordx4 v7, s[20:23], s6 offen offset:3072 lds
  s_add_u32 s6, s4, 147456
  s_add_u32 m0, s5, 4096
  s_nop 0
  s_nop 0
  buffer_load_dwordx4 v4, s[20:23], s6 offen offset:0 lds
  buffer_load_dwordx4 v5, s[20:23], s6 offen offset:1024 lds
  buffer_load_dwordx4 v6, s[20:23], s6 offen offset:2048 lds
  buffer_load_dwordx4 v7, s[20:23], s6 offen offset:3072 lds
  s_add_u32 s6, s4, 196608
  s_add_u32 m0, s5, 16384
  s_nop 0
  s_nop 0
  buffer_load_dwordx4 v4, s[20:23], s6 offen offset:0 lds
  buffer_load_dwordx4 v5, s[20:23], s6 offen offset:1024 lds
  buffer_load_dwordx4 v6, s[20:23], s6 offen offset:2048 lds
  buffer_load_dwordx4 v7, s[20:23], s6 offen offset:3072 lds
  s_add_u32 s6, s4, 212992
  s_add_u32 m0, s5, 20480
  s_nop 0
  s_nop 0
  buffer_load_dwordx4 v4, s[20:23], s6 offen offset:0 lds
  buffer_load_dwordx4 v5, s[20:23], s6 offen offset:1024 lds
  buffer_load_dwordx4 v6, s[20:23], s6 offen offset:2048 lds
  buffer_load_dwordx4 v7, s[20:23], s6 offen offset:3072 lds
  s_add_u32 s6, s4, 262144
  s_add_u32 m0, s5, 49152
  s_nop 0
  s_nop 0
  buffer_load_dwordx4 v4, s[20:23], s6 offen offset:0 lds
  buffer_load_dwordx4 v5, s[20:23], s6 offen offset:1024 lds
  buffer_load_dwordx4 v6, s[20:23], s6 offen offset:2048 lds
  buffer_load_dwordx4 v7, s[20:23], s6 offen offset:3072 lds
  s_add_u32 s6, s4, 278528
  s_add_u32 m0, s5, 53248
  s_nop 0
  buffer_load_dwordx4 v4, s[20:23], s6 offen offset:0 lds
  buffer_load_dwordx4 v5, s[20:23], s6 offen offset:1024 lds
  buffer_load_dwordx4 v6, s[20:23], s6 offen offset:2048 lds
  buffer_load_dwordx4 v7, s[20:23], s6 offen offset:3072 lds
  s_waitcnt vmcnt(32)
  s_mov_b32 s6, 0
L_poll3:
  v_cmp_ne_u32 vcc, s3, v29
  s_cbranch_vccz L_pollok3
  s_add_u32 s6, s6, 1
  s_cmp_gt_u32 s6, 0x80000
  s_cbranch_scc1 L_pollok3
  buffer_load_dword v29, v28, s[16:19], 0 offen sc1
  s_waitcnt vmcnt(0)
  s_branch L_poll3
L_pollok3:
  s_mov_b64 exec, -1
  s_add_u32 s7, s69, 0
  buffer_load_dwordx4 a[128:131], v2, s[16:19], s7 offen offset:0 sc1
  buffer_load_dwordx4 a[132:135], v2, s[16:19], s7 offen offset:1024 sc1
  s_add_u32 s7, s7, s70
  buffer_load_dwordx4 a[136:139], v2, s[16:19], s7 offen offset:0 sc1
  buffer_load_dwordx4 a[140:143], v2, s[16:19], s7 offen offset:1024 sc1
  s_add_u32 s7, s7, s48
  buffer_load_dwordx4 a[144:147], v2, s[16:19], s7 offen offset:0 sc1
  buffer_load_dwordx4 a[148:151], v2, s[16:19], s7 offen offset:1024 sc1
  s_add_u32 s7, s7, s70
  buffer_load_dwordx4 a[152:155], v2, s[16:19], s7 offen offset:0 sc1
  buffer_load_dwordx4 a[156:159], v2, s[16:19], s7 offen offset:1024 sc1
  s_waitcnt vmcnt(0)
L_haveB:
  s_waitcnt lgkmcnt(15)
  v_mfma_f32_16x16x32_bf16 v[64:67], v[192:195], a[128:131], 0
  s_add_u32 s7, s69, 0
  ds_read_b64_tr_b16 v[248:249], v15 offset:32768
  v_mfma_f32_16x16x32_bf16 v[64:67], v[196:199], a[132:135], v[64:67]
  buffer_load_dwordx4 a[160:163], v2, s[16:19], s7 offen offset:2048 sc1
  v_mfma_f32_16x16x32_bf16 v[68:71], v[192:195], a[136:139], 0
  ds_read_b64_tr_b16 v[250:251], v15 offset:36864
  v_mfma_f32_16x16x32_bf16 v[68:71], v[196:199], a[140:143], v[68:71]
  v_mfma_f32_16x16x32_bf16 v[72:75], v[192:195], a[144:147], 0
  ds_read_b64_tr_b16 v[252:253], v15 offset:40960
  v_mfma_f32_16x16x32_bf16 v[72:75], v[196:199], a[148:151], v[72:75]
  buffer_load_dwordx4 a[164:167], v2, s[16:19], s7 offen offset:3072 sc1
  v_mfma_f32_16x16x32_bf16 v[76:79], v[192:195], a[152:155], 0
  ds_read_b64_tr_b16 v[254:255], v15 offset:45056
  v_mfma_f32_16x16x32_bf16 v[76:79], v[196:199], a[156:159], v[76:79]
  s_waitcnt vmcnt(26)
  s_barrier
  s_waitcnt lgkmcnt(15)
  v_mfma_f32_16x16x32_bf16 v[80:83], v[200:203], a[128:131], 0
  s_add_u32 s7, s7, s70
  ds_read_b64_tr_b16 v[192:193], v20 offset:0
  v_mfma_f32_16x16x32_bf16 v[80:83], v[204:207], a[132:135], v[80:83]
  buffer_load_dwordx4 a[168:171], v2, s[16:19], s7 offen offset:2048 sc1
  v_mfma_f32_16x16x32_bf16 v[84:87], v[200:203], a[136:139], 0
  ds_read_b64_tr_b16 v[194:195], v20 offset:4096
  v_mfma_f32_16x16x32_bf16 v[84:87], v[204:207], a[140:143], v[84:87]
  v_mfma_f32_16x16x32_bf16 v[88:91], v[200:203], a[144:147], 0
  ds_read_b64_tr_b16 v[196:197], v20 offset:8192
  v_mfma_f32_16x16x32_bf16 v[88:91], v[204:207], a[148:151], v[88:91]
  buffer_load_dwordx4 a[172:175], v2, s[16:19], s7 offen offset:3072 sc1
  v_mfma_f32_16x16x32_bf16 v[92:95], v[200:203], a[152:155], 0
  ds_read_b64_tr_b16 v[198:199], v20 offset:12288
  v_mfma_f32_16x16x32_bf16 v[92:95], v[204:207], a[156:159], v[92:95]
  s_waitcnt lgkmcnt(15)
  v_mfma_f32_16x16x32_bf16 v[96:99], v[208:211], a[128:131], 0
  s_add_u32 s7, s7, s48
  ds_read_b64_tr_b16 v[200:201], v21 offset:0
  v_mfma_f32_16x16x32_bf16 v[96:99], v[212:215], a[132:135], v[96:99]
  buffer_load_dwordx4 a[176:179], v2, s[16:19], s7 offen offset:2048 sc1
  v_mfma_f32_16x16x32_bf16 v[100:103], v[208:211], a[136:139], 0
  ds_read_b64_tr_b16 v[202:203], v21 offset:4096
  v_mfma_f32_16x16x32_bf16 v[100:103], v[212:215], a[140:143], v[100:103]
  v_mfma_f32_16x16x32_bf16 v[104:107], v[208:211], a[144:147], 0
  ds_read_b64_tr_b16 v[204:205], v21 offset:8192
  v_mfma_f32_16x16x32_bf16 v[104:107], v[212:215], a[148:151], v[104:107]
  buffer_load_dwordx4 a[180:183], v2, s[16:19], s7 offen offset:3072 sc1
  v_mfma_f32_16x16x32_bf16 v[108:111], v[208:211], a[152:155], 0
  ds_read_b64_tr_b16 v[206:207], v21 offset:12288
  v_mfma_f32_16x16x32_bf16 v[108:111], v[212:215], a[156:159], v[108:111]
  s_waitcnt lgkmcnt(15)
  v_mfma_f32_16x16x32_bf16 v[112:115], v[216:219], a[128:131], 0
  s_add_u32 s7, s7, s70
  ds_read_b64_tr_b16 v[208:209], v22 offset:0
  v_mfma_f32_16x16x32_bf16 v[112:115], v[220:223], a[132:135], v[112:115]
  buffer_load_dwordx4 a[184:187], v2, s[16:19], s7 offen offset:2048 sc1
  v_mfma_f32_16x16x32_bf16 v[116:119], v[216:219], a[136:139], 0
  ds_read_b64_tr_b16 v[210:211], v22 offset:4096
  v_mfma_f32_16x16x32_bf16 v[116:119], v[220:223], a[140:143], v[116:119]
  v_mfma_f32_16x16x32_bf16 v[120:123], v[216:219], a[144:147], 0
  ds_read_b64_tr_b16 v[212:213], v22 offset:8192
  v_mfma_f32_16x16x32_bf16 v[120:123], v[220:223], a[148:151], v[120:123]
  buffer_load_dwordx4 a[188:191], v2, s[16:19], s7 offen offset:3072 sc1
  v_mfma_f32_16x16x32_bf16 v[124:127], v[216:219], a[152:155], 0
  ds_read_b64_tr_b16 v[214:215], v22 offset:12288
  v_mfma_f32_16x16x32_bf16 v[124:127], v[220:223], a[156:159], v[124:127]
  s_waitcnt lgkmcnt(15)
  v_mfma_f32_16x16x32_bf16 v[128:131], v[224:227], a[128:131], 0
  s_add_u32 s7, s69, 4096
  ds_read_b64_tr_b16 v[216:217], v23 offset:0
  v_mfma_f32_16x16x32_bf16 v[128:131], v[228:231], a[132:135], v[128:131]
  buffer_load_dwordx4 a[192:195], v2, s[16:19], s7 offen offset:0 sc1
  v_mfma_f32_16x16x32_bf16 v[132:135], v[224:227], a[136:139], 0
  ds_read_b64_tr_b16 v[218:219], v23 offset:4096
  v_mfma_f32_16x16x32_bf16 v[132:135], v[228:231], a[140:143], v[132:135]
  v_mfma_f32_16x16x32_bf16 v[136:139], v[224:227], a[144:147], 0
  ds_read_b64_tr_b16 v[220:221], v23 offset:8192
  v_mfma_f32_16x16x32_bf16 v[136:139], v[228:231], a[148:151], v[136:139]
  buffer_load_dwordx4 a[196:199], v2, s[16:19], s7 offen offset:1024 sc1
  v_mfma_f32_16x16x32_bf16 v[140:143], v[224:227], a[152:155], 0
  ds_read_b64_tr_b16 v[222:223], v23 offset:12288
  v_mfma_f32_16x16x32_bf16 v[140:143], v[228:231], a[156:159], v[140:143]
  s_waitcnt lgkmcnt(15)
  v_mfma_f32_16x16x32_bf16 v[144:147], v[232:235], a[128:131], 0
  s_add_u32 s7, s7, s70
  ds_read_b64_tr_b16 v[224:225], v24 offset:0
  v_mfma_f32_16x16x32_bf16 v[144:147], v[236:239], a[132:135], v[144:147]
  buffer_load_dwordx4 a[200:203], v2, s[16:19], s7 offen offset:0 sc1
  v_mfma_f32_16x16x32_bf16 v[148:151], v[232:235], a[136:139], 0
  ds_read_b64_tr_b16 v[226:227], v24 offset:4096
  v_mfma_f32_16x16x32_bf16 v[148:151], v[236:239], a[140:143], v[148:151]
  v_mfma_f32_16x16x32_bf16 v[152:155], v[232:235], a[144:147], 0
  ds_read_b64_tr_b16 v[228:229], v24 offset:8192
  v_mfma_f32_16x16x32_bf16 v[152:155], v[236:239], a[148:151], v[152:155]
  buffer_load_dwordx4 a[204:207], v2, s[16:19], s7 offen offset:1024 sc1
  v_mfma_f32_16x16x32_bf16 v[156:159], v[232:235], a[152:155], 0
  ds_read_b64_tr_b16 v[230:231], v24 offset:12288
  v_mfma_f32_16x16x32_bf16 v[156:159], v[236:239], a[156:159], v[156:159]
  s_waitcnt lgkmcnt(15)
  v_mfma_f32_16x16x32_bf16 v[160:163], v[240:243], a[128:131], 0
  s_add_u32 s7, s7, s48
  ds_read_b64_tr_b16 v[232:233], v25 offset:0
  v_mfma_f32_16x16x32_bf16 v[160:163], v[244:247], a[132:135], v[160:163]
  buffer_load_dwordx4 a[208:211], v2, s[16:19], s7 offen offset:0 sc1
  v_mfma_f32_16x16x32_bf16 v[164:167], v[240:243], a[136:139], 0
  ds_read_b64_tr_b16 v[234:235], v25 offset:4096
  v_mfma_f32_16x16x32_bf16 v[164:167], v[244:247], a[140:143], v[164:167]
  v_mfma_f32_16x16x32_bf16 v[168:171], v[240:243], a[144:147], 0
  ds_read_b64_tr_b16 v[236:237], v25 offset:8192
  v_mfma_f32_16x16x32_bf16 v[168:171], v[244:247], a[148:151], v[168:171]
  buffer_load_dwordx4 a[212:215], v2, s[16:19], s7 offen offset:1024 sc1
  v_mfma_f32_16x16x32_bf16 v[172:175], v[240:243], a[152:155], 0
  ds_read_b64_tr_b16 v[238:239], v25 offset:12288
  v_mfma_f32_16x16x32_bf16 v[172:175], v[244:247], a[156:159], v[172:175]
  s_waitcnt lgkmcnt(15)
  v_mfma_f32_16x16x32_bf16 v[176:179], v[248:251], a[128:131], 0
  s_add_u32 s7, s7, s70
  ds_read_b64_tr_b16 v[240:241], v26 offset:0
  v_mfma_f32_16x16x32_bf16 v[176:179], v[252:255], a[132:135], v[176:179]
  buffer_load_dwordx4 a[216:219], v2, s[16:19], s7 offen offset:0 sc1
  v_mfma_f32_16x16x32_bf16 v[180:183], v[248:251], a[136:139], 0
  ds_read_b64_tr_b16 v[242:243], v26 offset:4096
  v_mfma_f32_16x16x32_bf16 v[180:183], v[252:255], a[140:143], v[180:183]
  v_mfma_f32_16x16x32_bf16 v[184:187], v[248:251], a[144:147], 0
  ds_read_b64_tr_b16 v[244:245], v26 offset:8192
  v_mfma_f32_16x16x32_bf16 v[184:187], v[252:255], a[148:151], v[184:187]
  buffer_load_dwordx4 a[220:223], v2, s[16:19], s7 offen offset:1024 sc1
  v_mfma_f32_16x16x32_bf16 v[188:191], v[248:251], a[152:155], 0
  ds_read_b64_tr_b16 v[246:247], v26 offset:12288
  v_mfma_f32_16x16x32_bf16 v[188:191], v[252:255], a[156:159], v[188:191]
  s_waitcnt vmcnt(8)
  s_waitcnt lgkmcnt(15)
  v_mfma_f32_16x16x32_bf16 v[64:67], v[192:195], a[160:163], v[64:67]
  s_add_u32 s7, s69, 4096
  ds_read_b64_tr_b16 v[248:249], v27 offset:0
  v_mfma_f32_16x16x32_bf16 v[64:67], v[196:199], a[164:167], v[64:67]
  buffer_load_dwordx4 a[224:227], v2, s[16:19], s7 offen offset:2048 sc1
  v_mfma_f32_16x16x32_bf16 v[68:71], v[192:195], a[168:171], v[68:71]
  ds_read_b64_tr_b16 v[250:251], v27 offset:4096
  v_mfma_f32_16x16x32_bf16 v[68:71], v[196:199], a[172:175], v[68:71]
  v_mfma_f32_16x16x32_bf16 v[72:75], v[192:195], a[176:179], v[72:75]
  ds_read_b64_tr_b16 v[252:253], v27 offset:8192
  v_mfma_f32_16x16x32_bf16 v[72:75], v[196:199], a[180:183], v[72:75]
  buffer_load_dwordx4 a[228:231], v2, s[16:19], s7 offen offset:3072 sc1
  v_mfma_f32_16x16x32_bf16 v[76:79], v[192:195], a[184:187], v[76:79]
  ds_read_b64_tr_b16 v[254:255], v27 offset:12288
  v_mfma_f32_16x16x32_bf16 v[76:79], v[196:199], a[188:191], v[76:79]
  s_barrier
  s_waitcnt lgkmcnt(15)
  v_mfma_f32_16x16x32_bf16 v[80:83], v[200:203], a[160:163], v[80:83]
  s_add_u32 s7, s7, s70
  ds_read_b64_tr_b16 v[192:193], v8 offset:0
  v_mfma_f32_16x16x32_bf16 v[80:83], v[204:207], a[164:167], v[80:83]
  buffer_load_dwordx4 a[232:235], v2, s[16:19], s7 offen offset:2048 sc1
  v_mfma_f32_16x16x32_bf16 v[84:87], v[200:203], a[168:171], v[84:87]
  ds_read_b64_tr_b16 v[194:195], v8 offset:4096
  v_mfma_f32_16x16x32_bf16 v[84:87], v[204:207], a[172:175], v[84:87]
  v_mfma_f32_16x16x32_bf16 v[88:91], v[200:203], a[176:179], v[88:91]
  ds_read_b64_tr_b16 v[196:197], v8 offset:8192
  v_mfma_f32_16x16x32_bf16 v[88:91], v[204:207], a[180:183], v[88:91]
  buffer_load_dwordx4 a[236:239], v2, s[16:19], s7 offen offset:3072 sc1
  v_mfma_f32_16x16x32_bf16 v[92:95], v[200:203], a[184:187], v[92:95]
  ds_read_b64_tr_b16 v[198:199], v8 offset:12288
  v_mfma_f32_16x16x32_bf16 v[92:95], v[204:207], a[188:191], v[92:95]
  s_waitcnt lgkmcnt(15)
  v_mfma_f32_16x16x32_bf16 v[96:99], v[208:211], a[160:163], v[96:99]
  s_add_u32 s7, s7, s48
  ds_read_b64_tr_b16 v[200:201], v9 offset:0
  v_mfma_f32_16x16x32_bf16 v[96:99], v[212:215], a[164:167], v[96:99]
  buffer_load_dwordx4 a[240:243], v2, s[16:19], s7 offen offset:2048 sc1
  v_mfma_f32_16x16x32_bf16 v[100:103], v[208:211], a[168:171], v[100:103]
  ds_read_b64_tr_b16 v[202:203], v9 offset:4096
  v_mfma_f32_16x16x32_bf16 v[100:103], v[212:215], a[172:175], v[100:103]
  v_mfma_f32_16x16x32_bf16 v[104:107], v[208:211], a[176:179], v[104:107]
  ds_read_b64_tr_b16 v[204:205], v9 offset:8192
  v_mfma_f32_16x16x32_bf16 v[104:107], v[212:215], a[180:183], v[104:107]
  buffer_load_dwordx4 a[244:247], v2, s[16:19], s7 offen offset:3072 sc1
  v_mfma_f32_16x16x32_bf16 v[108:111], v[208:211], a[184:187], v[108:111]
  ds_read_b64_tr_b16 v[206:207], v9 offset:12288
  v_mfma_f32_16x16x32_bf16 v[108:111], v[212:215], a[188:191], v[108:111]
  s_waitcnt lgkmcnt(15)
  v_mfma_f32_16x16x32_bf16 v[112:115], v[216:219], a[160:163], v[112:115]
  s_add_u32 s7, s7, s70
  ds_read_b64_tr_b16 v[208:209], v10 offset:0
  v_mfma_f32_16x16x32_bf16 v[112:115], v[220:223], a[164:167], v[112:115]
  buffer_load_dwordx4 a[248:251], v2, s[16:19], s7 offen offset:2048 sc1
  v_mfma_f32_16x16x32_bf16 v[116:119], v[216:219], a[168:171], v[116:119]
  ds_read_b64_tr_b16 v[210:211], v10 offset:4096
  v_mfma_f32_16x16x32_bf16 v[116:119], v[220:223], a[172:175], v[116:119]
  v_mfma_f32_16x16x32_bf16 v[120:123], v[216:219], a[176:179], v[120:123]
  ds_read_b64_tr_b16 v[212:213], v10 offset:8192
  v_mfma_f32_16x16x32_bf16 v[120:123], v[220:223], a[180:183], v[120:123]
  buffer_load_dwordx4 a[252:255], v2, s[16:19], s7 offen offset:3072 sc1
  v_mfma_f32_16x16x32_bf16 v[124:127], v[216:219], a[184:187], v[124:127]
  ds_read_b64_tr_b16 v[214:215], v10 offset:12288
  v_mfma_f32_16x16x32_bf16 v[124:127], v[220:223], a[188:191], v[124:127]
  s_waitcnt lgkmcnt(15)
  v_mfma_f32_16x16x32_bf16 v[128:131], v[224:227], a[160:163], v[128:131]
  s_add_u32 s7, s69, 8192
  ds_read_b64_tr_b16 v[216:217], v11 offset:0
  v_mfma_f32_16x16x32_bf16 v[128:131], v[228:231], a[164:167], v[128:131]
  buffer_load_dwordx4 a[128:131], v2, s[16:19], s7 offen offset:0 sc1
  v_mfma_f32_16x16x32_bf16 v[132:135], v[224:227], a[168:171], v[132:135]
  ds_read_b64_tr_b16 v[218:219], v11 offset:4096
  v_mfma_f32_16x16x32_bf16 v[132:135], v[228:231], a[172:175], v[132:135]
  v_mfma_f32_16x16x32_bf16 v[136:139], v[224:227], a[176:179], v[136:139]
  ds_read_b64_tr_b16 v[220:221], v11 offset:8192
  v_mfma_f32_16x16x32_bf16 v[136:139], v[228:231], a[180:183], v[136:139]
  buffer_load_dwordx4 a[132:135], v2, s[16:19], s7 offen offset:1024 sc1
  v_mfma_f32_16x16x32_bf16 v[140:143], v[224:227], a[184:187], v[140:143]
  ds_read_b64_tr_b16 v[222:223], v11 offset:12288
  v_mfma_f32_16x16x32_bf16 v[140:143], v[228:231], a[188:191], v[140:143]
  s_waitcnt lgkmcnt(15)
  v_mfma_f32_16x16x32_bf16 v[144:147], v[232:235], a[160:163], v[144:147]
  s_add_u32 s7, s7, s70
  ds_read_b64_tr_b16 v[224:225], v12 offset:0
  v_mfma_f32_16x16x32_bf16 v[144:147], v[236:239], a[164:167], v[144:147]
  buffer_load_dwordx4 a[136:139], v2, s[16:19], s7 offen offset:0 sc1
  v_mfma_f32_16x16x32_bf16 v[148:151], v[232:235], a[168:171], v[148:151]
  ds_read_b64_tr_b16 v[226:227], v12 offset:4096
  v_mfma_f32_16x16x32_bf16 v[148:151], v[236:239], a[172:175], v[148:151]
  v_mfma_f32_16x16x32_bf16 v[152:155], v[232:235], a[176:179], v[152:155]
  ds_read_b64_tr_b16 v[228:229], v12 offset:8192
  v_mfma_f32_16x16x32_bf16 v[152:155], v[236:239], a[180:183], v[152:155]
  buffer_load_dwordx4 a[140:143], v2, s[16:19], s7 offen offset:1024 sc1
  v_mfma_f32_16x16x32_bf16 v[156:159], v[232:235], a[184:187], v[156:159]
  ds_read_b64_tr_b16 v[230:231], v12 offset:12288
  v_mfma_f32_16x16x32_bf16 v[156:159], v[236:239], a[188:191], v[156:159]
  s_waitcnt lgkmcnt(15)
  v_mfma_f32_16x16x32_bf16 v[160:163], v[240:243], a[160:163], v[160:163]
  s_add_u32 s7, s7, s48
  ds_read_b64_tr_b16 v[232:233], v13 offset:0
  v_mfma_f32_16x16x32_bf16 v[160:163], v[244:247], a[164:167], v[160:163]
  buffer_load_dwordx4 a[144:147], v2, s[16:19], s7 offen offset:0 sc1
  v_mfma_f32_16x16x32_bf16 v[164:167], v[240:243], a[168:171], v[164:167]
  ds_read_b64_tr_b16 v[234:235], v13 offset:4096
  v_mfma_f32_16x16x32_bf16 v[164:167], v[244:247], a[172:175], v[164:167]
  v_mfma_f32_16x16x32_bf16 v[168:171], v[240:243], a[176:179], v[168:171]
  ds_read_b64_tr_b16 v[236:237], v13 offset:8192
  v_mfma_f32_16x16x32_bf16 v[168:171], v[244:247], a[180:183], v[168:171]
  buffer_load_dwordx4 a[148:151], v2, s[16:19], s7 offen offset:1024 sc1
  v_mfma_f32_16x16x32_bf16 v[172:175], v[240:243], a[184:187], v[172:175]
  ds_read_b64_tr_b16 v[238:239], v13 offset:12288
  v_mfma_f32_16x16x32_bf16 v[172:175], v[244:247], a[188:191], v[172:175]
  s_waitcnt lgkmcnt(15)
  v_mfma_f32_16x16x32_bf16 v[176:179], v[248:251], a[160:163], v[176:179]
  s_add_u32 s7, s7, s70
  ds_read_b64_tr_b16 v[240:241], v14 offset:0
  v_mfma_f32_16x16x32_bf16 v[176:179], v[252:255], a[164:167], v[176:179]
  buffer_load_dwordx4 a[152:155], v2, s[16:19], s7 offen offset:0 sc1
  v_mfma_f32_16x16x32_bf16 v[180:183], v[248:251], a[168:171], v[180:183]
  ds_read_b64_tr_b16 v[242:243], v14 offset:4096
  v_mfma_f32_16x16x32_bf16 v[180:183], v[252:255], a[172:175], v[180:183]
  v_mfma_f32_16x16x32_bf16 v[184:187], v[248:251], a[176:179], v[184:187]
  ds_read_b64_tr_b16 v[244:245], v14 offset:8192
  v_mfma_f32_16x16x32_bf16 v[184:187], v[252:255], a[180:183], v[184:187]
  buffer_load_dwordx4 a[156:159], v2, s[16:19], s7 offen offset:1024 sc1
  v_mfma_f32_16x16x32_bf16 v[188:191], v[248:251], a[184:187], v[188:191]
  ds_read_b64_tr_b16 v[246:247], v14 offset:12288
  v_mfma_f32_16x16x32_bf16 v[188:191], v[252:255], a[188:191], v[188:191]
  s_waitcnt vmcnt(16)
  s_waitcnt lgkmcnt(15)
  v_mfma_f32_16x16x32_bf16 v[64:67], v[192:195], a[192:195], v[64:67]
  s_add_u32 s7, s69, 8192
  ds_read_b64_tr_b16 v[248:249], v15 offset:0
  v_mfma_f32_16x16x32_bf16 v[64:67], v[196:199], a[196:199], v[64:67]
  buffer_load_dwordx4 a[160:163], v2, s[16:19], s7 offen offset:2048 sc1
  v_mfma_f32_16x16x32_bf16 v[68:71], v[192:195], a[200:203], v[68:71]
  ds_read_b64_tr_b16 v[250:251], v15 offset:4096
  v_mfma_f32_16x16x32_bf16 v[68:71], v[196:199], a[204:207], v[68:71]
  v_mfma_f32_16x16x32_bf16 v[72:75], v[192:195], a[208:211], v[72:75]
  ds_read_b64_tr_b16 v[252:253], v15 offset:8192
  v_mfma_f32_16x16x32_bf16 v[72:75], v[196:199], a[212:215], v[72:75]
  buffer_load_dwordx4 a[164:167], v2, s[16:19], s7 offen offset:3072 sc1
  v_mfma_f32_16x16x32_bf16 v[76:79], v[192:195], a[216:219], v[76:79]
  ds_read_b64_tr_b16 v[254:255], v15 offset:12288
  v_mfma_f32_16x16x32_bf16 v[76:79], v[196:199], a[220:223], v[76:79]
  s_barrier
  s_waitcnt lgkmcnt(15)
  v_mfma_f32_16x16x32_bf16 v[80:83], v[200:203], a[192:195], v[80:83]
  s_add_u32 s6, s4, 327680
  s_add_u32 m0, s5, 32768
  ds_read_b64_tr_b16 v[192:193], v8 offset:16384
  v_mfma_f32_16x16x32_bf16 v[80:83], v[204:207], a[196:199], v[80:83]
  buffer_load_dwordx4 v4, s[20:23], s6 offen offset:0 lds
  v_mfma_f32_16x16x32_bf16 v[84:87], v[200:203], a[200:203], v[84:87]
  ds_read_b64_tr_b16 v[194:195], v8 offset:20480
  v_mfma_f32_16x16x32_bf16 v[84:87], v[204:207], a[204:207], v[84:87]
  v_mfma_f32_16x16x32_bf16 v[88:91], v[200:203], a[208:211], v[88:91]
  s_add_u32 s7, s7, s70
  ds_read_b64_tr_b16 v[196:197], v8 offset:24576
  v_mfma_f32_16x16x32_bf16 v[88:91], v[204:207], a[212:215], v[88:91]
  buffer_load_dwordx4 a[168:171], v2, s[16:19], s7 offen offset:2048 sc1
  v_mfma_f32_16x16x32_bf16 v[92:95], v[200:203], a[216:219], v[92:95]
  ds_read_b64_tr_b16 v[198:199], v8 offset:28672
  v_mfma_f32_16x16x32_bf16 v[92:95], v[204:207], a[220:223], v[92:95]
  s_waitcnt lgkmcnt(15)
  v_mfma_f32_16x16x32_bf16 v[96:99], v[208:211], a[192:195], v[96:99]
  ds_read_b64_tr_b16 v[200:201], v9 offset:16384
  v_mfma_f32_16x16x32_bf16 v[96:99], v[212:215], a[196:199], v[96:99]
  buffer_load_dwordx4 v5, s[20:23], s6 offen offset:1024 lds
  v_mfma_f32_16x16x32_bf16 v[100:103], v[208:211], a[200:203], v[100:103]
  ds_read_b64_tr_b16 v[202:203], v9 offset:20480
  v_mfma_f32_16x16x32_bf16 v[100:103], v[212:215], a[204:207], v[100:103]
  v_mfma_f32_16x16x32_bf16 v[104:107], v[208:211], a[208:211], v[104:107]
  ds_read_b64_tr_b16 v[204:205], v9 offset:24576
  v_mfma_f32_16x16x32_bf16 v[104:107], v[212:215], a[212:215], v[104:107]
  buffer_load_dwordx4 a[172:175], v2, s[16:19], s7 offen offset:3072 sc1
  v_mfma_f32_16x16x32_bf16 v[108:111], v[208:211], a[216:219], v[108:111]
  ds_read_b64_tr_b16 v[206:207], v9 offset:28672
  v_mfma_f32_16x16x32_bf16 v[108:111], v[212:215], a[220:223], v[108:111]
  s_waitcnt lgkmcnt(15)
  v_mfma_f32_16x16x32_bf16 v[112:115], v[216:219], a[192:195], v[112:115]
  ds_read_b64_tr_b16 v[208:209], v10 offset:16384
  v_mfma_f32_16x16x32_bf16 v[112:115], v[220:223], a[196:199], v[112:115]
  buffer_load_dwordx4 v6, s[20:23], s6 offen offset:2048 lds
  v_mfma_f32_16x16x32_bf16 v[116:119], v[216:219], a[200:203], v[116:119]
  ds_read_b64_tr_b16 v[210:211], v10 offset:20480
  v_mfma_f32_16x16x32_bf16 v[116:119], v[220:223], a[204:207], v[116:119]
  v_mfma_f32_16x16x32_bf16 v[120:123], v[216:219], a[208:211], v[120:123]
  s_add_u32 s7, s7, s48
  ds_read_b64_tr_b16 v[212:213], v10 offset:24576
  v_mfma_f32_16x16x32_bf16 v[120:123], v[220:223], a[212:215], v[120:123]
  buffer_load_dwordx4 a[176:179], v2, s[16:19], s7 offen offset:2048 sc1
  v_mfma_f32_16x16x32_bf16 v[124:127], v[216:219], a[216:219], v[124:127]
  ds_read_b64_tr_b16 v[214:215], v10 offset:28672
  v_mfma_f32_16x16x32_bf16 v[124:127], v[220:223], a[220:223], v[124:127]
  s_waitcnt lgkmcnt(15)
  v_mfma_f32_16x16x32_bf16 v[128:131], v[224:227], a[192:195], v[128:131]
  ds_read_b64_tr_b16 v[216:217], v11 offset:16384
  v_mfma_f32_16x16x32_bf16 v[128:131], v[228:231], a[196:199], v[128:131]
  buffer_load_dwordx4 v7, s[20:23], s6 offen offset:3072 lds
  v_mfma_f32_16x16x32_bf16 v[132:135], v[224:227], a[200:203], v[132:135]
  ds_read_b64_tr_b16 v[218:219], v11 offset:20480
  v_mfma_f32_16x16x32_bf16 v[132:135], v[228:231], a[204:207], v[132:135]
  v_mfma_f32_16x16x32_bf16 v[136:139], v[224:227], a[208:211], v[136:139]
  ds_read_b64_tr_b16 v[220:221], v11 offset:24576
  v_mfma_f32_16x16x32_bf16 v[136:139], v[228:231], a[212:215], v[136:139]
  buffer_load_dwordx4 a[180:183], v2, s[16:19], s7 offen offset:3072 sc1
  v_mfma_f32_16x16x32_bf16 v[140:143], v[224:227], a[216:219], v[140:143]
  ds_read_b64_tr_b16 v[222:223], v11 offset:28672
  v_mfma_f32_16x16x32_bf16 v[140:143], v[228:231], a[220:223], v[140:143]
  s_waitcnt lgkmcnt(15)
  v_mfma_f32_16x16x32_bf16 v[144:147], v[232:235], a[192:195], v[144:147]
  s_add_u32 s6, s4, 344064
  s_add_u32 m0, s5, 36864
  ds_read_b64_tr_b16 v[224:225], v12 offset:16384
  v_mfma_f32_16x16x32_bf16 v[144:147], v[236:239], a[196:199], v[144:147]
  buffer_load_dwordx4 v4, s[20:23], s6 offen offset:0 lds
  v_mfma_f32_16x16x32_bf16 v[148:151], v[232:235], a[200:203], v[148:151]
  ds_read_b64_tr_b16 v[226:227], v12 offset:20480
  v_mfma_f32_16x16x32_bf16 v[148:151], v[236:239], a[204:207], v[148:151]
  v_mfma_f32_16x16x32_bf16 v[152:155], v[232:235], a[208:211], v[152:155]
  s_add_u32 s7, s7, s70
  ds_read_b64_tr_b16 v[228:229], v12 offset:24576
  v_mfma_f32_16x16x32_bf16 v[152:155], v[236:239], a[212:215], v[152:155]
  buffer_load_dwordx4 a[184:187], v2, s[16:19], s7 offen offset:2048 sc1
  v_mfma_f32_16x16x32_bf16 v[156:159], v[232:235], a[216:219], v[156:159]
  ds_read_b64_tr_b16 v[230:231], v12 offset:28672
  v_mfma_f32_16x16x32_bf16 v[156:159], v[236:239], a[220:223], v[156:159]
  s_waitcnt lgkmcnt(15)
  v_mfma_f32_16x16x32_bf16 v[160:163], v[240:243], a[192:195], v[160:163]
  ds_read_b64_tr_b16 v[232:233], v13 offset:16384
  v_mfma_f32_16x16x32_bf16 v[160:163], v[244:247], a[196:199], v[160:163]
  buffer_load_dwordx4 v5, s[20:23], s6 offen offset:1024 lds
  v_mfma_f32_16x16x32_bf16 v[164:167], v[240:243], a[200:203], v[164:167]
  ds_read_b64_tr_b16 v[234:235], v13 offset:20480
  v_mfma_f32_16x16x32_bf16 v[164:167], v[244:247], a[204:207], v[164:167]
  v_mfma_f32_16x16x32_bf16 v[168:171], v[240:243], a[208:211], v[168:171]
  ds_read_b64_tr_b16 v[236:237], v13 offset:24576
  v_mfma_f32_16x16x32_bf16 v[168:171], v[244:247], a[212:215], v[168:171]
  buffer_load_dwordx4 a[188:191], v2, s[16:19], s7 offen offset:3072 sc1
  v_mfma_f32_16x16x32_bf16 v[172:175], v[240:243], a[216:219], v[172:175]
  ds_read_b64_tr_b16 v[238:239], v13 offset:28672
  v_mfma_f32_16x16x32_bf16 v[172:175], v[244:247], a[220:223], v[172:175]
  s_waitcnt lgkmcnt(15)
  v_mfma_f32_16x16x32_bf16 v[176:179], v[248:251], a[192:195], v[176:179]
  ds_read_b64_tr_b16 v[240:241], v14 offset:16384
  v_mfma_f32_16x16x32_bf16 v[176:179], v[252:255], a[196:199], v[176:179]
  buffer_load_dwordx4 v6, s[20:23], s6 offen offset:2048 lds
  v_mfma_f32_16x16x32_bf16 v[180:183], v[248:251], a[200:203], v[180:183]
  ds_read_b64_tr_b16 v[242:243], v14 offset:20480
  v_mfma_f32_16x16x32_bf16 v[180:183], v[252:255], a[204:207], v[180:183]
  v_mfma_f32_16x16x32_bf16 v[184:187], v[248:251], a[208:211], v[184:187]
  ds_read_b64_tr_b16 v[244:245], v14 offset:24576
  v_mfma_f32_16x16x32_bf16 v[184:187], v[252:255], a[212:215], v[184:187]
  buffer_load_dwordx4 v7, s[20:23], s6 offen offset:3072 lds
  v_mfma_f32_16x16x32_bf16 v[188:191], v[248:251], a[216:219], v[188:191]
  ds_read_b64_tr_b16 v[246:247], v14 offset:28672
  v_mfma_f32_16x16x32_bf16 v[188:191], v[252:255], a[220:223], v[188:191]
  s_waitcnt vmcnt(24)
  s_waitcnt lgkmcnt(15)
  v_mfma_f32_16x16x32_bf16 v[64:67], v[192:195], a[224:227], v[64:67]
  s_add_u32 s7, s69, 12288
  ds_read_b64_tr_b16 v[248:249], v15 offset:16384
  v_mfma_f32_16x16x32_bf16 v[64:67], v[196:199], a[228:231], v[64:67]
  buffer_load_dwordx4 a[192:195], v2, s[16:19], s7 offen offset:0 sc1
  v_mfma_f32_16x16x32_bf16 v[68:71], v[192:195], a[232:235], v[68:71]
  ds_read_b64_tr_b16 v[250:251], v15 offset:20480
  v_mfma_f32_16x16x32_bf16 v[68:71], v[196:199], a[236:239], v[68:71]
  v_mfma_f32_16x16x32_bf16 v[72:75], v[192:195], a[240:243], v[72:75]
  ds_read_b64_tr_b16 v[252:253], v15 offset:24576
  v_mfma_f32_16x16x32_bf16 v[72:75], v[196:199], a[244:247], v[72:75]
  buffer_load_dwordx4 a[196:199], v2, s[16:19], s7 offen offset:1024 sc1
  v_mfma_f32_16x16x32_bf16 v[76:79], v[192:195], a[248:251], v[76:79]
  ds_read_b64_tr_b16 v[254:255], v15 offset:28672
  v_mfma_f32_16x16x32_bf16 v[76:79], v[196:199], a[252:255], v[76:79]
  s_barrier
  s_waitcnt lgkmcnt(15)
  v_mfma_f32_16x16x32_bf16 v[80:83], v[200:203], a[224:227], v[80:83]
  s_add_u32 s6, s4, 393216
  s_add_u32 m0, s5, 0
  ds_read_b64_tr_b16 v[192:193], v8 offset:49152
  v_mfma_f32_16x16x32_bf16 v[80:83], v[204:207], a[228:231], v[80:83]
  buffer_load_dwordx4 v4, s[20:23], s6 offen offset:0 lds
  v_mfma_f32_16x16x32_bf16 v[84:87], v[200:203], a[232:235], v[84:87]
  ds_read_b64_tr_b16 v[194:195], v8 offset:53248
  v_mfma_f32_16x16x32_bf16 v[84:87], v[204:207], a[236:239], v[84:87]
  v_mfma_f32_16x16x32_bf16 v[88:91], v[200:203], a[240:243], v[88:91]
  s_add_u32 s7, s7, s70
  ds_read_b64_tr_b16 v[196:197], v8 offset:57344
  v_mfma_f32_16x16x32_bf16 v[88:91], v[204:207], a[244:247], v[88:91]
  buffer_load_dwordx4 a[200:203], v2, s[16:19], s7 offen offset:0 sc1
  v_mfma_f32_16x16x32_bf16 v[92:95], v[200:203], a[248:251], v[92:95]
  ds_read_b64_tr_b16 v[198:199], v8 offset:61440
  v_mfma_f32_16x16x32_bf16 v[92:95], v[204:207], a[252:255], v[92:95]
  s_waitcnt lgkmcnt(15)
  v_mfma_f32_16x16x32_bf16 v[96:99], v[208:211], a[224:227], v[96:99]
  ds_read_b64_tr_b16 v[200:201], v9 offset:49152
  v_mfma_f32_16x16x32_bf16 v[96:99], v[212:215], a[228:231], v[96:99]
  buffer_load_dwordx4 v5, s[20:23], s6 offen offset:1024 lds
  v_mfma_f32_16x16x32_bf16 v[100:103], v[208:211], a[232:235], v[100:103]
  ds_read_b64_tr_b16 v[202:203], v9 offset:53248
  v_mfma_f32_16x16x32_bf16 v[100:103], v[212:215], a[236:239], v[100:103]
  v_mfma_f32_16x16x32_bf16 v[104:107], v[208:211], a[240:243], v[104:107]
  ds_read_b64_tr_b16 v[204:205], v9 offset:57344
  v_mfma_f32_16x16x32_bf16 v[104:107], v[212:215], a[244:247], v[104:107]
  buffer_load_dwordx4 a[204:207], v2, s[16:19], s7 offen offset:1024 sc1
  v_mfma_f32_16x16x32_bf16 v[108:111], v[208:211], a[248:251], v[108:111]
  ds_read_b64_tr_b16 v[206:207], v9 offset:61440
  v_mfma_f32_16x16x32_bf16 v[108:111], v[212:215], a[252:255], v[108:111]
  s_waitcnt lgkmcnt(15)
  v_mfma_f32_16x16x32_bf16 v[112:115], v[216:219], a[224:227], v[112:115]
  ds_read_b64_tr_b16 v[208:209], v10 offset:49152
  v_mfma_f32_16x16x32_bf16 v[112:115], v[220:223], a[228:231], v[112:115]
  buffer_load_dwordx4 v6, s[20:23], s6 offen offset:2048 lds
  v_mfma_f32_16x16x32_bf16 v[116:119], v[216:219], a[232:235], v[116:119]
  ds_read_b64_tr_b16 v[210:211], v10 offset:53248
  v_mfma_f32_16x16x32_bf16 v[116:119], v[220:223], a[236:239], v[116:119]
  v_mfma_f32_16x16x32_bf16 v[120:123], v[216:219], a[240:243], v[120:123]
  s_add_u32 s7, s7, s48
  ds_read_b64_tr_b16 v[212:213], v10 offset:57344
  v_mfma_f32_16x16x32_bf16 v[120:123], v[220:223], a[244:247], v[120:123]
  buffer_load_dwordx4 a[208:211], v2, s[16:19], s7 offen offset:0 sc1
  v_mfma_f32_16x16x32_bf16 v[124:127], v[216:219], a[248:251], v[124:127]
  ds_read_b64_tr_b16 v[214:215], v10 offset:61440
  v_mfma_f32_16x16x32_bf16 v[124:127], v[220:223], a[252:255], v[124:127]
  s_waitcnt lgkmcnt(15)
  v_mfma_f32_16x16x32_bf16 v[128:131], v[224:227], a[224:227], v[128:131]
  ds_read_b64_tr_b16 v[216:217], v11 offset:49152
  v_mfma_f32_16x16x32_bf16 v[128:131], v[228:231], a[228:231], v[128:131]
  buffer_load_dwordx4 v7, s[20:23], s6 offen offset:3072 lds
  v_mfma_f32_16x16x32_bf16 v[132:135], v[224:227], a[232:235], v[132:135]
  ds_read_b64_tr_b16 v[218:219], v11 offset:53248
  v_mfma_f32_16x16x32_bf16 v[132:135], v[228:231], a[236:239], v[132:135]
  v_mfma_f32_16x16x32_bf16 v[136:139], v[224:227], a[240:243], v[136:139]
  ds_read_b64_tr_b16 v[220:221], v11 offset:57344
  v_mfma_f32_16x16x32_bf16 v[136:139], v[228:231], a[244:247], v[136:139]
  buffer_load_dwordx4 a[212:215], v2, s[16:19], s7 offen offset:1024 sc1
  v_mfma_f32_16x16x32_bf16 v[140:143], v[224:227], a[248:251], v[140:143]
  ds_read_b64_tr_b16 v[222:223], v11 offset:61440
  v_mfma_f32_16x16x32_bf16 v[140:143], v[228:231], a[252:255], v[140:143]
  s_waitcnt lgkmcnt(15)
  v_mfma_f32_16x16x32_bf16 v[144:147], v[232:235], a[224:227], v[144:147]
  s_add_u32 s6, s4, 409600
  s_add_u32 m0, s5, 4096
  ds_read_b64_tr_b16 v[224:225], v12 offset:49152
  v_mfma_f32_16x16x32_bf16 v[144:147], v[236:239], a[228:231], v[144:147]
  buffer_load_dwordx4 v4, s[20:23], s6 offen offset:0 lds
  v_mfma_f32_16x16x32_bf16 v[148:151], v[232:235], a[232:235], v[148:151]
  ds_read_b64_tr_b16 v[226:227], v12 offset:53248
  v_mfma_f32_16x16x32_bf16 v[148:151], v[236:239], a[236:239], v[148:151]
  v_mfma_f32_16x16x32_bf16 v[152:155], v[232:235], a[240:243], v[152:155]
  s_add_u32 s7, s7, s70
  ds_read_b64_tr_b16 v[228:229], v12 offset:57344
  v_mfma_f32_16x16x32_bf16 v[152:155], v[236:239], a[244:247], v[152:155]
  buffer_load_dwordx4 a[216:219], v2, s[16:19], s7 offen offset:0 sc1
  v_mfma_f32_16x16x32_bf16 v[156:159], v[232:235], a[248:251], v[156:159]
  ds_read_b64_tr_b16 v[230:231], v12 offset:61440
  v_mfma_f32_16x16x32_bf16 v[156:159], v[236:239], a[252:255], v[156:159]
  s_waitcnt lgkmcnt(15)
  v_mfma_f32_16x16x32_bf16 v[160:163], v[240:243], a[224:227], v[160:163]
  ds_read_b64_tr_b16 v[232:233], v13 offset:49152
  v_mfma_f32_16x16x32_bf16 v[160:163], v[244:247], a[228:231], v[160:163]
  buffer_load_dwordx4 v5, s[20:23], s6 offen offset:1024 lds
  v_mfma_f32_16x16x32_bf16 v[164:167], v[240:243], a[232:235], v[164:167]
  ds_read_b64_tr_b16 v[234:235], v13 offset:53248
  v_mfma_f32_16x16x32_bf16 v[164:167], v[244:247], a[236:239], v[164:167]
  v_mfma_f32_16x16x32_bf16 v[168:171], v[240:243], a[240:243], v[168:171]
  ds_read_b64_tr_b16 v[236:237], v13 offset:57344
  v_mfma_f32_16x16x32_bf16 v[168:171], v[244:247], a[244:247], v[168:171]
  buffer_load_dwordx4 a[220:223], v2, s[16:19], s7 offen offset:1024 sc1
  v_mfma_f32_16x16x32_bf16 v[172:175], v[240:243], a[248:251], v[172:175]
  ds_read_b64_tr_b16 v[238:239], v13 offset:61440
  v_mfma_f32_16x16x32_bf16 v[172:175], v[244:247], a[252:255], v[172:175]
  s_waitcnt lgkmcnt(15)
  v_mfma_f32_16x16x32_bf16 v[176:179], v[248:251], a[224:227], v[176:179]
  ds_read_b64_tr_b16 v[240:241], v14 offset:49152
  v_mfma_f32_16x16x32_bf16 v[176:179], v[252:255], a[228:231], v[176:179]
  buffer_load_dwordx4 v6, s[20:23], s6 offen offset:2048 lds
  v_mfma_f32_16x16x32_bf16 v[180:183], v[248:251], a[232:235], v[180:183]
  ds_read_b64_tr_b16 v[242:243], v14 offset:53248
  v_mfma_f32_16x16x32_bf16 v[180:183], v[252:255], a[236:239], v[180:183]
  v_mfma_f32_16x16x32_bf16 v[184:187], v[248:251], a[240:243], v[184:187]
  ds_read_b64_tr_b16 v[244:245], v14 offset:57344
  v_mfma_f32_16x16x32_bf16 v[184:187], v[252:255], a[244:247], v[184:187]
  buffer_load_dwordx4 v7, s[20:23], s6 offen offset:3072 lds
  v_mfma_f32_16x16x32_bf16 v[188:191], v[248:251], a[248:251], v[188:191]
  ds_read_b64_tr_b16 v[246:247], v14 offset:61440
  v_mfma_f32_16x16x32_bf16 v[188:191], v[252:255], a[252:255], v[188:191]
  s_waitcnt vmcnt(32)
  s_waitcnt lgkmcnt(15)
  v_mfma_f32_16x16x32_bf16 v[64:67], v[192:195], a[128:131], v[64:67]
  s_add_u32 s7, s69, 12288
  ds_read_b64_tr_b16 v[248:249], v15 offset:49152
  v_mfma_f32_16x16x32_bf16 v[64:67], v[196:199], a[132:135], v[64:67]
  buffer_load_dwordx4 a[224:227], v2, s[16:19], s7 offen offset:2048 sc1
  v_mfma_f32_16x16x32_bf16 v[68:71], v[192:195], a[136:139], v[68:71]
  ds_read_b64_tr_b16 v[250:251], v15 offset:53248
  v_mfma_f32_16x16x32_bf16 v[68:71], v[196:199], a[140:143], v[68:71]
  v_mfma_f32_16x16x32_bf16 v[72:75], v[192:195], a[144:147], v[72:75]
  ds_read_b64_tr_b16 v[252:253], v15 offset:57344
  v_mfma_f32_16x16x32_bf16 v[72:75], v[196:199], a[148:151], v[72:75]
  buffer_load_dwordx4 a[228:231], v2, s[16:19], s7 offen offset:3072 sc1
  v_mfma_f32_16x16x32_bf16 v[76:79], v[192:195], a[152:155], v[76:79]
  ds_read_b64_tr_b16 v[254:255], v15 offset:61440
  v_mfma_f32_16x16x32_bf16 v[76:79], v[196:199], a[156:159], v[76:79]
  s_waitcnt vmcnt(18)
  s_barrier
  s_waitcnt lgkmcnt(15)
  v_mfma_f32_16x16x32_bf16 v[80:83], v[200:203], a[128:131], v[80:83]
  s_add_u32 s6, s4, 458752
  s_add_u32 m0, s5, 16384
  ds_read_b64_tr_b16 v[192:193], v8 offset:32768
  v_mfma_f32_16x16x32_bf16 v[80:83], v[204:207], a[132:135], v[80:83]
  buffer_load_dwordx4 v4, s[20:23], s6 offen offset:0 lds
  v_mfma_f32_16x16x32_bf16 v[84:87], v[200:203], a[136:139], v[84:87]
  ds_read_b64_tr_b16 v[194:195], v8 offset:36864
  v_mfma_f32_16x16x32_bf16 v[84:87], v[204:207], a[140:143], v[84:87]
  v_mfma_f32_16x16x32_bf16 v[88:91], v[200:203], a[144:147], v[88:91]
  s_add_u32 s7, s7, s70
  ds_read_b64_tr_b16 v[196:197], v8 offset:40960
  v_mfma_f32_16x16x32_bf16 v[88:91], v[204:207], a[148:151], v[88:91]
  buffer_load_dwordx4 a[232:235], v2, s[16:19], s7 offen offset:2048 sc1
  v_mfma_f32_16x16x32_bf16 v[92:95], v[200:203], a[152:155], v[92:95]
  ds_read_b64_tr_b16 v[198:199], v8 offset:45056
  v_mfma_f32_16x16x32_bf16 v[92:95], v[204:207], a[156:159], v[92:95]
  s_waitcnt lgkmcnt(15)
  v_mfma_f32_16x16x32_bf16 v[96:99], v[208:211], a[128:131], v[96:99]
  ds_read_b64_tr_b16 v[200:201], v9 offset:32768
  v_mfma_f32_16x16x32_bf16 v[96:99], v[212:215], a[132:135], v[96:99]
  buffer_load_dwordx4 v5, s[20:23], s6 offen offset:1024 lds
  v_mfma_f32_16x16x32_bf16 v[100:103], v[208:211], a[136:139], v[100:103]
  ds_read_b64_tr_b16 v[202:203], v9 offset:36864
  v_mfma_f32_16x16x32_bf16 v[100:103], v[212:215], a[140:143], v[100:103]
  v_mfma_f32_16x16x32_bf16 v[104:107], v[208:211], a[144:147], v[104:107]
  ds_read_b64_tr_b16 v[204:205], v9 offset:40960
  v_mfma_f32_16x16x32_bf16 v[104:107], v[212:215], a[148:151], v[104:107]
  buffer_load_dwordx4 a[236:239], v2, s[16:19], s7 offen offset:3072 sc1
  v_mfma_f32_16x16x32_bf16 v[108:111], v[208:211], a[152:155], v[108:111]
  ds_read_b64_tr_b16 v[206:207], v9 offset:45056
  v_mfma_f32_16x16x32_bf16 v[108:111], v[212:215], a[156:159], v[108:111]
  s_waitcnt lgkmcnt(15)
  v_mfma_f32_16x16x32_bf16 v[112:115], v[216:219], a[128:131], v[112:115]
  ds_read_b64_tr_b16 v[208:209], v10 offset:32768
  v_mfma_f32_16x16x32_bf16 v[112:115], v[220:223], a[132:135], v[112:115]
  buffer_load_dwordx4 v6, s[20:23], s6 offen offset:2048 lds
  v_mfma_f32_16x16x32_bf16 v[116:119], v[216:219], a[136:139], v[116:119]
  ds_read_b64_tr_b16 v[210:211], v10 offset:36864
  v_mfma_f32_16x16x32_bf16 v[116:119], v[220:223], a[140:143], v[116:119]
  v_mfma_f32_16x16x32_bf16 v[120:123], v[216:219], a[144:147], v[120:123]
  s_add_u32 s7, s7, s48
  ds_read_b64_tr_b16 v[212:213], v10 offset:40960
  v_mfma_f32_16x16x32_bf16 v[120:123], v[220:223], a[148:151], v[120:123]
  buffer_load_dwordx4 a[240:243], v2, s[16:19], s7 offen offset:2048 sc1
  v_mfma_f32_16x16x32_bf16 v[124:127], v[216:219], a[152:155], v[124:127]
  ds_read_b64_tr_b16 v[214:215], v10 offset:45056
  v_mfma_f32_16x16x32_bf16 v[124:127], v[220:223], a[156:159], v[124:127]
  s_waitcnt lgkmcnt(15)
  v_mfma_f32_16x16x32_bf16 v[128:131], v[224:227], a[128:131], v[128:131]
  ds_read_b64_tr_b16 v[216:217], v11 offset:32768
  v_mfma_f32_16x16x32_bf16 v[128:131], v[228:231], a[132:135], v[128:131]
  buffer_load_dwordx4 v7, s[20:23], s6 offen offset:3072 lds
  v_mfma_f32_16x16x32_bf16 v[132:135], v[224:227], a[136:139], v[132:135]
  ds_read_b64_tr_b16 v[218:219], v11 offset:36864
  v_mfma_f32_16x16x32_bf16 v[132:135], v[228:231], a[140:143], v[132:135]
  v_mfma_f32_16x16x32_bf16 v[136:139], v[224:227], a[144:147], v[136:139]
  ds_read_b64_tr_b16 v[220:221], v11 offset:40960
  v_mfma_f32_16x16x32_bf16 v[136:139], v[228:231], a[148:151], v[136:139]
  buffer_load_dwordx4 a[244:247], v2, s[16:19], s7 offen offset:3072 sc1
  v_mfma_f32_16x16x32_bf16 v[140:143], v[224:227], a[152:155], v[140:143]
  ds_read_b64_tr_b16 v[222:223], v11 offset:45056
  v_mfma_f32_16x16x32_bf16 v[140:143], v[228:231], a[156:159], v[140:143]
  s_waitcnt lgkmcnt(15)
  v_mfma_f32_16x16x32_bf16 v[144:147], v[232:235], a[128:131], v[144:147]
  s_add_u32 s6, s4, 475136
  s_add_u32 m0, s5, 20480
  ds_read_b64_tr_b16 v[224:225], v12 offset:32768
  v_mfma_f32_16x16x32_bf16 v[144:147], v[236:239], a[132:135], v[144:147]
  buffer_load_dwordx4 v4, s[20:23], s6 offen offset:0 lds
  v_mfma_f32_16x16x32_bf16 v[148:151], v[232:235], a[136:139], v[148:151]
  ds_read_b64_tr_b16 v[226:227], v12 offset:36864
  v_mfma_f32_16x16x32_bf16 v[148:151], v[236:239], a[140:143], v[148:151]
  v_mfma_f32_16x16x32_bf16 v[152:155], v[232:235], a[144:147], v[152:155]
  s_add_u32 s7, s7, s70
  ds_read_b64_tr_b16 v[228:229], v12 offset:40960
  v_mfma_f32_16x16x32_bf16 v[152:155], v[236:239], a[148:151], v[152:155]
  buffer_load_dwordx4 a[248:251], v2, s[16:19], s7 offen offset:2048 sc1
  v_mfma_f32_16x16x32_bf16 v[156:159], v[232:235], a[152:155], v[156:159]
  ds_read_b64_tr_b16 v[230:231], v12 offset:45056
  v_mfma_f32_16x16x32_bf16 v[156:159], v[236:239], a[156:159], v[156:159]
  s_waitcnt lgkmcnt(15)
  v_mfma_f32_16x16x32_bf16 v[160:163], v[240:243], a[128:131], v[160:163]
  ds_read_b64_tr_b16 v[232:233], v13 offset:32768
  v_mfma_f32_16x16x32_bf16 v[160:163], v[244:247], a[132:135], v[160:163]
  buffer_load_dwordx4 v5, s[20:23], s6 offen offset:1024 lds
  v_mfma_f32_16x16x32_bf16 v[164:167], v[240:243], a[136:139], v[164:167]
  ds_read_b64_tr_b16 v[234:235], v13 offset:36864
  v_mfma_f32_16x16x32_bf16 v[164:167], v[244:247], a[140:143], v[164:167]
  v_mfma_f32_16x16x32_bf16 v[168:171], v[240:243], a[144:147], v[168:171]
  ds_read_b64_tr_b16 v[236:237], v13 offset:40960
  v_mfma_f32_16x16x32_bf16 v[168:171], v[244:247], a[148:151], v[168:171]
  buffer_load_dwordx4 a[252:255], v2, s[16:19], s7 offen offset:3072 sc1
  v_mfma_f32_16x16x32_bf16 v[172:175], v[240:243], a[152:155], v[172:175]
  ds_read_b64_tr_b16 v[238:239], v13 offset:45056
  v_mfma_f32_16x16x32_bf16 v[172:175], v[244:247], a[156:159], v[172:175]
  s_waitcnt lgkmcnt(15)
  v_mfma_f32_16x16x32_bf16 v[176:179], v[248:251], a[128:131], v[176:179]
  ds_read_b64_tr_b16 v[240:241], v14 offset:32768
  v_mfma_f32_16x16x32_bf16 v[176:179], v[252:255], a[132:135], v[176:179]
  buffer_load_dwordx4 v6, s[20:23], s6 offen offset:2048 lds
  v_mfma_f32_16x16x32_bf16 v[180:183], v[248:251], a[136:139], v[180:183]
  ds_read_b64_tr_b16 v[242:243], v14 offset:36864
  v_mfma_f32_16x16x32_bf16 v[180:183], v[252:255], a[140:143], v[180:183]
  v_mfma_f32_16x16x32_bf16 v[184:187], v[248:251], a[144:147], v[184:187]
  ds_read_b64_tr_b16 v[244:245], v14 offset:40960
  v_mfma_f32_16x16x32_bf16 v[184:187], v[252:255], a[148:151], v[184:187]
  buffer_load_dwordx4 v7, s[20:23], s6 offen offset:3072 lds
  v_mfma_f32_16x16x32_bf16 v[188:191], v[248:251], a[152:155], v[188:191]
  ds_read_b64_tr_b16 v[246:247], v14 offset:45056
  v_mfma_f32_16x16x32_bf16 v[188:191], v[252:255], a[156:159], v[188:191]
  s_waitcnt lgkmcnt(15)
  v_mfma_f32_16x16x32_bf16 v[64:67], v[192:195], a[160:163], v[64:67]
  s_add_u32 s7, s69, 16384
  ds_read_b64_tr_b16 v[248:249], v15 offset:32768
  v_mfma_f32_16x16x32_bf16 v[64:67], v[196:199], a[164:167], v[64:67]
  buffer_load_dwordx4 a[128:131], v2, s[16:19], s7 offen offset:0 sc1
  v_mfma_f32_16x16x32_bf16 v[68:71], v[192:195], a[168:171], v[68:71]
  ds_read_b64_tr_b16 v[250:251], v15 offset:36864
  v_mfma_f32_16x16x32_bf16 v[68:71], v[196:199], a[172:175], v[68:71]
  v_mfma_f32_16x16x32_bf16 v[72:75], v[192:195], a[176:179], v[72:75]
  ds_read_b64_tr_b16 v[252:253], v15 offset:40960
  v_mfma_f32_16x16x32_bf16 v[72:75], v[196:199], a[180:183], v[72:75]
  buffer_load_dwordx4 a[132:135], v2, s[16:19], s7 offen offset:1024 sc1
  v_mfma_f32_16x16x32_bf16 v[76:79], v[192:195], a[184:187], v[76:79]
  ds_read_b64_tr_b16 v[254:255], v15 offset:45056
  v_mfma_f32_16x16x32_bf16 v[76:79], v[196:199], a[188:191], v[76:79]
  s_waitcnt vmcnt(18)
  s_barrier
  s_waitcnt lgkmcnt(15)
  v_mfma_f32_16x16x32_bf16 v[80:83], v[200:203], a[160:163], v[80:83]
  s_add_u32 s6, s4, 524288
  s_add_u32 m0, s5, 49152
  ds_read_b64_tr_b16 v[192:193], v8 offset:0
  v_mfma_f32_16x16x32_bf16 v[80:83], v[204:207], a[164:167], v[80:83]
  buffer_load_dwordx4 v4, s[20:23], s6 offen offset:0 lds
  v_mfma_f32_16x16x32_bf16 v[84:87], v[200:203], a[168:171], v[84:87]
  ds_read_b64_tr_b16 v[194:195], v8 offset:4096
  v_mfma_f32_16x16x32_bf16 v[84:87], v[204:207], a[172:175], v[84:87]
  v_mfma_f32_16x16x32_bf16 v[88:91], v[200:203], a[176:179], v[88:91]
  s_add_u32 s7, s7, s70
  ds_read_b64_tr_b16 v[196:197], v8 offset:8192
  v_mfma_f32_16x16x32_bf16 v[88:91], v[204:207], a[180:183], v[88:91]
  buffer_load_dwordx4 a[136:139], v2, s[16:19], s7 offen offset:0 sc1
  v_mfma_f32_16x16x32_bf16 v[92:95], v[200:203], a[184:187], v[92:95]
  ds_read_b64_tr_b16 v[198:199], v8 offset:12288
  v_mfma_f32_16x16x32_bf16 v[92:95], v[204:207], a[188:191], v[92:95]
  s_waitcnt lgkmcnt(15)
  v_mfma_f32_16x16x32_bf16 v[96:99], v[208:211], a[160:163], v[96:99]
  ds_read_b64_tr_b16 v[200:201], v9 offset:0
  v_mfma_f32_16x16x32_bf16 v[96:99], v[212:215], a[164:167], v[96:99]
  buffer_load_dwordx4 v5, s[20:23], s6 offen offset:1024 lds
  v_mfma_f32_16x16x32_bf16 v[100:103], v[208:211], a[168:171], v[100:103]
  ds_read_b64_tr_b16 v[202:203], v9 offset:4096
  v_mfma_f32_16x16x32_bf16 v[100:103], v[212:215], a[172:175], v[100:103]
  v_mfma_f32_16x16x32_bf16 v[104:107], v[208:211], a[176:179], v[104:107]
  ds_read_b64_tr_b16 v[204:205], v9 offset:8192
  v_mfma_f32_16x16x32_bf16 v[104:107], v[212:215], a[180:183], v[104:107]
  buffer_load_dwordx4 a[140:143], v2, s[16:19], s7 offen offset:1024 sc1
  v_mfma_f32_16x16x32_bf16 v[108:111], v[208:211], a[184:187], v[108:111]
  ds_read_b64_tr_b16 v[206:207], v9 offset:12288
  v_mfma_f32_16x16x32_bf16 v[108:111], v[212:215], a[188:191], v[108:111]
  s_waitcnt lgkmcnt(15)
  v_mfma_f32_16x16x32_bf16 v[112:115], v[216:219], a[160:163], v[112:115]
  ds_read_b64_tr_b16 v[208:209], v10 offset:0
  v_mfma_f32_16x16x32_bf16 v[112:115], v[220:223], a[164:167], v[112:115]
  buffer_load_dwordx4 v6, s[20:23], s6 offen offset:2048 lds
  v_mfma_f32_16x16x32_bf16 v[116:119], v[216:219], a[168:171], v[116:119]
  ds_read_b64_tr_b16 v[210:211], v10 offset:4096
  v_mfma_f32_16x16x32_bf16 v[116:119], v[220:223], a[172:175], v[116:119]
  v_mfma_f32_16x16x32_bf16 v[120:123], v[216:219], a[176:179], v[120:123]
  s_add_u32 s7, s7, s48
  ds_read_b64_tr_b16 v[212:213], v10 offset:8192
  v_mfma_f32_16x16x32_bf16 v[120:123], v[220:223], a[180:183], v[120:123]
  buffer_load_dwordx4 a[144:147], v2, s[16:19], s7 offen offset:0 sc1
  v_mfma_f32_16x16x32_bf16 v[124:127], v[216:219], a[184:187], v[124:127]
  ds_read_b64_tr_b16 v[214:215], v10 offset:12288
  v_mfma_f32_16x16x32_bf16 v[124:127], v[220:223], a[188:191], v[124:127]
  s_waitcnt lgkmcnt(15)
  v_mfma_f32_16x16x32_bf16 v[128:131], v[224:227], a[160:163], v[128:131]
  ds_read_b64_tr_b16 v[216:217], v11 offset:0
  v_mfma_f32_16x16x32_bf16 v[128:131], v[228:231], a[164:167], v[128:131]
  buffer_load_dwordx4 v7, s[20:23], s6 offen offset:3072 lds
  v_mfma_f32_16x16x32_bf16 v[132:135], v[224:227], a[168:171], v[132:135]
  ds_read_b64_tr_b16 v[218:219], v11 offset:4096
  v_mfma_f32_16x16x32_bf16 v[132:135], v[228:231], a[172:175], v[132:135]
  v_mfma_f32_16x16x32_bf16 v[136:139], v[224:227], a[176:179], v[136:139]
  ds_read_b64_tr_b16 v[220:221], v11 offset:8192
  v_mfma_f32_16x16x32_bf16 v[136:139], v[228:231], a[180:183], v[136:139]
  buffer_load_dwordx4 a[148:151], v2, s[16:19], s7 offen offset:1024 sc1
  v_mfma_f32_16x16x32_bf16 v[140:143], v[224:227], a[184:187], v[140:143]
  ds_read_b64_tr_b16 v[222:223], v11 offset:12288
  v_mfma_f32_16x16x32_bf16 v[140:143], v[228:231], a[188:191], v[140:143]
  s_waitcnt lgkmcnt(15)
  v_mfma_f32_16x16x32_bf16 v[144:147], v[232:235], a[160:163], v[144:147]
  s_add_u32 s6, s4, 540672
  s_add_u32 m0, s5, 53248
  ds_read_b64_tr_b16 v[224:225], v12 offset:0
  v_mfma_f32_16x16x32_bf16 v[144:147], v[236:239], a[164:167], v[144:147]
  buffer_load_dwordx4 v4, s[20:23], s6 offen offset:0 lds
  v_mfma_f32_16x16x32_bf16 v[148:151], v[232:235], a[168:171], v[148:151]
  ds_read_b64_tr_b16 v[226:227], v12 offset:4096
  v_mfma_f32_16x16x32_bf16 v[148:151], v[236:239], a[172:175], v[148:151]
  v_mfma_f32_16x16x32_bf16 v[152:155], v[232:235], a[176:179], v[152:155]
  s_add_u32 s7, s7, s70
  ds_read_b64_tr_b16 v[228:229], v12 offset:8192
  v_mfma_f32_16x16x32_bf16 v[152:155], v[236:239], a[180:183], v[152:155]
  buffer_load_dwordx4 a[152:155], v2, s[16:19], s7 offen offset:0 sc1
  v_mfma_f32_16x16x32_bf16 v[156:159], v[232:235], a[184:187], v[156:159]
  ds_read_b64_tr_b16 v[230:231], v12 offset:12288
  v_mfma_f32_16x16x32_bf16 v[156:159], v[236:239], a[188:191], v[156:159]
  s_waitcnt lgkmcnt(15)
  v_mfma_f32_16x16x32_bf16 v[160:163], v[240:243], a[160:163], v[160:163]
  ds_read_b64_tr_b16 v[232:233], v13 offset:0
  v_mfma_f32_16x16x32_bf16 v[160:163], v[244:247], a[164:167], v[160:163]
  buffer_load_dwordx4 v5, s[20:23], s6 offen offset:1024 lds
  v_mfma_f32_16x16x32_bf16 v[164:167], v[240:243], a[168:171], v[164:167]
  ds_read_b64_tr_b16 v[234:235], v13 offset:4096
  v_mfma_f32_16x16x32_bf16 v[164:167], v[244:247], a[172:175], v[164:167]
  v_mfma_f32_16x16x32_bf16 v[168:171], v[240:243], a[176:179], v[168:171]
  ds_read_b64_tr_b16 v[236:237], v13 offset:8192
  v_mfma_f32_16x16x32_bf16 v[168:171], v[244:247], a[180:183], v[168:171]
  buffer_load_dwordx4 a[156:159], v2, s[16:19], s7 offen offset:1024 sc1
  v_mfma_f32_16x16x32_bf16 v[172:175], v[240:243], a[184:187], v[172:175]
  ds_read_b64_tr_b16 v[238:239], v13 offset:12288
  v_mfma_f32_16x16x32_bf16 v[172:175], v[244:247], a[188:191], v[172:175]
  s_waitcnt lgkmcnt(15)
  v_mfma_f32_16x16x32_bf16 v[176:179], v[248:251], a[160:163], v[176:179]
  ds_read_b64_tr_b16 v[240:241], v14 offset:0
  v_mfma_f32_16x16x32_bf16 v[176:179], v[252:255], a[164:167], v[176:179]
  buffer_load_dwordx4 v6, s[20:23], s6 offen offset:2048 lds
  v_mfma_f32_16x16x32_bf16 v[180:183], v[248:251], a[168:171], v[180:183]
  ds_read_b64_tr_b16 v[242:243], v14 offset:4096
  v_mfma_f32_16x16x32_bf16 v[180:183], v[252:255], a[172:175], v[180:183]
  v_mfma_f32_16x16x32_bf16 v[184:187], v[248:251], a[176:179], v[184:187]
  ds_read_b64_tr_b16 v[244:245], v14 offset:8192
  v_mfma_f32_16x16x32_bf16 v[184:187], v[252:255], a[180:183], v[184:187]
  buffer_load_dwordx4 v7, s[20:23], s6 offen offset:3072 lds
  v_mfma_f32_16x16x32_bf16 v[188:191], v[248:251], a[184:187], v[188:191]
  ds_read_b64_tr_b16 v[246:247], v14 offset:12288
  v_mfma_f32_16x16x32_bf16 v[188:191], v[252:255], a[188:191], v[188:191]
  s_waitcnt lgkmcnt(15)
  v_mfma_f32_16x16x32_bf16 v[64:67], v[192:195], a[192:195], v[64:67]
  s_add_u32 s7, s69, 16384
  s_cmp_gt_u32 s71, 18
  s_cselect_b32 s35, s7, 1073741824
  ds_read_b64_tr_b16 v[248:249], v15 offset:0
  v_mfma_f32_16x16x32_bf16 v[64:67], v[196:199], a[196:199], v[64:67]
  buffer_load_dwordx4 a[160:163], v2, s[16:19], s35 offen offset:2048 sc1
  v_mfma_f32_16x16x32_bf16 v[68:71], v[192:195], a[200:203], v[68:71]
  ds_read_b64_tr_b16 v[250:251], v15 offset:4096
  v_mfma_f32_16x16x32_bf16 v[68:71], v[196:199], a[204:207], v[68:71]
  v_mfma_f32_16x16x32_bf16 v[72:75], v[192:195], a[208:211], v[72:75]
  s_cmp_gt_u32 s71, 19
  s_cselect_b32 s35, s7, 1073741824
  ds_read_b64_tr_b16 v[252:253], v15 offset:8192
  v_mfma_f32_16x16x32_bf16 v[72:75], v[196:199], a[212:215], v[72:75]
  buffer_load_dwordx4 a[164:167], v2, s[16:19], s35 offen offset:3072 sc1
  v_mfma_f32_16x16x32_bf16 v[76:79], v[192:195], a[216:219], v[76:79]
  ds_read_b64_tr_b16 v[254:255], v15 offset:12288
  v_mfma_f32_16x16x32_bf16 v[76:79], v[196:199], a[220:223], v[76:79]
  s_waitcnt vmcnt(18)
  s_barrier
  s_waitcnt lgkmcnt(15)
  v_mfma_f32_16x16x32_bf16 v[80:83], v[200:203], a[192:195], v[80:83]
  s_add_u32 s6, s4, 589824
  s_add_u32 m0, s5, 32768
  ds_read_b64_tr_b16 v[192:193], v8 offset:16384
  v_mfma_f32_16x16x32_bf16 v[80:83], v[204:207], a[196:199], v[80:83]
  buffer_load_dwordx4 v4, s[20:23], s6 offen offset:0 lds
  v_mfma_f32_16x16x32_bf16 v[84:87], v[200:203], a[200:203], v[84:87]
  ds_read_b64_tr_b16 v[194:195], v8 offset:20480
  v_mfma_f32_16x16x32_bf16 v[84:87], v[204:207], a[204:207], v[84:87]
  v_mfma_f32_16x16x32_bf16 v[88:91], v[200:203], a[208:211], v[88:91]
  s_add_u32 s7, s7, s70
  s_cmp_gt_u32 s71, 18
  s_cselect_b32 s35, s7, 1073741824
  ds_read_b64_tr_b16 v[196:197], v8 offset:24576
  v_mfma_f32_16x16x32_bf16 v[88:91], v[204:207], a[212:215], v[88:91]
  buffer_load_dwordx4 a[168:171], v2, s[16:19], s35 offen offset:2048 sc1
  v_mfma_f32_16x16x32_bf16 v[92:95], v[200:203], a[216:219], v[92:95]
  ds_read_b64_tr_b16 v[198:199], v8 offset:28672
  v_mfma_f32_16x16x32_bf16 v[92:95], v[204:207], a[220:223], v[92:95]
  s_waitcnt lgkmcnt(15)
  v_mfma_f32_16x16x32_bf16 v[96:99], v[208:211], a[192:195], v[96:99]
  ds_read_b64_tr_b16 v[200:201], v9 offset:16384
  v_mfma_f32_16x16x32_bf16 v[96:99], v[212:215], a[196:199], v[96:99]
  buffer_load_dwordx4 v5, s[20:23], s6 offen offset:1024 lds
  v_mfma_f32_16x16x32_bf16 v[100:103], v[208:211], a[200:203], v[100:103]
  ds_read_b64_tr_b16 v[202:203], v9 offset:20480
  v_mfma_f32_16x16x32_bf16 v[100:103], v[212:215], a[204:207], v[100:103]
  v_mfma_f32_16x16x32_bf16 v[104:107], v[208:211], a[208:211], v[104:107]
  s_cmp_gt_u32 s71, 19
  s_cselect_b32 s35, s7, 1073741824
  ds_read_b64_tr_b16 v[204:205], v9 offset:24576
  v_mfma_f32_16x16x32_bf16 v[104:107], v[212:215], a[212:215], v[104:107]
  buffer_load_dwordx4 a[172:175], v2, s[16:19], s35 offen offset:3072 sc1
  v_mfma_f32_16x16x32_bf16 v[108:111], v[208:211], a[216:219], v[108:111]
  ds_read_b64_tr_b16 v[206:207], v9 offset:28672
  v_mfma_f32_16x16x32_bf16 v[108:111], v[212:215], a[220:223], v[108:111]
  s_waitcnt lgkmcnt(15)
  v_mfma_f32_16x16x32_bf16 v[112:115], v[216:219], a[192:195], v[112:115]
  ds_read_b64_tr_b16 v[208:209], v10 offset:16384
  v_mfma_f32_16x16x32_bf16 v[112:115], v[220:223], a[196:199], v[112:115]
  buffer_load_dwordx4 v6, s[20:23], s6 offen offset:2048 lds
  v_mfma_f32_16x16x32_bf16 v[116:119], v[216:219], a[200:203], v[116:119]
  ds_read_b64_tr_b16 v[210:211], v10 offset:20480
  v_mfma_f32_16x16x32_bf16 v[116:119], v[220:223], a[204:207], v[116:119]
  v_mfma_f32_16x16x32_bf16 v[120:123], v[216:219], a[208:211], v[120:123]
  s_add_u32 s7, s7, s48
  s_cmp_gt_u32 s71, 18
  s_cselect_b32 s35, s7, 1073741824
  ds_read_b64_tr_b16 v[212:213], v10 offset:24576
  v_mfma_f32_16x16x32_bf16 v[120:123], v[220:223], a[212:215], v[120:123]
  buffer_load_dwordx4 a[176:179], v2, s[16:19], s35 offen offset:2048 sc1
  v_mfma_f32_16x16x32_bf16 v[124:127], v[216:219], a[216:219], v[124:127]
  ds_read_b64_tr_b16 v[214:215], v10 offset:28672
  v_mfma_f32_16x16x32_bf16 v[124:127], v[220:223], a[220:223], v[124:127]
  s_waitcnt lgkmcnt(15)
  v_mfma_f32_16x16x32_bf16 v[128:131], v[224:227], a[192:195], v[128:131]
  ds_read_b64_tr_b16 v[216:217], v11 offset:16384
  v_mfma_f32_16x16x32_bf16 v[128:131], v[228:231], a[196:199], v[128:131]
  buffer_load_dwordx4 v7, s[20:23], s6 offen offset:3072 lds
  v_mfma_f32_16x16x32_bf16 v[132:135], v[224:227], a[200:203], v[132:135]
  ds_read_b64_tr_b16 v[218:219], v11 offset:20480
  v_mfma_f32_16x16x32_bf16 v[132:135], v[228:231], a[204:207], v[132:135]
  v_mfma_f32_16x16x32_bf16 v[136:139], v[224:227], a[208:211], v[136:139]
  s_cmp_gt_u32 s71, 19
  s_cselect_b32 s35, s7, 1073741824
  ds_read_b64_tr_b16 v[220:221], v11 offset:24576
  v_mfma_f32_16x16x32_bf16 v[136:139], v[228:231], a[212:215], v[136:139]
  buffer_load_dwordx4 a[180:183], v2, s[16:19], s35 offen offset:3072 sc1
  v_mfma_f32_16x16x32_bf16 v[140:143], v[224:227], a[216:219], v[140:143]
  ds_read_b64_tr_b16 v[222:223], v11 offset:28672
  v_mfma_f32_16x16x32_bf16 v[140:143], v[228:231], a[220:223], v[140:143]
  s_waitcnt lgkmcnt(15)
  v_mfma_f32_16x16x32_bf16 v[144:147], v[232:235], a[192:195], v[144:147]
  s_add_u32 s6, s4, 606208
  s_add_u32 m0, s5, 36864
  ds_read_b64_tr_b16 v[224:225], v12 offset:16384
  v_mfma_f32_16x16x32_bf16 v[144:147], v[236:239], a[196:199], v[144:147]
  buffer_load_dwordx4 v4, s[20:23], s6 offen offset:0 lds
  v_mfma_f32_16x16x32_bf16 v[148:151], v[232:235], a[200:203], v[148:151]
  ds_read_b64_tr_b16 v[226:227], v12 offset:20480
  v_mfma_f32_16x16x32_bf16 v[148:151], v[236:239], a[204:207], v[148:151]
  v_mfma_f32_16x16x32_bf16 v[152:155], v[232:235], a[208:211], v[152:155]
  s_add_u32 s7, s7, s70
  s_cmp_gt_u32 s71, 18
  s_cselect_b32 s35, s7, 1073741824
  ds_read_b64_tr_b16 v[228:229], v12 offset:24576
  v_mfma_f32_16x16x32_bf16 v[152:155], v[236:239], a[212:215], v[152:155]
  buffer_load_dwordx4 a[184:187], v2, s[16:19], s35 offen offset:2048 sc1
  v_mfma_f32_16x16x32_bf16 v[156:159], v[232:235], a[216:219], v[156:159]
  ds_read_b64_tr_b16 v[230:231], v12 offset:28672
  v_mfma_f32_16x16x32_bf16 v[156:159], v[236:239], a[220:223], v[156:159]
  s_waitcnt lgkmcnt(15)
  v_mfma_f32_16x16x32_bf16 v[160:163], v[240:243], a[192:195], v[160:163]
  ds_read_b64_tr_b16 v[232:233], v13 offset:16384
  v_mfma_f32_16x16x32_bf16 v[160:163], v[244:247], a[196:199], v[160:163]
  buffer_load_dwordx4 v5, s[20:23], s6 offen offset:1024 lds
  v_mfma_f32_16x16x32_bf16 v[164:167], v[240:243], a[200:203], v[164:167]
  ds_read_b64_tr_b16 v[234:235], v13 offset:20480
  v_mfma_f32_16x16x32_bf16 v[164:167], v[244:247], a[204:207], v[164:167]
  v_mfma_f32_16x16x32_bf16 v[168:171], v[240:243], a[208:211], v[168:171]
  s_cmp_gt_u32 s71, 19
  s_cselect_b32 s35, s7, 1073741824
  ds_read_b64_tr_b16 v[236:237], v13 offset:24576
  v_mfma_f32_16x16x32_bf16 v[168:171], v[244:247], a[212:215], v[168:171]
  buffer_load_dwordx4 a[188:191], v2, s[16:19], s35 offen offset:3072 sc1
  v_mfma_f32_16x16x32_bf16 v[172:175], v[240:243], a[216:219], v[172:175]
  ds_read_b64_tr_b16 v[238:239], v13 offset:28672
  v_mfma_f32_16x16x32_bf16 v[172:175], v[244:247], a[220:223], v[172:175]
  s_waitcnt lgkmcnt(15)
  v_mfma_f32_16x16x32_bf16 v[176:179], v[248:251], a[192:195], v[176:179]
  ds_read_b64_tr_b16 v[240:241], v14 offset:16384
  v_mfma_f32_16x16x32_bf16 v[176:179], v[252:255], a[196:199], v[176:179]
  buffer_load_dwordx4 v6, s[20:23], s6 offen offset:2048 lds
  v_mfma_f32_16x16x32_bf16 v[180:183], v[248:251], a[200:203], v[180:183]
  ds_read_b64_tr_b16 v[242:243], v14 offset:20480
  v_mfma_f32_16x16x32_bf16 v[180:183], v[252:255], a[204:207], v[180:183]
  v_mfma_f32_16x16x32_bf16 v[184:187], v[248:251], a[208:211], v[184:187]
  ds_read_b64_tr_b16 v[244:245], v14 offset:24576
  v_mfma_f32_16x16x32_bf16 v[184:187], v[252:255], a[212:215], v[184:187]
  buffer_load_dwordx4 v7, s[20:23], s6 offen offset:3072 lds
  v_mfma_f32_16x16x32_bf16 v[188:191], v[248:251], a[216:219], v[188:191]
  ds_read_b64_tr_b16 v[246:247], v14 offset:28672
  v_mfma_f32_16x16x32_bf16 v[188:191], v[252:255], a[220:223], v[188:191]
  s_waitcnt lgkmcnt(15)
  v_mfma_f32_16x16x32_bf16 v[64:67], v[192:195], a[224:227], v[64:67]
  s_add_u32 s7, s69, 20480
  s_cmp_gt_u32 s71, 20
  s_cselect_b32 s35, s7, 1073741824
  ds_read_b64_tr_b16 v[248:249], v15 offset:16384
  v_mfma_f32_16x16x32_bf16 v[64:67], v[196:199], a[228:231], v[64:67]
  buffer_load_dwordx4 a[192:195], v2, s[16:19], s35 offen offset:0 sc1
  v_mfma_f32_16x16x32_bf16 v[68:71], v[192:195], a[232:235], v[68:71]
  ds_read_b64_tr_b16 v[250:251], v15 offset:20480
  v_mfma_f32_16x16x32_bf16 v[68:71], v[196:199], a[236:239], v[68:71]
  v_mfma_f32_16x16x32_bf16 v[72:75], v[192:195], a[240:243], v[72:75]
  s_cmp_gt_u32 s71, 21
  s_cselect_b32 s35, s7, 1073741824
  ds_read_b64_tr_b16 v[252:253], v15 offset:24576
  v_mfma_f32_16x16x32_bf16 v[72:75], v[196:199], a[244:247], v[72:75]
  buffer_load_dwordx4 a[196:199], v2, s[16:19], s35 offen offset:1024 sc1
  v_mfma_f32_16x16x32_bf16 v[76:79], v[192:195], a[248:251], v[76:79]
  ds_read_b64_tr_b16 v[254:255], v15 offset:28672
  v_mfma_f32_16x16x32_bf16 v[76:79], v[196:199], a[252:255], v[76:79]
  s_waitcnt vmcnt(18)
  s_barrier
  s_waitcnt lgkmcnt(15)
  v_mfma_f32_16x16x32_bf16 v[80:83], v[200:203], a[224:227], v[80:83]
  s_add_u32 s6, s4, 655360
  s_add_u32 m0, s5, 0
  ds_read_b64_tr_b16 v[192:193], v8 offset:49152
  v_mfma_f32_16x16x32_bf16 v[80:83], v[204:207], a[228:231], v[80:83]
  buffer_load_dwordx4 v4, s[20:23], s6 offen offset:0 lds
  v_mfma_f32_16x16x32_bf16 v[84:87], v[200:203], a[232:235], v[84:87]
  ds_read_b64_tr_b16 v[194:195], v8 offset:53248
  v_mfma_f32_16x16x32_bf16 v[84:87], v[204:207], a[236:239], v[84:87]
  v_mfma_f32_16x16x32_bf16 v[88:91], v[200:203], a[240:243], v[88:91]
  s_add_u32 s7, s7, s70
  s_cmp_gt_u32 s71, 20
  s_cselect_b32 s35, s7, 1073741824
  ds_read_b64_tr_b16 v[196:197], v8 offset:57344
  v_mfma_f32_16x16x32_bf16 v[88:91], v[204:207], a[244:247], v[88:91]
  buffer_load_dwordx4 a[200:203], v2, s[16:19], s35 offen offset:0 sc1
  v_mfma_f32_16x16x32_bf16 v[92:95], v[200:203], a[248:251], v[92:95]
  ds_read_b64_tr_b16 v[198:199], v8 offset:61440
  v_mfma_f32_16x16x32_bf16 v[92:95], v[204:207], a[252:255], v[92:95]
  s_waitcnt lgkmcnt(15)
  v_mfma_f32_16x16x32_bf16 v[96:99], v[208:211], a[224:227], v[96:99]
  ds_read_b64_tr_b16 v[200:201], v9 offset:49152
  v_mfma_f32_16x16x32_bf16 v[96:99], v[212:215], a[228:231], v[96:99]
  buffer_load_dwordx4 v5, s[20:23], s6 offen offset:1024 lds
  v_mfma_f32_16x16x32_bf16 v[100:103], v[208:211], a[232:235], v[100:103]
  ds_read_b64_tr_b16 v[202:203], v9 offset:53248
  v_mfma_f32_16x16x32_bf16 v[100:103], v[212:215], a[236:239], v[100:103]
  v_mfma_f32_16x16x32_bf16 v[104:107], v[208:211], a[240:243], v[104:107]
  s_cmp_gt_u32 s71, 21
  s_cselect_b32 s35, s7, 1073741824
  ds_read_b64_tr_b16 v[204:205], v9 offset:57344
  v_mfma_f32_16x16x32_bf16 v[104:107], v[212:215], a[244:247], v[104:107]
  buffer_load_dwordx4 a[204:207], v2, s[16:19], s35 offen offset:1024 sc1
  v_mfma_f32_16x16x32_bf16 v[108:111], v[208:211], a[248:251], v[108:111]
  ds_read_b64_tr_b16 v[206:207], v9 offset:61440
  v_mfma_f32_16x16x32_bf16 v[108:111], v[212:215], a[252:255], v[108:111]
  s_waitcnt lgkmcnt(15)
  v_mfma_f32_16x16x32_bf16 v[112:115], v[216:219], a[224:227], v[112:115]
  ds_read_b64_tr_b16 v[208:209], v10 offset:49152
  v_mfma_f32_16x16x32_bf16 v[112:115], v[220:223], a[228:231], v[112:115]
  buffer_load_dwordx4 v6, s[20:23], s6 offen offset:2048 lds
  v_mfma_f32_16x16x32_bf16 v[116:119], v[216:219], a[232:235], v[116:119]
  ds_read_b64_tr_b16 v[210:211], v10 offset:53248
  v_mfma_f32_16x16x32_bf16 v[116:119], v[220:223], a[236:239], v[116:119]
  v_mfma_f32_16x16x32_bf16 v[120:123], v[216:219], a[240:243], v[120:123]
  s_add_u32 s7, s7, s48
  s_cmp_gt_u32 s71, 20
  s_cselect_b32 s35, s7, 1073741824
  ds_read_b64_tr_b16 v[212:213], v10 offset:57344
  v_mfma_f32_16x16x32_bf16 v[120:123], v[220:223], a[244:247], v[120:123]
  buffer_load_dwordx4 a[208:211], v2, s[16:19], s35 offen offset:0 sc1
  v_mfma_f32_16x16x32_bf16 v[124:127], v[216:219], a[248:251], v[124:127]
  ds_read_b64_tr_b16 v[214:215], v10 offset:61440
  v_mfma_f32_16x16x32_bf16 v[124:127], v[220:223], a[252:255], v[124:127]
  s_waitcnt lgkmcnt(15)
  v_mfma_f32_16x16x32_bf16 v[128:131], v[224:227], a[224:227], v[128:131]
  ds_read_b64_tr_b16 v[216:217], v11 offset:49152
  v_mfma_f32_16x16x32_bf16 v[128:131], v[228:231], a[228:231], v[128:131]
  buffer_load_dwordx4 v7, s[20:23], s6 offen offset:3072 lds
  v_mfma_f32_16x16x32_bf16 v[132:135], v[224:227], a[232:235], v[132:135]
  ds_read_b64_tr_b16 v[218:219], v11 offset:53248
  v_mfma_f32_16x16x32_bf16 v[132:135], v[228:231], a[236:239], v[132:135]
  v_mfma_f32_16x16x32_bf16 v[136:139], v[224:227], a[240:243], v[136:139]
  s_cmp_gt_u32 s71, 21
  s_cselect_b32 s35, s7, 1073741824
  ds_read_b64_tr_b16 v[220:221], v11 offset:57344
  v_mfma_f32_16x16x32_bf16 v[136:139], v[228:231], a[244:247], v[136:139]
  buffer_load_dwordx4 a[212:215], v2, s[16:19], s35 offen offset:1024 sc1
  v_mfma_f32_16x16x32_bf16 v[140:143], v[224:227], a[248:251], v[140:143]
  ds_read_b64_tr_b16 v[222:223], v11 offset:61440
  v_mfma_f32_16x16x32_bf16 v[140:143], v[228:231], a[252:255], v[140:143]
  s_waitcnt lgkmcnt(15)
  v_mfma_f32_16x16x32_bf16 v[144:147], v[232:235], a[224:227], v[144:147]
  s_add_u32 s6, s4, 671744
  s_add_u32 m0, s5, 4096
  ds_read_b64_tr_b16 v[224:225], v12 offset:49152
  v_mfma_f32_16x16x32_bf16 v[144:147], v[236:239], a[228:231], v[144:147]
  buffer_load_dwordx4 v4, s[20:23], s6 offen offset:0 lds
  v_mfma_f32_16x16x32_bf16 v[148:151], v[232:235], a[232:235], v[148:151]
  ds_read_b64_tr_b16 v[226:227], v12 offset:53248
  v_mfma_f32_16x16x32_bf16 v[148:151], v[236:239], a[236:239], v[148:151]
  v_mfma_f32_16x16x32_bf16 v[152:155], v[232:235], a[240:243], v[152:155]
  s_add_u32 s7, s7, s70
  s_cmp_gt_u32 s71, 20
  s_cselect_b32 s35, s7, 1073741824
  ds_read_b64_tr_b16 v[228:229], v12 offset:57344
  v_mfma_f32_16x16x32_bf16 v[152:155], v[236:239], a[244:247], v[152:155]
  buffer_load_dwordx4 a[216:219], v2, s[16:19], s35 offen offset:0 sc1
  v_mfma_f32_16x16x32_bf16 v[156:159], v[232:235], a[248:251], v[156:159]
  ds_read_b64_tr_b16 v[230:231], v12 offset:61440
  v_mfma_f32_16x16x32_bf16 v[156:159], v[236:239], a[252:255], v[156:159]
  s_waitcnt lgkmcnt(15)
  v_mfma_f32_16x16x32_bf16 v[160:163], v[240:243], a[224:227], v[160:163]
  ds_read_b64_tr_b16 v[232:233], v13 offset:49152
  v_mfma_f32_16x16x32_bf16 v[160:163], v[244:247], a[228:231], v[160:163]
  buffer_load_dwordx4 v5, s[20:23], s6 offen offset:1024 lds
  v_mfma_f32_16x16x32_bf16 v[164:167], v[240:243], a[232:235], v[164:167]
  ds_read_b64_tr_b16 v[234:235], v13 offset:53248
  v_mfma_f32_16x16x32_bf16 v[164:167], v[244:247], a[236:239], v[164:167]
  v_mfma_f32_16x16x32_bf16 v[168:171], v[240:243], a[240:243], v[168:171]
  s_cmp_gt_u32 s71, 21
  s_cselect_b32 s35, s7, 1073741824
  ds_read_b64_tr_b16 v[236:237], v13 offset:57344
  v_mfma_f32_16x16x32_bf16 v[168:171], v[244:247], a[244:247], v[168:171]
  buffer_load_dwordx4 a[220:223], v2, s[16:19], s35 offen offset:1024 sc1
  v_mfma_f32_16x16x32_bf16 v[172:175], v[240:243], a[248:251], v[172:175]
  ds_read_b64_tr_b16 v[238:239], v13 offset:61440
  v_mfma_f32_16x16x32_bf16 v[172:175], v[244:247], a[252:255], v[172:175]
  s_waitcnt lgkmcnt(15)
  v_mfma_f32_16x16x32_bf16 v[176:179], v[248:251], a[224:227], v[176:179]
  ds_read_b64_tr_b16 v[240:241], v14 offset:49152
  v_mfma_f32_16x16x32_bf16 v[176:179], v[252:255], a[228:231], v[176:179]
  buffer_load_dwordx4 v6, s[20:23], s6 offen offset:2048 lds
  v_mfma_f32_16x16x32_bf16 v[180:183], v[248:251], a[232:235], v[180:183]
  ds_read_b64_tr_b16 v[242:243], v14 offset:53248
  v_mfma_f32_16x16x32_bf16 v[180:183], v[252:255], a[236:239], v[180:183]
  v_mfma_f32_16x16x32_bf16 v[184:187], v[248:251], a[240:243], v[184:187]
  ds_read_b64_tr_b16 v[244:245], v14 offset:57344
  v_mfma_f32_16x16x32_bf16 v[184:187], v[252:255], a[244:247], v[184:187]
  buffer_load_dwordx4 v7, s[20:23], s6 offen offset:3072 lds
  v_mfma_f32_16x16x32_bf16 v[188:191], v[248:251], a[248:251], v[188:191]
  ds_read_b64_tr_b16 v[246:247], v14 offset:61440
  v_mfma_f32_16x16x32_bf16 v[188:191], v[252:255], a[252:255], v[188:191]
  s_waitcnt lgkmcnt(15)
  v_mfma_f32_16x16x32_bf16 v[64:67], v[192:195], a[128:131], v[64:67]
  ds_read_b64_tr_b16 v[248:249], v15 offset:49152
  v_mfma_f32_16x16x32_bf16 v[64:67], v[196:199], a[132:135], v[64:67]
  s_lshl_b32 s50, s66, 8
  s_lshl_b32 s51, s64, 6
  v_mfma_f32_16x16x32_bf16 v[68:71], v[192:195], a[136:139], v[68:71]
  ds_read_b64_tr_b16 v[250:251], v15 offset:53248
  v_mfma_f32_16x16x32_bf16 v[68:71], v[196:199], a[140:143], v[68:71]
  s_add_u32 s50, s50, s51
  s_add_u32 s54, s49, s50
  v_mfma_f32_16x16x32_bf16 v[72:75], v[192:195], a[144:147], v[72:75]
  ds_read_b64_tr_b16 v[252:253], v15 offset:57344
  v_mfma_f32_16x16x32_bf16 v[72:75], v[196:199], a[148:151], v[72:75]
  v_and_b32 v16, 15, v1
  v_mfma_f32_16x16x32_bf16 v[76:79], v[192:195], a[152:155], v[76:79]
  ds_read_b64_tr_b16 v[254:255], v15 offset:61440
  v_mfma_f32_16x16x32_bf16 v[76:79], v[196:199], a[156:159], v[76:79]
  s_waitcnt vmcnt(16)
  s_barrier
  s_waitcnt lgkmcnt(15)
  v_lshrrev_b32 v17, 4, v1
  v_mfma_f32_16x16x32_bf16 v[80:83], v[200:203], a[128:131], v[80:83]
  ds_read_b64_tr_b16 v[192:193], v8 offset:32768
  v_mfma_f32_16x16x32_bf16 v[80:83], v[204:207], a[132:135], v[80:83]
  v_lshlrev_b32 v18, 3, v17
  v_mfma_f32_16x16x32_bf16 v[84:87], v[200:203], a[136:139], v[84:87]
  ds_read_b64_tr_b16 v[194:195], v8 offset:36864
  v_mfma_f32_16x16x32_bf16 v[84:87], v[204:207], a[140:143], v[84:87]
  v_lshl_add_u32 v19, v16, 10, v18
  v_mfma_f32_16x16x32_bf16 v[88:91], v[200:203], a[144:147], v[88:91]
  ds_read_b64_tr_b16 v[196:197], v8 offset:40960
  v_mfma_f32_16x16x32_bf16 v[88:91], v[204:207], a[148:151], v[88:91]
  v_add_u32 v20, 16384, v19
  s_lshl_b32 s51, s68, 16
  v_mfma_f32_16x16x32_bf16 v[92:95], v[200:203], a[152:155], v[92:95]
  ds_read_b64_tr_b16 v[198:199], v8 offset:45056
  v_mfma_f32_16x16x32_bf16 v[92:95], v[204:207], a[156:159], v[92:95]
  s_waitcnt lgkmcnt(15)
  s_lshl_b32 s55, s67, 15
  s_add_u32 s51, s51, s55
  v_mfma_f32_16x16x32_bf16 v[96:99], v[208:211], a[128:131], v[96:99]
  ds_read_b64_tr_b16 v[200:201], v9 offset:32768
  v_mfma_f32_16x16x32_bf16 v[96:99], v[212:215], a[132:135], v[96:99]
  s_add_u32 s51, s51, 16384
  v_mfma_f32_16x16x32_bf16 v[100:103], v[208:211], a[136:139], v[100:103]
  ds_read_b64_tr_b16 v[202:203], v9 offset:36864
  v_mfma_f32_16x16x32_bf16 v[100:103], v[212:215], a[140:143], v[100:103]
  v_add_u32 v21, s51, v2
  s_xor_b32 s51, s51, 0x10000
  v_mfma_f32_16x16x32_bf16 v[104:107], v[208:211], a[144:147], v[104:107]
  ds_read_b64_tr_b16 v[204:205], v9 offset:40960
  v_mfma_f32_16x16x32_bf16 v[104:107], v[212:215], a[148:151], v[104:107]
  v_add_u32 v22, s51, v2
  s_and_b32 s55, s2, 0xfc
  v_mfma_f32_16x16x32_bf16 v[108:111], v[208:211], a[152:155], v[108:111]
  ds_read_b64_tr_b16 v[206:207], v9 offset:45056
  v_mfma_f32_16x16x32_bf16 v[108:111], v[212:215], a[156:159], v[108:111]
  s_waitcnt lgkmcnt(15)
  s_lshl_b32 s56, s55, 9
  s_lshl_b32 s55, s55, 15
  v_mfma_f32_16x16x32_bf16 v[112:115], v[216:219], a[128:131], v[112:115]
  ds_read_b64_tr_b16 v[208:209], v10 offset:32768
  v_mfma_f32_16x16x32_bf16 v[112:115], v[220:223], a[132:135], v[112:115]
  s_lshl_b32 s51, s36, 13
  s_add_u32 s55, s55, s51
  v_mfma_f32_16x16x32_bf16 v[116:119], v[216:219], a[136:139], v[116:119]
  ds_read_b64_tr_b16 v[210:211], v10 offset:36864
  v_mfma_f32_16x16x32_bf16 v[116:119], v[220:223], a[140:143], v[116:119]
  s_add_u32 s55, s55, 58720256
  s_lshl_b32 s51, s36, 7
  v_mfma_f32_16x16x32_bf16 v[120:123], v[216:219], a[144:147], v[120:123]
  ds_read_b64_tr_b16 v[212:213], v10 offset:40960
  v_mfma_f32_16x16x32_bf16 v[120:123], v[220:223], a[148:151], v[120:123]
  s_add_u32 s56, s56, s51
  s_add_u32 s56, s56, 96993280
  v_mfma_f32_16x16x32_bf16 v[124:127], v[216:219], a[152:155], v[124:127]
  ds_read_b64_tr_b16 v[214:215], v10 offset:45056
  v_mfma_f32_16x16x32_bf16 v[124:127], v[220:223], a[156:159], v[124:127]
  s_waitcnt lgkmcnt(15)
  v_and_b32 v23, 3, v1
  v_mfma_f32_16x16x32_bf16 v[128:131], v[224:227], a[128:131], v[128:131]
  ds_read_b64_tr_b16 v[216:217], v11 offset:32768
  v_mfma_f32_16x16x32_bf16 v[128:131], v[228:231], a[132:135], v[128:131]
  v_lshlrev_b32 v23, 9, v23
  v_mfma_f32_16x16x32_bf16 v[132:135], v[224:227], a[136:139], v[132:135]
  ds_read_b64_tr_b16 v[218:219], v11 offset:36864
  v_mfma_f32_16x16x32_bf16 v[132:135], v[228:231], a[140:143], v[132:135]
  v_add_u32 v23, s56, v23
  s_lshl_b32 s51, s64, 15
  v_mfma_f32_16x16x32_bf16 v[136:139], v[224:227], a[144:147], v[136:139]
  ds_read_b64_tr_b16 v[220:221], v11 offset:40960
  v_mfma_f32_16x16x32_bf16 v[136:139], v[228:231], a[148:151], v[136:139]
  s_add_u32 s56, s55, s51
  s_lshl_b32 s51, s64, 11
  v_mfma_f32_16x16x32_bf16 v[140:143], v[224:227], a[152:155], v[140:143]
  ds_read_b64_tr_b16 v[222:223], v11 offset:45056
  v_mfma_f32_16x16x32_bf16 v[140:143], v[228:231], a[156:159], v[140:143]
  s_waitcnt lgkmcnt(15)
  s_add_u32 s55, s55, s51
  s_add_u32 s40, s55, 0
  v_mfma_f32_16x16x32_bf16 v[144:147], v[232:235], a[128:131], v[144:147]
  ds_read_b64_tr_b16 v[224:225], v12 offset:32768
  v_mfma_f32_16x16x32_bf16 v[144:147], v[236:239], a[132:135], v[144:147]
  s_add_u32 s44, s56, 0
  s_cmp_eq_u32 s64, 0
  v_mfma_f32_16x16x32_bf16 v[148:151], v[232:235], a[136:139], v[148:151]
  ds_read_b64_tr_b16 v[226:227], v12 offset:36864
  v_mfma_f32_16x16x32_bf16 v[148:151], v[236:239], a[140:143], v[148:151]
  s_cselect_b32 s40, 1073741824, s40
  s_cselect_b32 s44, 1073741824, s44
  v_mfma_f32_16x16x32_bf16 v[152:155], v[232:235], a[144:147], v[152:155]
  ds_read_b64_tr_b16 v[228:229], v12 offset:40960
  v_mfma_f32_16x16x32_bf16 v[152:155], v[236:239], a[148:151], v[152:155]
  s_add_u32 s41, s55, 32768
  s_add_u32 s45, s56, 2048
  v_mfma_f32_16x16x32_bf16 v[156:159], v[232:235], a[152:155], v[156:159]
  ds_read_b64_tr_b16 v[230:231], v12 offset:45056
  v_mfma_f32_16x16x32_bf16 v[156:159], v[236:239], a[156:159], v[156:159]
  s_waitcnt lgkmcnt(15)
  s_cmp_eq_u32 s64, 1
  s_cselect_b32 s41, 1073741824, s41
  v_mfma_f32_16x16x32_bf16 v[160:163], v[240:243], a[128:131], v[160:163]
  ds_read_b64_tr_b16 v[232:233], v13 offset:32768
  v_mfma_f32_16x16x32_bf16 v[160:163], v[244:247], a[132:135], v[160:163]
  s_cselect_b32 s45, 1073741824, s45
  s_add_u32 s42, s55, 65536
  v_mfma_f32_16x16x32_bf16 v[164:167], v[240:243], a[136:139], v[164:167]
  ds_read_b64_tr_b16 v[234:235], v13 offset:36864
  v_mfma_f32_16x16x32_bf16 v[164:167], v[244:247], a[140:143], v[164:167]
  s_add_u32 s46, s56, 4096
  s_cmp_eq_u32 s64, 2
  v_mfma_f32_16x16x32_bf16 v[168:171], v[240:243], a[144:147], v[168:171]
  ds_read_b64_tr_b16 v[236:237], v13 offset:40960
  v_mfma_f32_16x16x32_bf16 v[168:171], v[244:247], a[148:151], v[168:171]
  s_cselect_b32 s42, 1073741824, s42
  s_cselect_b32 s46, 1073741824, s46
  v_mfma_f32_16x16x32_bf16 v[172:175], v[240:243], a[152:155], v[172:175]
  ds_read_b64_tr_b16 v[238:239], v13 offset:45056
  v_mfma_f32_16x16x32_bf16 v[172:175], v[244:247], a[156:159], v[172:175]
  s_waitcnt lgkmcnt(15)
  s_add_u32 s43, s55, 98304
  s_add_u32 s47, s56, 6144
  v_mfma_f32_16x16x32_bf16 v[176:179], v[248:251], a[128:131], v[176:179]
  ds_read_b64_tr_b16 v[240:241], v14 offset:32768
  v_mfma_f32_16x16x32_bf16 v[176:179], v[252:255], a[132:135], v[176:179]
  s_cmp_eq_u32 s64, 3
  s_cselect_b32 s43, 1073741824, s43
  v_mfma_f32_16x16x32_bf16 v[180:183], v[248:251], a[136:139], v[180:183]
  ds_read_b64_tr_b16 v[242:243], v14 offset:36864
  v_mfma_f32_16x16x32_bf16 v[180:183], v[252:255], a[140:143], v[180:183]
  s_cselect_b32 s47, 1073741824, s47
  v_mfma_f32_16x16x32_bf16 v[184:187], v[248:251], a[144:147], v[184:187]
  ds_read_b64_tr_b16 v[244:245], v14 offset:40960
  v_mfma_f32_16x16x32_bf16 v[184:187], v[252:255], a[148:151], v[184:187]
  v_mfma_f32_16x16x32_bf16 v[188:191], v[248:251], a[152:155], v[188:191]
  ds_read_b64_tr_b16 v[246:247], v14 offset:45056
  v_mfma_f32_16x16x32_bf16 v[188:191], v[252:255], a[156:159], v[188:191]
  s_waitcnt lgkmcnt(15)
  v_mfma_f32_16x16x32_bf16 v[64:67], v[192:195], a[160:163], v[64:67]
  ds_read_b64_tr_b16 v[248:249], v15 offset:32768
  v_mfma_f32_16x16x32_bf16 v[64:67], v[196:199], a[164:167], v[64:67]
  v_mfma_f32_16x16x32_bf16 v[68:71], v[192:195], a[168:171], v[68:71]
  ds_read_b64_tr_b16 v[250:251], v15 offset:36864
  v_mfma_f32_16x16x32_bf16 v[68:71], v[196:199], a[172:175], v[68:71]
  buffer_load_dwordx2 v[24:25], v19, s[24:27], s54 offen offset:0
  v_mfma_f32_16x16x32_bf16 v[72:75], v[192:195], a[176:179], v[72:75]
  ds_read_b64_tr_b16 v[252:253], v15 offset:40960
  v_mfma_f32_16x16x32_bf16 v[72:75], v[196:199], a[180:183], v[72:75]
  v_mfma_f32_16x16x32_bf16 v[76:79], v[192:195], a[184:187], v[76:79]
  ds_read_b64_tr_b16 v[254:255], v15 offset:45056
  v_mfma_f32_16x16x32_bf16 v[76:79], v[196:199], a[188:191], v[76:79]
  s_waitcnt vmcnt(1)
  s_barrier
  s_waitcnt lgkmcnt(15)
  v_mfma_f32_16x16x32_bf16 v[80:83], v[200:203], a[160:163], v[80:83]
  ds_read_b64_tr_b16 v[192:193], v8 offset:0
  v_mfma_f32_16x16x32_bf16 v[80:83], v[204:207], a[164:167], v[80:83]
  v_mfma_f32_16x16x32_bf16 v[84:87], v[200:203], a[168:171], v[84:87]
  ds_read_b64_tr_b16 v[194:195], v8 offset:4096
  v_mfma_f32_16x16x32_bf16 v[84:87], v[204:207], a[172:175], v[84:87]
  buffer_load_dwordx2 v[26:27], v19, s[24:27], s54 offen offset:32
  v_mfma_f32_16x16x32_bf16 v[88:91], v[200:203], a[176:179], v[88:91]
  ds_read_b64_tr_b16 v[196:197], v8 offset:8192
  v_mfma_f32_16x16x32_bf16 v[88:91], v[204:207], a[180:183], v[88:91]
  v_mfma_f32_16x16x32_bf16 v[92:95], v[200:203], a[184:187], v[92:95]
  ds_read_b64_tr_b16 v[198:199], v8 offset:12288
  v_mfma_f32_16x16x32_bf16 v[92:95], v[204:207], a[188:191], v[92:95]
  s_waitcnt lgkmcnt(15)
  v_mfma_f32_16x16x32_bf16 v[96:99], v[208:211], a[160:163], v[96:99]
  ds_read_b64_tr_b16 v[200:201], v9 offset:0
  v_mfma_f32_16x16x32_bf16 v[96:99], v[212:215], a[164:167], v[96:99]
  v_mfma_f32_16x16x32_bf16 v[100:103], v[208:211], a[168:171], v[100:103]
  ds_read_b64_tr_b16 v[202:203], v9 offset:4096
  v_mfma_f32_16x16x32_bf16 v[100:103], v[212:215], a[172:175], v[100:103]
  buffer_load_dwordx2 v[28:29], v20, s[24:27], s54 offen offset:0
  v_mfma_f32_16x16x32_bf16 v[104:107], v[208:211], a[176:179], v[104:107]
  ds_read_b64_tr_b16 v[204:205], v9 offset:8192
  v_mfma_f32_16x16x32_bf16 v[104:107], v[212:215], a[180:183], v[104:107]
  v_mfma_f32_16x16x32_bf16 v[108:111], v[208:211], a[184:187], v[108:111]
  ds_read_b64_tr_b16 v[206:207], v9 offset:12288
  v_mfma_f32_16x16x32_bf16 v[108:111], v[212:215], a[188:191], v[108:111]
  s_waitcnt lgkmcnt(15)
  v_mfma_f32_16x16x32_bf16 v[112:115], v[216:219], a[160:163], v[112:115]
  ds_read_b64_tr_b16 v[208:209], v10 offset:0
  v_mfma_f32_16x16x32_bf16 v[112:115], v[220:223], a[164:167], v[112:115]
  v_mfma_f32_16x16x32_bf16 v[116:119], v[216:219], a[168:171], v[116:119]
  ds_read_b64_tr_b16 v[210:211], v10 offset:4096
  v_mfma_f32_16x16x32_bf16 v[116:119], v[220:223], a[172:175], v[116:119]
  buffer_load_dwordx2 v[30:31], v20, s[24:27], s54 offen offset:32
  v_mfma_f32_16x16x32_bf16 v[120:123], v[216:219], a[176:179], v[120:123]
  ds_read_b64_tr_b16 v[212:213], v10 offset:8192
  v_mfma_f32_16x16x32_bf16 v[120:123], v[220:223], a[180:183], v[120:123]
  v_mfma_f32_16x16x32_bf16 v[124:127], v[216:219], a[184:187], v[124:127]
  ds_read_b64_tr_b16 v[214:215], v10 offset:12288
  v_mfma_f32_16x16x32_bf16 v[124:127], v[220:223], a[188:191], v[124:127]
  s_waitcnt lgkmcnt(15)
  v_mfma_f32_16x16x32_bf16 v[128:131], v[224:227], a[160:163], v[128:131]
  ds_read_b64_tr_b16 v[216:217], v11 offset:0
  v_mfma_f32_16x16x32_bf16 v[128:131], v[228:231], a[164:167], v[128:131]
  v_mfma_f32_16x16x32_bf16 v[132:135], v[224:227], a[168:171], v[132:135]
  ds_read_b64_tr_b16 v[218:219], v11 offset:4096
  v_mfma_f32_16x16x32_bf16 v[132:135], v[228:231], a[172:175], v[132:135]
  buffer_load_dwordx2 v[32:33], v18, s[12:15], s50 offen offset:0
  v_mfma_f32_16x16x32_bf16 v[136:139], v[224:227], a[176:179], v[136:139]
  ds_read_b64_tr_b16 v[220:221], v11 offset:8192
  v_mfma_f32_16x16x32_bf16 v[136:139], v[228:231], a[180:183], v[136:139]
  v_mfma_f32_16x16x32_bf16 v[140:143], v[224:227], a[184:187], v[140:143]
  ds_read_b64_tr_b16 v[222:223], v11 offset:12288
  v_mfma_f32_16x16x32_bf16 v[140:143], v[228:231], a[188:191], v[140:143]
  s_waitcnt lgkmcnt(15)
  v_mfma_f32_16x16x32_bf16 v[144:147], v[232:235], a[160:163], v[144:147]
  ds_read_b64_tr_b16 v[224:225], v12 offset:0
  v_mfma_f32_16x16x32_bf16 v[144:147], v[236:239], a[164:167], v[144:147]
  v_mfma_f32_16x16x32_bf16 v[148:151], v[232:235], a[168:171], v[148:151]
  ds_read_b64_tr_b16 v[226:227], v12 offset:4096
  v_mfma_f32_16x16x32_bf16 v[148:151], v[236:239], a[172:175], v[148:151]
  buffer_load_dwordx2 v[34:35], v18, s[12:15], s50 offen offset:32
  v_mfma_f32_16x16x32_bf16 v[152:155], v[232:235], a[176:179], v[152:155]
  ds_read_b64_tr_b16 v[228:229], v12 offset:8192
  v_mfma_f32_16x16x32_bf16 v[152:155], v[236:239], a[180:183], v[152:155]
  v_mfma_f32_16x16x32_bf16 v[156:159], v[232:235], a[184:187], v[156:159]
  ds_read_b64_tr_b16 v[230:231], v12 offset:12288
  v_mfma_f32_16x16x32_bf16 v[156:159], v[236:239], a[188:191], v[156:159]
  s_waitcnt lgkmcnt(15)
  v_mfma_f32_16x16x32_bf16 v[160:163], v[240:243], a[160:163], v[160:163]
  ds_read_b64_tr_b16 v[232:233], v13 offset:0
  v_mfma_f32_16x16x32_bf16 v[160:163], v[244:247], a[164:167], v[160:163]
  v_mfma_f32_16x16x32_bf16 v[164:167], v[240:243], a[168:171], v[164:167]
  ds_read_b64_tr_b16 v[234:235], v13 offset:4096
  v_mfma_f32_16x16x32_bf16 v[164:167], v[244:247], a[172:175], v[164:167]
  buffer_load_dword v38, v23, s[16:19], 0 offen sc1
  v_mfma_f32_16x16x32_bf16 v[168:171], v[240:243], a[176:179], v[168:171]
  ds_read_b64_tr_b16 v[236:237], v13 offset:8192
  v_mfma_f32_16x16x32_bf16 v[168:171], v[244:247], a[180:183], v[168:171]
  v_mfma_f32_16x16x32_bf16 v[172:175], v[240:243], a[184:187], v[172:175]
  ds_read_b64_tr_b16 v[238:239], v13 offset:12288
  v_mfma_f32_16x16x32_bf16 v[172:175], v[244:247], a[188:191], v[172:175]
  s_waitcnt lgkmcnt(15)
  v_mfma_f32_16x16x32_bf16 v[176:179], v[248:251], a[160:163], v[176:179]
  ds_read_b64_tr_b16 v[240:241], v14 offset:0
  v_mfma_f32_16x16x32_bf16 v[176:179], v[252:255], a[164:167], v[176:179]
  v_mfma_f32_16x16x32_bf16 v[180:183], v[248:251], a[168:171], v[180:183]
  ds_read_b64_tr_b16 v[242:243], v14 offset:4096
  v_mfma_f32_16x16x32_bf16 v[180:183], v[252:255], a[172:175], v[180:183]
  v_mfma_f32_16x16x32_bf16 v[184:187], v[248:251], a[176:179], v[184:187]
  ds_read_b64_tr_b16 v[244:245], v14 offset:8192
  v_mfma_f32_16x16x32_bf16 v[184:187], v[252:255], a[180:183], v[184:187]
  v_mfma_f32_16x16x32_bf16 v[188:191], v[248:251], a[184:187], v[188:191]
  ds_read_b64_tr_b16 v[246:247], v14 offset:12288
  v_mfma_f32_16x16x32_bf16 v[188:191], v[252:255], a[188:191], v[188:191]
  s_waitcnt lgkmcnt(15)
  v_mfma_f32_16x16x32_bf16 v[64:67], v[192:195], a[192:195], v[64:67]
  ds_read_b64_tr_b16 v[248:249], v15 offset:0
  v_mfma_f32_16x16x32_bf16 v[64:67], v[196:199], a[196:199], v[64:67]
  v_mfma_f32_16x16x32_bf16 v[68:71], v[192:195], a[200:203], v[68:71]
  ds_read_b64_tr_b16 v[250:251], v15 offset:4096
  v_mfma_f32_16x16x32_bf16 v[68:71], v[196:199], a[204:207], v[68:71]
  v_mfma_f32_16x16x32_bf16 v[72:75], v[192:195], a[208:211], v[72:75]
  ds_read_b64_tr_b16 v[252:253], v15 offset:8192
  v_mfma_f32_16x16x32_bf16 v[72:75], v[196:199], a[212:215], v[72:75]
  v_mfma_f32_16x16x32_bf16 v[76:79], v[192:195], a[216:219], v[76:79]
  ds_read_b64_tr_b16 v[254:255], v15 offset:12288
  v_mfma_f32_16x16x32_bf16 v[76:79], v[196:199], a[220:223], v[76:79]
  s_waitcnt lgkmcnt(15)
  v_mfma_f32_16x16x32_bf16 v[80:83], v[200:203], a[192:195], v[80:83]
  v_mfma_f32_16x16x32_bf16 v[80:83], v[204:207], a[196:199], v[80:83]
  v_mfma_f32_16x16x32_bf16 v[84:87], v[200:203], a[200:203], v[84:87]
  v_mfma_f32_16x16x32_bf16 v[84:87], v[204:207], a[204:207], v[84:87]
  v_mfma_f32_16x16x32_bf16 v[88:91], v[200:203], a[208:211], v[88:91]
  v_mfma_f32_16x16x32_bf16 v[88:91], v[204:207], a[212:215], v[88:91]
  v_mfma_f32_16x16x32_bf16 v[92:95], v[200:203], a[216:219], v[92:95]
  v_mfma_f32_16x16x32_bf16 v[92:95], v[204:207], a[220:223], v[92:95]
  s_waitcnt lgkmcnt(15)
  v_mfma_f32_16x16x32_bf16 v[96:99], v[208:211], a[192:195], v[96:99]
  v_mfma_f32_16x16x32_bf16 v[96:99], v[212:215], a[196:199], v[96:99]
  ds_write_b128 v21, v[72:75] offset:0
  v_mfma_f32_16x16x32_bf16 v[100:103], v[208:211], a[200:203], v[100:103]
  v_mfma_f32_16x16x32_bf16 v[100:103], v[212:215], a[204:207], v[100:103]
  v_mfma_f32_16x16x32_bf16 v[104:107], v[208:211], a[208:211], v[104:107]
  v_mfma_f32_16x16x32_bf16 v[104:107], v[212:215], a[212:215], v[104:107]
  ds_write_b128 v21, v[76:79] offset:1024
  v_mfma_f32_16x16x32_bf16 v[108:111], v[208:211], a[216:219], v[108:111]
  v_mfma_f32_16x16x32_bf16 v[108:111], v[212:215], a[220:223], v[108:111]
  s_waitcnt lgkmcnt(15)
  v_mfma_f32_16x16x32_bf16 v[112:115], v[216:219], a[192:195], v[112:115]
  v_mfma_f32_16x16x32_bf16 v[112:115], v[220:223], a[196:199], v[112:115]
  ds_write_b128 v21, v[88:91] offset:2048
  v_mfma_f32_16x16x32_bf16 v[116:119], v[216:219], a[200:203], v[116:119]
  v_mfma_f32_16x16x32_bf16 v[116:119], v[220:223], a[204:207], v[116:119]
  v_mfma_f32_16x16x32_bf16 v[120:123], v[216:219], a[208:211], v[120:123]
  v_mfma_f32_16x16x32_bf16 v[120:123], v[220:223], a[212:215], v[120:123]
  ds_write_b128 v21, v[92:95] offset:3072
  v_mfma_f32_16x16x32_bf16 v[124:127], v[216:219], a[216:219], v[124:127]
  v_mfma_f32_16x16x32_bf16 v[124:127], v[220:223], a[220:223], v[124:127]
  s_waitcnt lgkmcnt(12)
  v_mfma_f32_16x16x32_bf16 v[128:131], v[224:227], a[192:195], v[128:131]
  v_mfma_f32_16x16x32_bf16 v[128:131], v[228:231], a[196:199], v[128:131]
  ds_write_b128 v21, v[104:107] offset:4096
  v_mfma_f32_16x16x32_bf16 v[132:135], v[224:227], a[200:203], v[132:135]
  v_mfma_f32_16x16x32_bf16 v[132:135], v[228:231], a[204:207], v[132:135]
  v_mfma_f32_16x16x32_bf16 v[136:139], v[224:227], a[208:211], v[136:139]
  v_mfma_f32_16x16x32_bf16 v[136:139], v[228:231], a[212:215], v[136:139]
  ds_write_b128 v21, v[108:111] offset:5120
  v_mfma_f32_16x16x32_bf16 v[140:143], v[224:227], a[216:219], v[140:143]
  v_mfma_f32_16x16x32_bf16 v[140:143], v[228:231], a[220:223], v[140:143]
  s_waitcnt lgkmcnt(8)
  v_mfma_f32_16x16x32_bf16 v[144:147], v[232:235], a[192:195], v[144:147]
  v_mfma_f32_16x16x32_bf16 v[144:147], v[236:239], a[196:199], v[144:147]
  ds_write_b128 v21, v[120:123] offset:6144
  v_mfma_f32_16x16x32_bf16 v[148:151], v[232:235], a[200:203], v[148:151]
  v_mfma_f32_16x16x32_bf16 v[148:151], v[236:239], a[204:207], v[148:151]
  v_mfma_f32_16x16x32_bf16 v[152:155], v[232:235], a[208:211], v[152:155]
  v_mfma_f32_16x16x32_bf16 v[152:155], v[236:239], a[212:215], v[152:155]
  ds_write_b128 v21, v[124:127] offset:7168
  v_mfma_f32_16x16x32_bf16 v[156:159], v[232:235], a[216:219], v[156:159]
  v_mfma_f32_16x16x32_bf16 v[156:159], v[236:239], a[220:223], v[156:159]
  s_waitcnt lgkmcnt(4)
  v_mfma_f32_16x16x32_bf16 v[160:163], v[240:243], a[192:195], v[160:163]
  v_mfma_f32_16x16x32_bf16 v[160:163], v[244:247], a[196:199], v[160:163]
  ds_write_b128 v21, v[136:139] offset:8192
  v_mfma_f32_16x16x32_bf16 v[164:167], v[240:243], a[200:203], v[164:167]
  v_mfma_f32_16x16x32_bf16 v[164:167], v[244:247], a[204:207], v[164:167]
  v_mfma_f32_16x16x32_bf16 v[168:171], v[240:243], a[208:211], v[168:171]
  v_mfma_f32_16x16x32_bf16 v[168:171], v[244:247], a[212:215], v[168:171]
  ds_write_b128 v21, v[140:143] offset:9216
  v_mfma_f32_16x16x32_bf16 v[172:175], v[240:243], a[216:219], v[172:175]
  v_mfma_f32_16x16x32_bf16 v[172:175], v[244:247], a[220:223], v[172:175]
  s_waitcnt lgkmcnt(0)
  v_mfma_f32_16x16x32_bf16 v[176:179], v[248:251], a[192:195], v[176:179]
  v_mfma_f32_16x16x32_bf16 v[176:179], v[252:255], a[196:199], v[176:179]
  ds_write_b128 v21, v[152:155] offset:10240
  v_mfma_f32_16x16x32_bf16 v[180:183], v[248:251], a[200:203], v[180:183]
  v_mfma_f32_16x16x32_bf16 v[180:183], v[252:255], a[204:207], v[180:183]
  v_mfma_f32_16x16x32_bf16 v[184:187], v[248:251], a[208:211], v[184:187]
  v_mfma_f32_16x16x32_bf16 v[184:187], v[252:255], a[212:215], v[184:187]
  ds_write_b128 v21, v[156:159] offset:11264
  v_mfma_f32_16x16x32_bf16 v[188:191], v[248:251], a[216:219], v[188:191]
  v_mfma_f32_16x16x32_bf16 v[188:191], v[252:255], a[220:223], v[188:191]
  s_waitcnt vmcnt(0)
  ds_write_b128 v21, v[168:171] offset:12288
  ds_write_b128 v21, v[172:175] offset:13312
  s_nop 4
  ds_write_b128 v21, v[184:187] offset:14336
  ds_write_b128 v21, v[188:191] offset:15360
  v_lshlrev_b32 v72, 16, v24
  v_and_b32 v73, 0xffff0000, v24
  v_lshlrev_b32 v74, 16, v25
  v_and_b32 v75, 0xffff0000, v25
  v_lshlrev_b32 v88, 16, v26
  v_and_b32 v89, 0xffff0000, v26
  v_lshlrev_b32 v90, 16, v27
  v_and_b32 v91, 0xffff0000, v27
  v_lshlrev_b32 v104, 16, v28
  v_and_b32 v105, 0xffff0000, v28
  v_lshlrev_b32 v106, 16, v29
  v_and_b32 v107, 0xffff0000, v29
  v_lshlrev_b32 v120, 16, v30
  v_and_b32 v121, 0xffff0000, v30
  v_lshlrev_b32 v122, 16, v31
  v_and_b32 v123, 0xffff0000, v31
  v_lshlrev_b32 v136, 16, v32
  v_and_b32 v137, 0xffff0000, v32
  v_lshlrev_b32 v138, 16, v33
  v_and_b32 v139, 0xffff0000, v33
  v_lshlrev_b32 v152, 16, v34
  v_and_b32 v153, 0xffff0000, v34
  v_lshlrev_b32 v154, 16, v35
  v_and_b32 v155, 0xffff0000, v35
  s_mov_b32 s6, 0
L_poll4:
  v_cmp_ne_u32 vcc, s3, v38
  s_cbranch_vccz L_pollok4
  s_add_u32 s6, s6, 1
  s_cmp_gt_u32 s6, 0x80000
  s_cbranch_scc1 L_pollok4
  buffer_load_dword v38, v23, s[16:19], 0 offen sc1
  s_waitcnt vmcnt(0)
  s_branch L_poll4
L_pollok4:
  s_waitcnt lgkmcnt(0)
  s_barrier
  s_nop 0
  ds_read_b128 v[192:195], v22 offset:0
  ds_read_b128 v[196:199], v22 offset:1024
  ds_read_b128 v[200:203], v22 offset:2048
  ds_read_b128 v[204:207], v22 offset:3072
  ds_read_b128 v[208:211], v22 offset:4096
  ds_read_b128 v[212:215], v22 offset:5120
  ds_read_b128 v[216:219], v22 offset:6144
  ds_read_b128 v[220:223], v22 offset:7168
  ds_read_b128 v[224:227], v22 offset:8192
  ds_read_b128 v[228:231], v22 offset:9216
  ds_read_b128 v[232:235], v22 offset:10240
  ds_read_b128 v[236:239], v22 offset:11264
  ds_read_b128 v[240:243], v22 offset:12288
  ds_read_b128 v[244:247], v22 offset:13312
  ds_read_b128 v[248:251], v22 offset:14336
  ds_read_b128 v[252:255], v22 offset:15360
  s_waitcnt lgkmcnt(15)
  v_pk_add_f32 v[64:65], v[64:65], v[192:193]
  v_pk_add_f32 v[66:67], v[66:67], v[194:195]
  s_waitcnt lgkmcnt(14)
  v_pk_add_f32 v[68:69], v[68:69], v[196:197]
  v_pk_add_f32 v[70:71], v[70:71], v[198:199]
  s_waitcnt lgkmcnt(13)
  v_pk_add_f32 v[80:81], v[80:81], v[200:201]
  v_pk_add_f32 v[82:83], v[82:83], v[202:203]
  s_waitcnt lgkmcnt(12)
  v_pk_add_f32 v[84:85], v[84:85], v[204:205]
  v_pk_add_f32 v[86:87], v[86:87], v[206:207]
  v_cvt_pk_bf16_f32 v40, v64, v65
  v_cvt_pk_bf16_f32 v41, v66, v67
  v_cvt_pk_bf16_f32 v42, v68, v69
  v_cvt_pk_bf16_f32 v43, v70, v71
  v_cvt_pk_bf16_f32 v44, v80, v81
  v_cvt_pk_bf16_f32 v45, v82, v83
  v_cvt_pk_bf16_f32 v46, v84, v85
  v_cvt_pk_bf16_f32 v47, v86, v87
  buffer_store_dwordx4 v[40:43], v2, s[16:19], s44 offen sc1
  buffer_store_dwordx4 v[44:47], v2, s[16:19], s44 offen offset:1024 sc1
  s_waitcnt lgkmcnt(11)
  v_pk_add_f32 v[96:97], v[96:97], v[208:209]
  v_pk_add_f32 v[98:99], v[98:99], v[210:211]
  s_waitcnt lgkmcnt(10)
  v_pk_add_f32 v[100:101], v[100:101], v[212:213]
  v_pk_add_f32 v[102:103], v[102:103], v[214:215]
  s_waitcnt lgkmcnt(9)
  v_pk_add_f32 v[112:113], v[112:113], v[216:217]
  v_pk_add_f32 v[114:115], v[114:115], v[218:219]
  s_waitcnt lgkmcnt(8)
  v_pk_add_f32 v[116:117], v[116:117], v[220:221]
  v_pk_add_f32 v[118:119], v[118:119], v[222:223]
  v_cvt_pk_bf16_f32 v48, v96, v97
  v_cvt_pk_bf16_f32 v49, v98, v99
  v_cvt_pk_bf16_f32 v50, v100, v101
  v_cvt_pk_bf16_f32 v51, v102, v103
  v_cvt_pk_bf16_f32 v52, v112, v113
  v_cvt_pk_bf16_f32 v53, v114, v115
  v_cvt_pk_bf16_f32 v54, v116, v117
  v_cvt_pk_bf16_f32 v55, v118, v119
  buffer_store_dwordx4 v[48:51], v2, s[16:19], s45 offen sc1
  buffer_store_dwordx4 v[52:55], v2, s[16:19], s45 offen offset:1024 sc1
  s_waitcnt lgkmcnt(7)
  v_pk_add_f32 v[128:129], v[128:129], v[224:225]
  v_pk_add_f32 v[130:131], v[130:131], v[226:227]
  s_waitcnt lgkmcnt(6)
  v_pk_add_f32 v[132:133], v[132:133], v[228:229]
  v_pk_add_f32 v[134:135], v[134:135], v[230:231]
  s_waitcnt lgkmcnt(5)
  v_pk_add_f32 v[144:145], v[144:145], v[232:233]
  v_pk_add_f32 v[146:147], v[146:147], v[234:235]
  s_waitcnt lgkmcnt(4)
  v_pk_add_f32 v[148:149], v[148:149], v[236:237]
  v_pk_add_f32 v[150:151], v[150:151], v[238:239]
  v_cvt_pk_bf16_f32 v40, v128, v129
  v_cvt_pk_bf16_f32 v41, v130, v131
  v_cvt_pk_bf16_f32 v42, v132, v133
  v_cvt_pk_bf16_f32 v43, v134, v135
  v_cvt_pk_bf16_f32 v44, v144, v145
  v_cvt_pk_bf16_f32 v45, v146, v147
  v_cvt_pk_bf16_f32 v46, v148, v149
  v_cvt_pk_bf16_f32 v47, v150, v151
  buffer_store_dwordx4 v[40:43], v2, s[16:19], s46 offen sc1
  buffer_store_dwordx4 v[44:47], v2, s[16:19], s46 offen offset:1024 sc1
  s_waitcnt lgkmcnt(3)
  v_pk_add_f32 v[160:161], v[160:161], v[240:241]
  v_pk_add_f32 v[162:163], v[162:163], v[242:243]
  s_waitcnt lgkmcnt(2)
  v_pk_add_f32 v[164:165], v[164:165], v[244:245]
  v_pk_add_f32 v[166:167], v[166:167], v[246:247]
  s_waitcnt lgkmcnt(1)
  v_pk_add_f32 v[176:177], v[176:177], v[248:249]
  v_pk_add_f32 v[178:179], v[178:179], v[250:251]
  s_waitcnt lgkmcnt(0)
  v_pk_add_f32 v[180:181], v[180:181], v[252:253]
  v_pk_add_f32 v[182:183], v[182:183], v[254:255]
  v_cvt_pk_bf16_f32 v48, v160, v161
  v_cvt_pk_bf16_f32 v49, v162, v163
  v_cvt_pk_bf16_f32 v50, v164, v165
  v_cvt_pk_bf16_f32 v51, v166, v167
  v_cvt_pk_bf16_f32 v52, v176, v177
  v_cvt_pk_bf16_f32 v53, v178, v179
  v_cvt_pk_bf16_f32 v54, v180, v181
  v_cvt_pk_bf16_f32 v55, v182, v183
  buffer_store_dwordx4 v[48:51], v2, s[16:19], s47 offen sc1
  buffer_store_dwordx4 v[52:55], v2, s[16:19], s47 offen offset:1024 sc1
  buffer_load_dwordx4 v[192:195], v2, s[16:19], s40 offen offset:0 sc1
  buffer_load_dwordx4 v[196:199], v2, s[16:19], s40 offen offset:1024 sc1
  buffer_load_dwordx4 v[200:203], v2, s[16:19], s41 offen offset:0 sc1
  buffer_load_dwordx4 v[204:207], v2, s[16:19], s41 offen offset:1024 sc1
  buffer_load_dwordx4 v[208:211], v2, s[16:19], s42 offen offset:0 sc1
  buffer_load_dwordx4 v[212:215], v2, s[16:19], s42 offen offset:1024 sc1
  buffer_load_dwordx4 v[216:219], v2, s[16:19], s43 offen offset:0 sc1
  buffer_load_dwordx4 v[220:223], v2, s[16:19], s43 offen offset:1024 sc1
  s_cmp_lg_u32 s64, 0
  s_cbranch_scc1 L_nown0
  v_mov_b32 v224, v64
  v_mov_b32 v240, 0
  v_mov_b32 v225, v65
  v_mov_b32 v241, 0
  v_mov_b32 v226, v66
  v_mov_b32 v242, 0
  v_mov_b32 v227, v67
  v_mov_b32 v243, 0
  v_mov_b32 v228, v68
  v_mov_b32 v244, 0
  v_mov_b32 v229, v69
  v_mov_b32 v245, 0
  v_mov_b32 v230, v70
  v_mov_b32 v246, 0
  v_mov_b32 v231, v71
  v_mov_b32 v247, 0
  v_mov_b32 v232, v80
  v_mov_b32 v248, 0
  v_mov_b32 v233, v81
  v_mov_b32 v249, 0
  v_mov_b32 v234, v82
  v_mov_b32 v250, 0
  v_mov_b32 v235, v83
  v_mov_b32 v251, 0
  v_mov_b32 v236, v84
  v_mov_b32 v252, 0
  v_mov_b32 v237, v85
  v_mov_b32 v253, 0
  v_mov_b32 v238, v86
  v_mov_b32 v254, 0
  v_mov_b32 v239, v87
  v_mov_b32 v255, 0
L_nown0:
  s_cmp_lg_u32 s64, 1
  s_cbranch_scc1 L_nown1
  v_mov_b32 v224, v96
  v_mov_b32 v240, 0
  v_mov_b32 v225, v97
  v_mov_b32 v241, 0
  v_mov_b32 v226, v98
  v_mov_b32 v242, 0
  v_mov_b32 v227, v99
  v_mov_b32 v243, 0
  v_mov_b32 v228, v100
  v_mov_b32 v244, 0
  v_mov_b32 v229, v101
  v_mov_b32 v245, 0
  v_mov_b32 v230, v102
  v_mov_b32 v246, 0
  v_mov_b32 v231, v103
  v_mov_b32 v247, 0
  v_mov_b32 v232, v112
  v_mov_b32 v248, 0
  v_mov_b32 v233, v113
  v_mov_b32 v249, 0
  v_mov_b32 v234, v114
  v_mov_b32 v250, 0
  v_mov_b32 v235, v115
  v_mov_b32 v251, 0
  v_mov_b32 v236, v116
  v_mov_b32 v252, 0
  v_mov_b32 v237, v117
  v_mov_b32 v253, 0
  v_mov_b32 v238, v118
  v_mov_b32 v254, 0
  v_mov_b32 v239, v119
  v_mov_b32 v255, 0
L_nown1:
  s_cmp_lg_u32 s64, 2
  s_cbranch_scc1 L_nown2
  v_mov_b32 v224, v128
  v_mov_b32 v240, 0
  v_mov_b32 v225, v129
  v_mov_b32 v241, 0
  v_mov_b32 v226, v130
  v_mov_b32 v242, 0
  v_mov_b32 v227, v131
  v_mov_b32 v243, 0
  v_mov_b32 v228, v132
  v_mov_b32 v244, 0
  v_mov_b32 v229, v133
  v_mov_b32 v245, 0
  v_mov_b32 v230, v134
  v_mov_b32 v246, 0
  v_mov_b32 v231, v135
  v_mov_b32 v247, 0
  v_mov_b32 v232, v144
  v_mov_b32 v248, 0
  v_mov_b32 v233, v145
  v_mov_b32 v249, 0
  v_mov_b32 v234, v146
  v_mov_b32 v250, 0
  v_mov_b32 v235, v147
  v_mov_b32 v251, 0
  v_mov_b32 v236, v148
  v_mov_b32 v252, 0
  v_mov_b32 v237, v149
  v_mov_b32 v253, 0
  v_mov_b32 v238, v150
  v_mov_b32 v254, 0
  v_mov_b32 v239, v151
  v_mov_b32 v255, 0
L_nown2:
  s_cmp_lg_u32 s64, 3
  s_cbranch_scc1 L_nown3
  v_mov_b32 v240, v160
  v_mov_b32 v224, 0
  v_mov_b32 v241, v161
  v_mov_b32 v225, 0
  v_mov_b32 v242, v162
  v_mov_b32 v226, 0
  v_mov_b32 v243, v163
  v_mov_b32 v227, 0
  v_mov_b32 v244, v164
  v_mov_b32 v228, 0
  v_mov_b32 v245, v165
  v_mov_b32 v229, 0
  v_mov_b32 v246, v166
  v_mov_b32 v230, 0
  v_mov_b32 v247, v167
  v_mov_b32 v231, 0
  v_mov_b32 v248, v176
  v_mov_b32 v232, 0
  v_mov_b32 v249, v177
  v_mov_b32 v233, 0
  v_mov_b32 v250, v178
  v_mov_b32 v234, 0
  v_mov_b32 v251, v179
  v_mov_b32 v235, 0
  v_mov_b32 v252, v180
  v_mov_b32 v236, 0
  v_mov_b32 v253, v181
  v_mov_b32 v237, 0
  v_mov_b32 v254, v182
  v_mov_b32 v238, 0
  v_mov_b32 v255, v183
  v_mov_b32 v239, 0
L_nown3:
  s_mov_b32 s35, 3216550459
  s_mov_b32 s6, 0
L_dpoll:
  s_waitcnt vmcnt(0)
  v_max3_u32 v36, v192, v193, v194
  v_max3_u32 v37, v195, v196, v197
  v_max3_u32 v36, v36, v198, v199
  v_max3_u32 v37, v37, v200, v201
  v_max3_u32 v36, v36, v202, v203
  v_max3_u32 v37, v37, v204, v205
  v_max3_u32 v36, v36, v206, v207
  v_max3_u32 v37, v37, v208, v209
  v_max3_u32 v36, v36, v210, v211
  v_max3_u32 v37, v37, v212, v213
  v_max3_u32 v36, v36, v214, v215
  v_max3_u32 v37, v37, v216, v217
  v_max3_u32 v36, v36, v218, v219
  v_max3_u32 v37, v37, v220, v221
  v_max3_u32 v36, v36, v222, v223
  v_max_u32 v36, v36, v37
  v_cmp_eq_u32 vcc, -1, v36
  s_cbranch_vccz L_dok
  s_add_u32 s6, s6, 1
  s_cmp_gt_u32 s6, 0x40000
  s_cbranch_scc1 L_dok
  s_nop 0
  buffer_load_dwordx4 v[192:195], v2, s[16:19], s40 offen offset:0 sc1
  buffer_load_dwordx4 v[196:199], v2, s[16:19], s40 offen offset:1024 sc1
  buffer_load_dwordx4 v[200:203], v2, s[16:19], s41 offen offset:0 sc1
  buffer_load_dwordx4 v[204:207], v2, s[16:19], s41 offen offset:1024 sc1
  buffer_load_dwordx4 v[208:211], v2, s[16:19], s42 offen offset:0 sc1
  buffer_load_dwordx4 v[212:215], v2, s[16:19], s42 offen offset:1024 sc1
  buffer_load_dwordx4 v[216:219], v2, s[16:19], s43 offen offset:0 sc1
  buffer_load_dwordx4 v[220:223], v2, s[16:19], s43 offen offset:1024 sc1
  s_branch L_dpoll
L_w_kh1:
  s_setpc_b64 s[52:53]
L_dok:
  v_lshlrev_b32 v40, 16, v192
  v_and_b32 v41, 0xffff0000, v192
  v_lshlrev_b32 v42, 16, v193
  v_and_b32 v43, 0xffff0000, v193
  v_lshlrev_b32 v44, 16, v194
  v_and_b32 v45, 0xffff0000, v194
  v_lshlrev_b32 v46, 16, v195
  v_and_b32 v47, 0xffff0000, v195
  v_lshlrev_b32 v48, 16, v196
  v_and_b32 v49, 0xffff0000, v196
  v_lshlrev_b32 v50, 16, v197
  v_and_b32 v51, 0xffff0000, v197
  v_lshlrev_b32 v52, 16, v198
  v_and_b32 v53, 0xffff0000, v198
  v_lshlrev_b32 v54, 16, v199
  v_and_b32 v55, 0xffff0000, v199
  v_pk_add_f32 v[224:225], v[224:225], v[40:41]
  v_pk_add_f32 v[226:227], v[226:227], v[42:43]
  v_pk_add_f32 v[228:229], v[228:229], v[44:45]
  v_pk_add_f32 v[230:231], v[230:231], v[46:47]
  v_pk_add_f32 v[232:233], v[232:233], v[48:49]
  v_pk_add_f32 v[234:235], v[234:235], v[50:51]
  v_pk_add_f32 v[236:237], v[236:237], v[52:53]
  v_pk_add_f32 v[238:239], v[238:239], v[54:55]
  v_lshlrev_b32 v40, 16, v200
  v_and_b32 v41, 0xffff0000, v200
  v_lshlrev_b32 v42, 16, v201
  v_and_b32 v43, 0xffff0000, v201
  v_lshlrev_b32 v44, 16, v202
  v_and_b32 v45, 0xffff0000, v202
  v_lshlrev_b32 v46, 16, v203
  v_and_b32 v47, 0xffff0000, v203
  v_lshlrev_b32 v48, 16, v204
  v_and_b32 v49, 0xffff0000, v204
  v_lshlrev_b32 v50, 16, v205
  v_and_b32 v51, 0xffff0000, v205
  v_lshlrev_b32 v52, 16, v206
  v_and_b32 v53, 0xffff0000, v206
  v_lshlrev_b32 v54, 16, v207
  v_and_b32 v55, 0xffff0000, v207
  v_pk_add_f32 v[224:225], v[224:225], v[40:41]
  v_pk_add_f32 v[226:227], v[226:227], v[42:43]
  v_pk_add_f32 v[228:229], v[228:229], v[44:45]
  v_pk_add_f32 v[230:231], v[230:231], v[46:47]
  v_pk_add_f32 v[232:233], v[232:233], v[48:49]
  v_pk_add_f32 v[234:235], v[234:235], v[50:51]
  v_pk_add_f32 v[236:237], v[236:237], v[52:53]
  v_pk_add_f32 v[238:239], v[238:239], v[54:55]
  v_lshlrev_b32 v40, 16, v208
  v_and_b32 v41, 0xffff0000, v208
  v_lshlrev_b32 v42, 16, v209
  v_and_b32 v43, 0xffff0000, v209
  v_lshlrev_b32 v44, 16, v210
  v_and_b32 v45, 0xffff0000, v210
  v_lshlrev_b32 v46, 16, v211
  v_and_b32 v47, 0xffff0000, v211
  v_lshlrev_b32 v48, 16, v212
  v_and_b32 v49, 0xffff0000, v212
  v_lshlrev_b32 v50, 16, v213
  v_and_b32 v51, 0xffff0000, v213
  v_lshlrev_b32 v52, 16, v214
  v_and_b32 v53, 0xffff0000, v214
  v_lshlrev_b32 v54, 16, v215
  v_and_b32 v55, 0xffff0000, v215
  v_pk_add_f32 v[224:225], v[224:225], v[40:41]
  v_pk_add_f32 v[226:227], v[226:227], v[42:43]
  v_pk_add_f32 v[228:229], v[228:229], v[44:45]
  v_pk_add_f32 v[230:231], v[230:231], v[46:47]
  v_pk_add_f32 v[232:233], v[232:233], v[48:49]
  v_pk_add_f32 v[234:235], v[234:235], v[50:51]
  v_pk_add_f32 v[236:237], v[236:237], v[52:53]
  v_pk_add_f32 v[238:239], v[238:239], v[54:55]
  v_lshlrev_b32 v40, 16, v216
  v_and_b32 v41, 0xffff0000, v216
  v_lshlrev_b32 v42, 16, v217
  v_and_b32 v43, 0xffff0000, v217
  v_lshlrev_b32 v44, 16, v218
  v_and_b32 v45, 0xffff0000, v218
  v_lshlrev_b32 v46, 16, v219
  v_and_b32 v47, 0xffff0000, v219
  v_lshlrev_b32 v48, 16, v220
  v_and_b32 v49, 0xffff0000, v220
  v_lshlrev_b32 v50, 16, v221
  v_and_b32 v51, 0xffff0000, v221
  v_lshlrev_b32 v52, 16, v222
  v_and_b32 v53, 0xffff0000, v222
  v_lshlrev_b32 v54, 16, v223
  v_and_b32 v55, 0xffff0000, v223
  v_pk_add_f32 v[240:241], v[240:241], v[40:41]
  v_pk_add_f32 v[242:243], v[242:243], v[42:43]
  v_pk_add_f32 v[244:245], v[244:245], v[44:45]
  v_pk_add_f32 v[246:247], v[246:247], v[46:47]
  v_pk_add_f32 v[248:249], v[248:249], v[48:49]
  v_pk_add_f32 v[250:251], v[250:251], v[50:51]
  v_pk_add_f32 v[252:253], v[252:253], v[52:53]
  v_pk_add_f32 v[254:255], v[254:255], v[54:55]
  v_pk_add_f32 v[240:241], v[240:241], v[136:137]
  v_pk_add_f32 v[242:243], v[242:243], v[138:139]
  v_pk_add_f32 v[244:245], v[244:245], v[136:137]
  v_pk_add_f32 v[246:247], v[246:247], v[138:139]
  v_pk_add_f32 v[248:249], v[248:249], v[152:153]
  v_pk_add_f32 v[250:251], v[250:251], v[154:155]
  v_pk_add_f32 v[252:253], v[252:253], v[152:153]
  v_pk_add_f32 v[254:255], v[254:255], v[154:155]
  v_mul_f32 v40, s35, v240
  v_mul_f32 v41, s35, v241
  v_mul_f32 v42, s35, v242
  v_mul_f32 v43, s35, v243
  v_mul_f32 v44, s35, v244
  v_mul_f32 v45, s35, v245
  v_mul_f32 v46, s35, v246
  v_mul_f32 v47, s35, v247
  v_mul_f32 v48, s35, v248
  v_mul_f32 v49, s35, v249
  v_mul_f32 v50, s35, v250
  v_mul_f32 v51, s35, v251
  v_mul_f32 v52, s35, v252
  v_mul_f32 v53, s35, v253
  v_mul_f32 v54, s35, v254
  v_mul_f32 v55, s35, v255
  v_exp_f32 v40, v40
  v_exp_f32 v41, v41
  v_exp_f32 v42, v42
  v_exp_f32 v43, v43
  v_exp_f32 v44, v44
  v_exp_f32 v45, v45
  v_exp_f32 v46, v46
  v_exp_f32 v47, v47
  v_exp_f32 v48, v48
  v_exp_f32 v49, v49
  v_exp_f32 v50, v50
  v_exp_f32 v51, v51
  v_exp_f32 v52, v52
  v_exp_f32 v53, v53
  v_exp_f32 v54, v54
  v_exp_f32 v55, v55
  v_add_f32 v40, 1.0, v40
  v_add_f32 v41, 1.0, v41
  v_add_f32 v42, 1.0, v42
  v_add_f32 v43, 1.0, v43
  v_add_f32 v44, 1.0, v44
  v_add_f32 v45, 1.0, v45
  v_add_f32 v46, 1.0, v46
  v_add_f32 v47, 1.0, v47
  v_add_f32 v48, 1.0, v48
  v_add_f32 v49, 1.0, v49
  v_add_f32 v50, 1.0, v50
  v_add_f32 v51, 1.0, v51
  v_add_f32 v52, 1.0, v52
  v_add_f32 v53, 1.0, v53
  v_add_f32 v54, 1.0, v54
  v_add_f32 v55, 1.0, v55
  v_rcp_f32 v40, v40
  v_rcp_f32 v41, v41
  v_rcp_f32 v42, v42
  v_rcp_f32 v43, v43
  v_rcp_f32 v44, v44
  v_rcp_f32 v45, v45
  v_rcp_f32 v46, v46
  v_rcp_f32 v47, v47
  v_rcp_f32 v48, v48
  v_rcp_f32 v49, v49
  v_rcp_f32 v50, v50
  v_rcp_f32 v51, v51
  v_rcp_f32 v52, v52
  v_rcp_f32 v53, v53
  v_rcp_f32 v54, v54
  v_rcp_f32 v55, v55
  v_pk_mul_f32 v[240:241], v[240:241], v[40:41]
  v_pk_mul_f32 v[242:243], v[242:243], v[42:43]
  v_pk_mul_f32 v[244:245], v[244:245], v[44:45]
  v_pk_mul_f32 v[246:247], v[246:247], v[46:47]
  v_pk_mul_f32 v[248:249], v[248:249], v[48:49]
  v_pk_mul_f32 v[250:251], v[250:251], v[50:51]
  v_pk_mul_f32 v[252:253], v[252:253], v[52:53]
  v_pk_mul_f32 v[254:255], v[254:255], v[54:55]
  v_pk_fma_f32 v[224:225], v[224:225], v[240:241], v[72:73]
  v_pk_fma_f32 v[226:227], v[226:227], v[242:243], v[74:75]
  v_cvt_pk_bf16_f32 v224, v224, v225
  v_cvt_pk_bf16_f32 v225, v226, v227
  buffer_store_dwordx2 v[224:225], v19, s[28:31], s54 offen offset:0
  v_pk_fma_f32 v[228:229], v[228:229], v[244:245], v[104:105]
  v_pk_fma_f32 v[230:231], v[230:231], v[246:247], v[106:107]
  v_cvt_pk_bf16_f32 v228, v228, v229
  v_cvt_pk_bf16_f32 v229, v230, v231
  buffer_store_dwordx2 v[228:229], v20, s[28:31], s54 offen offset:0
  v_pk_fma_f32 v[232:233], v[232:233], v[248:249], v[88:89]
  v_pk_fma_f32 v[234:235], v[234:235], v[250:251], v[90:91]
  v_cvt_pk_bf16_f32 v232, v232, v233
  v_cvt_pk_bf16_f32 v233, v234, v235
  buffer_store_dwordx2 v[232:233], v19, s[28:31], s54 offen offset:32
  v_pk_fma_f32 v[236:237], v[236:237], v[252:253], v[120:121]
  v_pk_fma_f32 v[238:239], v[238:239], v[254:255], v[122:123]
  v_cvt_pk_bf16_f32 v236, v236, v237
  v_cvt_pk_bf16_f32 v237, v238, v239
  buffer_store_dwordx2 v[236:237], v20, s[28:31], s54 offen offset:32
L_end:
  s_endpgm
L_maddr:
  s_mul_i32 s6, s36, 0x4000
  s_add_u32 s6, s6, 0xc000
  s_cmp_eq_u32 s36, 0
  s_cselect_b32 s6, 0x4000, s6
  s_cselect_b32 s7, 0x1c000, 0
  s_cmp_eq_u32 s36, 3
  s_cselect_b32 s6, 0x1c000, s6
  s_cselect_b32 s7, 0x4000, s7
  s_cmp_eq_u32 s36, 1
  s_cselect_b32 s7, 0x14000, s7
  s_cmp_eq_u32 s36, 2
  s_cselect_b32 s7, 0x10000, s7
  v_add_u32 v197, s6, v2
  v_add_u32 v198, s7, v2
  s_lshl_b32 s34, s36, 10
  s_add_u32 s34, s34, 131072
  v_add_u32 v199, s34, v2
  s_xor_b32 s34, s34, 3072
  v_add_u32 v200, s34, v2
  s_lshl_b32 s34, s36, 2
  s_add_u32 s34, s34, 135168
  v_mov_b32_e64 v201, s34
  s_setpc_b64 s[52:53]
L_maxpass:
  v_mov_b32 v12, 0xff7fffff
  v_mov_b32 v13, 0xff7fffff
  v_mov_b32 v14, 0xff7fffff
  v_mov_b32 v15, 0xff7fffff
  v_mov_b32 v8, 0xff7fffff
  v_add_u32 v9, 0x10000, v2
  s_mov_b32 s64, 0
  s_lshr_b32 s54, s56, 2
  s_sub_u32 s65, 31, s49
  s_waitcnt lgkmcnt(0)
  s_barrier
L_mp_loop:
  s_lshl_b32 s50, s64, 15
  s_add_u32 s50, s50, s40
  s_add_u32 m0, s41, 0x10000
  s_nop 0
  buffer_load_dwordx4 v2, s[16:19], s50 offen offset:0 sc1 lds
  buffer_load_dwordx4 v2, s[16:19], s50 offen offset:1024 sc1 lds
  buffer_load_dwordx4 v2, s[16:19], s50 offen offset:2048 sc1 lds
  buffer_load_dwordx4 v2, s[16:19], s50 offen offset:3072 sc1 lds
  s_waitcnt vmcnt(0)
  s_barrier
  s_cmp_gt_u32 s64, s54
  s_cbranch_scc1 L_mp_next
  ds_read_b128 a[144:147], v9 offset:0
  ds_read_b128 a[148:151], v9 offset:1024
  ds_read_b128 a[152:155], v9 offset:2048
  ds_read_b128 a[156:159], v9 offset:3072
  ds_read_b128 a[176:179], v9 offset:4096
  ds_read_b128 a[180:183], v9 offset:5120
  ds_read_b128 a[184:187], v9 offset:6144
  ds_read_b128 a[188:191], v9 offset:7168
  ds_read_b128 a[128:131], v9 offset:8192
  ds_read_b128 a[132:135], v9 offset:9216
  ds_read_b128 a[136:139], v9 offset:10240
  ds_read_b128 a[140:143], v9 offset:11264
  ds_read_b128 a[160:163], v9 offset:12288
  ds_read_b128 a[164:167], v9 offset:13312
  ds_read_b128 a[168:171], v9 offset:14336
  ds_read_b128 a[172:175], v9 offset:15360
  s_waitcnt lgkmcnt(0)
  v_mfma_f32_16x16x32_bf16 v[48:51], a[144:147], v[32:35], 0
  v_mfma_f32_16x16x32_bf16 v[48:51], a[148:151], v[64:67], v[48:51]
  v_mfma_f32_16x16x32_bf16 v[48:51], a[152:155], v[96:99], v[48:51]
  v_mfma_f32_16x16x32_bf16 v[48:51], a[156:159], v[128:131], v[48:51]
  v_mfma_f32_16x16x32_bf16 v[52:55], a[144:147], v[36:39], 0
  v_mfma_f32_16x16x32_bf16 v[52:55], a[148:151], v[68:71], v[52:55]
  v_mfma_f32_16x16x32_bf16 v[52:55], a[152:155], v[100:103], v[52:55]
  v_mfma_f32_16x16x32_bf16 v[52:55], a[156:159], v[132:135], v[52:55]
  v_mfma_f32_16x16x32_bf16 v[56:59], a[144:147], v[40:43], 0
  v_mfma_f32_16x16x32_bf16 v[56:59], a[148:151], v[72:75], v[56:59]
  v_mfma_f32_16x16x32_bf16 v[56:59], a[152:155], v[104:107], v[56:59]
  v_mfma_f32_16x16x32_bf16 v[56:59], a[156:159], v[136:139], v[56:59]
  v_mfma_f32_16x16x32_bf16 v[60:63], a[144:147], v[44:47], 0
  v_mfma_f32_16x16x32_bf16 v[60:63], a[148:151], v[76:79], v[60:63]
  v_mfma_f32_16x16x32_bf16 v[60:63], a[152:155], v[108:111], v[60:63]
  v_mfma_f32_16x16x32_bf16 v[60:63], a[156:159], v[140:143], v[60:63]
  v_mfma_f32_16x16x32_bf16 v[80:83], a[176:179], v[32:35], 0
  v_mfma_f32_16x16x32_bf16 v[80:83], a[180:183], v[64:67], v[80:83]
  v_mfma_f32_16x16x32_bf16 v[80:83], a[184:187], v[96:99], v[80:83]
  v_mfma_f32_16x16x32_bf16 v[80:83], a[188:191], v[128:131], v[80:83]
  v_mfma_f32_16x16x32_bf16 v[84:87], a[176:179], v[36:39], 0
  v_mfma_f32_16x16x32_bf16 v[84:87], a[180:183], v[68:71], v[84:87]
  v_mfma_f32_16x16x32_bf16 v[84:87], a[184:187], v[100:103], v[84:87]
  v_mfma_f32_16x16x32_bf16 v[84:87], a[188:191], v[132:135], v[84:87]
  v_mfma_f32_16x16x32_bf16 v[88:91], a[176:179], v[40:43], 0
  v_mfma_f32_16x16x32_bf16 v[88:91], a[180:183], v[72:75], v[88:91]
  v_mfma_f32_16x16x32_bf16 v[88:91], a[184:187], v[104:107], v[88:91]
  v_mfma_f32_16x16x32_bf16 v[88:91], a[188:191], v[136:139], v[88:91]
  v_mfma_f32_16x16x32_bf16 v[92:95], a[176:179], v[44:47], 0
  v_mfma_f32_16x16x32_bf16 v[92:95], a[180:183], v[76:79], v[92:95]
  v_mfma_f32_16x16x32_bf16 v[92:95], a[184:187], v[108:111], v[92:95]
  v_mfma_f32_16x16x32_bf16 v[92:95], a[188:191], v[140:143], v[92:95]
  v_mfma_f32_16x16x32_bf16 v[112:115], a[128:131], v[32:35], 0
  v_mfma_f32_16x16x32_bf16 v[112:115], a[132:135], v[64:67], v[112:115]
  v_mfma_f32_16x16x32_bf16 v[112:115], a[136:139], v[96:99], v[112:115]
  v_mfma_f32_16x16x32_bf16 v[112:115], a[140:143], v[128:131], v[112:115]
  v_mfma_f32_16x16x32_bf16 v[116:119], a[128:131], v[36:39], 0
  v_mfma_f32_16x16x32_bf16 v[116:119], a[132:135], v[68:71], v[116:119]
  v_mfma_f32_16x16x32_bf16 v[116:119], a[136:139], v[100:103], v[116:119]
  v_mfma_f32_16x16x32_bf16 v[116:119], a[140:143], v[132:135], v[116:119]
  v_mfma_f32_16x16x32_bf16 v[120:123], a[128:131], v[40:43], 0
  v_mfma_f32_16x16x32_bf16 v[120:123], a[132:135], v[72:75], v[120:123]
  v_mfma_f32_16x16x32_bf16 v[120:123], a[136:139], v[104:107], v[120:123]
  v_mfma_f32_16x16x32_bf16 v[120:123], a[140:143], v[136:139], v[120:123]
  v_mfma_f32_16x16x32_bf16 v[124:127], a[128:131], v[44:47], 0
  v_mfma_f32_16x16x32_bf16 v[124:127], a[132:135], v[76:79], v[124:127]
  v_mfma_f32_16x16x32_bf16 v[124:127], a[136:139], v[108:111], v[124:127]
  v_mfma_f32_16x16x32_bf16 v[124:127], a[140:143], v[140:143], v[124:127]
  v_mfma_f32_16x16x32_bf16 v[144:147], a[160:163], v[32:35], 0
  v_mfma_f32_16x16x32_bf16 v[144:147], a[164:167], v[64:67], v[144:147]
  v_mfma_f32_16x16x32_bf16 v[144:147], a[168:171], v[96:99], v[144:147]
  v_mfma_f32_16x16x32_bf16 v[144:147], a[172:175], v[128:131], v[144:147]
  v_mfma_f32_16x16x32_bf16 v[148:151], a[160:163], v[36:39], 0
  v_mfma_f32_16x16x32_bf16 v[148:151], a[164:167], v[68:71], v[148:151]
  v_mfma_f32_16x16x32_bf16 v[148:151], a[168:171], v[100:103], v[148:151]
  v_mfma_f32_16x16x32_bf16 v[148:151], a[172:175], v[132:135], v[148:151]
  v_mfma_f32_16x16x32_bf16 v[152:155], a[160:163], v[40:43], 0
  v_mfma_f32_16x16x32_bf16 v[152:155], a[164:167], v[72:75], v[152:155]
  v_mfma_f32_16x16x32_bf16 v[152:155], a[168:171], v[104:107], v[152:155]
  v_mfma_f32_16x16x32_bf16 v[152:155], a[172:175], v[136:139], v[152:155]
  v_mfma_f32_16x16x32_bf16 v[156:159], a[160:163], v[44:47], 0
  v_mfma_f32_16x16x32_bf16 v[156:159], a[164:167], v[76:79], v[156:159]
  v_mfma_f32_16x16x32_bf16 v[156:159], a[168:171], v[108:111], v[156:159]
  v_mfma_f32_16x16x32_bf16 v[156:159], a[172:175], v[140:143], v[156:159]
  s_nop 7
  s_cmp_lg_u32 s64, s54
  s_cbranch_scc1 L_mp_nomask
  v_cndmask_b32 v48, v8, v48, s[8:9]
  v_cndmask_b32 v49, v8, v49, s[10:11]
  v_cndmask_b32 v50, v8, v50, s[12:13]
  v_cndmask_b32 v51, v8, v51, s[14:15]
  v_mov_b32 v80, v8
  v_mov_b32 v81, v8
  v_mov_b32 v82, v8
  v_mov_b32 v83, v8
  v_cndmask_b32 v84, v8, v84, s[8:9]
  v_cndmask_b32 v85, v8, v85, s[10:11]
  v_cndmask_b32 v86, v8, v86, s[12:13]
  v_cndmask_b32 v87, v8, v87, s[14:15]
  v_mov_b32 v112, v8
  v_mov_b32 v113, v8
  v_mov_b32 v114, v8
  v_mov_b32 v115, v8
  v_mov_b32 v116, v8
  v_mov_b32 v117, v8
  v_mov_b32 v118, v8
  v_mov_b32 v119, v8
  v_cndmask_b32 v120, v8, v120, s[8:9]
  v_cndmask_b32 v121, v8, v121, s[10:11]
  v_cndmask_b32 v122, v8, v122, s[12:13]
  v_cndmask_b32 v123, v8, v123, s[14:15]
  v_mov_b32 v144, v8
  v_mov_b32 v145, v8
  v_mov_b32 v146, v8
  v_mov_b32 v147, v8
  v_mov_b32 v148, v8
  v_mov_b32 v149, v8
  v_mov_b32 v150, v8
  v_mov_b32 v151, v8
  v_mov_b32 v152, v8
  v_mov_b32 v153, v8
  v_mov_b32 v154, v8
  v_mov_b32 v155, v8
  v_cndmask_b32 v156, v8, v156, s[8:9]
  v_cndmask_b32 v157, v8, v157, s[10:11]
  v_cndmask_b32 v158, v8, v158, s[12:13]
  v_cndmask_b32 v159, v8, v159, s[14:15]
L_mp_nomask:
  v_max3_f32 v12, v12, v48, v49
  v_max3_f32 v12, v12, v50, v51
  v_max3_f32 v12, v12, v80, v81
  v_max3_f32 v12, v12, v82, v83
  v_max3_f32 v12, v12, v112, v113
  v_max3_f32 v12, v12, v114, v115
  v_max3_f32 v12, v12, v144, v145
  v_max3_f32 v12, v12, v146, v147
  v_max3_f32 v13, v13, v52, v53
  v_max3_f32 v13, v13, v54, v55
  v_max3_f32 v13, v13, v84, v85
  v_max3_f32 v13, v13, v86, v87
  v_max3_f32 v13, v13, v116, v117
  v_max3_f32 v13, v13, v118, v119
  v_max3_f32 v13, v13, v148, v149
  v_max3_f32 v13, v13, v150, v151
  v_max3_f32 v14, v14, v56, v57
  v_max3_f32 v14, v14, v58, v59
  v_max3_f32 v14, v14, v88, v89
  v_max3_f32 v14, v14, v90, v91
  v_max3_f32 v14, v14, v120, v121
  v_max3_f32 v14, v14, v122, v123
  v_max3_f32 v14, v14, v152, v153
  v_max3_f32 v14, v14, v154, v155
  v_max3_f32 v15, v15, v60, v61
  v_max3_f32 v15, v15, v62, v63
  v_max3_f32 v15, v15, v92, v93
  v_max3_f32 v15, v15, v94, v95
  v_max3_f32 v15, v15, v124, v125
  v_max3_f32 v15, v15, v126, v127
  v_max3_f32 v15, v15, v156, v157
  v_max3_f32 v15, v15, v158, v159
L_mp_next:
  s_barrier
  s_add_u32 s64, s64, 1
  s_cmp_le_u32 s64, s65
  s_cbranch_scc1 L_mp_loop
  ds_read_b128 a[144:147], v3 offset:0
  ds_read_b128 a[148:151], v3 offset:1024
  ds_read_b128 a[152:155], v3 offset:2048
  ds_read_b128 a[156:159], v3 offset:3072
  ds_read_b128 a[128:131], v3 offset:4096
  ds_read_b128 a[132:135], v3 offset:5120
  ds_read_b128 a[136:139], v3 offset:6144
  ds_read_b128 a[140:143], v3 offset:7168
  ds_read_b128 a[160:163], v3 offset:8192
  ds_read_b128 a[164:167], v3 offset:9216
  ds_read_b128 a[168:171], v3 offset:10240
  ds_read_b128 a[172:175], v3 offset:11264
  ds_read_b128 a[176:179], v3 offset:12288
  ds_read_b128 a[180:183], v3 offset:13312
  ds_read_b128 a[184:187], v3 offset:14336
  ds_read_b128 a[188:191], v3 offset:15360
  s_waitcnt lgkmcnt(0)
  s_setpc_b64 s[52:53]
L_saferestart:
  s_mov_b32 s60, 0
  s_waitcnt vmcnt(0) lgkmcnt(0)
  s_barrier
  s_load_dwordx2 s[4:5], s[0:1], 16
  s_load_dwordx4 s[8:11], s[0:1], 56
  s_lshl_b32 s49, s38, 1
  s_lshr_b32 s48, s36, 1
  s_lshl_b32 s48, s48, 16
  s_and_b32 s50, s36, 1
  s_lshl_b32 s50, s50, 2
  s_lshr_b32 s51, s36, 1
  s_xor_b32 s51, s51, s36
  s_and_b32 s51, s51, 1
  s_lshl_b32 s51, s51, 2
  s_sub_u32 s57, 15, s38
  s_lshl_b32 s57, s57, 3
  s_add_u32 s57, s57, s51
  s_lshl_b32 s56, s38, 3
  s_add_u32 s56, s56, s50
  s_cmp_lt_u32 s36, 2
  s_cselect_b32 s56, s57, s56
  s_lshl_b32 s40, s37, 20
  s_add_u32 s40, s40, s41
  s_add_u32 s40, s40, 2097152
  s_and_b32 s7, s37, 1
  s_lshl_b32 s6, s7, 5
  s_lshl_b32 s7, s7, 1
  s_mul_i32 s32, s37, 96
  s_mul_i32 s33, s36, 44032
  s_add_u32 s33, s33, s32
  s_lshl_b32 s34, s56, 14
  s_add_u32 s34, s34, 0
  s_mul_i32 s35, s36, 2304
  s_add_u32 s53, s32, s6
  s_lshl_b32 s6, s6, 1
  s_sub_u32 s54, s32, s6
  s_lshl_b32 s44, s36, 17
  s_lshl_b32 s47, s37, 8
  s_add_u32 s44, s44, s47
  s_mov_b32 s45, 0
  s_mov_b32 s46, 1073741824
  v_mul_u32_u24 v20, 43, v1
  v_lshrrev_b32 v20, 8, v20
  v_mul_u32_u24 v21, 6, v20
  v_sub_u32 v21, v1, v21
  v_add_u32 v21, s7, v21
  v_subrev_u32 v22, 6, v21
  v_min_u32 v21, v21, v22
  v_mul_u32_u24 v16, 2752, v20
  v_lshl_add_u32 v16, v21, 4, v16
  v_cmp_gt_u32 vcc, 48, v1
  v_mov_b32 v20, 1073741824
  v_lshrrev_b32 v21, 4, v1
  v_cndmask_b32 v16, v20, v16, vcc
  v_add_u32 v17, 20864, v16
  v_mul_u32_u24 v18, 1152, v21
  v_bfe_u32 v22, v1, 2, 2
  v_mul_u32_u24 v22, 96, v22
  v_add_u32 v18, v18, v22
  v_and_b32 v22, 3, v1
  v_lshl_add_u32 v18, v22, 3, v18
  v_add_u32 v18, 103424, v18
  v_lshlrev_b32 v19, 3, v21
  v_and_b32 v24, 31, v1
  v_lshlrev_b32 v24, 7, v24
  s_waitcnt lgkmcnt(0)
  s_mov_b32 s20, s4
  s_mov_b32 s21, s5
  s_mov_b32 s22, 4194304
  s_mov_b32 s23, 0x20000
  s_mov_b32 s24, s8
  s_mov_b32 s25, s9
  s_mov_b32 s26, 1409024
  s_mov_b32 s27, 0x20000
  s_mov_b32 s28, s10
  s_mov_b32 s29, s11
  s_mov_b32 s30, 2752
  s_mov_b32 s31, 0x20000
  buffer_load_dwordx2 v[26:27], v19, s[28:31], s53 offen offset:0
  buffer_load_dwordx2 v[28:29], v19, s[28:31], s53 offen offset:32
  buffer_load_dwordx2 v[30:31], v19, s[28:31], s54 offen offset:64
  v_and_b32 v248, 15, v1
  v_lshrrev_b32 v249, 4, v1
  v_lshrrev_b32 v250, 1, v248
  v_xor_b32 v250, v250, v249
  v_and_b32 v251, 1, v248
  v_lshlrev_b32 v251, 4, v251
  v_lshl_add_u32 v251, v249, 13, v251
  v_lshl_add_u32 v4, v250, 5, v251
  v_add_u32 v5, 31744, v4
  v_xor_b32 v250, 4, v250
  v_lshl_add_u32 v6, v250, 5, v251
  v_add_u32 v6, 63488, v6
  v_add_u32 v7, 31744, v6
  v_bfe_u32 v248, v1, 2, 2
  v_lshlrev_b32 v250, 3, v249
  v_add_u32 v250, v250, v248
  v_lshlrev_b32 v250, 8, v250
  v_and_b32 v251, 3, v1
  v_lshl_add_u32 v250, v251, 3, v250
  v_add_u32 v250, 87040, v250
  v_and_b32 v251, 1, v249
  v_lshl_add_u32 v248, v251, 2, v248
  v_xor_b32 v251, 0, v248
  v_lshl_add_u32 v8, v251, 5, v250
  v_xor_b32 v251, 1, v248
  v_lshl_add_u32 v9, v251, 5, v250
  v_xor_b32 v251, 2, v248
  v_lshl_add_u32 v10, v251, 5, v250
  v_xor_b32 v251, 3, v248
  v_lshl_add_u32 v11, v251, 5, v250
  v_xor_b32 v251, 4, v248
  v_lshl_add_u32 v12, v251, 5, v250
  v_xor_b32 v251, 5, v248
  v_lshl_add_u32 v13, v251, 5, v250
  v_xor_b32 v251, 6, v248
  v_lshl_add_u32 v14, v251, 5, v250
  v_xor_b32 v251, 7, v248
  v_lshl_add_u32 v15, v251, 5, v250
  s_add_u32 s50, s44, 0
  s_add_u32 m0, s41, 138240
  s_nop 0
  buffer_load_dwordx4 v4, s[20:23], s50 offen lds
  buffer_load_dwordx4 v5, s[20:23], s50 offen offset:1024 lds
  buffer_load_dwordx4 v6, s[20:23], s50 offen offset:2048 lds
  buffer_load_dwordx4 v7, s[20:23], s50 offen offset:3072 lds
  s_add_u32 s50, s33, 0
  s_add_u32 m0, s35, 154624
  s_nop 0
  buffer_load_dwordx4 v16, s[24:27], s50 offen lds
  buffer_load_dwordx4 v17, s[24:27], s50 offen offset:1152 lds
  s_add_u32 s50, s44, 524288
  s_add_u32 m0, s41, 87040
  s_nop 0
  s_nop 0
  buffer_load_dwordx4 v4, s[20:23], s50 offen lds
  buffer_load_dwordx4 v5, s[20:23], s50 offen offset:1024 lds
  buffer_load_dwordx4 v6, s[20:23], s50 offen offset:2048 lds
  buffer_load_dwordx4 v7, s[20:23], s50 offen offset:3072 lds
  s_add_u32 s50, s33, 176128
  s_add_u32 m0, s35, 103424
  s_nop 0
  buffer_load_dwordx4 v16, s[24:27], s50 offen lds
  buffer_load_dwordx4 v17, s[24:27], s50 offen offset:1152 lds
  s_add_u32 s51, s34, 0
  s_nop 0
  buffer_load_dwordx4 a[0:3], v2, s[16:19], s51 offen offset:0 sc1
  buffer_load_dwordx4 a[4:7], v2, s[16:19], s51 offen offset:1024 sc1
  s_add_u32 s51, s51, 16384
  s_nop 0
  buffer_load_dwordx4 a[64:67], v2, s[16:19], s51 offen offset:0 sc1
  buffer_load_dwordx4 a[68:71], v2, s[16:19], s51 offen offset:1024 sc1
  s_add_u32 s51, s51, 16384
  s_nop 0
  buffer_load_dwordx4 a[128:131], v2, s[16:19], s51 offen offset:0 sc1
  buffer_load_dwordx4 a[132:135], v2, s[16:19], s51 offen offset:1024 sc1
  s_add_u32 s51, s51, 16384
  s_nop 0
  buffer_load_dwordx4 a[192:195], v2, s[16:19], s51 offen offset:0 sc1
  buffer_load_dwordx4 a[196:199], v2, s[16:19], s51 offen offset:1024 sc1
  s_add_u32 s51, s34, 2048
  s_nop 0
  buffer_load_dwordx4 a[8:11], v2, s[16:19], s51 offen offset:0 sc1
  buffer_load_dwordx4 a[12:15], v2, s[16:19], s51 offen offset:1024 sc1
  s_add_u32 s51, s51, 16384
  s_nop 0
  buffer_load_dwordx4 a[72:75], v2, s[16:19], s51 offen offset:0 sc1
  buffer_load_dwordx4 a[76:79], v2, s[16:19], s51 offen offset:1024 sc1
  s_add_u32 s51, s51, 16384
  s_nop 0
  buffer_load_dwordx4 a[136:139], v2, s[16:19], s51 offen offset:0 sc1
  buffer_load_dwordx4 a[140:143], v2, s[16:19], s51 offen offset:1024 sc1
  s_add_u32 s51, s51, 16384
  s_nop 0
  buffer_load_dwordx4 a[200:203], v2, s[16:19], s51 offen offset:0 sc1
  buffer_load_dwordx4 a[204:207], v2, s[16:19], s51 offen offset:1024 sc1
  s_add_u32 s51, s34, 4096
  s_nop 0
  buffer_load_dwordx4 a[16:19], v2, s[16:19], s51 offen offset:0 sc1
  buffer_load_dwordx4 a[20:23], v2, s[16:19], s51 offen offset:1024 sc1
  s_add_u32 s51, s51, 16384
  s_nop 0
  buffer_load_dwordx4 a[80:83], v2, s[16:19], s51 offen offset:0 sc1
  buffer_load_dwordx4 a[84:87], v2, s[16:19], s51 offen offset:1024 sc1
  s_add_u32 s51, s51, 16384
  s_nop 0
  buffer_load_dwordx4 a[144:147], v2, s[16:19], s51 offen offset:0 sc1
  buffer_load_dwordx4 a[148:151], v2, s[16:19], s51 offen offset:1024 sc1
  s_add_u32 s51, s51, 16384
  s_nop 0
  buffer_load_dwordx4 a[208:211], v2, s[16:19], s51 offen offset:0 sc1
  buffer_load_dwordx4 a[212:215], v2, s[16:19], s51 offen offset:1024 sc1
  s_waitcnt vmcnt(0)
  v_lshlrev_b32 v32, 16, v26
  v_and_b32 v33, 0xffff0000, v26
  v_lshlrev_b32 v34, 16, v27
  v_and_b32 v35, 0xffff0000, v27
  v_lshlrev_b32 v36, 16, v28
  v_and_b32 v37, 0xffff0000, v28
  v_lshlrev_b32 v38, 16, v29
  v_and_b32 v39, 0xffff0000, v29
  v_lshlrev_b32 v40, 16, v30
  v_and_b32 v41, 0xffff0000, v30
  v_lshlrev_b32 v42, 16, v31
  v_and_b32 v43, 0xffff0000, v31
  v_mov_b32 v20, v32
  v_mov_b32 v21, v33
  v_mov_b32 v22, v34
  v_mov_b32 v23, v35
  v_mov_b32 v24, v36
  v_mov_b32 v25, v37
  v_mov_b32 v26, v38
  v_mov_b32 v27, v39
  v_mov_b32 v28, v40
  v_mov_b32 v29, v41
  v_mov_b32 v30, v42
  v_mov_b32 v31, v43
  s_barrier
  ds_read_b64_tr_b16 v[208:209], v8 offset:51200
  ds_read_b64_tr_b16 v[210:211], v8 offset:52224
  ds_read_b64_tr_b16 v[212:213], v8 offset:59392
  ds_read_b64_tr_b16 v[214:215], v8 offset:60416
  ds_read_b64_tr_b16 v[216:217], v9 offset:51200
  ds_read_b64_tr_b16 v[218:219], v9 offset:52224
  ds_read_b64_tr_b16 v[220:221], v9 offset:59392
  ds_read_b64_tr_b16 v[222:223], v9 offset:60416
  ds_read_b64_tr_b16 v[224:225], v10 offset:51200
  ds_read_b64_tr_b16 v[226:227], v10 offset:52224
  ds_read_b64_tr_b16 v[228:229], v10 offset:59392
  ds_read_b64_tr_b16 v[230:231], v10 offset:60416
  ds_read_b64_tr_b16 v[232:233], v11 offset:51200
  ds_read_b64_tr_b16 v[234:235], v11 offset:52224
  ds_read_b64_tr_b16 v[236:237], v11 offset:59392
  ds_read_b64_tr_b16 v[238:239], v11 offset:60416
  ds_read_b64_tr_b16 v[240:241], v12 offset:51200
  ds_read_b64_tr_b16 v[242:243], v12 offset:52224
  ds_read_b64_tr_b16 v[244:245], v12 offset:59392
  ds_read_b64_tr_b16 v[246:247], v12 offset:60416
  s_waitcnt lgkmcnt(0)
  s_branch L_qgemm
.p2align 6
L_w_main_d:
  s_setpc_b64 s[52:53]
L_w2_main_d:
  s_setpc_b64 s[56:57]
L_main_d:
  v_mfma_f32_16x16x32_bf16 a[192:195], a[208:211], v[208:211], a[192:195]
  v_exp_f32 v112, v112
  v_mfma_f32_16x16x32_bf16 a[196:199], a[208:211], v[212:215], a[196:199]
  v_mfma_f32_16x16x32_bf16 a[200:203], a[208:211], v[216:219], a[200:203]
  s_waitcnt lgkmcnt(8)
  v_exp_f32 v113, v113
  v_mfma_f32_16x16x32_bf16 a[204:207], a[208:211], v[220:223], a[204:207]
  ds_read_b128 a[176:179], v3 offset:4096
  v_cvt_pk_bf16_f32 v224, v112, v113
  v_mfma_f32_16x16x32_bf16 a[0:3], a[128:131], v[208:211], a[0:3]
  v_exp_f32 v114, v114
  v_mfma_f32_16x16x32_bf16 a[4:7], a[128:131], v[212:215], a[4:7]
  v_mfma_f32_16x16x32_bf16 a[8:11], a[128:131], v[216:219], a[8:11]
  v_exp_f32 v115, v115
  v_mfma_f32_16x16x32_bf16 a[12:15], a[128:131], v[220:223], a[12:15]
  ds_read_b128 a[180:183], v3 offset:5120
  v_cvt_pk_bf16_f32 v225, v114, v115
  v_mfma_f32_16x16x32_bf16 a[16:19], a[132:135], v[208:211], a[16:19]
  v_exp_f32 v144, v144
  v_mfma_f32_16x16x32_bf16 a[20:23], a[132:135], v[212:215], a[20:23]
  v_mfma_f32_16x16x32_bf16 a[24:27], a[132:135], v[216:219], a[24:27]
  v_exp_f32 v145, v145
  v_mfma_f32_16x16x32_bf16 a[28:31], a[132:135], v[220:223], a[28:31]
  ds_read_b128 a[184:187], v3 offset:6144
  v_cvt_pk_bf16_f32 v226, v144, v145
  v_mfma_f32_16x16x32_bf16 a[32:35], a[136:139], v[208:211], a[32:35]
  v_exp_f32 v146, v146
  v_mfma_f32_16x16x32_bf16 a[36:39], a[136:139], v[212:215], a[36:39]
  v_mfma_f32_16x16x32_bf16 a[40:43], a[136:139], v[216:219], a[40:43]
  v_exp_f32 v147, v147
  v_mfma_f32_16x16x32_bf16 a[44:47], a[136:139], v[220:223], a[44:47]
  ds_read_b128 a[188:191], v3 offset:7168
  v_cvt_pk_bf16_f32 v227, v146, v147
  v_mfma_f32_16x16x32_bf16 a[48:51], a[140:143], v[208:211], a[48:51]
  v_exp_f32 v116, v116
  v_mfma_f32_16x16x32_bf16 a[52:55], a[140:143], v[212:215], a[52:55]
  v_mfma_f32_16x16x32_bf16 a[56:59], a[140:143], v[216:219], a[56:59]
  s_waitcnt lgkmcnt(8)
  v_exp_f32 v117, v117
  v_mfma_f32_16x16x32_bf16 a[60:63], a[140:143], v[220:223], a[60:63]
  v_cvt_pk_bf16_f32 v228, v116, v117
  v_mfma_f32_16x16x32_bf16 v[48:51], a[144:147], v[32:35], v[240:243]
  v_exp_f32 v118, v118
  v_mfma_f32_16x16x32_bf16 v[48:51], a[148:151], v[64:67], v[48:51]
  v_mfma_f32_16x16x32_bf16 v[48:51], a[152:155], v[96:99], v[48:51]
  s_add_u32 s50, s39, 3
  v_exp_f32 v119, v119
  v_mfma_f32_16x16x32_bf16 v[48:51], a[156:159], v[128:131], v[48:51]
  ds_read_b128 a[128:131], v19 offset:8192
  v_cvt_pk_bf16_f32 v229, v118, v119
  v_mfma_f32_16x16x32_bf16 v[52:55], a[144:147], v[36:39], v[244:247]
  s_lshl_b32 s51, s50, 1
  v_exp_f32 v148, v148
  v_mfma_f32_16x16x32_bf16 v[52:55], a[148:151], v[68:71], v[52:55]
  v_mfma_f32_16x16x32_bf16 v[52:55], a[152:155], v[100:103], v[52:55]
  s_sub_u32 s51, s51, s5
  v_exp_f32 v149, v149
  v_mfma_f32_16x16x32_bf16 v[52:55], a[156:159], v[132:135], v[52:55]
  ds_read_b128 a[132:135], v19 offset:9216
  v_cvt_pk_bf16_f32 v230, v148, v149
  v_mfma_f32_16x16x32_bf16 v[56:59], a[144:147], v[40:43], v[248:251]
  s_cmp_eq_u32 s50, s4
  v_exp_f32 v150, v150
  v_mfma_f32_16x16x32_bf16 v[56:59], a[148:151], v[72:75], v[56:59]
  v_mfma_f32_16x16x32_bf16 v[56:59], a[152:155], v[104:107], v[56:59]
  s_cselect_b32 s51, s6, s51
  v_exp_f32 v151, v151
  v_mfma_f32_16x16x32_bf16 v[56:59], a[156:159], v[136:139], v[56:59]
  ds_read_b128 a[136:139], v19 offset:10240
  v_cvt_pk_bf16_f32 v231, v150, v151
  v_mfma_f32_16x16x32_bf16 v[60:63], a[144:147], v[44:47], v[252:255]
  s_cmp_lt_u32 s50, s4
  v_exp_f32 v120, v120
  v_mfma_f32_16x16x32_bf16 v[60:63], a[148:151], v[76:79], v[60:63]
  v_mfma_f32_16x16x32_bf16 v[60:63], a[152:155], v[108:111], v[60:63]
  s_waitcnt lgkmcnt(7)
  v_exp_f32 v121, v121
  v_mfma_f32_16x16x32_bf16 v[60:63], a[156:159], v[140:143], v[60:63]
  ds_read_b128 a[140:143], v19 offset:11264
  v_cvt_pk_bf16_f32 v232, v120, v121
  v_mfma_f32_16x16x32_bf16 a[64:67], a[160:163], v[208:211], a[64:67]
  s_cselect_b32 s51, s50, s51
  v_exp_f32 v122, v122
  v_mfma_f32_16x16x32_bf16 a[68:71], a[160:163], v[212:215], a[68:71]
  global_load_dwordx4 v[12:15], v16, s[62:63]
  v_mfma_f32_16x16x32_bf16 a[72:75], a[160:163], v[216:219], a[72:75]
  s_cmp_gt_u32 s50, 16
  v_exp_f32 v123, v123
  v_mfma_f32_16x16x32_bf16 a[76:79], a[160:163], v[220:223], a[76:79]
  ds_read_b128 a[144:147], v3 offset:8192
  v_cvt_pk_bf16_f32 v233, v122, v123
  v_mfma_f32_16x16x32_bf16 a[80:83], a[164:167], v[208:211], a[80:83]
  s_cselect_b32 s51, 0x8000, s51
  v_exp_f32 v152, v152
  v_mfma_f32_16x16x32_bf16 a[84:87], a[164:167], v[212:215], a[84:87]
  v_mfma_f32_16x16x32_bf16 a[88:91], a[164:167], v[216:219], a[88:91]
  s_lshl_b32 s51, s51, 15
  v_exp_f32 v153, v153
  v_mfma_f32_16x16x32_bf16 a[92:95], a[164:167], v[220:223], a[92:95]
  ds_read_b128 a[148:151], v3 offset:9216
  v_cvt_pk_bf16_f32 v234, v152, v153
  v_mfma_f32_16x16x32_bf16 a[96:99], a[168:171], v[208:211], a[96:99]
  s_add_u32 s42, s51, s40
  v_exp_f32 v154, v154
  v_mfma_f32_16x16x32_bf16 a[100:103], a[168:171], v[212:215], a[100:103]
  v_mfma_f32_16x16x32_bf16 a[104:107], a[168:171], v[216:219], a[104:107]
  s_add_u32 s50, s39, 2
  v_exp_f32 v155, v155
  v_mfma_f32_16x16x32_bf16 a[108:111], a[168:171], v[220:223], a[108:111]
  ds_read_b128 a[152:155], v3 offset:10240
  v_cvt_pk_bf16_f32 v235, v154, v155
  v_mfma_f32_16x16x32_bf16 a[112:115], a[172:175], v[208:211], a[112:115]
  s_lshl_b32 s51, s50, 1
  v_exp_f32 v124, v124
  v_mfma_f32_16x16x32_bf16 a[116:119], a[172:175], v[212:215], a[116:119]
  v_mfma_f32_16x16x32_bf16 a[120:123], a[172:175], v[216:219], a[120:123]
  s_waitcnt lgkmcnt(7)
  v_exp_f32 v125, v125
  v_mfma_f32_16x16x32_bf16 a[124:127], a[172:175], v[220:223], a[124:127]
  ds_read_b128 a[156:159], v3 offset:11264
  v_cvt_pk_bf16_f32 v236, v124, v125
  v_mfma_f32_16x16x32_bf16 v[80:83], a[176:179], v[32:35], v[240:243]
  s_sub_u32 s51, s51, s5
  v_exp_f32 v126, v126
  v_mfma_f32_16x16x32_bf16 v[80:83], a[180:183], v[64:67], v[80:83]
  v_mfma_f32_16x16x32_bf16 v[80:83], a[184:187], v[96:99], v[80:83]
  s_cmp_eq_u32 s50, s4
  v_exp_f32 v127, v127
  v_mfma_f32_16x16x32_bf16 v[80:83], a[188:191], v[128:131], v[80:83]
  ds_read_b128 a[160:163], v19 offset:12288
  v_cvt_pk_bf16_f32 v237, v126, v127
  v_mfma_f32_16x16x32_bf16 v[84:87], a[176:179], v[36:39], v[244:247]
  s_cselect_b32 s51, s6, s51
  v_exp_f32 v156, v156
  v_mfma_f32_16x16x32_bf16 v[84:87], a[180:183], v[68:71], v[84:87]
  v_mfma_f32_16x16x32_bf16 v[84:87], a[184:187], v[100:103], v[84:87]
  s_cmp_lt_u32 s50, s4
  v_exp_f32 v157, v157
  v_mfma_f32_16x16x32_bf16 v[84:87], a[188:191], v[132:135], v[84:87]
  ds_read_b128 a[164:167], v19 offset:13312
  v_cvt_pk_bf16_f32 v238, v156, v157
  v_mfma_f32_16x16x32_bf16 v[88:91], a[176:179], v[40:43], v[248:251]
  s_cselect_b32 s51, s50, s51
  v_exp_f32 v158, v158
  v_mfma_f32_16x16x32_bf16 v[88:91], a[180:183], v[72:75], v[88:91]
  v_mfma_f32_16x16x32_bf16 v[88:91], a[184:187], v[104:107], v[88:91]
  s_cmp_gt_u32 s50, 16
  v_exp_f32 v159, v159
  v_mfma_f32_16x16x32_bf16 v[88:91], a[188:191], v[136:139], v[88:91]
  ds_read_b128 a[168:171], v19 offset:14336
  v_cvt_pk_bf16_f32 v239, v158, v159
  v_mfma_f32_16x16x32_bf16 v[92:95], a[176:179], v[44:47], v[252:255]
  s_cselect_b32 s51, 0x8000, s51
  v_mfma_f32_16x16x32_bf16 v[92:95], a[180:183], v[76:79], v[92:95]
  s_lshl_b32 s51, s51, 15
  s_add_u32 s43, s51, s40
  v_mfma_f32_16x16x32_bf16 v[92:95], a[184:187], v[108:111], v[92:95]
  s_add_u32 s43, s43, 16384
  v_mfma_f32_16x16x32_bf16 v[92:95], a[188:191], v[140:143], v[92:95]
  ds_read_b128 a[172:175], v19 offset:15360
  v_mfma_f32_16x16x32_bf16 a[192:195], a[208:211], v[224:227], a[192:195]
  s_and_b32 s50, s39, 1
  v_exp_f32 v48, v48
  v_mfma_f32_16x16x32_bf16 a[196:199], a[208:211], v[228:231], a[196:199]
  ds_read_b128 a[176:179], v3 offset:12288
  v_mfma_f32_16x16x32_bf16 a[200:203], a[208:211], v[232:235], a[200:203]
  s_waitcnt lgkmcnt(9)
  v_exp_f32 v49, v49
  v_mfma_f32_16x16x32_bf16 a[204:207], a[208:211], v[236:239], a[204:207]
  ds_read_b128 a[180:183], v3 offset:13312
  v_cvt_pk_bf16_f32 v208, v48, v49
  v_mfma_f32_16x16x32_bf16 a[0:3], a[128:131], v[224:227], a[0:3]
  s_lshl_b32 s50, s50, 14
  v_exp_f32 v50, v50
  v_mfma_f32_16x16x32_bf16 a[4:7], a[128:131], v[228:231], a[4:7]
  ds_read_b128 a[184:187], v3 offset:14336
  v_mfma_f32_16x16x32_bf16 a[8:11], a[128:131], v[232:235], a[8:11]
  s_add_u32 s51, s39, 2
  v_exp_f32 v51, v51
  v_mfma_f32_16x16x32_bf16 a[12:15], a[128:131], v[236:239], a[12:15]
  ds_read_b128 a[188:191], v3 offset:15360
  v_cvt_pk_bf16_f32 v209, v50, v51
  v_mfma_f32_16x16x32_bf16 a[16:19], a[132:135], v[224:227], a[16:19]
  s_sub_u32 s51, s51, s49
  v_exp_f32 v80, v80
  v_mfma_f32_16x16x32_bf16 a[20:23], a[132:135], v[228:231], a[20:23]
  s_cmp_ge_i32 s51, 2
  s_cselect_b32 s46, s48, 0
  v_mfma_f32_16x16x32_bf16 a[24:27], a[132:135], v[232:235], a[24:27]
  s_add_u32 s46, s46, s50
  v_exp_f32 v81, v81
  v_mfma_f32_16x16x32_bf16 a[28:31], a[132:135], v[236:239], a[28:31]
  s_cmp_ge_i32 s51, 3
  v_cvt_pk_bf16_f32 v210, v80, v81
  v_mfma_f32_16x16x32_bf16 a[32:35], a[136:139], v[224:227], a[32:35]
  s_cselect_b32 s47, s48, 0
  v_exp_f32 v82, v82
  v_mfma_f32_16x16x32_bf16 a[36:39], a[136:139], v[228:231], a[36:39]
  s_xor_b32 s51, s50, 0x4000
  s_add_u32 s47, s47, s51
  v_mfma_f32_16x16x32_bf16 a[40:43], a[136:139], v[232:235], a[40:43]
  s_add_u32 s47, s47, 0x8000
  v_exp_f32 v83, v83
  v_mfma_f32_16x16x32_bf16 a[44:47], a[136:139], v[236:239], a[44:47]
  v_cvt_pk_bf16_f32 v211, v82, v83
  v_mfma_f32_16x16x32_bf16 a[48:51], a[140:143], v[224:227], a[48:51]
  s_add_u32 s58, s51, s41
  v_exp_f32 v52, v52
  v_mfma_f32_16x16x32_bf16 a[52:55], a[140:143], v[228:231], a[52:55]
  s_add_u32 s59, s50, s41
  s_add_u32 s59, s59, 0x8000
  v_mfma_f32_16x16x32_bf16 a[56:59], a[140:143], v[232:235], a[56:59]
  s_waitcnt lgkmcnt(8)
  v_exp_f32 v53, v53
  v_mfma_f32_16x16x32_bf16 a[60:63], a[140:143], v[236:239], a[60:63]
  s_waitcnt vmcnt(0) lgkmcnt(0)
  s_barrier
  v_cvt_pk_bf16_f32 v212, v52, v53
  v_mfma_f32_16x16x32_bf16 v[112:115], a[144:147], v[32:35], v[240:243]
  v_exp_f32 v54, v54
  v_mfma_f32_16x16x32_bf16 v[112:115], a[148:151], v[64:67], v[112:115]
  v_add_u32 v3, s46, v2
  v_add_u32 v19, s47, v2
  v_mfma_f32_16x16x32_bf16 v[112:115], a[152:155], v[96:99], v[112:115]
  v_exp_f32 v55, v55
  v_mfma_f32_16x16x32_bf16 v[112:115], a[156:159], v[128:131], v[112:115]
  ds_read_b128 a[128:131], v19 offset:0
  v_cvt_pk_bf16_f32 v213, v54, v55
  v_mfma_f32_16x16x32_bf16 v[116:119], a[144:147], v[36:39], v[244:247]
  s_mov_b32 m0, s58
  v_exp_f32 v84, v84
  v_mfma_f32_16x16x32_bf16 v[116:119], a[148:151], v[68:71], v[116:119]
  buffer_load_dwordx4 v2, s[16:19], s42 offen offset:0 sc1 lds
  v_mfma_f32_16x16x32_bf16 v[116:119], a[152:155], v[100:103], v[116:119]
  s_add_u32 s50, s39, 3
  v_exp_f32 v85, v85
  v_mfma_f32_16x16x32_bf16 v[116:119], a[156:159], v[132:135], v[116:119]
  ds_read_b128 a[132:135], v19 offset:1024
  v_cvt_pk_bf16_f32 v214, v84, v85
  v_mfma_f32_16x16x32_bf16 v[120:123], a[144:147], v[40:43], v[248:251]
  s_lshl_b32 s51, s50, 1
  v_exp_f32 v86, v86
  v_mfma_f32_16x16x32_bf16 v[120:123], a[148:151], v[72:75], v[120:123]
  buffer_load_dwordx4 v2, s[16:19], s42 offen offset:1024 sc1 lds
  v_mfma_f32_16x16x32_bf16 v[120:123], a[152:155], v[104:107], v[120:123]
  s_sub_u32 s51, s51, s5
  v_exp_f32 v87, v87
  v_mfma_f32_16x16x32_bf16 v[120:123], a[156:159], v[136:139], v[120:123]
  ds_read_b128 a[136:139], v19 offset:2048
  v_cvt_pk_bf16_f32 v215, v86, v87
  v_mfma_f32_16x16x32_bf16 v[124:127], a[144:147], v[44:47], v[252:255]
  s_cmp_eq_u32 s50, s4
  v_exp_f32 v56, v56
  v_mfma_f32_16x16x32_bf16 v[124:127], a[148:151], v[76:79], v[124:127]
  buffer_load_dwordx4 v2, s[16:19], s42 offen offset:2048 sc1 lds
  v_mfma_f32_16x16x32_bf16 v[124:127], a[152:155], v[108:111], v[124:127]
  v_exp_f32 v57, v57
  v_mfma_f32_16x16x32_bf16 v[124:127], a[156:159], v[140:143], v[124:127]
  ds_read_b128 a[140:143], v19 offset:3072
  v_cvt_pk_bf16_f32 v216, v56, v57
  v_mfma_f32_16x16x32_bf16 a[64:67], a[160:163], v[224:227], a[64:67]
  s_cselect_b32 s51, s6, s51
  v_exp_f32 v58, v58
  v_mfma_f32_16x16x32_bf16 a[68:71], a[160:163], v[228:231], a[68:71]
  buffer_load_dwordx4 v2, s[16:19], s42 offen offset:3072 sc1 lds
  v_mfma_f32_16x16x32_bf16 a[72:75], a[160:163], v[232:235], a[72:75]
  s_add_u32 s51, s51, 1
  v_exp_f32 v59, v59
  v_mfma_f32_16x16x32_bf16 a[76:79], a[160:163], v[236:239], a[76:79]
  ds_read_b128 a[144:147], v3 offset:0
  v_cvt_pk_bf16_f32 v217, v58, v59
  v_mfma_f32_16x16x32_bf16 a[80:83], a[164:167], v[224:227], a[80:83]
  s_mov_b32 m0, s59
  v_exp_f32 v88, v88
  v_mfma_f32_16x16x32_bf16 a[84:87], a[164:167], v[228:231], a[84:87]
  buffer_load_dwordx4 v2, s[16:19], s43 offen offset:0 sc1 lds
  v_mfma_f32_16x16x32_bf16 a[88:91], a[164:167], v[232:235], a[88:91]
  s_cmp_lt_u32 s50, s4
  v_exp_f32 v89, v89
  v_mfma_f32_16x16x32_bf16 a[92:95], a[164:167], v[236:239], a[92:95]
  ds_read_b128 a[148:151], v3 offset:1024
  v_cvt_pk_bf16_f32 v218, v88, v89
  v_mfma_f32_16x16x32_bf16 a[96:99], a[168:171], v[224:227], a[96:99]
  s_cselect_b32 s51, 0x8000, s51
  v_exp_f32 v90, v90
  v_mfma_f32_16x16x32_bf16 a[100:103], a[168:171], v[228:231], a[100:103]
  buffer_load_dwordx4 v2, s[16:19], s43 offen offset:1024 sc1 lds
  v_mfma_f32_16x16x32_bf16 a[104:107], a[168:171], v[232:235], a[104:107]
  s_cmp_gt_u32 s50, 16
  v_exp_f32 v91, v91
  v_mfma_f32_16x16x32_bf16 a[108:111], a[168:171], v[236:239], a[108:111]
  ds_read_b128 a[152:155], v3 offset:2048
  v_cvt_pk_bf16_f32 v219, v90, v91
  v_mfma_f32_16x16x32_bf16 a[112:115], a[172:175], v[224:227], a[112:115]
  s_cselect_b32 s51, 0x8000, s51
  v_exp_f32 v60, v60
  v_mfma_f32_16x16x32_bf16 a[116:119], a[172:175], v[228:231], a[116:119]
  buffer_load_dwordx4 v2, s[16:19], s43 offen offset:2048 sc1 lds
  v_mfma_f32_16x16x32_bf16 a[120:123], a[172:175], v[232:235], a[120:123]
  v_exp_f32 v61, v61
  v_mfma_f32_16x16x32_bf16 a[124:127], a[172:175], v[236:239], a[124:127]
  ds_read_b128 a[156:159], v3 offset:3072
  v_cvt_pk_bf16_f32 v220, v60, v61
  v_mfma_f32_16x16x32_bf16 v[144:147], a[176:179], v[32:35], v[240:243]
  s_lshl_b32 s51, s51, 15
  v_exp_f32 v62, v62
  v_mfma_f32_16x16x32_bf16 v[144:147], a[180:183], v[64:67], v[144:147]
  buffer_load_dwordx4 v2, s[16:19], s43 offen offset:3072 sc1 lds
  v_mfma_f32_16x16x32_bf16 v[144:147], a[184:187], v[96:99], v[144:147]
  s_add_u32 s44, s51, s40
  v_exp_f32 v63, v63
  v_mfma_f32_16x16x32_bf16 v[144:147], a[188:191], v[128:131], v[144:147]
  ds_read_b128 a[160:163], v19 offset:4096
  v_cvt_pk_bf16_f32 v221, v62, v63
  v_mfma_f32_16x16x32_bf16 v[148:151], a[176:179], v[36:39], v[244:247]
  s_add_u32 s50, s39, 2
  v_exp_f32 v92, v92
  v_mfma_f32_16x16x32_bf16 v[148:151], a[180:183], v[68:71], v[148:151]
  s_lshl_b32 s51, s50, 1
  s_sub_u32 s51, s51, s5
  v_mfma_f32_16x16x32_bf16 v[148:151], a[184:187], v[100:103], v[148:151]
  s_cmp_eq_u32 s50, s4
  v_exp_f32 v93, v93
  v_mfma_f32_16x16x32_bf16 v[148:151], a[188:191], v[132:135], v[148:151]
  ds_read_b128 a[164:167], v19 offset:5120
  v_cvt_pk_bf16_f32 v222, v92, v93
  v_mfma_f32_16x16x32_bf16 v[152:155], a[176:179], v[40:43], v[248:251]
  s_cselect_b32 s51, s6, s51
  v_exp_f32 v94, v94
  v_mfma_f32_16x16x32_bf16 v[152:155], a[180:183], v[72:75], v[152:155]
  s_add_u32 s51, s51, 1
  s_cmp_lt_u32 s50, s4
  v_mfma_f32_16x16x32_bf16 v[152:155], a[184:187], v[104:107], v[152:155]
  s_cselect_b32 s51, 0x8000, s51
  v_exp_f32 v95, v95
  v_mfma_f32_16x16x32_bf16 v[152:155], a[188:191], v[136:139], v[152:155]
  ds_read_b128 a[168:171], v19 offset:6144
  v_cvt_pk_bf16_f32 v223, v94, v95
  v_mfma_f32_16x16x32_bf16 v[156:159], a[176:179], v[44:47], v[252:255]
  s_cmp_gt_u32 s50, 16
  s_cselect_b32 s51, 0x8000, s51
  v_mfma_f32_16x16x32_bf16 v[156:159], a[180:183], v[76:79], v[156:159]
  s_lshl_b32 s51, s51, 15
  s_add_u32 s45, s51, s40
  v_mfma_f32_16x16x32_bf16 v[156:159], a[184:187], v[108:111], v[156:159]
  s_add_u32 s45, s45, 16384
  s_add_u32 s39, s39, 1
  v_mfma_f32_16x16x32_bf16 v[156:159], a[188:191], v[140:143], v[156:159]
  ds_read_b128 a[172:175], v19 offset:7168
  s_cmp_le_i32 s39, s54
  s_cbranch_scc1 L_main_d
  s_setpc_b64 s[52:53]
.p2align 6
L_w_main_s:
  s_setpc_b64 s[52:53]
L_w2_main_s:
  s_setpc_b64 s[56:57]
L_main_s:
  v_mfma_f32_16x16x32_bf16 a[192:195], a[208:211], v[208:211], a[192:195]
  v_exp_f32 v112, v112
  v_mfma_f32_16x16x32_bf16 a[196:199], a[208:211], v[212:215], a[196:199]
  v_mfma_f32_16x16x32_bf16 a[200:203], a[208:211], v[216:219], a[200:203]
  s_waitcnt lgkmcnt(8)
  v_exp_f32 v113, v113
  v_mfma_f32_16x16x32_bf16 a[204:207], a[208:211], v[220:223], a[204:207]
  ds_read_b128 a[176:179], v3 offset:4096
  v_cvt_pk_bf16_f32 v224, v112, v113
  v_mfma_f32_16x16x32_bf16 a[0:3], a[128:131], v[208:211], a[0:3]
  s_add_u32 m0, s58, 0x10000
  v_exp_f32 v114, v114
  v_mfma_f32_16x16x32_bf16 a[4:7], a[128:131], v[212:215], a[4:7]
  buffer_load_dwordx4 v2, s[16:19], s44 offen offset:0 sc1 lds
  v_mfma_f32_16x16x32_bf16 a[8:11], a[128:131], v[216:219], a[8:11]
  v_exp_f32 v115, v115
  v_mfma_f32_16x16x32_bf16 a[12:15], a[128:131], v[220:223], a[12:15]
  ds_read_b128 a[180:183], v3 offset:5120
  v_cvt_pk_bf16_f32 v225, v114, v115
  v_mfma_f32_16x16x32_bf16 a[16:19], a[132:135], v[208:211], a[16:19]
  v_exp_f32 v144, v144
  v_mfma_f32_16x16x32_bf16 a[20:23], a[132:135], v[212:215], a[20:23]
  buffer_load_dwordx4 v2, s[16:19], s44 offen offset:1024 sc1 lds
  v_mfma_f32_16x16x32_bf16 a[24:27], a[132:135], v[216:219], a[24:27]
  v_exp_f32 v145, v145
  v_mfma_f32_16x16x32_bf16 a[28:31], a[132:135], v[220:223], a[28:31]
  ds_read_b128 a[184:187], v3 offset:6144
  v_cvt_pk_bf16_f32 v226, v144, v145
  v_mfma_f32_16x16x32_bf16 a[32:35], a[136:139], v[208:211], a[32:35]
  v_exp_f32 v146, v146
  v_mfma_f32_16x16x32_bf16 a[36:39], a[136:139], v[212:215], a[36:39]
  buffer_load_dwordx4 v2, s[16:19], s44 offen offset:2048 sc1 lds
  v_mfma_f32_16x16x32_bf16 a[40:43], a[136:139], v[216:219], a[40:43]
  v_exp_f32 v147, v147
  v_mfma_f32_16x16x32_bf16 a[44:47], a[136:139], v[220:223], a[44:47]
  ds_read_b128 a[188:191], v3 offset:7168
  v_cvt_pk_bf16_f32 v227, v146, v147
  v_mfma_f32_16x16x32_bf16 a[48:51], a[140:143], v[208:211], a[48:51]
  v_exp_f32 v116, v116
  v_mfma_f32_16x16x32_bf16 a[52:55], a[140:143], v[212:215], a[52:55]
  buffer_load_dwordx4 v2, s[16:19], s44 offen offset:3072 sc1 lds
  v_mfma_f32_16x16x32_bf16 a[56:59], a[140:143], v[216:219], a[56:59]
  s_waitcnt lgkmcnt(8)
  v_exp_f32 v117, v117
  v_mfma_f32_16x16x32_bf16 a[60:63], a[140:143], v[220:223], a[60:63]
  v_cvt_pk_bf16_f32 v228, v116, v117
  v_mfma_f32_16x16x32_bf16 v[48:51], a[144:147], v[32:35], v[240:243]
  s_add_u32 m0, s59, 0x10000
  v_exp_f32 v118, v118
  v_mfma_f32_16x16x32_bf16 v[48:51], a[148:151], v[64:67], v[48:51]
  buffer_load_dwordx4 v2, s[16:19], s45 offen offset:0 sc1 lds
  v_mfma_f32_16x16x32_bf16 v[48:51], a[152:155], v[96:99], v[48:51]
  s_add_u32 s50, s39, 3
  v_exp_f32 v119, v119
  v_mfma_f32_16x16x32_bf16 v[48:51], a[156:159], v[128:131], v[48:51]
  ds_read_b128 a[128:131], v19 offset:8192
  v_cvt_pk_bf16_f32 v229, v118, v119
  v_mfma_f32_16x16x32_bf16 v[52:55], a[144:147], v[36:39], v[244:247]
  s_lshl_b32 s51, s50, 1
  v_exp_f32 v148, v148
  v_mfma_f32_16x16x32_bf16 v[52:55], a[148:151], v[68:71], v[52:55]
  buffer_load_dwordx4 v2, s[16:19], s45 offen offset:1024 sc1 lds
  v_mfma_f32_16x16x32_bf16 v[52:55], a[152:155], v[100:103], v[52:55]
  s_sub_u32 s51, s51, s5
  v_exp_f32 v149, v149
  v_mfma_f32_16x16x32_bf16 v[52:55], a[156:159], v[132:135], v[52:55]
  ds_read_b128 a[132:135], v19 offset:9216
  v_cvt_pk_bf16_f32 v230, v148, v149
  v_mfma_f32_16x16x32_bf16 v[56:59], a[144:147], v[40:43], v[248:251]
  s_cmp_eq_u32 s50, s4
  v_exp_f32 v150, v150
  v_mfma_f32_16x16x32_bf16 v[56:59], a[148:151], v[72:75], v[56:59]
  buffer_load_dwordx4 v2, s[16:19], s45 offen offset:2048 sc1 lds
  v_mfma_f32_16x16x32_bf16 v[56:59], a[152:155], v[104:107], v[56:59]
  s_cselect_b32 s51, s6, s51
  v_exp_f32 v151, v151
  v_mfma_f32_16x16x32_bf16 v[56:59], a[156:159], v[136:139], v[56:59]
  ds_read_b128 a[136:139], v19 offset:10240
  v_cvt_pk_bf16_f32 v231, v150, v151
  v_mfma_f32_16x16x32_bf16 v[60:63], a[144:147], v[44:47], v[252:255]
  s_cmp_lt_u32 s50, s4
  v_exp_f32 v120, v120
  v_mfma_f32_16x16x32_bf16 v[60:63], a[148:151], v[76:79], v[60:63]
  buffer_load_dwordx4 v2, s[16:19], s45 offen offset:3072 sc1 lds
  v_mfma_f32_16x16x32_bf16 v[60:63], a[152:155], v[108:111], v[60:63]
  s_waitcnt lgkmcnt(7)
  v_exp_f32 v121, v121
  v_mfma_f32_16x16x32_bf16 v[60:63], a[156:159], v[140:143], v[60:63]
  ds_read_b128 a[140:143], v19 offset:11264
  v_cvt_pk_bf16_f32 v232, v120, v121
  v_mfma_f32_16x16x32_bf16 a[64:67], a[160:163], v[208:211], a[64:67]
  s_cselect_b32 s51, s50, s51
  v_exp_f32 v122, v122
  v_mfma_f32_16x16x32_bf16 a[68:71], a[160:163], v[212:215], a[68:71]
  global_load_dwordx4 v[12:15], v16, s[62:63]
  v_mfma_f32_16x16x32_bf16 a[72:75], a[160:163], v[216:219], a[72:75]
  s_cmp_gt_u32 s50, 16
  v_exp_f32 v123, v123
  v_mfma_f32_16x16x32_bf16 a[76:79], a[160:163], v[220:223], a[76:79]
  ds_read_b128 a[144:147], v3 offset:8192
  v_cvt_pk_bf16_f32 v233, v122, v123
  v_mfma_f32_16x16x32_bf16 a[80:83], a[164:167], v[208:211], a[80:83]
  s_cselect_b32 s51, 0x8000, s51
  v_exp_f32 v152, v152
  v_mfma_f32_16x16x32_bf16 a[84:87], a[164:167], v[212:215], a[84:87]
  v_mfma_f32_16x16x32_bf16 a[88:91], a[164:167], v[216:219], a[88:91]
  s_lshl_b32 s51, s51, 15
  v_exp_f32 v153, v153
  v_mfma_f32_16x16x32_bf16 a[92:95], a[164:167], v[220:223], a[92:95]
  ds_read_b128 a[148:151], v3 offset:9216
  v_cvt_pk_bf16_f32 v234, v152, v153
  v_mfma_f32_16x16x32_bf16 a[96:99], a[168:171], v[208:211], a[96:99]
  s_add_u32 s42, s51, s40
  v_exp_f32 v154, v154
  v_mfma_f32_16x16x32_bf16 a[100:103], a[168:171], v[212:215], a[100:103]
  v_mfma_f32_16x16x32_bf16 a[104:107], a[168:171], v[216:219], a[104:107]
  s_add_u32 s50, s39, 2
  v_exp_f32 v155, v155
  v_mfma_f32_16x16x32_bf16 a[108:111], a[168:171], v[220:223], a[108:111]
  ds_read_b128 a[152:155], v3 offset:10240
  v_cvt_pk_bf16_f32 v235, v154, v155
  v_mfma_f32_16x16x32_bf16 a[112:115], a[172:175], v[208:211], a[112:115]
  s_lshl_b32 s51, s50, 1
  v_exp_f32 v124, v124
  v_mfma_f32_16x16x32_bf16 a[116:119], a[172:175], v[212:215], a[116:119]
  v_mfma_f32_16x16x32_bf16 a[120:123], a[172:175], v[216:219], a[120:123]
  s_waitcnt lgkmcnt(7)
  v_exp_f32 v125, v125
  v_mfma_f32_16x16x32_bf16 a[124:127], a[172:175], v[220:223], a[124:127]
  ds_read_b128 a[156:159], v3 offset:11264
  v_cvt_pk_bf16_f32 v236, v124, v125
  v_mfma_f32_16x16x32_bf16 v[80:83], a[176:179], v[32:35], v[240:243]
  s_sub_u32 s51, s51, s5
  v_exp_f32 v126, v126
  v_mfma_f32_16x16x32_bf16 v[80:83], a[180:183], v[64:67], v[80:83]
  v_mfma_f32_16x16x32_bf16 v[80:83], a[184:187], v[96:99], v[80:83]
  s_cmp_eq_u32 s50, s4
  v_exp_f32 v127, v127
  v_mfma_f32_16x16x32_bf16 v[80:83], a[188:191], v[128:131], v[80:83]
  ds_read_b128 a[160:163], v19 offset:12288
  v_cvt_pk_bf16_f32 v237, v126, v127
  v_mfma_f32_16x16x32_bf16 v[84:87], a[176:179], v[36:39], v[244:247]
  s_cselect_b32 s51, s6, s51
  v_exp_f32 v156, v156
  v_mfma_f32_16x16x32_bf16 v[84:87], a[180:183], v[68:71], v[84:87]
  v_mfma_f32_16x16x32_bf16 v[84:87], a[184:187], v[100:103], v[84:87]
  s_cmp_lt_u32 s50, s4
  v_exp_f32 v157, v157
  v_mfma_f32_16x16x32_bf16 v[84:87], a[188:191], v[132:135], v[84:87]
  ds_read_b128 a[164:167], v19 offset:13312
  v_cvt_pk_bf16_f32 v238, v156, v157
  v_mfma_f32_16x16x32_bf16 v[88:91], a[176:179], v[40:43], v[248:251]
  s_cselect_b32 s51, s50, s51
  v_exp_f32 v158, v158
  v_mfma_f32_16x16x32_bf16 v[88:91], a[180:183], v[72:75], v[88:91]
  v_mfma_f32_16x16x32_bf16 v[88:91], a[184:187], v[104:107], v[88:91]
  s_cmp_gt_u32 s50, 16
  v_exp_f32 v159, v159
  v_mfma_f32_16x16x32_bf16 v[88:91], a[188:191], v[136:139], v[88:91]
  ds_read_b128 a[168:171], v19 offset:14336
  v_cvt_pk_bf16_f32 v239, v158, v159
  v_mfma_f32_16x16x32_bf16 v[92:95], a[176:179], v[44:47], v[252:255]
  s_cselect_b32 s51, 0x8000, s51
  v_mfma_f32_16x16x32_bf16 v[92:95], a[180:183], v[76:79], v[92:95]
  s_lshl_b32 s51, s51, 15
  s_add_u32 s43, s51, s40
  v_mfma_f32_16x16x32_bf16 v[92:95], a[184:187], v[108:111], v[92:95]
  s_add_u32 s43, s43, 16384
  v_mfma_f32_16x16x32_bf16 v[92:95], a[188:191], v[140:143], v[92:95]
  ds_read_b128 a[172:175], v19 offset:15360
  v_mfma_f32_16x16x32_bf16 a[192:195], a[208:211], v[224:227], a[192:195]
  s_and_b32 s50, s39, 1
  v_exp_f32 v48, v48
  v_mfma_f32_16x16x32_bf16 a[196:199], a[208:211], v[228:231], a[196:199]
  ds_read_b128 a[176:179], v3 offset:12288
  v_mfma_f32_16x16x32_bf16 a[200:203], a[208:211], v[232:235], a[200:203]
  s_waitcnt lgkmcnt(9)
  v_exp_f32 v49, v49
  v_mfma_f32_16x16x32_bf16 a[204:207], a[208:211], v[236:239], a[204:207]
  ds_read_b128 a[180:183], v3 offset:13312
  v_cvt_pk_bf16_f32 v208, v48, v49
  v_mfma_f32_16x16x32_bf16 a[0:3], a[128:131], v[224:227], a[0:3]
  s_lshl_b32 s50, s50, 14
  v_exp_f32 v50, v50
  v_mfma_f32_16x16x32_bf16 a[4:7], a[128:131], v[228:231], a[4:7]
  ds_read_b128 a[184:187], v3 offset:14336
  v_mfma_f32_16x16x32_bf16 a[8:11], a[128:131], v[232:235], a[8:11]
  s_add_u32 s51, s39, 2
  v_exp_f32 v51, v51
  v_mfma_f32_16x16x32_bf16 a[12:15], a[128:131], v[236:239], a[12:15]
  ds_read_b128 a[188:191], v3 offset:15360
  v_cvt_pk_bf16_f32 v209, v50, v51
  v_mfma_f32_16x16x32_bf16 a[16:19], a[132:135], v[224:227], a[16:19]
  s_sub_u32 s51, s51, s49
  v_exp_f32 v80, v80
  v_mfma_f32_16x16x32_bf16 a[20:23], a[132:135], v[228:231], a[20:23]
  s_cmp_ge_i32 s51, 2
  s_cselect_b32 s46, s48, 0
  v_mfma_f32_16x16x32_bf16 a[24:27], a[132:135], v[232:235], a[24:27]
  s_add_u32 s46, s46, s50
  v_exp_f32 v81, v81
  v_mfma_f32_16x16x32_bf16 a[28:31], a[132:135], v[236:239], a[28:31]
  s_cmp_ge_i32 s51, 3
  v_cvt_pk_bf16_f32 v210, v80, v81
  v_mfma_f32_16x16x32_bf16 a[32:35], a[136:139], v[224:227], a[32:35]
  s_cselect_b32 s47, s48, 0
  v_exp_f32 v82, v82
  v_mfma_f32_16x16x32_bf16 a[36:39], a[136:139], v[228:231], a[36:39]
  s_xor_b32 s51, s50, 0x4000
  s_add_u32 s47, s47, s51
  v_mfma_f32_16x16x32_bf16 a[40:43], a[136:139], v[232:235], a[40:43]
  s_add_u32 s47, s47, 0x8000
  v_exp_f32 v83, v83
  v_mfma_f32_16x16x32_bf16 a[44:47], a[136:139], v[236:239], a[44:47]
  v_cvt_pk_bf16_f32 v211, v82, v83
  v_mfma_f32_16x16x32_bf16 a[48:51], a[140:143], v[224:227], a[48:51]
  s_add_u32 s58, s51, s41
  v_exp_f32 v52, v52
  v_mfma_f32_16x16x32_bf16 a[52:55], a[140:143], v[228:231], a[52:55]
  s_add_u32 s59, s50, s41
  s_add_u32 s59, s59, 0x8000
  v_mfma_f32_16x16x32_bf16 a[56:59], a[140:143], v[232:235], a[56:59]
  s_waitcnt lgkmcnt(8)
  v_exp_f32 v53, v53
  v_mfma_f32_16x16x32_bf16 a[60:63], a[140:143], v[236:239], a[60:63]
  s_waitcnt vmcnt(0) lgkmcnt(0)
  s_barrier
  v_cvt_pk_bf16_f32 v212, v52, v53
  v_mfma_f32_16x16x32_bf16 v[112:115], a[144:147], v[32:35], v[240:243]
  v_exp_f32 v54, v54
  v_mfma_f32_16x16x32_bf16 v[112:115], a[148:151], v[64:67], v[112:115]
  v_add_u32 v3, s46, v2
  v_add_u32 v19, s47, v2
  v_mfma_f32_16x16x32_bf16 v[112:115], a[152:155], v[96:99], v[112:115]
  v_exp_f32 v55, v55
  v_mfma_f32_16x16x32_bf16 v[112:115], a[156:159], v[128:131], v[112:115]
  ds_read_b128 a[128:131], v19 offset:0
  v_cvt_pk_bf16_f32 v213, v54, v55
  v_mfma_f32_16x16x32_bf16 v[116:119], a[144:147], v[36:39], v[244:247]
  s_mov_b32 m0, s58
  v_exp_f32 v84, v84
  v_mfma_f32_16x16x32_bf16 v[116:119], a[148:151], v[68:71], v[116:119]
  buffer_load_dwordx4 v2, s[16:19], s42 offen offset:0 sc1 lds
  v_mfma_f32_16x16x32_bf16 v[116:119], a[152:155], v[100:103], v[116:119]
  s_add_u32 s50, s39, 3
  v_exp_f32 v85, v85
  v_mfma_f32_16x16x32_bf16 v[116:119], a[156:159], v[132:135], v[116:119]
  ds_read_b128 a[132:135], v19 offset:1024
  v_cvt_pk_bf16_f32 v214, v84, v85
  v_mfma_f32_16x16x32_bf16 v[120:123], a[144:147], v[40:43], v[248:251]
  s_lshl_b32 s51, s50, 1
  v_exp_f32 v86, v86
  v_mfma_f32_16x16x32_bf16 v[120:123], a[148:151], v[72:75], v[120:123]
  buffer_load_dwordx4 v2, s[16:19], s42 offen offset:1024 sc1 lds
  v_mfma_f32_16x16x32_bf16 v[120:123], a[152:155], v[104:107], v[120:123]
  s_sub_u32 s51, s51, s5
  v_exp_f32 v87, v87
  v_mfma_f32_16x16x32_bf16 v[120:123], a[156:159], v[136:139], v[120:123]
  ds_read_b128 a[136:139], v19 offset:2048
  v_cvt_pk_bf16_f32 v215, v86, v87
  v_mfma_f32_16x16x32_bf16 v[124:127], a[144:147], v[44:47], v[252:255]
  s_cmp_eq_u32 s50, s4
  v_exp_f32 v56, v56
  v_mfma_f32_16x16x32_bf16 v[124:127], a[148:151], v[76:79], v[124:127]
  buffer_load_dwordx4 v2, s[16:19], s42 offen offset:2048 sc1 lds
  v_mfma_f32_16x16x32_bf16 v[124:127], a[152:155], v[108:111], v[124:127]
  v_exp_f32 v57, v57
  v_mfma_f32_16x16x32_bf16 v[124:127], a[156:159], v[140:143], v[124:127]
  ds_read_b128 a[140:143], v19 offset:3072
  v_cvt_pk_bf16_f32 v216, v56, v57
  v_mfma_f32_16x16x32_bf16 a[64:67], a[160:163], v[224:227], a[64:67]
  s_cselect_b32 s51, s6, s51
  v_exp_f32 v58, v58
  v_mfma_f32_16x16x32_bf16 a[68:71], a[160:163], v[228:231], a[68:71]
  buffer_load_dwordx4 v2, s[16:19], s42 offen offset:3072 sc1 lds
  v_mfma_f32_16x16x32_bf16 a[72:75], a[160:163], v[232:235], a[72:75]
  s_add_u32 s51, s51, 1
  v_exp_f32 v59, v59
  v_mfma_f32_16x16x32_bf16 a[76:79], a[160:163], v[236:239], a[76:79]
  ds_read_b128 a[144:147], v3 offset:0
  v_cvt_pk_bf16_f32 v217, v58, v59
  v_mfma_f32_16x16x32_bf16 a[80:83], a[164:167], v[224:227], a[80:83]
  s_mov_b32 m0, s59
  v_exp_f32 v88, v88
  v_mfma_f32_16x16x32_bf16 a[84:87], a[164:167], v[228:231], a[84:87]
  buffer_load_dwordx4 v2, s[16:19], s43 offen offset:0 sc1 lds
  v_mfma_f32_16x16x32_bf16 a[88:91], a[164:167], v[232:235], a[88:91]
  s_cmp_lt_u32 s50, s4
  v_exp_f32 v89, v89
  v_mfma_f32_16x16x32_bf16 a[92:95], a[164:167], v[236:239], a[92:95]
  ds_read_b128 a[148:151], v3 offset:1024
  v_cvt_pk_bf16_f32 v218, v88, v89
  v_mfma_f32_16x16x32_bf16 a[96:99], a[168:171], v[224:227], a[96:99]
  s_cselect_b32 s51, 0x8000, s51
  v_exp_f32 v90, v90
  v_mfma_f32_16x16x32_bf16 a[100:103], a[168:171], v[228:231], a[100:103]
  buffer_load_dwordx4 v2, s[16:19], s43 offen offset:1024 sc1 lds
  v_mfma_f32_16x16x32_bf16 a[104:107], a[168:171], v[232:235], a[104:107]
  s_cmp_gt_u32 s50, 16
  v_exp_f32 v91, v91
  v_mfma_f32_16x16x32_bf16 a[108:111], a[168:171], v[236:239], a[108:111]
  ds_read_b128 a[152:155], v3 offset:2048
  v_cvt_pk_bf16_f32 v219, v90, v91
  v_mfma_f32_16x16x32_bf16 a[112:115], a[172:175], v[224:227], a[112:115]
  s_cselect_b32 s51, 0x8000, s51
  v_exp_f32 v60, v60
  v_mfma_f32_16x16x32_bf16 a[116:119], a[172:175], v[228:231], a[116:119]
  buffer_load_dwordx4 v2, s[16:19], s43 offen offset:2048 sc1 lds
  v_mfma_f32_16x16x32_bf16 a[120:123], a[172:175], v[232:235], a[120:123]
  v_exp_f32 v61, v61
  v_mfma_f32_16x16x32_bf16 a[124:127], a[172:175], v[236:239], a[124:127]
  ds_read_b128 a[156:159], v3 offset:3072
  v_cvt_pk_bf16_f32 v220, v60, v61
  v_mfma_f32_16x16x32_bf16 v[144:147], a[176:179], v[32:35], v[240:243]
  s_lshl_b32 s51, s51, 15
  v_exp_f32 v62, v62
  v_mfma_f32_16x16x32_bf16 v[144:147], a[180:183], v[64:67], v[144:147]
  buffer_load_dwordx4 v2, s[16:19], s43 offen offset:3072 sc1 lds
  v_mfma_f32_16x16x32_bf16 v[144:147], a[184:187], v[96:99], v[144:147]
  s_add_u32 s44, s51, s40
  v_exp_f32 v63, v63
  v_mfma_f32_16x16x32_bf16 v[144:147], a[188:191], v[128:131], v[144:147]
  ds_read_b128 a[160:163], v19 offset:4096
  v_cvt_pk_bf16_f32 v221, v62, v63
  v_mfma_f32_16x16x32_bf16 v[148:151], a[176:179], v[36:39], v[244:247]
  s_add_u32 s50, s39, 2
  v_exp_f32 v92, v92
  v_mfma_f32_16x16x32_bf16 v[148:151], a[180:183], v[68:71], v[148:151]
  s_lshl_b32 s51, s50, 1
  s_sub_u32 s51, s51, s5
  v_mfma_f32_16x16x32_bf16 v[148:151], a[184:187], v[100:103], v[148:151]
  s_cmp_eq_u32 s50, s4
  v_exp_f32 v93, v93
  v_mfma_f32_16x16x32_bf16 v[148:151], a[188:191], v[132:135], v[148:151]
  ds_read_b128 a[164:167], v19 offset:5120
  v_cvt_pk_bf16_f32 v222, v92, v93
  v_mfma_f32_16x16x32_bf16 v[152:155], a[176:179], v[40:43], v[248:251]
  s_cselect_b32 s51, s6, s51
  v_exp_f32 v94, v94
  v_mfma_f32_16x16x32_bf16 v[152:155], a[180:183], v[72:75], v[152:155]
  s_add_u32 s51, s51, 1
  s_cmp_lt_u32 s50, s4
  v_mfma_f32_16x16x32_bf16 v[152:155], a[184:187], v[104:107], v[152:155]
  s_cselect_b32 s51, 0x8000, s51
  v_exp_f32 v95, v95
  v_mfma_f32_16x16x32_bf16 v[152:155], a[188:191], v[136:139], v[152:155]
  ds_read_b128 a[168:171], v19 offset:6144
  v_cvt_pk_bf16_f32 v223, v94, v95
  v_mfma_f32_16x16x32_bf16 v[156:159], a[176:179], v[44:47], v[252:255]
  s_cmp_gt_u32 s50, 16
  s_cselect_b32 s51, 0x8000, s51
  v_mfma_f32_16x16x32_bf16 v[156:159], a[180:183], v[76:79], v[156:159]
  s_lshl_b32 s51, s51, 15
  s_add_u32 s45, s51, s40
  v_mfma_f32_16x16x32_bf16 v[156:159], a[184:187], v[108:111], v[156:159]
  s_add_u32 s45, s45, 16384
  s_add_u32 s39, s39, 1
  v_mfma_f32_16x16x32_bf16 v[156:159], a[188:191], v[140:143], v[156:159]
  ds_read_b128 a[172:175], v19 offset:7168
  s_cmp_le_i32 s39, s54
  s_cbranch_scc1 L_main_s
  s_setpc_b64 s[52:53]
.p2align 6
L_w_b_full_full_1fd:
  s_setpc_b64 s[52:53]
L_w2_b_full_full_1fd:
  s_setpc_b64 s[56:57]
L_b_full_full_1fd:
  v_mfma_f32_16x16x32_bf16 a[192:195], a[208:211], v[208:211], 0
  v_exp_f32 v112, v112
  v_mfma_f32_16x16x32_bf16 a[196:199], a[208:211], v[212:215], 0
  v_mfma_f32_16x16x32_bf16 a[200:203], a[208:211], v[216:219], 0
  s_waitcnt lgkmcnt(8)
  v_exp_f32 v113, v113
  v_mfma_f32_16x16x32_bf16 a[204:207], a[208:211], v[220:223], 0
  ds_read_b128 a[176:179], v3 offset:4096
  v_cvt_pk_bf16_f32 v224, v112, v113
  v_mfma_f32_16x16x32_bf16 a[0:3], a[128:131], v[208:211], 0
  v_exp_f32 v114, v114
  v_mfma_f32_16x16x32_bf16 a[4:7], a[128:131], v[212:215], 0
  v_mfma_f32_16x16x32_bf16 a[8:11], a[128:131], v[216:219], 0
  v_exp_f32 v115, v115
  v_mfma_f32_16x16x32_bf16 a[12:15], a[128:131], v[220:223], 0
  ds_read_b128 a[180:183], v3 offset:5120
  v_cvt_pk_bf16_f32 v225, v114, v115
  v_mfma_f32_16x16x32_bf16 a[16:19], a[132:135], v[208:211], 0
  v_exp_f32 v144, v144
  v_mfma_f32_16x16x32_bf16 a[20:23], a[132:135], v[212:215], 0
  v_mfma_f32_16x16x32_bf16 a[24:27], a[132:135], v[216:219], 0
  v_exp_f32 v145, v145
  v_mfma_f32_16x16x32_bf16 a[28:31], a[132:135], v[220:223], 0
  ds_read_b128 a[184:187], v3 offset:6144
  v_cvt_pk_bf16_f32 v226, v144, v145
  v_mfma_f32_16x16x32_bf16 a[32:35], a[136:139], v[208:211], 0
  v_exp_f32 v146, v146
  v_mfma_f32_16x16x32_bf16 a[36:39], a[136:139], v[212:215], 0
  v_mfma_f32_16x16x32_bf16 a[40:43], a[136:139], v[216:219], 0
  v_exp_f32 v147, v147
  v_mfma_f32_16x16x32_bf16 a[44:47], a[136:139], v[220:223], 0
  ds_read_b128 a[188:191], v3 offset:7168
  v_cvt_pk_bf16_f32 v227, v146, v147
  v_mfma_f32_16x16x32_bf16 a[48:51], a[140:143], v[208:211], 0
  v_exp_f32 v116, v116
  v_mfma_f32_16x16x32_bf16 a[52:55], a[140:143], v[212:215], 0
  v_mfma_f32_16x16x32_bf16 a[56:59], a[140:143], v[216:219], 0
  s_waitcnt lgkmcnt(8)
  v_exp_f32 v117, v117
  v_mfma_f32_16x16x32_bf16 a[60:63], a[140:143], v[220:223], 0
  v_cvt_pk_bf16_f32 v228, v116, v117
  v_mfma_f32_16x16x32_bf16 v[48:51], a[144:147], v[32:35], v[240:243]
  v_exp_f32 v118, v118
  v_mfma_f32_16x16x32_bf16 v[48:51], a[148:151], v[64:67], v[48:51]
  v_mfma_f32_16x16x32_bf16 v[48:51], a[152:155], v[96:99], v[48:51]
  s_add_u32 s50, s39, 3
  v_exp_f32 v119, v119
  v_mfma_f32_16x16x32_bf16 v[48:51], a[156:159], v[128:131], v[48:51]
  ds_read_b128 a[128:131], v19 offset:8192
  v_cvt_pk_bf16_f32 v229, v118, v119
  v_mfma_f32_16x16x32_bf16 v[52:55], a[144:147], v[36:39], v[244:247]
  s_lshl_b32 s51, s50, 1
  v_exp_f32 v148, v148
  v_mfma_f32_16x16x32_bf16 v[52:55], a[148:151], v[68:71], v[52:55]
  v_mfma_f32_16x16x32_bf16 v[52:55], a[152:155], v[100:103], v[52:55]
  s_sub_u32 s51, s51, s5
  v_exp_f32 v149, v149
  v_mfma_f32_16x16x32_bf16 v[52:55], a[156:159], v[132:135], v[52:55]
  ds_read_b128 a[132:135], v19 offset:9216
  v_cvt_pk_bf16_f32 v230, v148, v149
  v_mfma_f32_16x16x32_bf16 v[56:59], a[144:147], v[40:43], v[248:251]
  s_cmp_eq_u32 s50, s4
  v_exp_f32 v150, v150
  v_mfma_f32_16x16x32_bf16 v[56:59], a[148:151], v[72:75], v[56:59]
  v_mfma_f32_16x16x32_bf16 v[56:59], a[152:155], v[104:107], v[56:59]
  s_cselect_b32 s51, s6, s51
  v_exp_f32 v151, v151
  v_mfma_f32_16x16x32_bf16 v[56:59], a[156:159], v[136:139], v[56:59]
  ds_read_b128 a[136:139], v19 offset:10240
  v_cvt_pk_bf16_f32 v231, v150, v151
  v_mfma_f32_16x16x32_bf16 v[60:63], a[144:147], v[44:47], v[252:255]
  s_cmp_lt_u32 s50, s4
  v_exp_f32 v120, v120
  v_mfma_f32_16x16x32_bf16 v[60:63], a[148:151], v[76:79], v[60:63]
  v_mfma_f32_16x16x32_bf16 v[60:63], a[152:155], v[108:111], v[60:63]
  s_waitcnt lgkmcnt(7)
  v_exp_f32 v121, v121
  v_mfma_f32_16x16x32_bf16 v[60:63], a[156:159], v[140:143], v[60:63]
  ds_read_b128 a[140:143], v19 offset:11264
  v_cvt_pk_bf16_f32 v232, v120, v121
  v_mfma_f32_16x16x32_bf16 a[64:67], a[160:163], v[208:211], 0
  s_cselect_b32 s51, s50, s51
  v_exp_f32 v122, v122
  v_mfma_f32_16x16x32_bf16 a[68:71], a[160:163], v[212:215], 0
  v_mfma_f32_16x16x32_bf16 a[72:75], a[160:163], v[216:219], 0
  s_cmp_gt_u32 s50, 16
  v_exp_f32 v123, v123
  v_mfma_f32_16x16x32_bf16 a[76:79], a[160:163], v[220:223], 0
  ds_read_b128 a[144:147], v3 offset:8192
  v_cvt_pk_bf16_f32 v233, v122, v123
  v_mfma_f32_16x16x32_bf16 a[80:83], a[164:167], v[208:211], 0
  s_cselect_b32 s51, 0x8000, s51
  v_exp_f32 v152, v152
  v_mfma_f32_16x16x32_bf16 a[84:87], a[164:167], v[212:215], 0
  v_mfma_f32_16x16x32_bf16 a[88:91], a[164:167], v[216:219], 0
  s_lshl_b32 s51, s51, 15
  v_exp_f32 v153, v153
  v_mfma_f32_16x16x32_bf16 a[92:95], a[164:167], v[220:223], 0
  ds_read_b128 a[148:151], v3 offset:9216
  v_cvt_pk_bf16_f32 v234, v152, v153
  v_mfma_f32_16x16x32_bf16 a[96:99], a[168:171], v[208:211], 0
  s_add_u32 s42, s51, s40
  v_exp_f32 v154, v154
  v_mfma_f32_16x16x32_bf16 a[100:103], a[168:171], v[212:215], 0
  v_mfma_f32_16x16x32_bf16 a[104:107], a[168:171], v[216:219], 0
  s_add_u32 s50, s39, 2
  v_exp_f32 v155, v155
  v_mfma_f32_16x16x32_bf16 a[108:111], a[168:171], v[220:223], 0
  ds_read_b128 a[152:155], v3 offset:10240
  v_cvt_pk_bf16_f32 v235, v154, v155
  v_mfma_f32_16x16x32_bf16 a[112:115], a[172:175], v[208:211], 0
  s_lshl_b32 s51, s50, 1
  v_exp_f32 v124, v124
  v_mfma_f32_16x16x32_bf16 a[116:119], a[172:175], v[212:215], 0
  v_mfma_f32_16x16x32_bf16 a[120:123], a[172:175], v[216:219], 0
  s_waitcnt lgkmcnt(7)
  v_exp_f32 v125, v125
  v_mfma_f32_16x16x32_bf16 a[124:127], a[172:175], v[220:223], 0
  ds_read_b128 a[156:159], v3 offset:11264
  v_cvt_pk_bf16_f32 v236, v124, v125
  v_mfma_f32_16x16x32_bf16 v[80:83], a[176:179], v[32:35], v[240:243]
  s_sub_u32 s51, s51, s5
  v_exp_f32 v126, v126
  v_mfma_f32_16x16x32_bf16 v[80:83], a[180:183], v[64:67], v[80:83]
  v_mfma_f32_16x16x32_bf16 v[80:83], a[184:187], v[96:99], v[80:83]
  s_cmp_eq_u32 s50, s4
  v_exp_f32 v127, v127
  v_mfma_f32_16x16x32_bf16 v[80:83], a[188:191], v[128:131], v[80:83]
  ds_read_b128 a[160:163], v19 offset:12288
  v_cvt_pk_bf16_f32 v237, v126, v127
  v_mfma_f32_16x16x32_bf16 v[84:87], a[176:179], v[36:39], v[244:247]
  s_cselect_b32 s51, s6, s51
  v_exp_f32 v156, v156
  v_mfma_f32_16x16x32_bf16 v[84:87], a[180:183], v[68:71], v[84:87]
  v_mfma_f32_16x16x32_bf16 v[84:87], a[184:187], v[100:103], v[84:87]
  s_cmp_lt_u32 s50, s4
  v_exp_f32 v157, v157
  v_mfma_f32_16x16x32_bf16 v[84:87], a[188:191], v[132:135], v[84:87]
  ds_read_b128 a[164:167], v19 offset:13312
  v_cvt_pk_bf16_f32 v238, v156, v157
  v_mfma_f32_16x16x32_bf16 v[88:91], a[176:179], v[40:43], v[248:251]
  s_cselect_b32 s51, s50, s51
  v_exp_f32 v158, v158
  v_mfma_f32_16x16x32_bf16 v[88:91], a[180:183], v[72:75], v[88:91]
  v_mfma_f32_16x16x32_bf16 v[88:91], a[184:187], v[104:107], v[88:91]
  s_cmp_gt_u32 s50, 16
  v_exp_f32 v159, v159
  v_mfma_f32_16x16x32_bf16 v[88:91], a[188:191], v[136:139], v[88:91]
  ds_read_b128 a[168:171], v19 offset:14336
  v_cvt_pk_bf16_f32 v239, v158, v159
  v_mfma_f32_16x16x32_bf16 v[92:95], a[176:179], v[44:47], v[252:255]
  s_cselect_b32 s51, 0x8000, s51
  v_mfma_f32_16x16x32_bf16 v[92:95], a[180:183], v[76:79], v[92:95]
  s_lshl_b32 s51, s51, 15
  s_add_u32 s43, s51, s40
  v_mfma_f32_16x16x32_bf16 v[92:95], a[184:187], v[108:111], v[92:95]
  s_add_u32 s43, s43, 16384
  v_mfma_f32_16x16x32_bf16 v[92:95], a[188:191], v[140:143], v[92:95]
  ds_read_b128 a[172:175], v19 offset:15360
  v_mfma_f32_16x16x32_bf16 a[192:195], a[208:211], v[224:227], a[192:195]
  s_and_b32 s50, s39, 1
  v_exp_f32 v48, v48
  v_mfma_f32_16x16x32_bf16 a[196:199], a[208:211], v[228:231], a[196:199]
  ds_read_b128 a[176:179], v3 offset:12288
  v_mfma_f32_16x16x32_bf16 a[200:203], a[208:211], v[232:235], a[200:203]
  s_waitcnt lgkmcnt(9)
  v_exp_f32 v49, v49
  v_mfma_f32_16x16x32_bf16 a[204:207], a[208:211], v[236:239], a[204:207]
  ds_read_b128 a[180:183], v3 offset:13312
  v_cvt_pk_bf16_f32 v208, v48, v49
  v_mfma_f32_16x16x32_bf16 a[0:3], a[128:131], v[224:227], a[0:3]
  s_lshl_b32 s50, s50, 14
  v_exp_f32 v50, v50
  v_mfma_f32_16x16x32_bf16 a[4:7], a[128:131], v[228:231], a[4:7]
  ds_read_b128 a[184:187], v3 offset:14336
  v_mfma_f32_16x16x32_bf16 a[8:11], a[128:131], v[232:235], a[8:11]
  s_add_u32 s51, s39, 2
  v_exp_f32 v51, v51
  v_mfma_f32_16x16x32_bf16 a[12:15], a[128:131], v[236:239], a[12:15]
  ds_read_b128 a[188:191], v3 offset:15360
  v_cvt_pk_bf16_f32 v209, v50, v51
  v_mfma_f32_16x16x32_bf16 a[16:19], a[132:135], v[224:227], a[16:19]
  s_sub_u32 s51, s51, s49
  v_exp_f32 v80, v80
  v_mfma_f32_16x16x32_bf16 a[20:23], a[132:135], v[228:231], a[20:23]
  s_cmp_ge_i32 s51, 2
  s_cselect_b32 s46, s48, 0
  v_mfma_f32_16x16x32_bf16 a[24:27], a[132:135], v[232:235], a[24:27]
  s_add_u32 s46, s46, s50
  v_exp_f32 v81, v81
  v_mfma_f32_16x16x32_bf16 a[28:31], a[132:135], v[236:239], a[28:31]
  s_cmp_ge_i32 s51, 3
  v_cvt_pk_bf16_f32 v210, v80, v81
  v_mfma_f32_16x16x32_bf16 a[32:35], a[136:139], v[224:227], a[32:35]
  s_cselect_b32 s47, s48, 0
  v_exp_f32 v82, v82
  v_mfma_f32_16x16x32_bf16 a[36:39], a[136:139], v[228:231], a[36:39]
  s_xor_b32 s51, s50, 0x4000
  s_add_u32 s47, s47, s51
  v_mfma_f32_16x16x32_bf16 a[40:43], a[136:139], v[232:235], a[40:43]
  s_add_u32 s47, s47, 0x8000
  v_exp_f32 v83, v83
  v_mfma_f32_16x16x32_bf16 a[44:47], a[136:139], v[236:239], a[44:47]
  v_cvt_pk_bf16_f32 v211, v82, v83
  v_mfma_f32_16x16x32_bf16 a[48:51], a[140:143], v[224:227], a[48:51]
  s_add_u32 s58, s51, s41
  v_exp_f32 v52, v52
  v_mfma_f32_16x16x32_bf16 a[52:55], a[140:143], v[228:231], a[52:55]
  s_add_u32 s59, s50, s41
  s_add_u32 s59, s59, 0x8000
  v_mfma_f32_16x16x32_bf16 a[56:59], a[140:143], v[232:235], a[56:59]
  s_waitcnt lgkmcnt(8)
  v_exp_f32 v53, v53
  v_mfma_f32_16x16x32_bf16 a[60:63], a[140:143], v[236:239], a[60:63]
  s_waitcnt vmcnt(7) lgkmcnt(0)
  s_barrier
  v_cvt_pk_bf16_f32 v212, v52, v53
  v_mfma_f32_16x16x32_bf16 v[112:115], a[144:147], v[32:35], v[240:243]
  v_exp_f32 v54, v54
  v_mfma_f32_16x16x32_bf16 v[112:115], a[148:151], v[64:67], v[112:115]
  v_add_u32 v3, s46, v2
  v_add_u32 v19, s47, v2
  v_mfma_f32_16x16x32_bf16 v[112:115], a[152:155], v[96:99], v[112:115]
  v_exp_f32 v55, v55
  v_mfma_f32_16x16x32_bf16 v[112:115], a[156:159], v[128:131], v[112:115]
  ds_read_b128 a[128:131], v19 offset:0
  v_cvt_pk_bf16_f32 v213, v54, v55
  v_mfma_f32_16x16x32_bf16 v[116:119], a[144:147], v[36:39], v[244:247]
  s_mov_b32 m0, s58
  v_exp_f32 v84, v84
  v_mfma_f32_16x16x32_bf16 v[116:119], a[148:151], v[68:71], v[116:119]
  buffer_load_dwordx4 v2, s[16:19], s42 offen offset:0 sc1 lds
  v_mfma_f32_16x16x32_bf16 v[116:119], a[152:155], v[100:103], v[116:119]
  s_add_u32 s50, s39, 3
  v_exp_f32 v85, v85
  v_mfma_f32_16x16x32_bf16 v[116:119], a[156:159], v[132:135], v[116:119]
  ds_read_b128 a[132:135], v19 offset:1024
  v_cvt_pk_bf16_f32 v214, v84, v85
  v_mfma_f32_16x16x32_bf16 v[120:123], a[144:147], v[40:43], v[248:251]
  s_lshl_b32 s51, s50, 1
  v_exp_f32 v86, v86
  v_mfma_f32_16x16x32_bf16 v[120:123], a[148:151], v[72:75], v[120:123]
  buffer_load_dwordx4 v2, s[16:19], s42 offen offset:1024 sc1 lds
  v_mfma_f32_16x16x32_bf16 v[120:123], a[152:155], v[104:107], v[120:123]
  s_sub_u32 s51, s51, s5
  v_exp_f32 v87, v87
  v_mfma_f32_16x16x32_bf16 v[120:123], a[156:159], v[136:139], v[120:123]
  ds_read_b128 a[136:139], v19 offset:2048
  v_cvt_pk_bf16_f32 v215, v86, v87
  v_mfma_f32_16x16x32_bf16 v[124:127], a[144:147], v[44:47], v[252:255]
  s_cmp_eq_u32 s50, s4
  v_exp_f32 v56, v56
  v_mfma_f32_16x16x32_bf16 v[124:127], a[148:151], v[76:79], v[124:127]
  buffer_load_dwordx4 v2, s[16:19], s42 offen offset:2048 sc1 lds
  v_mfma_f32_16x16x32_bf16 v[124:127], a[152:155], v[108:111], v[124:127]
  v_exp_f32 v57, v57
  v_mfma_f32_16x16x32_bf16 v[124:127], a[156:159], v[140:143], v[124:127]
  ds_read_b128 a[140:143], v19 offset:3072
  v_cvt_pk_bf16_f32 v216, v56, v57
  v_mfma_f32_16x16x32_bf16 a[64:67], a[160:163], v[224:227], a[64:67]
  s_cselect_b32 s51, s6, s51
  v_exp_f32 v58, v58
  v_mfma_f32_16x16x32_bf16 a[68:71], a[160:163], v[228:231], a[68:71]
  buffer_load_dwordx4 v2, s[16:19], s42 offen offset:3072 sc1 lds
  v_mfma_f32_16x16x32_bf16 a[72:75], a[160:163], v[232:235], a[72:75]
  s_add_u32 s51, s51, 1
  v_exp_f32 v59, v59
  v_mfma_f32_16x16x32_bf16 a[76:79], a[160:163], v[236:239], a[76:79]
  ds_read_b128 a[144:147], v3 offset:0
  v_cvt_pk_bf16_f32 v217, v58, v59
  v_mfma_f32_16x16x32_bf16 a[80:83], a[164:167], v[224:227], a[80:83]
  s_mov_b32 m0, s59
  v_exp_f32 v88, v88
  v_mfma_f32_16x16x32_bf16 a[84:87], a[164:167], v[228:231], a[84:87]
  buffer_load_dwordx4 v2, s[16:19], s43 offen offset:0 sc1 lds
  v_mfma_f32_16x16x32_bf16 a[88:91], a[164:167], v[232:235], a[88:91]
  s_cmp_lt_u32 s50, s4
  v_exp_f32 v89, v89
  v_mfma_f32_16x16x32_bf16 a[92:95], a[164:167], v[236:239], a[92:95]
  ds_read_b128 a[148:151], v3 offset:1024
  v_cvt_pk_bf16_f32 v218, v88, v89
  v_mfma_f32_16x16x32_bf16 a[96:99], a[168:171], v[224:227], a[96:99]
  s_cselect_b32 s51, 0x8000, s51
  v_exp_f32 v90, v90
  v_mfma_f32_16x16x32_bf16 a[100:103], a[168:171], v[228:231], a[100:103]
  buffer_load_dwordx4 v2, s[16:19], s43 offen offset:1024 sc1 lds
  v_mfma_f32_16x16x32_bf16 a[104:107], a[168:171], v[232:235], a[104:107]
  s_cmp_gt_u32 s50, 16
  v_exp_f32 v91, v91
  v_mfma_f32_16x16x32_bf16 a[108:111], a[168:171], v[236:239], a[108:111]
  ds_read_b128 a[152:155], v3 offset:2048
  v_cvt_pk_bf16_f32 v219, v90, v91
  v_mfma_f32_16x16x32_bf16 a[112:115], a[172:175], v[224:227], a[112:115]
  s_cselect_b32 s51, 0x8000, s51
  v_exp_f32 v60, v60
  v_mfma_f32_16x16x32_bf16 a[116:119], a[172:175], v[228:231], a[116:119]
  buffer_load_dwordx4 v2, s[16:19], s43 offen offset:2048 sc1 lds
  v_mfma_f32_16x16x32_bf16 a[120:123], a[172:175], v[232:235], a[120:123]
  v_exp_f32 v61, v61
  v_mfma_f32_16x16x32_bf16 a[124:127], a[172:175], v[236:239], a[124:127]
  ds_read_b128 a[156:159], v3 offset:3072
  v_cvt_pk_bf16_f32 v220, v60, v61
  v_mfma_f32_16x16x32_bf16 v[144:147], a[176:179], v[32:35], v[240:243]
  s_lshl_b32 s51, s51, 15
  v_exp_f32 v62, v62
  v_mfma_f32_16x16x32_bf16 v[144:147], a[180:183], v[64:67], v[144:147]
  buffer_load_dwordx4 v2, s[16:19], s43 offen offset:3072 sc1 lds
  v_mfma_f32_16x16x32_bf16 v[144:147], a[184:187], v[96:99], v[144:147]
  s_add_u32 s44, s51, s40
  v_exp_f32 v63, v63
  v_mfma_f32_16x16x32_bf16 v[144:147], a[188:191], v[128:131], v[144:147]
  ds_read_b128 a[160:163], v19 offset:4096
  v_cvt_pk_bf16_f32 v221, v62, v63
  v_mfma_f32_16x16x32_bf16 v[148:151], a[176:179], v[36:39], v[244:247]
  s_add_u32 s50, s39, 2
  v_exp_f32 v92, v92
  v_mfma_f32_16x16x32_bf16 v[148:151], a[180:183], v[68:71], v[148:151]
  s_lshl_b32 s51, s50, 1
  s_sub_u32 s51, s51, s5
  global_load_dword v4, v18, s[70:71]
  v_mfma_f32_16x16x32_bf16 v[148:151], a[184:187], v[100:103], v[148:151]
  s_cmp_eq_u32 s50, s4
  v_exp_f32 v93, v93
  v_mfma_f32_16x16x32_bf16 v[148:151], a[188:191], v[132:135], v[148:151]
  ds_read_b128 a[164:167], v19 offset:5120
  v_cvt_pk_bf16_f32 v222, v92, v93
  v_mfma_f32_16x16x32_bf16 v[152:155], a[176:179], v[40:43], v[248:251]
  s_cselect_b32 s51, s6, s51
  v_exp_f32 v94, v94
  v_mfma_f32_16x16x32_bf16 v[152:155], a[180:183], v[72:75], v[152:155]
  s_add_u32 s51, s51, 1
  s_cmp_lt_u32 s50, s4
  global_load_dword v4, v17, s[66:67]
  v_mfma_f32_16x16x32_bf16 v[152:155], a[184:187], v[104:107], v[152:155]
  s_cselect_b32 s51, 0x8000, s51
  v_exp_f32 v95, v95
  v_mfma_f32_16x16x32_bf16 v[152:155], a[188:191], v[136:139], v[152:155]
  ds_read_b128 a[168:171], v19 offset:6144
  v_cvt_pk_bf16_f32 v223, v94, v95
  v_mfma_f32_16x16x32_bf16 v[156:159], a[176:179], v[44:47], v[252:255]
  s_cmp_gt_u32 s50, 16
  s_cselect_b32 s51, 0x8000, s51
  v_mfma_f32_16x16x32_bf16 v[156:159], a[180:183], v[76:79], v[156:159]
  s_lshl_b32 s51, s51, 15
  s_add_u32 s45, s51, s40
  v_mfma_f32_16x16x32_bf16 v[156:159], a[184:187], v[108:111], v[156:159]
  s_add_u32 s45, s45, 16384
  s_add_u32 s39, s39, 1
  v_mfma_f32_16x16x32_bf16 v[156:159], a[188:191], v[140:143], v[156:159]
  ds_read_b128 a[172:175], v19 offset:7168
  s_setpc_b64 s[52:53]
.p2align 6
L_w_b_full_full_1t0:
  s_setpc_b64 s[52:53]
L_w2_b_full_full_1t0:
  s_setpc_b64 s[56:57]
L_b_full_full_1t0:
  v_mfma_f32_16x16x32_bf16 a[192:195], a[208:211], v[208:211], 0
  v_exp_f32 v112, v112
  v_mfma_f32_16x16x32_bf16 a[196:199], a[208:211], v[212:215], 0
  v_mfma_f32_16x16x32_bf16 a[200:203], a[208:211], v[216:219], 0
  s_waitcnt lgkmcnt(8)
  v_exp_f32 v113, v113
  v_mfma_f32_16x16x32_bf16 a[204:207], a[208:211], v[220:223], 0
  ds_read_b128 a[176:179], v3 offset:4096
  v_cvt_pk_bf16_f32 v224, v112, v113
  v_mfma_f32_16x16x32_bf16 a[0:3], a[128:131], v[208:211], 0
  s_add_u32 m0, s58, 0x10000
  v_exp_f32 v114, v114
  v_mfma_f32_16x16x32_bf16 a[4:7], a[128:131], v[212:215], 0
  buffer_load_dwordx4 v2, s[16:19], s44 offen offset:0 sc1 lds
  v_mfma_f32_16x16x32_bf16 a[8:11], a[128:131], v[216:219], 0
  v_exp_f32 v115, v115
  v_mfma_f32_16x16x32_bf16 a[12:15], a[128:131], v[220:223], 0
  ds_read_b128 a[180:183], v3 offset:5120
  v_cvt_pk_bf16_f32 v225, v114, v115
  v_mfma_f32_16x16x32_bf16 a[16:19], a[132:135], v[208:211], 0
  v_exp_f32 v144, v144
  v_mfma_f32_16x16x32_bf16 a[20:23], a[132:135], v[212:215], 0
  buffer_load_dwordx4 v2, s[16:19], s44 offen offset:1024 sc1 lds
  v_mfma_f32_16x16x32_bf16 a[24:27], a[132:135], v[216:219], 0
  v_exp_f32 v145, v145
  v_mfma_f32_16x16x32_bf16 a[28:31], a[132:135], v[220:223], 0
  ds_read_b128 a[184:187], v3 offset:6144
  v_cvt_pk_bf16_f32 v226, v144, v145
  v_mfma_f32_16x16x32_bf16 a[32:35], a[136:139], v[208:211], 0
  v_exp_f32 v146, v146
  v_mfma_f32_16x16x32_bf16 a[36:39], a[136:139], v[212:215], 0
  buffer_load_dwordx4 v2, s[16:19], s44 offen offset:2048 sc1 lds
  v_mfma_f32_16x16x32_bf16 a[40:43], a[136:139], v[216:219], 0
  v_exp_f32 v147, v147
  v_mfma_f32_16x16x32_bf16 a[44:47], a[136:139], v[220:223], 0
  ds_read_b128 a[188:191], v3 offset:7168
  v_cvt_pk_bf16_f32 v227, v146, v147
  v_mfma_f32_16x16x32_bf16 a[48:51], a[140:143], v[208:211], 0
  v_exp_f32 v116, v116
  v_mfma_f32_16x16x32_bf16 a[52:55], a[140:143], v[212:215], 0
  buffer_load_dwordx4 v2, s[16:19], s44 offen offset:3072 sc1 lds
  v_mfma_f32_16x16x32_bf16 a[56:59], a[140:143], v[216:219], 0
  s_waitcnt lgkmcnt(8)
  v_exp_f32 v117, v117
  v_mfma_f32_16x16x32_bf16 a[60:63], a[140:143], v[220:223], 0
  v_cvt_pk_bf16_f32 v228, v116, v117
  v_mfma_f32_16x16x32_bf16 v[48:51], a[144:147], v[32:35], v[240:243]
  s_add_u32 m0, s59, 0x10000
  v_exp_f32 v118, v118
  v_mfma_f32_16x16x32_bf16 v[48:51], a[148:151], v[64:67], v[48:51]
  buffer_load_dwordx4 v2, s[16:19], s45 offen offset:0 sc1 lds
  v_mfma_f32_16x16x32_bf16 v[48:51], a[152:155], v[96:99], v[48:51]
  s_add_u32 s50, s39, 3
  v_exp_f32 v119, v119
  v_mfma_f32_16x16x32_bf16 v[48:51], a[156:159], v[128:131], v[48:51]
  ds_read_b128 a[128:131], v19 offset:8192
  v_cvt_pk_bf16_f32 v229, v118, v119
  v_mfma_f32_16x16x32_bf16 v[52:55], a[144:147], v[36:39], v[244:247]
  s_lshl_b32 s51, s50, 1
  v_exp_f32 v148, v148
  v_mfma_f32_16x16x32_bf16 v[52:55], a[148:151], v[68:71], v[52:55]
  buffer_load_dwordx4 v2, s[16:19], s45 offen offset:1024 sc1 lds
  v_mfma_f32_16x16x32_bf16 v[52:55], a[152:155], v[100:103], v[52:55]
  s_sub_u32 s51, s51, s5
  v_exp_f32 v149, v149
  v_mfma_f32_16x16x32_bf16 v[52:55], a[156:159], v[132:135], v[52:55]
  ds_read_b128 a[132:135], v19 offset:9216
  v_cvt_pk_bf16_f32 v230, v148, v149
  v_mfma_f32_16x16x32_bf16 v[56:59], a[144:147], v[40:43], v[248:251]
  s_cmp_eq_u32 s50, s4
  v_exp_f32 v150, v150
  v_mfma_f32_16x16x32_bf16 v[56:59], a[148:151], v[72:75], v[56:59]
  buffer_load_dwordx4 v2, s[16:19], s45 offen offset:2048 sc1 lds
  v_mfma_f32_16x16x32_bf16 v[56:59], a[152:155], v[104:107], v[56:59]
  s_cselect_b32 s51, s6, s51
  v_exp_f32 v151, v151
  v_mfma_f32_16x16x32_bf16 v[56:59], a[156:159], v[136:139], v[56:59]
  ds_read_b128 a[136:139], v19 offset:10240
  v_cvt_pk_bf16_f32 v231, v150, v151
  v_mfma_f32_16x16x32_bf16 v[60:63], a[144:147], v[44:47], v[252:255]
  s_cmp_lt_u32 s50, s4
  v_exp_f32 v120, v120
  v_mfma_f32_16x16x32_bf16 v[60:63], a[148:151], v[76:79], v[60:63]
  buffer_load_dwordx4 v2, s[16:19], s45 offen offset:3072 sc1 lds
  v_mfma_f32_16x16x32_bf16 v[60:63], a[152:155], v[108:111], v[60:63]
  s_waitcnt lgkmcnt(7)
  v_exp_f32 v121, v121
  v_mfma_f32_16x16x32_bf16 v[60:63], a[156:159], v[140:143], v[60:63]
  ds_read_b128 a[140:143], v19 offset:11264
  v_cvt_pk_bf16_f32 v232, v120, v121
  v_mfma_f32_16x16x32_bf16 a[64:67], a[160:163], v[208:211], 0
  s_cselect_b32 s51, s50, s51
  v_exp_f32 v122, v122
  v_mfma_f32_16x16x32_bf16 a[68:71], a[160:163], v[212:215], 0
  v_mfma_f32_16x16x32_bf16 a[72:75], a[160:163], v[216:219], 0
  s_cmp_gt_u32 s50, 16
  v_exp_f32 v123, v123
  v_mfma_f32_16x16x32_bf16 a[76:79], a[160:163], v[220:223], 0
  ds_read_b128 a[144:147], v3 offset:8192
  v_cvt_pk_bf16_f32 v233, v122, v123
  v_mfma_f32_16x16x32_bf16 a[80:83], a[164:167], v[208:211], 0
  s_cselect_b32 s51, 0x8000, s51
  v_exp_f32 v152, v152
  v_mfma_f32_16x16x32_bf16 a[84:87], a[164:167], v[212:215], 0
  v_mfma_f32_16x16x32_bf16 a[88:91], a[164:167], v[216:219], 0
  s_lshl_b32 s51, s51, 15
  v_exp_f32 v153, v153
  v_mfma_f32_16x16x32_bf16 a[92:95], a[164:167], v[220:223], 0
  ds_read_b128 a[148:151], v3 offset:9216
  v_cvt_pk_bf16_f32 v234, v152, v153
  v_mfma_f32_16x16x32_bf16 a[96:99], a[168:171], v[208:211], 0
  s_add_u32 s42, s51, s40
  v_exp_f32 v154, v154
  v_mfma_f32_16x16x32_bf16 a[100:103], a[168:171], v[212:215], 0
  v_mfma_f32_16x16x32_bf16 a[104:107], a[168:171], v[216:219], 0
  s_add_u32 s50, s39, 2
  v_exp_f32 v155, v155
  v_mfma_f32_16x16x32_bf16 a[108:111], a[168:171], v[220:223], 0
  ds_read_b128 a[152:155], v3 offset:10240
  v_cvt_pk_bf16_f32 v235, v154, v155
  v_mfma_f32_16x16x32_bf16 a[112:115], a[172:175], v[208:211], 0
  s_lshl_b32 s51, s50, 1
  v_exp_f32 v124, v124
  v_mfma_f32_16x16x32_bf16 a[116:119], a[172:175], v[212:215], 0
  v_mfma_f32_16x16x32_bf16 a[120:123], a[172:175], v[216:219], 0
  s_waitcnt lgkmcnt(7)
  v_exp_f32 v125, v125
  v_mfma_f32_16x16x32_bf16 a[124:127], a[172:175], v[220:223], 0
  ds_read_b128 a[156:159], v3 offset:11264
  v_cvt_pk_bf16_f32 v236, v124, v125
  v_mfma_f32_16x16x32_bf16 v[80:83], a[176:179], v[32:35], v[240:243]
  s_sub_u32 s51, s51, s5
  v_exp_f32 v126, v126
  v_mfma_f32_16x16x32_bf16 v[80:83], a[180:183], v[64:67], v[80:83]
  v_mfma_f32_16x16x32_bf16 v[80:83], a[184:187], v[96:99], v[80:83]
  s_cmp_eq_u32 s50, s4
  v_exp_f32 v127, v127
  v_mfma_f32_16x16x32_bf16 v[80:83], a[188:191], v[128:131], v[80:83]
  ds_read_b128 a[160:163], v19 offset:12288
  v_cvt_pk_bf16_f32 v237, v126, v127
  v_mfma_f32_16x16x32_bf16 v[84:87], a[176:179], v[36:39], v[244:247]
  s_cselect_b32 s51, s6, s51
  v_exp_f32 v156, v156
  v_mfma_f32_16x16x32_bf16 v[84:87], a[180:183], v[68:71], v[84:87]
  v_mfma_f32_16x16x32_bf16 v[84:87], a[184:187], v[100:103], v[84:87]
  s_cmp_lt_u32 s50, s4
  v_exp_f32 v157, v157
  v_mfma_f32_16x16x32_bf16 v[84:87], a[188:191], v[132:135], v[84:87]
  ds_read_b128 a[164:167], v19 offset:13312
  v_cvt_pk_bf16_f32 v238, v156, v157
  v_mfma_f32_16x16x32_bf16 v[88:91], a[176:179], v[40:43], v[248:251]
  s_cselect_b32 s51, s50, s51
  v_exp_f32 v158, v158
  v_mfma_f32_16x16x32_bf16 v[88:91], a[180:183], v[72:75], v[88:91]
  v_mfma_f32_16x16x32_bf16 v[88:91], a[184:187], v[104:107], v[88:91]
  s_cmp_gt_u32 s50, 16
  v_exp_f32 v159, v159
  v_mfma_f32_16x16x32_bf16 v[88:91], a[188:191], v[136:139], v[88:91]
  ds_read_b128 a[168:171], v19 offset:14336
  v_cvt_pk_bf16_f32 v239, v158, v159
  v_mfma_f32_16x16x32_bf16 v[92:95], a[176:179], v[44:47], v[252:255]
  s_cselect_b32 s51, 0x8000, s51
  v_mfma_f32_16x16x32_bf16 v[92:95], a[180:183], v[76:79], v[92:95]
  s_lshl_b32 s51, s51, 15
  s_add_u32 s43, s51, s40
  v_mfma_f32_16x16x32_bf16 v[92:95], a[184:187], v[108:111], v[92:95]
  s_add_u32 s43, s43, 16384
  v_mfma_f32_16x16x32_bf16 v[92:95], a[188:191], v[140:143], v[92:95]
  ds_read_b128 a[172:175], v19 offset:15360
  v_mfma_f32_16x16x32_bf16 a[192:195], a[208:211], v[224:227], a[192:195]
  s_and_b32 s50, s39, 1
  v_exp_f32 v48, v48
  v_mfma_f32_16x16x32_bf16 a[196:199], a[208:211], v[228:231], a[196:199]
  ds_read_b128 a[176:179], v3 offset:12288
  v_mfma_f32_16x16x32_bf16 a[200:203], a[208:211], v[232:235], a[200:203]
  s_waitcnt lgkmcnt(9)
  v_exp_f32 v49, v49
  v_mfma_f32_16x16x32_bf16 a[204:207], a[208:211], v[236:239], a[204:207]
  ds_read_b128 a[180:183], v3 offset:13312
  v_cvt_pk_bf16_f32 v208, v48, v49
  v_mfma_f32_16x16x32_bf16 a[0:3], a[128:131], v[224:227], a[0:3]
  s_lshl_b32 s50, s50, 14
  v_exp_f32 v50, v50
  v_mfma_f32_16x16x32_bf16 a[4:7], a[128:131], v[228:231], a[4:7]
  ds_read_b128 a[184:187], v3 offset:14336
  v_mfma_f32_16x16x32_bf16 a[8:11], a[128:131], v[232:235], a[8:11]
  s_add_u32 s51, s39, 2
  v_exp_f32 v51, v51
  v_mfma_f32_16x16x32_bf16 a[12:15], a[128:131], v[236:239], a[12:15]
  ds_read_b128 a[188:191], v3 offset:15360
  v_cvt_pk_bf16_f32 v209, v50, v51
  v_mfma_f32_16x16x32_bf16 a[16:19], a[132:135], v[224:227], a[16:19]
  s_sub_u32 s51, s51, s49
  v_exp_f32 v80, v80
  v_mfma_f32_16x16x32_bf16 a[20:23], a[132:135], v[228:231], a[20:23]
  s_cmp_ge_i32 s51, 2
  s_cselect_b32 s46, s48, 0
  v_mfma_f32_16x16x32_bf16 a[24:27], a[132:135], v[232:235], a[24:27]
  s_add_u32 s46, s46, s50
  v_exp_f32 v81, v81
  v_mfma_f32_16x16x32_bf16 a[28:31], a[132:135], v[236:239], a[28:31]
  s_cmp_ge_i32 s51, 3
  v_cvt_pk_bf16_f32 v210, v80, v81
  v_mfma_f32_16x16x32_bf16 a[32:35], a[136:139], v[224:227], a[32:35]
  s_cselect_b32 s47, s48, 0
  v_exp_f32 v82, v82
  v_mfma_f32_16x16x32_bf16 a[36:39], a[136:139], v[228:231], a[36:39]
  s_xor_b32 s51, s50, 0x4000
  s_add_u32 s47, s47, s51
  v_mfma_f32_16x16x32_bf16 a[40:43], a[136:139], v[232:235], a[40:43]
  s_add_u32 s47, s47, 0x8000
  v_exp_f32 v83, v83
  v_mfma_f32_16x16x32_bf16 a[44:47], a[136:139], v[236:239], a[44:47]
  v_cvt_pk_bf16_f32 v211, v82, v83
  v_mfma_f32_16x16x32_bf16 a[48:51], a[140:143], v[224:227], a[48:51]
  s_add_u32 s58, s51, s41
  v_exp_f32 v52, v52
  v_mfma_f32_16x16x32_bf16 a[52:55], a[140:143], v[228:231], a[52:55]
  s_add_u32 s59, s50, s41
  s_add_u32 s59, s59, 0x8000
  v_mfma_f32_16x16x32_bf16 a[56:59], a[140:143], v[232:235], a[56:59]
  s_waitcnt lgkmcnt(8)
  v_exp_f32 v53, v53
  v_mfma_f32_16x16x32_bf16 a[60:63], a[140:143], v[236:239], a[60:63]
  s_waitcnt vmcnt(0) lgkmcnt(0)
  s_barrier
  v_cvt_pk_bf16_f32 v212, v52, v53
  v_mfma_f32_16x16x32_bf16 v[112:115], a[144:147], v[32:35], v[240:243]
  v_exp_f32 v54, v54
  v_mfma_f32_16x16x32_bf16 v[112:115], a[148:151], v[64:67], v[112:115]
  v_add_u32 v3, s46, v2
  v_add_u32 v19, s47, v2
  v_mfma_f32_16x16x32_bf16 v[112:115], a[152:155], v[96:99], v[112:115]
  v_exp_f32 v55, v55
  v_mfma_f32_16x16x32_bf16 v[112:115], a[156:159], v[128:131], v[112:115]
  ds_read_b128 a[128:131], v19 offset:0
  v_cvt_pk_bf16_f32 v213, v54, v55
  v_mfma_f32_16x16x32_bf16 v[116:119], a[144:147], v[36:39], v[244:247]
  s_mov_b32 m0, s58
  v_exp_f32 v84, v84
  v_mfma_f32_16x16x32_bf16 v[116:119], a[148:151], v[68:71], v[116:119]
  buffer_load_dwordx4 v2, s[16:19], s42 offen offset:0 sc1 lds
  v_mfma_f32_16x16x32_bf16 v[116:119], a[152:155], v[100:103], v[116:119]
  s_add_u32 s50, s39, 3
  v_exp_f32 v85, v85
  v_mfma_f32_16x16x32_bf16 v[116:119], a[156:159], v[132:135], v[116:119]
  ds_read_b128 a[132:135], v19 offset:1024
  v_cvt_pk_bf16_f32 v214, v84, v85
  v_mfma_f32_16x16x32_bf16 v[120:123], a[144:147], v[40:43], v[248:251]
  s_lshl_b32 s51, s50, 1
  v_exp_f32 v86, v86
  v_mfma_f32_16x16x32_bf16 v[120:123], a[148:151], v[72:75], v[120:123]
  buffer_load_dwordx4 v2, s[16:19], s42 offen offset:1024 sc1 lds
  v_mfma_f32_16x16x32_bf16 v[120:123], a[152:155], v[104:107], v[120:123]
  s_sub_u32 s51, s51, s5
  v_exp_f32 v87, v87
  v_mfma_f32_16x16x32_bf16 v[120:123], a[156:159], v[136:139], v[120:123]
  ds_read_b128 a[136:139], v19 offset:2048
  v_cvt_pk_bf16_f32 v215, v86, v87
  v_mfma_f32_16x16x32_bf16 v[124:127], a[144:147], v[44:47], v[252:255]
  s_cmp_eq_u32 s50, s4
  v_exp_f32 v56, v56
  v_mfma_f32_16x16x32_bf16 v[124:127], a[148:151], v[76:79], v[124:127]
  buffer_load_dwordx4 v2, s[16:19], s42 offen offset:2048 sc1 lds
  v_mfma_f32_16x16x32_bf16 v[124:127], a[152:155], v[108:111], v[124:127]
  v_exp_f32 v57, v57
  v_mfma_f32_16x16x32_bf16 v[124:127], a[156:159], v[140:143], v[124:127]
  ds_read_b128 a[140:143], v19 offset:3072
  v_cvt_pk_bf16_f32 v216, v56, v57
  v_mfma_f32_16x16x32_bf16 a[64:67], a[160:163], v[224:227], a[64:67]
  s_cselect_b32 s51, s6, s51
  v_exp_f32 v58, v58
  v_mfma_f32_16x16x32_bf16 a[68:71], a[160:163], v[228:231], a[68:71]
  buffer_load_dwordx4 v2, s[16:19], s42 offen offset:3072 sc1 lds
  v_mfma_f32_16x16x32_bf16 a[72:75], a[160:163], v[232:235], a[72:75]
  s_add_u32 s51, s51, 1
  v_exp_f32 v59, v59
  v_mfma_f32_16x16x32_bf16 a[76:79], a[160:163], v[236:239], a[76:79]
  ds_read_b128 a[144:147], v3 offset:0
  v_cvt_pk_bf16_f32 v217, v58, v59
  v_mfma_f32_16x16x32_bf16 a[80:83], a[164:167], v[224:227], a[80:83]
  s_mov_b32 m0, s59
  v_exp_f32 v88, v88
  v_mfma_f32_16x16x32_bf16 a[84:87], a[164:167], v[228:231], a[84:87]
  buffer_load_dwordx4 v2, s[16:19], s43 offen offset:0 sc1 lds
  v_mfma_f32_16x16x32_bf16 a[88:91], a[164:167], v[232:235], a[88:91]
  s_cmp_lt_u32 s50, s4
  v_exp_f32 v89, v89
  v_mfma_f32_16x16x32_bf16 a[92:95], a[164:167], v[236:239], a[92:95]
  ds_read_b128 a[148:151], v3 offset:1024
  v_cvt_pk_bf16_f32 v218, v88, v89
  v_mfma_f32_16x16x32_bf16 a[96:99], a[168:171], v[224:227], a[96:99]
  s_cselect_b32 s51, 0x8000, s51
  v_exp_f32 v90, v90
  v_mfma_f32_16x16x32_bf16 a[100:103], a[168:171], v[228:231], a[100:103]
  buffer_load_dwordx4 v2, s[16:19], s43 offen offset:1024 sc1 lds
  v_mfma_f32_16x16x32_bf16 a[104:107], a[168:171], v[232:235], a[104:107]
  s_cmp_gt_u32 s50, 16
  v_exp_f32 v91, v91
  v_mfma_f32_16x16x32_bf16 a[108:111], a[168:171], v[236:239], a[108:111]
  ds_read_b128 a[152:155], v3 offset:2048
  v_cvt_pk_bf16_f32 v219, v90, v91
  v_mfma_f32_16x16x32_bf16 a[112:115], a[172:175], v[224:227], a[112:115]
  s_cselect_b32 s51, 0x8000, s51
  v_exp_f32 v60, v60
  v_mfma_f32_16x16x32_bf16 a[116:119], a[172:175], v[228:231], a[116:119]
  buffer_load_dwordx4 v2, s[16:19], s43 offen offset:2048 sc1 lds
  v_mfma_f32_16x16x32_bf16 a[120:123], a[172:175], v[232:235], a[120:123]
  v_exp_f32 v61, v61
  v_mfma_f32_16x16x32_bf16 a[124:127], a[172:175], v[236:239], a[124:127]
  ds_read_b128 a[156:159], v3 offset:3072
  v_cvt_pk_bf16_f32 v220, v60, v61
  v_mfma_f32_16x16x32_bf16 v[144:147], a[176:179], v[32:35], v[240:243]
  s_lshl_b32 s51, s51, 15
  v_exp_f32 v62, v62
  v_mfma_f32_16x16x32_bf16 v[144:147], a[180:183], v[64:67], v[144:147]
  buffer_load_dwordx4 v2, s[16:19], s43 offen offset:3072 sc1 lds
  v_mfma_f32_16x16x32_bf16 v[144:147], a[184:187], v[96:99], v[144:147]
  s_add_u32 s44, s51, s40
  v_exp_f32 v63, v63
  v_mfma_f32_16x16x32_bf16 v[144:147], a[188:191], v[128:131], v[144:147]
  ds_read_b128 a[160:163], v19 offset:4096
  v_cvt_pk_bf16_f32 v221, v62, v63
  v_mfma_f32_16x16x32_bf16 v[148:151], a[176:179], v[36:39], v[244:247]
  s_add_u32 s50, s39, 2
  v_exp_f32 v92, v92
  v_mfma_f32_16x16x32_bf16 v[148:151], a[180:183], v[68:71], v[148:151]
  s_lshl_b32 s51, s50, 1
  s_sub_u32 s51, s51, s5
  global_load_dword v4, v18, s[70:71]
  v_mfma_f32_16x16x32_bf16 v[148:151], a[184:187], v[100:103], v[148:151]
  s_cmp_eq_u32 s50, s4
  v_exp_f32 v93, v93
  v_mfma_f32_16x16x32_bf16 v[148:151], a[188:191], v[132:135], v[148:151]
  ds_read_b128 a[164:167], v19 offset:5120
  v_cvt_pk_bf16_f32 v222, v92, v93
  v_mfma_f32_16x16x32_bf16 v[152:155], a[176:179], v[40:43], v[248:251]
  s_cselect_b32 s51, s6, s51
  v_exp_f32 v94, v94
  v_mfma_f32_16x16x32_bf16 v[152:155], a[180:183], v[72:75], v[152:155]
  s_add_u32 s51, s51, 1
  s_cmp_lt_u32 s50, s4
  global_load_dword v4, v17, s[66:67]
  v_mfma_f32_16x16x32_bf16 v[152:155], a[184:187], v[104:107], v[152:155]
  s_cselect_b32 s51, 0x8000, s51
  v_exp_f32 v95, v95
  v_mfma_f32_16x16x32_bf16 v[152:155], a[188:191], v[136:139], v[152:155]
  ds_read_b128 a[168:171], v19 offset:6144
  v_cvt_pk_bf16_f32 v223, v94, v95
  v_mfma_f32_16x16x32_bf16 v[156:159], a[176:179], v[44:47], v[252:255]
  s_cmp_gt_u32 s50, 16
  s_cselect_b32 s51, 0x8000, s51
  v_mfma_f32_16x16x32_bf16 v[156:159], a[180:183], v[76:79], v[156:159]
  s_lshl_b32 s51, s51, 15
  s_add_u32 s45, s51, s40
  v_mfma_f32_16x16x32_bf16 v[156:159], a[184:187], v[108:111], v[156:159]
  s_add_u32 s45, s45, 16384
  s_add_u32 s39, s39, 1
  v_mfma_f32_16x16x32_bf16 v[156:159], a[188:191], v[140:143], v[156:159]
  ds_read_b128 a[172:175], v19 offset:7168
  s_setpc_b64 s[52:53]
.p2align 6
L_w_b_None_full_0lastlo:
  s_setpc_b64 s[52:53]
L_w2_b_None_full_0lastlo:
  s_setpc_b64 s[56:57]
L_b_None_full_0lastlo:
  v_mfma_f32_16x16x32_bf16 a[192:195], a[208:211], v[208:211], a[192:195]
  v_exp_f32 v112, v112
  v_mfma_f32_16x16x32_bf16 a[196:199], a[208:211], v[212:215], a[196:199]
  v_mfma_f32_16x16x32_bf16 a[200:203], a[208:211], v[216:219], a[200:203]
  s_waitcnt lgkmcnt(8)
  v_exp_f32 v113, v113
  v_mfma_f32_16x16x32_bf16 a[204:207], a[208:211], v[220:223], a[204:207]
  v_cvt_pk_bf16_f32 v224, v112, v113
  v_mfma_f32_16x16x32_bf16 a[0:3], a[128:131], v[208:211], a[0:3]
  v_exp_f32 v114, v114
  v_mfma_f32_16x16x32_bf16 a[4:7], a[128:131], v[212:215], a[4:7]
  v_exp_f32 v115, v115
  s_nop 0
  v_cvt_pk_bf16_f32 v225, v114, v115
  v_mfma_f32_16x16x32_bf16 a[8:11], a[128:131], v[216:219], a[8:11]
  v_exp_f32 v144, v144
  v_mfma_f32_16x16x32_bf16 a[12:15], a[128:131], v[220:223], a[12:15]
  v_exp_f32 v145, v145
  s_nop 0
  v_cvt_pk_bf16_f32 v226, v144, v145
  v_mfma_f32_16x16x32_bf16 a[16:19], a[132:135], v[208:211], a[16:19]
  v_exp_f32 v146, v146
  v_mfma_f32_16x16x32_bf16 a[20:23], a[132:135], v[212:215], a[20:23]
  v_exp_f32 v147, v147
  s_nop 0
  v_cvt_pk_bf16_f32 v227, v146, v147
  v_mfma_f32_16x16x32_bf16 a[24:27], a[132:135], v[216:219], a[24:27]
  v_exp_f32 v116, v116
  v_mfma_f32_16x16x32_bf16 a[28:31], a[132:135], v[220:223], a[28:31]
  v_exp_f32 v117, v117
  s_nop 0
  v_cvt_pk_bf16_f32 v228, v116, v117
  v_mfma_f32_16x16x32_bf16 a[32:35], a[136:139], v[208:211], a[32:35]
  v_exp_f32 v118, v118
  v_mfma_f32_16x16x32_bf16 a[36:39], a[136:139], v[212:215], a[36:39]
  v_exp_f32 v119, v119
  ds_read_b128 a[128:131], v19 offset:8192
  v_cvt_pk_bf16_f32 v229, v118, v119
  v_mfma_f32_16x16x32_bf16 a[40:43], a[136:139], v[216:219], a[40:43]
  v_exp_f32 v148, v148
  v_mfma_f32_16x16x32_bf16 a[44:47], a[136:139], v[220:223], a[44:47]
  v_exp_f32 v149, v149
  ds_read_b128 a[132:135], v19 offset:9216
  v_cvt_pk_bf16_f32 v230, v148, v149
  v_mfma_f32_16x16x32_bf16 a[48:51], a[140:143], v[208:211], a[48:51]
  v_exp_f32 v150, v150
  v_mfma_f32_16x16x32_bf16 a[52:55], a[140:143], v[212:215], a[52:55]
  v_exp_f32 v151, v151
  ds_read_b128 a[136:139], v19 offset:10240
  v_cvt_pk_bf16_f32 v231, v150, v151
  v_mfma_f32_16x16x32_bf16 a[56:59], a[140:143], v[216:219], a[56:59]
  v_exp_f32 v120, v120
  v_mfma_f32_16x16x32_bf16 a[60:63], a[140:143], v[220:223], a[60:63]
  s_waitcnt lgkmcnt(3)
  v_exp_f32 v121, v121
  ds_read_b128 a[140:143], v19 offset:11264
  v_cvt_pk_bf16_f32 v232, v120, v121
  v_mfma_f32_16x16x32_bf16 a[64:67], a[160:163], v[208:211], a[64:67]
  v_exp_f32 v122, v122
  v_mfma_f32_16x16x32_bf16 a[68:71], a[160:163], v[212:215], a[68:71]
  v_exp_f32 v123, v123
  s_nop 0
  v_cvt_pk_bf16_f32 v233, v122, v123
  v_mfma_f32_16x16x32_bf16 a[72:75], a[160:163], v[216:219], a[72:75]
  v_exp_f32 v152, v152
  v_mfma_f32_16x16x32_bf16 a[76:79], a[160:163], v[220:223], a[76:79]
  v_exp_f32 v153, v153
  s_nop 0
  v_cvt_pk_bf16_f32 v234, v152, v153
  v_mfma_f32_16x16x32_bf16 a[80:83], a[164:167], v[208:211], a[80:83]
  v_exp_f32 v154, v154
  v_mfma_f32_16x16x32_bf16 a[84:87], a[164:167], v[212:215], a[84:87]
  v_exp_f32 v155, v155
  s_nop 0
  v_cvt_pk_bf16_f32 v235, v154, v155
  v_mfma_f32_16x16x32_bf16 a[88:91], a[164:167], v[216:219], a[88:91]
  v_exp_f32 v124, v124
  v_mfma_f32_16x16x32_bf16 a[92:95], a[164:167], v[220:223], a[92:95]
  v_exp_f32 v125, v125
  s_nop 0
  v_cvt_pk_bf16_f32 v236, v124, v125
  v_mfma_f32_16x16x32_bf16 a[96:99], a[168:171], v[208:211], a[96:99]
  v_exp_f32 v126, v126
  v_mfma_f32_16x16x32_bf16 a[100:103], a[168:171], v[212:215], a[100:103]
  v_exp_f32 v127, v127
  ds_read_b128 a[160:163], v19 offset:12288
  v_cvt_pk_bf16_f32 v237, v126, v127
  v_mfma_f32_16x16x32_bf16 a[104:107], a[168:171], v[216:219], a[104:107]
  v_exp_f32 v156, v156
  v_mfma_f32_16x16x32_bf16 a[108:111], a[168:171], v[220:223], a[108:111]
  v_exp_f32 v157, v157
  ds_read_b128 a[164:167], v19 offset:13312
  v_cvt_pk_bf16_f32 v238, v156, v157
  v_mfma_f32_16x16x32_bf16 a[112:115], a[172:175], v[208:211], a[112:115]
  v_exp_f32 v158, v158
  v_mfma_f32_16x16x32_bf16 a[116:119], a[172:175], v[212:215], a[116:119]
  v_exp_f32 v159, v159
  ds_read_b128 a[168:171], v19 offset:14336
  v_cvt_pk_bf16_f32 v239, v158, v159
  v_mfma_f32_16x16x32_bf16 a[120:123], a[172:175], v[216:219], a[120:123]
  v_mfma_f32_16x16x32_bf16 a[124:127], a[172:175], v[220:223], a[124:127]
  ds_read_b128 a[172:175], v19 offset:15360
  s_waitcnt vmcnt(0)
  v_mfma_f32_16x16x32_bf16 a[192:195], a[208:211], v[224:227], a[192:195]
  v_mfma_f32_16x16x32_bf16 a[196:199], a[208:211], v[228:231], a[196:199]
  v_mfma_f32_16x16x32_bf16 a[200:203], a[208:211], v[232:235], a[200:203]
  s_waitcnt lgkmcnt(4)
  v_mfma_f32_16x16x32_bf16 a[204:207], a[208:211], v[236:239], a[204:207]
  v_mfma_f32_16x16x32_bf16 a[0:3], a[128:131], v[224:227], a[0:3]
  v_mfma_f32_16x16x32_bf16 a[4:7], a[128:131], v[228:231], a[4:7]
  v_mfma_f32_16x16x32_bf16 a[8:11], a[128:131], v[232:235], a[8:11]
  v_mfma_f32_16x16x32_bf16 a[12:15], a[128:131], v[236:239], a[12:15]
  v_mfma_f32_16x16x32_bf16 a[16:19], a[132:135], v[224:227], a[16:19]
  v_mfma_f32_16x16x32_bf16 a[20:23], a[132:135], v[228:231], a[20:23]
  v_mfma_f32_16x16x32_bf16 a[24:27], a[132:135], v[232:235], a[24:27]
  v_mfma_f32_16x16x32_bf16 a[28:31], a[132:135], v[236:239], a[28:31]
  v_mfma_f32_16x16x32_bf16 a[32:35], a[136:139], v[224:227], a[32:35]
  s_nop 1
  ds_write_b128 v197, a[8:11] offset:0
  v_mfma_f32_16x16x32_bf16 a[36:39], a[136:139], v[228:231], a[36:39]
  ds_write_b128 v197, a[12:15] offset:8192
  v_mfma_f32_16x16x32_bf16 a[40:43], a[136:139], v[232:235], a[40:43]
  v_accvgpr_read_b32 v128, a0
  v_accvgpr_read_b32 v129, a1
  v_mfma_f32_16x16x32_bf16 a[44:47], a[136:139], v[236:239], a[44:47]
  v_accvgpr_read_b32 v130, a2
  v_accvgpr_read_b32 v131, a3
  v_mfma_f32_16x16x32_bf16 a[48:51], a[140:143], v[224:227], a[48:51]
  v_accvgpr_read_b32 v160, a4
  v_accvgpr_read_b32 v161, a5
  v_mfma_f32_16x16x32_bf16 a[52:55], a[140:143], v[228:231], a[52:55]
  v_accvgpr_read_b32 v162, a6
  v_accvgpr_read_b32 v163, a7
  v_mfma_f32_16x16x32_bf16 a[56:59], a[140:143], v[232:235], a[56:59]
  ds_write_b128 v197, a[24:27] offset:1024
  v_mfma_f32_16x16x32_bf16 a[60:63], a[140:143], v[236:239], a[60:63]
  s_waitcnt lgkmcnt(0)
  ds_write_b128 v197, a[28:31] offset:9216
  v_mfma_f32_16x16x32_bf16 a[64:67], a[160:163], v[224:227], a[64:67]
  v_accvgpr_read_b32 v132, a16
  v_accvgpr_read_b32 v133, a17
  v_mfma_f32_16x16x32_bf16 a[68:71], a[160:163], v[228:231], a[68:71]
  v_accvgpr_read_b32 v134, a18
  v_accvgpr_read_b32 v135, a19
  v_mfma_f32_16x16x32_bf16 a[72:75], a[160:163], v[232:235], a[72:75]
  v_accvgpr_read_b32 v164, a20
  v_accvgpr_read_b32 v165, a21
  v_mfma_f32_16x16x32_bf16 a[76:79], a[160:163], v[236:239], a[76:79]
  v_accvgpr_read_b32 v166, a22
  v_accvgpr_read_b32 v167, a23
  v_mfma_f32_16x16x32_bf16 a[80:83], a[164:167], v[224:227], a[80:83]
  ds_write_b128 v197, a[40:43] offset:2048
  v_mfma_f32_16x16x32_bf16 a[84:87], a[164:167], v[228:231], a[84:87]
  ds_write_b128 v197, a[44:47] offset:10240
  v_mfma_f32_16x16x32_bf16 a[88:91], a[164:167], v[232:235], a[88:91]
  v_accvgpr_read_b32 v136, a32
  v_accvgpr_read_b32 v137, a33
  v_mfma_f32_16x16x32_bf16 a[92:95], a[164:167], v[236:239], a[92:95]
  v_accvgpr_read_b32 v138, a34
  v_accvgpr_read_b32 v139, a35
  v_mfma_f32_16x16x32_bf16 a[96:99], a[168:171], v[224:227], a[96:99]
  v_accvgpr_read_b32 v168, a36
  v_accvgpr_read_b32 v169, a37
  v_mfma_f32_16x16x32_bf16 a[100:103], a[168:171], v[228:231], a[100:103]
  v_accvgpr_read_b32 v170, a38
  v_accvgpr_read_b32 v171, a39
  v_mfma_f32_16x16x32_bf16 a[104:107], a[168:171], v[232:235], a[104:107]
  ds_write_b128 v197, a[56:59] offset:3072
  v_mfma_f32_16x16x32_bf16 a[108:111], a[168:171], v[236:239], a[108:111]
  ds_write_b128 v197, a[60:63] offset:11264
  v_mfma_f32_16x16x32_bf16 a[112:115], a[172:175], v[224:227], a[112:115]
  v_accvgpr_read_b32 v140, a48
  v_accvgpr_read_b32 v141, a49
  v_mfma_f32_16x16x32_bf16 a[116:119], a[172:175], v[228:231], a[116:119]
  v_accvgpr_read_b32 v142, a50
  v_accvgpr_read_b32 v143, a51
  v_mfma_f32_16x16x32_bf16 a[120:123], a[172:175], v[232:235], a[120:123]
  v_accvgpr_read_b32 v172, a52
  v_accvgpr_read_b32 v173, a53
  v_mfma_f32_16x16x32_bf16 a[124:127], a[172:175], v[236:239], a[124:127]
  v_accvgpr_read_b32 v174, a54
  v_accvgpr_read_b32 v175, a55
  ds_write_b128 v197, a[72:75] offset:4096
  ds_write_b128 v197, a[76:79] offset:12288
  v_accvgpr_read_b32 v144, a64
  v_accvgpr_read_b32 v145, a65
  v_accvgpr_read_b32 v146, a66
  v_accvgpr_read_b32 v147, a67
  v_accvgpr_read_b32 v176, a68
  v_accvgpr_read_b32 v177, a69
  v_accvgpr_read_b32 v178, a70
  v_accvgpr_read_b32 v179, a71
  ds_write_b128 v197, a[88:91] offset:5120
  ds_write_b128 v197, a[92:95] offset:13312
  v_accvgpr_read_b32 v148, a80
  v_accvgpr_read_b32 v149, a81
  v_accvgpr_read_b32 v150, a82
  v_accvgpr_read_b32 v151, a83
  v_accvgpr_read_b32 v180, a84
  v_accvgpr_read_b32 v181, a85
  v_accvgpr_read_b32 v182, a86
  v_accvgpr_read_b32 v183, a87
  ds_write_b128 v197, a[104:107] offset:6144
  ds_write_b128 v197, a[108:111] offset:14336
  v_accvgpr_read_b32 v152, a96
  v_accvgpr_read_b32 v153, a97
  v_accvgpr_read_b32 v154, a98
  v_accvgpr_read_b32 v155, a99
  v_accvgpr_read_b32 v184, a100
  v_accvgpr_read_b32 v185, a101
  v_accvgpr_read_b32 v186, a102
  v_accvgpr_read_b32 v187, a103
  ds_write_b128 v197, a[120:123] offset:7168
  ds_write_b128 v197, a[124:127] offset:15360
  v_accvgpr_read_b32 v156, a112
  v_accvgpr_read_b32 v157, a113
  v_accvgpr_read_b32 v158, a114
  v_accvgpr_read_b32 v159, a115
  v_accvgpr_read_b32 v188, a116
  v_accvgpr_read_b32 v189, a117
  v_accvgpr_read_b32 v190, a118
  v_accvgpr_read_b32 v191, a119
  s_nop 7
  s_setpc_b64 s[52:53]
.p2align 6
L_w_b_diag_full_0:
  s_setpc_b64 s[52:53]
L_w2_b_diag_full_0:
  s_setpc_b64 s[56:57]
L_b_diag_full_0:
  v_mfma_f32_16x16x32_bf16 a[192:195], a[208:211], v[208:211], a[192:195]
  v_exp_f32 v112, v112
  v_mfma_f32_16x16x32_bf16 a[196:199], a[208:211], v[212:215], a[196:199]
  v_mfma_f32_16x16x32_bf16 a[200:203], a[208:211], v[216:219], a[200:203]
  s_waitcnt lgkmcnt(8)
  v_exp_f32 v113, v113
  v_mfma_f32_16x16x32_bf16 a[204:207], a[208:211], v[220:223], a[204:207]
  ds_read_b128 a[176:179], v3 offset:4096
  v_cvt_pk_bf16_f32 v224, v112, v113
  v_mfma_f32_16x16x32_bf16 a[0:3], a[128:131], v[208:211], a[0:3]
  s_add_u32 m0, s58, 0x10000
  v_exp_f32 v114, v114
  v_mfma_f32_16x16x32_bf16 a[4:7], a[128:131], v[212:215], a[4:7]
  buffer_load_dwordx4 v2, s[16:19], s44 offen offset:0 sc1 lds
  v_mfma_f32_16x16x32_bf16 a[8:11], a[128:131], v[216:219], a[8:11]
  v_exp_f32 v115, v115
  v_mfma_f32_16x16x32_bf16 a[12:15], a[128:131], v[220:223], a[12:15]
  ds_read_b128 a[180:183], v3 offset:5120
  v_cvt_pk_bf16_f32 v225, v114, v115
  v_mfma_f32_16x16x32_bf16 a[16:19], a[132:135], v[208:211], a[16:19]
  v_exp_f32 v144, v144
  v_mfma_f32_16x16x32_bf16 a[20:23], a[132:135], v[212:215], a[20:23]
  buffer_load_dwordx4 v2, s[16:19], s44 offen offset:1024 sc1 lds
  v_mfma_f32_16x16x32_bf16 a[24:27], a[132:135], v[216:219], a[24:27]
  v_exp_f32 v145, v145
  v_mfma_f32_16x16x32_bf16 a[28:31], a[132:135], v[220:223], a[28:31]
  ds_read_b128 a[184:187], v3 offset:6144
  v_cvt_pk_bf16_f32 v226, v144, v145
  v_mfma_f32_16x16x32_bf16 a[32:35], a[136:139], v[208:211], a[32:35]
  v_exp_f32 v146, v146
  v_mfma_f32_16x16x32_bf16 a[36:39], a[136:139], v[212:215], a[36:39]
  buffer_load_dwordx4 v2, s[16:19], s44 offen offset:2048 sc1 lds
  v_mfma_f32_16x16x32_bf16 a[40:43], a[136:139], v[216:219], a[40:43]
  v_exp_f32 v147, v147
  v_mfma_f32_16x16x32_bf16 a[44:47], a[136:139], v[220:223], a[44:47]
  ds_read_b128 a[188:191], v3 offset:7168
  v_cvt_pk_bf16_f32 v227, v146, v147
  v_mfma_f32_16x16x32_bf16 a[48:51], a[140:143], v[208:211], a[48:51]
  v_exp_f32 v116, v116
  v_mfma_f32_16x16x32_bf16 a[52:55], a[140:143], v[212:215], a[52:55]
  buffer_load_dwordx4 v2, s[16:19], s44 offen offset:3072 sc1 lds
  v_mfma_f32_16x16x32_bf16 a[56:59], a[140:143], v[216:219], a[56:59]
  s_waitcnt lgkmcnt(8)
  v_exp_f32 v117, v117
  v_mfma_f32_16x16x32_bf16 a[60:63], a[140:143], v[220:223], a[60:63]
  v_cvt_pk_bf16_f32 v228, v116, v117
  v_mfma_f32_16x16x32_bf16 v[48:51], a[144:147], v[32:35], v[240:243]
  s_add_u32 m0, s59, 0x10000
  v_exp_f32 v118, v118
  v_mfma_f32_16x16x32_bf16 v[48:51], a[148:151], v[64:67], v[48:51]
  buffer_load_dwordx4 v2, s[16:19], s45 offen offset:0 sc1 lds
  v_mfma_f32_16x16x32_bf16 v[48:51], a[152:155], v[96:99], v[48:51]
  s_add_u32 s50, s39, 3
  v_exp_f32 v119, v119
  v_mfma_f32_16x16x32_bf16 v[48:51], a[156:159], v[128:131], v[48:51]
  ds_read_b128 a[128:131], v19 offset:8192
  v_cvt_pk_bf16_f32 v229, v118, v119
  v_mfma_f32_16x16x32_bf16 v[52:55], a[144:147], v[36:39], v[244:247]
  s_lshl_b32 s51, s50, 1
  v_exp_f32 v148, v148
  v_mfma_f32_16x16x32_bf16 v[52:55], a[148:151], v[68:71], v[52:55]
  buffer_load_dwordx4 v2, s[16:19], s45 offen offset:1024 sc1 lds
  v_mfma_f32_16x16x32_bf16 v[52:55], a[152:155], v[100:103], v[52:55]
  s_sub_u32 s51, s51, s5
  v_exp_f32 v149, v149
  v_mfma_f32_16x16x32_bf16 v[52:55], a[156:159], v[132:135], v[52:55]
  ds_read_b128 a[132:135], v19 offset:9216
  v_cvt_pk_bf16_f32 v230, v148, v149
  v_mfma_f32_16x16x32_bf16 v[56:59], a[144:147], v[40:43], v[248:251]
  s_cmp_eq_u32 s50, s4
  v_exp_f32 v150, v150
  v_mfma_f32_16x16x32_bf16 v[56:59], a[148:151], v[72:75], v[56:59]
  buffer_load_dwordx4 v2, s[16:19], s45 offen offset:2048 sc1 lds
  v_mfma_f32_16x16x32_bf16 v[56:59], a[152:155], v[104:107], v[56:59]
  s_cselect_b32 s51, s6, s51
  v_exp_f32 v151, v151
  v_mfma_f32_16x16x32_bf16 v[56:59], a[156:159], v[136:139], v[56:59]
  ds_read_b128 a[136:139], v19 offset:10240
  v_cvt_pk_bf16_f32 v231, v150, v151
  v_mfma_f32_16x16x32_bf16 v[60:63], a[144:147], v[44:47], v[252:255]
  s_cmp_lt_u32 s50, s4
  v_exp_f32 v120, v120
  v_mfma_f32_16x16x32_bf16 v[60:63], a[148:151], v[76:79], v[60:63]
  buffer_load_dwordx4 v2, s[16:19], s45 offen offset:3072 sc1 lds
  v_mfma_f32_16x16x32_bf16 v[60:63], a[152:155], v[108:111], v[60:63]
  s_waitcnt lgkmcnt(7)
  v_exp_f32 v121, v121
  v_mfma_f32_16x16x32_bf16 v[60:63], a[156:159], v[140:143], v[60:63]
  ds_read_b128 a[140:143], v19 offset:11264
  v_cvt_pk_bf16_f32 v232, v120, v121
  v_mfma_f32_16x16x32_bf16 a[64:67], a[160:163], v[208:211], a[64:67]
  s_cselect_b32 s51, s50, s51
  v_exp_f32 v122, v122
  v_mfma_f32_16x16x32_bf16 a[68:71], a[160:163], v[212:215], a[68:71]
  v_mfma_f32_16x16x32_bf16 a[72:75], a[160:163], v[216:219], a[72:75]
  s_cmp_gt_u32 s50, 16
  v_exp_f32 v123, v123
  v_mfma_f32_16x16x32_bf16 a[76:79], a[160:163], v[220:223], a[76:79]
  ds_read_b128 a[144:147], v3 offset:8192
  v_cvt_pk_bf16_f32 v233, v122, v123
  v_mfma_f32_16x16x32_bf16 a[80:83], a[164:167], v[208:211], a[80:83]
  s_cselect_b32 s51, 0x8000, s51
  v_exp_f32 v152, v152
  v_mfma_f32_16x16x32_bf16 a[84:87], a[164:167], v[212:215], a[84:87]
  v_mfma_f32_16x16x32_bf16 a[88:91], a[164:167], v[216:219], a[88:91]
  s_lshl_b32 s51, s51, 15
  v_exp_f32 v153, v153
  v_mfma_f32_16x16x32_bf16 a[92:95], a[164:167], v[220:223], a[92:95]
  ds_read_b128 a[148:151], v3 offset:9216
  v_cvt_pk_bf16_f32 v234, v152, v153
  v_mfma_f32_16x16x32_bf16 a[96:99], a[168:171], v[208:211], a[96:99]
  s_add_u32 s42, s51, s40
  v_exp_f32 v154, v154
  v_mfma_f32_16x16x32_bf16 a[100:103], a[168:171], v[212:215], a[100:103]
  v_mfma_f32_16x16x32_bf16 a[104:107], a[168:171], v[216:219], a[104:107]
  s_add_u32 s50, s39, 2
  v_exp_f32 v155, v155
  v_mfma_f32_16x16x32_bf16 a[108:111], a[168:171], v[220:223], a[108:111]
  ds_read_b128 a[152:155], v3 offset:10240
  v_cvt_pk_bf16_f32 v235, v154, v155
  v_mfma_f32_16x16x32_bf16 a[112:115], a[172:175], v[208:211], a[112:115]
  s_lshl_b32 s51, s50, 1
  v_exp_f32 v124, v124
  v_mfma_f32_16x16x32_bf16 a[116:119], a[172:175], v[212:215], a[116:119]
  v_mfma_f32_16x16x32_bf16 a[120:123], a[172:175], v[216:219], a[120:123]
  s_waitcnt lgkmcnt(7)
  v_exp_f32 v125, v125
  v_mfma_f32_16x16x32_bf16 a[124:127], a[172:175], v[220:223], a[124:127]
  ds_read_b128 a[156:159], v3 offset:11264
  v_cvt_pk_bf16_f32 v236, v124, v125
  s_sub_u32 s51, s51, s5
  v_exp_f32 v126, v126
  s_cmp_eq_u32 s50, s4
  v_exp_f32 v127, v127
  ds_read_b128 a[160:163], v19 offset:12288
  v_cvt_pk_bf16_f32 v237, v126, v127
  v_mfma_f32_16x16x32_bf16 v[84:87], a[176:179], v[36:39], v[244:247]
  s_cselect_b32 s51, s6, s51
  v_exp_f32 v156, v156
  v_mfma_f32_16x16x32_bf16 v[84:87], a[180:183], v[68:71], v[84:87]
  v_mfma_f32_16x16x32_bf16 v[84:87], a[184:187], v[100:103], v[84:87]
  s_cmp_lt_u32 s50, s4
  v_exp_f32 v157, v157
  v_mfma_f32_16x16x32_bf16 v[84:87], a[188:191], v[132:135], v[84:87]
  ds_read_b128 a[164:167], v19 offset:13312
  v_cvt_pk_bf16_f32 v238, v156, v157
  v_mfma_f32_16x16x32_bf16 v[88:91], a[176:179], v[40:43], v[248:251]
  s_cselect_b32 s51, s50, s51
  v_exp_f32 v158, v158
  v_mfma_f32_16x16x32_bf16 v[88:91], a[180:183], v[72:75], v[88:91]
  v_mfma_f32_16x16x32_bf16 v[88:91], a[184:187], v[104:107], v[88:91]
  s_cmp_gt_u32 s50, 16
  v_exp_f32 v159, v159
  v_mfma_f32_16x16x32_bf16 v[88:91], a[188:191], v[136:139], v[88:91]
  ds_read_b128 a[168:171], v19 offset:14336
  v_cvt_pk_bf16_f32 v239, v158, v159
  v_mfma_f32_16x16x32_bf16 v[92:95], a[176:179], v[44:47], v[252:255]
  s_cselect_b32 s51, 0x8000, s51
  v_mfma_f32_16x16x32_bf16 v[92:95], a[180:183], v[76:79], v[92:95]
  s_lshl_b32 s51, s51, 15
  s_add_u32 s43, s51, s40
  v_mfma_f32_16x16x32_bf16 v[92:95], a[184:187], v[108:111], v[92:95]
  s_add_u32 s43, s43, 16384
  v_mfma_f32_16x16x32_bf16 v[92:95], a[188:191], v[140:143], v[92:95]
  ds_read_b128 a[172:175], v19 offset:15360
  v_mfma_f32_16x16x32_bf16 a[192:195], a[208:211], v[224:227], a[192:195]
  s_and_b32 s50, s39, 1
  v_exp_f32 v48, v48
  v_mfma_f32_16x16x32_bf16 a[196:199], a[208:211], v[228:231], a[196:199]
  ds_read_b128 a[176:179], v3 offset:12288
  v_cndmask_b32 v48, 0, v48, s[8:9]
  v_mfma_f32_16x16x32_bf16 a[200:203], a[208:211], v[232:235], a[200:203]
  s_waitcnt lgkmcnt(9)
  v_exp_f32 v49, v49
  v_mfma_f32_16x16x32_bf16 a[204:207], a[208:211], v[236:239], a[204:207]
  ds_read_b128 a[180:183], v3 offset:13312
  v_cndmask_b32 v49, 0, v49, s[10:11]
  v_cvt_pk_bf16_f32 v208, v48, v49
  v_mfma_f32_16x16x32_bf16 a[0:3], a[128:131], v[224:227], a[0:3]
  s_lshl_b32 s50, s50, 14
  v_exp_f32 v50, v50
  v_mfma_f32_16x16x32_bf16 a[4:7], a[128:131], v[228:231], a[4:7]
  ds_read_b128 a[184:187], v3 offset:14336
  v_cndmask_b32 v50, 0, v50, s[12:13]
  v_mfma_f32_16x16x32_bf16 a[8:11], a[128:131], v[232:235], a[8:11]
  s_add_u32 s51, s39, 2
  v_exp_f32 v51, v51
  v_mfma_f32_16x16x32_bf16 a[12:15], a[128:131], v[236:239], a[12:15]
  ds_read_b128 a[188:191], v3 offset:15360
  v_cndmask_b32 v51, 0, v51, s[14:15]
  v_cvt_pk_bf16_f32 v209, v50, v51
  v_mfma_f32_16x16x32_bf16 a[16:19], a[132:135], v[224:227], a[16:19]
  s_sub_u32 s51, s51, s49
  v_mov_b32 v80, 0
  v_mfma_f32_16x16x32_bf16 a[20:23], a[132:135], v[228:231], a[20:23]
  s_cmp_ge_i32 s51, 2
  s_cselect_b32 s46, s48, 0
  v_mfma_f32_16x16x32_bf16 a[24:27], a[132:135], v[232:235], a[24:27]
  s_add_u32 s46, s46, s50
  v_mov_b32 v81, 0
  v_mfma_f32_16x16x32_bf16 a[28:31], a[132:135], v[236:239], a[28:31]
  s_cmp_ge_i32 s51, 3
  v_cvt_pk_bf16_f32 v210, v80, v81
  v_mfma_f32_16x16x32_bf16 a[32:35], a[136:139], v[224:227], a[32:35]
  s_cselect_b32 s47, s48, 0
  v_mov_b32 v82, 0
  v_mfma_f32_16x16x32_bf16 a[36:39], a[136:139], v[228:231], a[36:39]
  s_xor_b32 s51, s50, 0x4000
  s_add_u32 s47, s47, s51
  v_mfma_f32_16x16x32_bf16 a[40:43], a[136:139], v[232:235], a[40:43]
  s_add_u32 s47, s47, 0x8000
  v_mov_b32 v83, 0
  v_mfma_f32_16x16x32_bf16 a[44:47], a[136:139], v[236:239], a[44:47]
  v_cvt_pk_bf16_f32 v211, v82, v83
  v_mfma_f32_16x16x32_bf16 a[48:51], a[140:143], v[224:227], a[48:51]
  s_add_u32 s58, s51, s41
  v_exp_f32 v52, v52
  v_mfma_f32_16x16x32_bf16 a[52:55], a[140:143], v[228:231], a[52:55]
  s_add_u32 s59, s50, s41
  s_add_u32 s59, s59, 0x8000
  v_mfma_f32_16x16x32_bf16 a[56:59], a[140:143], v[232:235], a[56:59]
  s_waitcnt lgkmcnt(8)
  v_exp_f32 v53, v53
  v_mfma_f32_16x16x32_bf16 a[60:63], a[140:143], v[236:239], a[60:63]
  s_waitcnt vmcnt(0) lgkmcnt(0)
  s_barrier
  v_cvt_pk_bf16_f32 v212, v52, v53
  v_exp_f32 v54, v54
  v_add_u32 v3, s46, v2
  v_add_u32 v19, s47, v2
  v_exp_f32 v55, v55
  ds_read_b128 a[128:131], v19 offset:0
  v_cvt_pk_bf16_f32 v213, v54, v55
  s_mov_b32 m0, s58
  v_exp_f32 v84, v84
  buffer_load_dwordx4 v2, s[16:19], s42 offen offset:0 sc1 lds
  v_cndmask_b32 v84, 0, v84, s[8:9]
  s_add_u32 s50, s39, 3
  v_exp_f32 v85, v85
  ds_read_b128 a[132:135], v19 offset:1024
  v_cndmask_b32 v85, 0, v85, s[10:11]
  v_cvt_pk_bf16_f32 v214, v84, v85
  v_mfma_f32_16x16x32_bf16 v[120:123], a[144:147], v[40:43], v[248:251]
  s_lshl_b32 s51, s50, 1
  v_exp_f32 v86, v86
  v_mfma_f32_16x16x32_bf16 v[120:123], a[148:151], v[72:75], v[120:123]
  buffer_load_dwordx4 v2, s[16:19], s42 offen offset:1024 sc1 lds
  v_cndmask_b32 v86, 0, v86, s[12:13]
  v_mfma_f32_16x16x32_bf16 v[120:123], a[152:155], v[104:107], v[120:123]
  s_sub_u32 s51, s51, s5
  v_exp_f32 v87, v87
  v_mfma_f32_16x16x32_bf16 v[120:123], a[156:159], v[136:139], v[120:123]
  ds_read_b128 a[136:139], v19 offset:2048
  v_cndmask_b32 v87, 0, v87, s[14:15]
  v_cvt_pk_bf16_f32 v215, v86, v87
  v_mfma_f32_16x16x32_bf16 v[124:127], a[144:147], v[44:47], v[252:255]
  s_cmp_eq_u32 s50, s4
  v_exp_f32 v56, v56
  v_mfma_f32_16x16x32_bf16 v[124:127], a[148:151], v[76:79], v[124:127]
  buffer_load_dwordx4 v2, s[16:19], s42 offen offset:2048 sc1 lds
  v_mfma_f32_16x16x32_bf16 v[124:127], a[152:155], v[108:111], v[124:127]
  v_exp_f32 v57, v57
  v_mfma_f32_16x16x32_bf16 v[124:127], a[156:159], v[140:143], v[124:127]
  ds_read_b128 a[140:143], v19 offset:3072
  v_cvt_pk_bf16_f32 v216, v56, v57
  v_mfma_f32_16x16x32_bf16 a[64:67], a[160:163], v[224:227], a[64:67]
  s_cselect_b32 s51, s6, s51
  v_exp_f32 v58, v58
  v_mfma_f32_16x16x32_bf16 a[68:71], a[160:163], v[228:231], a[68:71]
  buffer_load_dwordx4 v2, s[16:19], s42 offen offset:3072 sc1 lds
  v_mfma_f32_16x16x32_bf16 a[72:75], a[160:163], v[232:235], a[72:75]
  s_add_u32 s51, s51, 1
  v_exp_f32 v59, v59
  v_mfma_f32_16x16x32_bf16 a[76:79], a[160:163], v[236:239], a[76:79]
  ds_read_b128 a[144:147], v3 offset:0
  v_cvt_pk_bf16_f32 v217, v58, v59
  v_mfma_f32_16x16x32_bf16 a[80:83], a[164:167], v[224:227], a[80:83]
  s_mov_b32 m0, s59
  v_exp_f32 v88, v88
  v_mfma_f32_16x16x32_bf16 a[84:87], a[164:167], v[228:231], a[84:87]
  buffer_load_dwordx4 v2, s[16:19], s43 offen offset:0 sc1 lds
  v_mfma_f32_16x16x32_bf16 a[88:91], a[164:167], v[232:235], a[88:91]
  s_cmp_lt_u32 s50, s4
  v_exp_f32 v89, v89
  v_mfma_f32_16x16x32_bf16 a[92:95], a[164:167], v[236:239], a[92:95]
  ds_read_b128 a[148:151], v3 offset:1024
  v_cvt_pk_bf16_f32 v218, v88, v89
  v_mfma_f32_16x16x32_bf16 a[96:99], a[168:171], v[224:227], a[96:99]
  s_cselect_b32 s51, 0x8000, s51
  v_exp_f32 v90, v90
  v_mfma_f32_16x16x32_bf16 a[100:103], a[168:171], v[228:231], a[100:103]
  buffer_load_dwordx4 v2, s[16:19], s43 offen offset:1024 sc1 lds
  v_mfma_f32_16x16x32_bf16 a[104:107], a[168:171], v[232:235], a[104:107]
  s_cmp_gt_u32 s50, 16
  v_exp_f32 v91, v91
  v_mfma_f32_16x16x32_bf16 a[108:111], a[168:171], v[236:239], a[108:111]
  ds_read_b128 a[152:155], v3 offset:2048
  v_cvt_pk_bf16_f32 v219, v90, v91
  v_mfma_f32_16x16x32_bf16 a[112:115], a[172:175], v[224:227], a[112:115]
  s_cselect_b32 s51, 0x8000, s51
  v_exp_f32 v60, v60
  v_mfma_f32_16x16x32_bf16 a[116:119], a[172:175], v[228:231], a[116:119]
  buffer_load_dwordx4 v2, s[16:19], s43 offen offset:2048 sc1 lds
  v_mfma_f32_16x16x32_bf16 a[120:123], a[172:175], v[232:235], a[120:123]
  v_exp_f32 v61, v61
  v_mfma_f32_16x16x32_bf16 a[124:127], a[172:175], v[236:239], a[124:127]
  ds_read_b128 a[156:159], v3 offset:3072
  v_cvt_pk_bf16_f32 v220, v60, v61
  s_lshl_b32 s51, s51, 15
  v_exp_f32 v62, v62
  buffer_load_dwordx4 v2, s[16:19], s43 offen offset:3072 sc1 lds
  s_add_u32 s44, s51, s40
  v_exp_f32 v63, v63
  ds_read_b128 a[160:163], v19 offset:4096
  v_cvt_pk_bf16_f32 v221, v62, v63
  s_add_u32 s50, s39, 2
  v_exp_f32 v92, v92
  s_lshl_b32 s51, s50, 1
  s_sub_u32 s51, s51, s5
  s_cmp_eq_u32 s50, s4
  v_exp_f32 v93, v93
  ds_read_b128 a[164:167], v19 offset:5120
  v_cvt_pk_bf16_f32 v222, v92, v93
  s_cselect_b32 s51, s6, s51
  v_exp_f32 v94, v94
  s_add_u32 s51, s51, 1
  s_cmp_lt_u32 s50, s4
  s_cselect_b32 s51, 0x8000, s51
  v_exp_f32 v95, v95
  ds_read_b128 a[168:171], v19 offset:6144
  v_cvt_pk_bf16_f32 v223, v94, v95
  v_mfma_f32_16x16x32_bf16 v[156:159], a[176:179], v[44:47], v[252:255]
  s_cmp_gt_u32 s50, 16
  s_cselect_b32 s51, 0x8000, s51
  v_mfma_f32_16x16x32_bf16 v[156:159], a[180:183], v[76:79], v[156:159]
  s_lshl_b32 s51, s51, 15
  s_add_u32 s45, s51, s40
  v_mfma_f32_16x16x32_bf16 v[156:159], a[184:187], v[108:111], v[156:159]
  s_add_u32 s45, s45, 16384
  s_add_u32 s39, s39, 1
  v_mfma_f32_16x16x32_bf16 v[156:159], a[188:191], v[140:143], v[156:159]
  ds_read_b128 a[172:175], v19 offset:7168
  s_setpc_b64 s[52:53]
.p2align 6
L_w_b_full_diag_0:
  s_setpc_b64 s[52:53]
L_w2_b_full_diag_0:
  s_setpc_b64 s[56:57]
L_b_full_diag_0:
  v_mfma_f32_16x16x32_bf16 a[192:195], a[208:211], v[208:211], a[192:195]
  v_mfma_f32_16x16x32_bf16 a[196:199], a[208:211], v[212:215], a[196:199]
  v_mfma_f32_16x16x32_bf16 a[200:203], a[208:211], v[216:219], a[200:203]
  s_waitcnt lgkmcnt(8)
  v_mfma_f32_16x16x32_bf16 a[204:207], a[208:211], v[220:223], a[204:207]
  ds_read_b128 a[176:179], v3 offset:4096
  v_mfma_f32_16x16x32_bf16 a[0:3], a[128:131], v[208:211], a[0:3]
  s_add_u32 m0, s58, 0x10000
  v_mfma_f32_16x16x32_bf16 a[4:7], a[128:131], v[212:215], a[4:7]
  buffer_load_dwordx4 v2, s[16:19], s44 offen offset:0 sc1 lds
  v_mfma_f32_16x16x32_bf16 a[8:11], a[128:131], v[216:219], a[8:11]
  v_mfma_f32_16x16x32_bf16 a[12:15], a[128:131], v[220:223], a[12:15]
  ds_read_b128 a[180:183], v3 offset:5120
  v_mfma_f32_16x16x32_bf16 a[16:19], a[132:135], v[208:211], a[16:19]
  v_mfma_f32_16x16x32_bf16 a[20:23], a[132:135], v[212:215], a[20:23]
  buffer_load_dwordx4 v2, s[16:19], s44 offen offset:1024 sc1 lds
  v_mfma_f32_16x16x32_bf16 a[24:27], a[132:135], v[216:219], a[24:27]
  v_mfma_f32_16x16x32_bf16 a[28:31], a[132:135], v[220:223], a[28:31]
  ds_read_b128 a[184:187], v3 offset:6144
  v_mfma_f32_16x16x32_bf16 a[32:35], a[136:139], v[208:211], a[32:35]
  v_mfma_f32_16x16x32_bf16 a[36:39], a[136:139], v[212:215], a[36:39]
  buffer_load_dwordx4 v2, s[16:19], s44 offen offset:2048 sc1 lds
  v_mfma_f32_16x16x32_bf16 a[40:43], a[136:139], v[216:219], a[40:43]
  v_mfma_f32_16x16x32_bf16 a[44:47], a[136:139], v[220:223], a[44:47]
  ds_read_b128 a[188:191], v3 offset:7168
  v_mfma_f32_16x16x32_bf16 a[48:51], a[140:143], v[208:211], a[48:51]
  v_mfma_f32_16x16x32_bf16 a[52:55], a[140:143], v[212:215], a[52:55]
  buffer_load_dwordx4 v2, s[16:19], s44 offen offset:3072 sc1 lds
  v_mfma_f32_16x16x32_bf16 a[56:59], a[140:143], v[216:219], a[56:59]
  s_waitcnt lgkmcnt(8)
  v_mfma_f32_16x16x32_bf16 a[60:63], a[140:143], v[220:223], a[60:63]
  v_mfma_f32_16x16x32_bf16 v[48:51], a[144:147], v[32:35], v[240:243]
  s_add_u32 m0, s59, 0x10000
  v_mfma_f32_16x16x32_bf16 v[48:51], a[148:151], v[64:67], v[48:51]
  buffer_load_dwordx4 v2, s[16:19], s45 offen offset:0 sc1 lds
  v_mfma_f32_16x16x32_bf16 v[48:51], a[152:155], v[96:99], v[48:51]
  s_add_u32 s50, s39, 3
  v_mfma_f32_16x16x32_bf16 v[48:51], a[156:159], v[128:131], v[48:51]
  ds_read_b128 a[128:131], v19 offset:8192
  v_mfma_f32_16x16x32_bf16 v[52:55], a[144:147], v[36:39], v[244:247]
  s_lshl_b32 s51, s50, 1
  v_mfma_f32_16x16x32_bf16 v[52:55], a[148:151], v[68:71], v[52:55]
  buffer_load_dwordx4 v2, s[16:19], s45 offen offset:1024 sc1 lds
  v_mfma_f32_16x16x32_bf16 v[52:55], a[152:155], v[100:103], v[52:55]
  s_sub_u32 s51, s51, s5
  v_mfma_f32_16x16x32_bf16 v[52:55], a[156:159], v[132:135], v[52:55]
  ds_read_b128 a[132:135], v19 offset:9216
  v_mfma_f32_16x16x32_bf16 v[56:59], a[144:147], v[40:43], v[248:251]
  s_cmp_eq_u32 s50, s4
  v_mfma_f32_16x16x32_bf16 v[56:59], a[148:151], v[72:75], v[56:59]
  buffer_load_dwordx4 v2, s[16:19], s45 offen offset:2048 sc1 lds
  v_mfma_f32_16x16x32_bf16 v[56:59], a[152:155], v[104:107], v[56:59]
  s_cselect_b32 s51, s6, s51
  v_mfma_f32_16x16x32_bf16 v[56:59], a[156:159], v[136:139], v[56:59]
  ds_read_b128 a[136:139], v19 offset:10240
  v_mfma_f32_16x16x32_bf16 v[60:63], a[144:147], v[44:47], v[252:255]
  s_cmp_lt_u32 s50, s4
  v_exp_f32 v120, v120
  v_mfma_f32_16x16x32_bf16 v[60:63], a[148:151], v[76:79], v[60:63]
  buffer_load_dwordx4 v2, s[16:19], s45 offen offset:3072 sc1 lds
  v_cndmask_b32 v120, 0, v120, s[8:9]
  v_mfma_f32_16x16x32_bf16 v[60:63], a[152:155], v[108:111], v[60:63]
  s_waitcnt lgkmcnt(7)
  v_exp_f32 v121, v121
  v_mfma_f32_16x16x32_bf16 v[60:63], a[156:159], v[140:143], v[60:63]
  ds_read_b128 a[140:143], v19 offset:11264
  v_cndmask_b32 v121, 0, v121, s[10:11]
  v_cvt_pk_bf16_f32 v232, v120, v121
  v_mfma_f32_16x16x32_bf16 a[64:67], a[160:163], v[208:211], a[64:67]
  s_cselect_b32 s51, s50, s51
  v_exp_f32 v122, v122
  v_mfma_f32_16x16x32_bf16 a[68:71], a[160:163], v[212:215], a[68:71]
  v_cndmask_b32 v122, 0, v122, s[12:13]
  v_mfma_f32_16x16x32_bf16 a[72:75], a[160:163], v[216:219], a[72:75]
  s_cmp_gt_u32 s50, 16
  v_exp_f32 v123, v123
  v_mfma_f32_16x16x32_bf16 a[76:79], a[160:163], v[220:223], a[76:79]
  ds_read_b128 a[144:147], v3 offset:8192
  v_cndmask_b32 v123, 0, v123, s[14:15]
  v_cvt_pk_bf16_f32 v233, v122, v123
  v_mfma_f32_16x16x32_bf16 a[80:83], a[164:167], v[208:211], a[80:83]
  s_cselect_b32 s51, 0x8000, s51
  v_mov_b32 v152, 0
  v_mfma_f32_16x16x32_bf16 a[84:87], a[164:167], v[212:215], a[84:87]
  v_mfma_f32_16x16x32_bf16 a[88:91], a[164:167], v[216:219], a[88:91]
  s_lshl_b32 s51, s51, 15
  v_mov_b32 v153, 0
  v_mfma_f32_16x16x32_bf16 a[92:95], a[164:167], v[220:223], a[92:95]
  ds_read_b128 a[148:151], v3 offset:9216
  v_cvt_pk_bf16_f32 v234, v152, v153
  v_mfma_f32_16x16x32_bf16 a[96:99], a[168:171], v[208:211], a[96:99]
  s_add_u32 s42, s51, s40
  v_mov_b32 v154, 0
  v_mfma_f32_16x16x32_bf16 a[100:103], a[168:171], v[212:215], a[100:103]
  v_mfma_f32_16x16x32_bf16 a[104:107], a[168:171], v[216:219], a[104:107]
  s_add_u32 s50, s39, 2
  v_mov_b32 v155, 0
  v_mfma_f32_16x16x32_bf16 a[108:111], a[168:171], v[220:223], a[108:111]
  ds_read_b128 a[152:155], v3 offset:10240
  v_cvt_pk_bf16_f32 v235, v154, v155
  v_mfma_f32_16x16x32_bf16 a[112:115], a[172:175], v[208:211], a[112:115]
  s_lshl_b32 s51, s50, 1
  v_exp_f32 v124, v124
  v_mfma_f32_16x16x32_bf16 a[116:119], a[172:175], v[212:215], a[116:119]
  v_mfma_f32_16x16x32_bf16 a[120:123], a[172:175], v[216:219], a[120:123]
  s_waitcnt lgkmcnt(7)
  v_exp_f32 v125, v125
  v_mfma_f32_16x16x32_bf16 a[124:127], a[172:175], v[220:223], a[124:127]
  ds_read_b128 a[156:159], v3 offset:11264
  v_cvt_pk_bf16_f32 v236, v124, v125
  v_mfma_f32_16x16x32_bf16 v[80:83], a[176:179], v[32:35], v[240:243]
  s_sub_u32 s51, s51, s5
  v_exp_f32 v126, v126
  v_mfma_f32_16x16x32_bf16 v[80:83], a[180:183], v[64:67], v[80:83]
  v_mfma_f32_16x16x32_bf16 v[80:83], a[184:187], v[96:99], v[80:83]
  s_cmp_eq_u32 s50, s4
  v_exp_f32 v127, v127
  v_mfma_f32_16x16x32_bf16 v[80:83], a[188:191], v[128:131], v[80:83]
  ds_read_b128 a[160:163], v19 offset:12288
  v_cvt_pk_bf16_f32 v237, v126, v127
  v_mfma_f32_16x16x32_bf16 v[84:87], a[176:179], v[36:39], v[244:247]
  s_cselect_b32 s51, s6, s51
  v_exp_f32 v156, v156
  v_mfma_f32_16x16x32_bf16 v[84:87], a[180:183], v[68:71], v[84:87]
  v_cndmask_b32 v156, 0, v156, s[8:9]
  v_mfma_f32_16x16x32_bf16 v[84:87], a[184:187], v[100:103], v[84:87]
  s_cmp_lt_u32 s50, s4
  v_exp_f32 v157, v157
  v_mfma_f32_16x16x32_bf16 v[84:87], a[188:191], v[132:135], v[84:87]
  ds_read_b128 a[164:167], v19 offset:13312
  v_cndmask_b32 v157, 0, v157, s[10:11]
  v_cvt_pk_bf16_f32 v238, v156, v157
  v_mfma_f32_16x16x32_bf16 v[88:91], a[176:179], v[40:43], v[248:251]
  s_cselect_b32 s51, s50, s51
  v_exp_f32 v158, v158
  v_mfma_f32_16x16x32_bf16 v[88:91], a[180:183], v[72:75], v[88:91]
  v_cndmask_b32 v158, 0, v158, s[12:13]
  v_mfma_f32_16x16x32_bf16 v[88:91], a[184:187], v[104:107], v[88:91]
  s_cmp_gt_u32 s50, 16
  v_exp_f32 v159, v159
  v_mfma_f32_16x16x32_bf16 v[88:91], a[188:191], v[136:139], v[88:91]
  ds_read_b128 a[168:171], v19 offset:14336
  v_cndmask_b32 v159, 0, v159, s[14:15]
  v_cvt_pk_bf16_f32 v239, v158, v159
  v_mfma_f32_16x16x32_bf16 v[92:95], a[176:179], v[44:47], v[252:255]
  s_cselect_b32 s51, 0x8000, s51
  v_mfma_f32_16x16x32_bf16 v[92:95], a[180:183], v[76:79], v[92:95]
  s_lshl_b32 s51, s51, 15
  s_add_u32 s43, s51, s40
  v_mfma_f32_16x16x32_bf16 v[92:95], a[184:187], v[108:111], v[92:95]
  s_add_u32 s43, s43, 16384
  v_mfma_f32_16x16x32_bf16 v[92:95], a[188:191], v[140:143], v[92:95]
  ds_read_b128 a[172:175], v19 offset:15360
  s_and_b32 s50, s39, 1
  v_exp_f32 v48, v48
  ds_read_b128 a[176:179], v3 offset:12288
  v_mfma_f32_16x16x32_bf16 a[200:203], a[208:211], v[232:235], a[200:203]
  s_waitcnt lgkmcnt(9)
  v_exp_f32 v49, v49
  v_mfma_f32_16x16x32_bf16 a[204:207], a[208:211], v[236:239], a[204:207]
  ds_read_b128 a[180:183], v3 offset:13312
  v_cvt_pk_bf16_f32 v208, v48, v49
  s_lshl_b32 s50, s50, 14
  v_exp_f32 v50, v50
  ds_read_b128 a[184:187], v3 offset:14336
  v_mfma_f32_16x16x32_bf16 a[8:11], a[128:131], v[232:235], a[8:11]
  s_add_u32 s51, s39, 2
  v_exp_f32 v51, v51
  v_mfma_f32_16x16x32_bf16 a[12:15], a[128:131], v[236:239], a[12:15]
  ds_read_b128 a[188:191], v3 offset:15360
  v_cvt_pk_bf16_f32 v209, v50, v51
  s_sub_u32 s51, s51, s49
  v_exp_f32 v80, v80
  s_cmp_ge_i32 s51, 2
  s_cselect_b32 s46, s48, 0
  v_mfma_f32_16x16x32_bf16 a[24:27], a[132:135], v[232:235], a[24:27]
  s_add_u32 s46, s46, s50
  v_exp_f32 v81, v81
  v_mfma_f32_16x16x32_bf16 a[28:31], a[132:135], v[236:239], a[28:31]
  s_cmp_ge_i32 s51, 3
  v_cvt_pk_bf16_f32 v210, v80, v81
  s_cselect_b32 s47, s48, 0
  v_exp_f32 v82, v82
  s_xor_b32 s51, s50, 0x4000
  s_add_u32 s47, s47, s51
  v_mfma_f32_16x16x32_bf16 a[40:43], a[136:139], v[232:235], a[40:43]
  s_add_u32 s47, s47, 0x8000
  v_exp_f32 v83, v83
  v_mfma_f32_16x16x32_bf16 a[44:47], a[136:139], v[236:239], a[44:47]
  v_cvt_pk_bf16_f32 v211, v82, v83
  s_add_u32 s58, s51, s41
  v_exp_f32 v52, v52
  s_add_u32 s59, s50, s41
  s_add_u32 s59, s59, 0x8000
  v_mfma_f32_16x16x32_bf16 a[56:59], a[140:143], v[232:235], a[56:59]
  s_waitcnt lgkmcnt(8)
  v_exp_f32 v53, v53
  v_mfma_f32_16x16x32_bf16 a[60:63], a[140:143], v[236:239], a[60:63]
  s_waitcnt vmcnt(0) lgkmcnt(0)
  s_barrier
  v_cvt_pk_bf16_f32 v212, v52, v53
  v_mfma_f32_16x16x32_bf16 v[112:115], a[144:147], v[32:35], v[240:243]
  v_exp_f32 v54, v54
  v_mfma_f32_16x16x32_bf16 v[112:115], a[148:151], v[64:67], v[112:115]
  v_add_u32 v3, s46, v2
  v_add_u32 v19, s47, v2
  v_mfma_f32_16x16x32_bf16 v[112:115], a[152:155], v[96:99], v[112:115]
  v_exp_f32 v55, v55
  v_mfma_f32_16x16x32_bf16 v[112:115], a[156:159], v[128:131], v[112:115]
  ds_read_b128 a[128:131], v19 offset:0
  v_cvt_pk_bf16_f32 v213, v54, v55
  v_mfma_f32_16x16x32_bf16 v[116:119], a[144:147], v[36:39], v[244:247]
  s_mov_b32 m0, s58
  v_exp_f32 v84, v84
  v_mfma_f32_16x16x32_bf16 v[116:119], a[148:151], v[68:71], v[116:119]
  buffer_load_dwordx4 v2, s[16:19], s42 offen offset:0 sc1 lds
  v_mfma_f32_16x16x32_bf16 v[116:119], a[152:155], v[100:103], v[116:119]
  s_add_u32 s50, s39, 3
  v_exp_f32 v85, v85
  v_mfma_f32_16x16x32_bf16 v[116:119], a[156:159], v[132:135], v[116:119]
  ds_read_b128 a[132:135], v19 offset:1024
  v_cvt_pk_bf16_f32 v214, v84, v85
  v_mfma_f32_16x16x32_bf16 v[120:123], a[144:147], v[40:43], v[248:251]
  s_lshl_b32 s51, s50, 1
  v_exp_f32 v86, v86
  v_mfma_f32_16x16x32_bf16 v[120:123], a[148:151], v[72:75], v[120:123]
  buffer_load_dwordx4 v2, s[16:19], s42 offen offset:1024 sc1 lds
  v_mfma_f32_16x16x32_bf16 v[120:123], a[152:155], v[104:107], v[120:123]
  s_sub_u32 s51, s51, s5
  v_exp_f32 v87, v87
  v_mfma_f32_16x16x32_bf16 v[120:123], a[156:159], v[136:139], v[120:123]
  ds_read_b128 a[136:139], v19 offset:2048
  v_cvt_pk_bf16_f32 v215, v86, v87
  v_mfma_f32_16x16x32_bf16 v[124:127], a[144:147], v[44:47], v[252:255]
  s_cmp_eq_u32 s50, s4
  v_exp_f32 v56, v56
  v_mfma_f32_16x16x32_bf16 v[124:127], a[148:151], v[76:79], v[124:127]
  buffer_load_dwordx4 v2, s[16:19], s42 offen offset:2048 sc1 lds
  v_mfma_f32_16x16x32_bf16 v[124:127], a[152:155], v[108:111], v[124:127]
  v_exp_f32 v57, v57
  v_mfma_f32_16x16x32_bf16 v[124:127], a[156:159], v[140:143], v[124:127]
  ds_read_b128 a[140:143], v19 offset:3072
  v_cvt_pk_bf16_f32 v216, v56, v57
  s_cselect_b32 s51, s6, s51
  v_exp_f32 v58, v58
  buffer_load_dwordx4 v2, s[16:19], s42 offen offset:3072 sc1 lds
  v_mfma_f32_16x16x32_bf16 a[72:75], a[160:163], v[232:235], a[72:75]
  s_add_u32 s51, s51, 1
  v_exp_f32 v59, v59
  v_mfma_f32_16x16x32_bf16 a[76:79], a[160:163], v[236:239], a[76:79]
  ds_read_b128 a[144:147], v3 offset:0
  v_cvt_pk_bf16_f32 v217, v58, v59
  s_mov_b32 m0, s59
  v_exp_f32 v88, v88
  buffer_load_dwordx4 v2, s[16:19], s43 offen offset:0 sc1 lds
  v_mfma_f32_16x16x32_bf16 a[88:91], a[164:167], v[232:235], a[88:91]
  s_cmp_lt_u32 s50, s4
  v_exp_f32 v89, v89
  v_mfma_f32_16x16x32_bf16 a[92:95], a[164:167], v[236:239], a[92:95]
  ds_read_b128 a[148:151], v3 offset:1024
  v_cvt_pk_bf16_f32 v218, v88, v89
  s_cselect_b32 s51, 0x8000, s51
  v_exp_f32 v90, v90
  buffer_load_dwordx4 v2, s[16:19], s43 offen offset:1024 sc1 lds
  v_mfma_f32_16x16x32_bf16 a[104:107], a[168:171], v[232:235], a[104:107]
  s_cmp_gt_u32 s50, 16
  v_exp_f32 v91, v91
  v_mfma_f32_16x16x32_bf16 a[108:111], a[168:171], v[236:239], a[108:111]
  ds_read_b128 a[152:155], v3 offset:2048
  v_cvt_pk_bf16_f32 v219, v90, v91
  s_cselect_b32 s51, 0x8000, s51
  v_exp_f32 v60, v60
  buffer_load_dwordx4 v2, s[16:19], s43 offen offset:2048 sc1 lds
  v_mfma_f32_16x16x32_bf16 a[120:123], a[172:175], v[232:235], a[120:123]
  v_exp_f32 v61, v61
  v_mfma_f32_16x16x32_bf16 a[124:127], a[172:175], v[236:239], a[124:127]
  ds_read_b128 a[156:159], v3 offset:3072
  v_cvt_pk_bf16_f32 v220, v60, v61
  v_mfma_f32_16x16x32_bf16 v[144:147], a[176:179], v[32:35], v[240:243]
  s_lshl_b32 s51, s51, 15
  v_exp_f32 v62, v62
  v_mfma_f32_16x16x32_bf16 v[144:147], a[180:183], v[64:67], v[144:147]
  buffer_load_dwordx4 v2, s[16:19], s43 offen offset:3072 sc1 lds
  v_mfma_f32_16x16x32_bf16 v[144:147], a[184:187], v[96:99], v[144:147]
  s_add_u32 s44, s51, s40
  v_exp_f32 v63, v63
  v_mfma_f32_16x16x32_bf16 v[144:147], a[188:191], v[128:131], v[144:147]
  ds_read_b128 a[160:163], v19 offset:4096
  v_cvt_pk_bf16_f32 v221, v62, v63
  v_mfma_f32_16x16x32_bf16 v[148:151], a[176:179], v[36:39], v[244:247]
  s_add_u32 s50, s39, 2
  v_exp_f32 v92, v92
  v_mfma_f32_16x16x32_bf16 v[148:151], a[180:183], v[68:71], v[148:151]
  s_lshl_b32 s51, s50, 1
  s_sub_u32 s51, s51, s5
  v_mfma_f32_16x16x32_bf16 v[148:151], a[184:187], v[100:103], v[148:151]
  s_cmp_eq_u32 s50, s4
  v_exp_f32 v93, v93
  v_mfma_f32_16x16x32_bf16 v[148:151], a[188:191], v[132:135], v[148:151]
  ds_read_b128 a[164:167], v19 offset:5120
  v_cvt_pk_bf16_f32 v222, v92, v93
  v_mfma_f32_16x16x32_bf16 v[152:155], a[176:179], v[40:43], v[248:251]
  s_cselect_b32 s51, s6, s51
  v_exp_f32 v94, v94
  v_mfma_f32_16x16x32_bf16 v[152:155], a[180:183], v[72:75], v[152:155]
  s_add_u32 s51, s51, 1
  s_cmp_lt_u32 s50, s4
  v_mfma_f32_16x16x32_bf16 v[152:155], a[184:187], v[104:107], v[152:155]
  s_cselect_b32 s51, 0x8000, s51
  v_exp_f32 v95, v95
  v_mfma_f32_16x16x32_bf16 v[152:155], a[188:191], v[136:139], v[152:155]
  ds_read_b128 a[168:171], v19 offset:6144
  v_cvt_pk_bf16_f32 v223, v94, v95
  v_mfma_f32_16x16x32_bf16 v[156:159], a[176:179], v[44:47], v[252:255]
  s_cmp_gt_u32 s50, 16
  s_cselect_b32 s51, 0x8000, s51
  v_mfma_f32_16x16x32_bf16 v[156:159], a[180:183], v[76:79], v[156:159]
  s_lshl_b32 s51, s51, 15
  s_add_u32 s45, s51, s40
  v_mfma_f32_16x16x32_bf16 v[156:159], a[184:187], v[108:111], v[156:159]
  s_add_u32 s45, s45, 16384
  s_add_u32 s39, s39, 1
  v_mfma_f32_16x16x32_bf16 v[156:159], a[188:191], v[140:143], v[156:159]
  ds_read_b128 a[172:175], v19 offset:7168
  s_setpc_b64 s[52:53]
.p2align 6
L_w_b_None_diag_0lastlo:
  s_setpc_b64 s[52:53]
L_w2_b_None_diag_0lastlo:
  s_setpc_b64 s[56:57]
L_b_None_diag_0lastlo:
  v_mfma_f32_16x16x32_bf16 a[192:195], a[208:211], v[208:211], a[192:195]
  v_mfma_f32_16x16x32_bf16 a[196:199], a[208:211], v[212:215], a[196:199]
  v_mfma_f32_16x16x32_bf16 a[200:203], a[208:211], v[216:219], a[200:203]
  s_waitcnt lgkmcnt(8)
  v_mfma_f32_16x16x32_bf16 a[204:207], a[208:211], v[220:223], a[204:207]
  v_mfma_f32_16x16x32_bf16 a[0:3], a[128:131], v[208:211], a[0:3]
  v_mfma_f32_16x16x32_bf16 a[4:7], a[128:131], v[212:215], a[4:7]
  v_mfma_f32_16x16x32_bf16 a[8:11], a[128:131], v[216:219], a[8:11]
  v_mfma_f32_16x16x32_bf16 a[12:15], a[128:131], v[220:223], a[12:15]
  v_mfma_f32_16x16x32_bf16 a[16:19], a[132:135], v[208:211], a[16:19]
  v_mfma_f32_16x16x32_bf16 a[20:23], a[132:135], v[212:215], a[20:23]
  v_mfma_f32_16x16x32_bf16 a[24:27], a[132:135], v[216:219], a[24:27]
  v_mfma_f32_16x16x32_bf16 a[28:31], a[132:135], v[220:223], a[28:31]
  v_mfma_f32_16x16x32_bf16 a[32:35], a[136:139], v[208:211], a[32:35]
  v_mfma_f32_16x16x32_bf16 a[36:39], a[136:139], v[212:215], a[36:39]
  ds_read_b128 a[128:131], v19 offset:8192
  v_mfma_f32_16x16x32_bf16 a[40:43], a[136:139], v[216:219], a[40:43]
  v_mfma_f32_16x16x32_bf16 a[44:47], a[136:139], v[220:223], a[44:47]
  ds_read_b128 a[132:135], v19 offset:9216
  v_mfma_f32_16x16x32_bf16 a[48:51], a[140:143], v[208:211], a[48:51]
  v_mfma_f32_16x16x32_bf16 a[52:55], a[140:143], v[212:215], a[52:55]
  ds_read_b128 a[136:139], v19 offset:10240
  v_mfma_f32_16x16x32_bf16 a[56:59], a[140:143], v[216:219], a[56:59]
  v_exp_f32 v120, v120
  s_nop 0
  v_cndmask_b32 v120, 0, v120, s[8:9]
  v_mfma_f32_16x16x32_bf16 a[60:63], a[140:143], v[220:223], a[60:63]
  s_waitcnt lgkmcnt(3)
  v_exp_f32 v121, v121
  ds_read_b128 a[140:143], v19 offset:11264
  v_cndmask_b32 v121, 0, v121, s[10:11]
  v_cvt_pk_bf16_f32 v232, v120, v121
  v_mfma_f32_16x16x32_bf16 a[64:67], a[160:163], v[208:211], a[64:67]
  v_exp_f32 v122, v122
  s_nop 0
  v_cndmask_b32 v122, 0, v122, s[12:13]
  v_mfma_f32_16x16x32_bf16 a[68:71], a[160:163], v[212:215], a[68:71]
  v_exp_f32 v123, v123
  s_nop 0
  v_cndmask_b32 v123, 0, v123, s[14:15]
  v_cvt_pk_bf16_f32 v233, v122, v123
  v_mfma_f32_16x16x32_bf16 a[72:75], a[160:163], v[216:219], a[72:75]
  v_mov_b32 v152, 0
  v_mfma_f32_16x16x32_bf16 a[76:79], a[160:163], v[220:223], a[76:79]
  v_mov_b32 v153, 0
  v_cvt_pk_bf16_f32 v234, v152, v153
  v_mfma_f32_16x16x32_bf16 a[80:83], a[164:167], v[208:211], a[80:83]
  v_mov_b32 v154, 0
  v_mfma_f32_16x16x32_bf16 a[84:87], a[164:167], v[212:215], a[84:87]
  v_mov_b32 v155, 0
  v_cvt_pk_bf16_f32 v235, v154, v155
  v_mfma_f32_16x16x32_bf16 a[88:91], a[164:167], v[216:219], a[88:91]
  v_exp_f32 v124, v124
  v_mfma_f32_16x16x32_bf16 a[92:95], a[164:167], v[220:223], a[92:95]
  v_exp_f32 v125, v125
  s_nop 0
  v_cvt_pk_bf16_f32 v236, v124, v125
  v_mfma_f32_16x16x32_bf16 a[96:99], a[168:171], v[208:211], a[96:99]
  v_exp_f32 v126, v126
  v_mfma_f32_16x16x32_bf16 a[100:103], a[168:171], v[212:215], a[100:103]
  v_exp_f32 v127, v127
  ds_read_b128 a[160:163], v19 offset:12288
  v_cvt_pk_bf16_f32 v237, v126, v127
  v_mfma_f32_16x16x32_bf16 a[104:107], a[168:171], v[216:219], a[104:107]
  v_exp_f32 v156, v156
  s_nop 0
  v_cndmask_b32 v156, 0, v156, s[8:9]
  v_mfma_f32_16x16x32_bf16 a[108:111], a[168:171], v[220:223], a[108:111]
  v_exp_f32 v157, v157
  ds_read_b128 a[164:167], v19 offset:13312
  v_cndmask_b32 v157, 0, v157, s[10:11]
  v_cvt_pk_bf16_f32 v238, v156, v157
  v_mfma_f32_16x16x32_bf16 a[112:115], a[172:175], v[208:211], a[112:115]
  v_exp_f32 v158, v158
  s_nop 0
  v_cndmask_b32 v158, 0, v158, s[12:13]
  v_mfma_f32_16x16x32_bf16 a[116:119], a[172:175], v[212:215], a[116:119]
  v_exp_f32 v159, v159
  ds_read_b128 a[168:171], v19 offset:14336
  v_cndmask_b32 v159, 0, v159, s[14:15]
  v_cvt_pk_bf16_f32 v239, v158, v159
  v_mfma_f32_16x16x32_bf16 a[120:123], a[172:175], v[216:219], a[120:123]
  v_mfma_f32_16x16x32_bf16 a[124:127], a[172:175], v[220:223], a[124:127]
  ds_read_b128 a[172:175], v19 offset:15360
  s_waitcnt vmcnt(0)
  v_mfma_f32_16x16x32_bf16 a[200:203], a[208:211], v[232:235], a[200:203]
  s_waitcnt lgkmcnt(4)
  v_mfma_f32_16x16x32_bf16 a[204:207], a[208:211], v[236:239], a[204:207]
  v_mfma_f32_16x16x32_bf16 a[8:11], a[128:131], v[232:235], a[8:11]
  v_mfma_f32_16x16x32_bf16 a[12:15], a[128:131], v[236:239], a[12:15]
  v_mfma_f32_16x16x32_bf16 a[24:27], a[132:135], v[232:235], a[24:27]
  v_mfma_f32_16x16x32_bf16 a[28:31], a[132:135], v[236:239], a[28:31]
  v_mfma_f32_16x16x32_bf16 a[40:43], a[136:139], v[232:235], a[40:43]
  s_nop 3
  ds_write_b128 v197, a[8:11] offset:0
  v_mfma_f32_16x16x32_bf16 a[44:47], a[136:139], v[236:239], a[44:47]
  ds_write_b128 v197, a[12:15] offset:8192
  v_mfma_f32_16x16x32_bf16 a[56:59], a[140:143], v[232:235], a[56:59]
  v_accvgpr_read_b32 v128, a0
  v_accvgpr_read_b32 v129, a1
  v_mfma_f32_16x16x32_bf16 a[60:63], a[140:143], v[236:239], a[60:63]
  s_waitcnt lgkmcnt(0)
  v_accvgpr_read_b32 v130, a2
  v_accvgpr_read_b32 v131, a3
  v_mfma_f32_16x16x32_bf16 a[72:75], a[160:163], v[232:235], a[72:75]
  v_accvgpr_read_b32 v160, a4
  v_accvgpr_read_b32 v161, a5
  v_mfma_f32_16x16x32_bf16 a[76:79], a[160:163], v[236:239], a[76:79]
  v_accvgpr_read_b32 v162, a6
  v_accvgpr_read_b32 v163, a7
  v_mfma_f32_16x16x32_bf16 a[88:91], a[164:167], v[232:235], a[88:91]
  ds_write_b128 v197, a[24:27] offset:1024
  v_mfma_f32_16x16x32_bf16 a[92:95], a[164:167], v[236:239], a[92:95]
  ds_write_b128 v197, a[28:31] offset:9216
  v_mfma_f32_16x16x32_bf16 a[104:107], a[168:171], v[232:235], a[104:107]
  v_accvgpr_read_b32 v132, a16
  v_accvgpr_read_b32 v133, a17
  v_mfma_f32_16x16x32_bf16 a[108:111], a[168:171], v[236:239], a[108:111]
  v_accvgpr_read_b32 v134, a18
  v_accvgpr_read_b32 v135, a19
  v_mfma_f32_16x16x32_bf16 a[120:123], a[172:175], v[232:235], a[120:123]
  v_accvgpr_read_b32 v164, a20
  v_accvgpr_read_b32 v165, a21
  v_mfma_f32_16x16x32_bf16 a[124:127], a[172:175], v[236:239], a[124:127]
  v_accvgpr_read_b32 v166, a22
  v_accvgpr_read_b32 v167, a23
  ds_write_b128 v197, a[40:43] offset:2048
  ds_write_b128 v197, a[44:47] offset:10240
  v_accvgpr_read_b32 v136, a32
  v_accvgpr_read_b32 v137, a33
  v_accvgpr_read_b32 v138, a34
  v_accvgpr_read_b32 v139, a35
  v_accvgpr_read_b32 v168, a36
  v_accvgpr_read_b32 v169, a37
  v_accvgpr_read_b32 v170, a38
  v_accvgpr_read_b32 v171, a39
  ds_write_b128 v197, a[56:59] offset:3072
  ds_write_b128 v197, a[60:63] offset:11264
  v_accvgpr_read_b32 v140, a48
  v_accvgpr_read_b32 v141, a49
  v_accvgpr_read_b32 v142, a50
  v_accvgpr_read_b32 v143, a51
  v_accvgpr_read_b32 v172, a52
  v_accvgpr_read_b32 v173, a53
  v_accvgpr_read_b32 v174, a54
  v_accvgpr_read_b32 v175, a55
  ds_write_b128 v197, a[72:75] offset:4096
  ds_write_b128 v197, a[76:79] offset:12288
  v_accvgpr_read_b32 v144, a64
  v_accvgpr_read_b32 v145, a65
  v_accvgpr_read_b32 v146, a66
  v_accvgpr_read_b32 v147, a67
  v_accvgpr_read_b32 v176, a68
  v_accvgpr_read_b32 v177, a69
  v_accvgpr_read_b32 v178, a70
  v_accvgpr_read_b32 v179, a71
  ds_write_b128 v197, a[88:91] offset:5120
  ds_write_b128 v197, a[92:95] offset:13312
  v_accvgpr_read_b32 v148, a80
  v_accvgpr_read_b32 v149, a81
  v_accvgpr_read_b32 v150, a82
  v_accvgpr_read_b32 v151, a83
  v_accvgpr_read_b32 v180, a84
  v_accvgpr_read_b32 v181, a85
  v_accvgpr_read_b32 v182, a86
  v_accvgpr_read_b32 v183, a87
  ds_write_b128 v197, a[104:107] offset:6144
  ds_write_b128 v197, a[108:111] offset:14336
  v_accvgpr_read_b32 v152, a96
  v_accvgpr_read_b32 v153, a97
  v_accvgpr_read_b32 v154, a98
  v_accvgpr_read_b32 v155, a99
  v_accvgpr_read_b32 v184, a100
  v_accvgpr_read_b32 v185, a101
  v_accvgpr_read_b32 v186, a102
  v_accvgpr_read_b32 v187, a103
  ds_write_b128 v197, a[120:123] offset:7168
  ds_write_b128 v197, a[124:127] offset:15360
  v_accvgpr_read_b32 v156, a112
  v_accvgpr_read_b32 v157, a113
  v_accvgpr_read_b32 v158, a114
  v_accvgpr_read_b32 v159, a115
  v_accvgpr_read_b32 v188, a116
  v_accvgpr_read_b32 v189, a117
  v_accvgpr_read_b32 v190, a118
  v_accvgpr_read_b32 v191, a119
  s_nop 7
  s_setpc_b64 s[52:53]
.p2align 6
L_w_b_None_diag_0epi:
  s_setpc_b64 s[52:53]
L_w2_b_None_diag_0epi:
  s_setpc_b64 s[56:57]
L_b_None_diag_0epi:
  v_mfma_f32_16x16x32_bf16 a[192:195], a[208:211], v[208:211], a[192:195]
  v_mfma_f32_16x16x32_bf16 a[196:199], a[208:211], v[212:215], a[196:199]
  v_mfma_f32_16x16x32_bf16 a[200:203], a[208:211], v[216:219], a[200:203]
  s_waitcnt lgkmcnt(8)
  v_mfma_f32_16x16x32_bf16 a[204:207], a[208:211], v[220:223], a[204:207]
  v_mfma_f32_16x16x32_bf16 a[0:3], a[128:131], v[208:211], a[0:3]
  s_add_u32 m0, s58, 0x10000
  s_nop 0
  buffer_load_dwordx4 v2, s[16:19], s44 offen offset:0 sc1 lds
  v_mfma_f32_16x16x32_bf16 a[4:7], a[128:131], v[212:215], a[4:7]
  v_mfma_f32_16x16x32_bf16 a[8:11], a[128:131], v[216:219], a[8:11]
  buffer_load_dwordx4 v2, s[16:19], s44 offen offset:1024 sc1 lds
  v_mfma_f32_16x16x32_bf16 a[12:15], a[128:131], v[220:223], a[12:15]
  v_mfma_f32_16x16x32_bf16 a[16:19], a[132:135], v[208:211], a[16:19]
  buffer_load_dwordx4 v2, s[16:19], s44 offen offset:2048 sc1 lds
  v_mfma_f32_16x16x32_bf16 a[20:23], a[132:135], v[212:215], a[20:23]
  v_mfma_f32_16x16x32_bf16 a[24:27], a[132:135], v[216:219], a[24:27]
  buffer_load_dwordx4 v2, s[16:19], s44 offen offset:3072 sc1 lds
  v_mfma_f32_16x16x32_bf16 a[28:31], a[132:135], v[220:223], a[28:31]
  s_waitcnt lgkmcnt(4)
  v_mfma_f32_16x16x32_bf16 a[32:35], a[136:139], v[208:211], a[32:35]
  s_add_u32 m0, s59, 0x10000
  s_nop 0
  buffer_load_dwordx4 v2, s[16:19], s45 offen offset:0 sc1 lds
  v_mfma_f32_16x16x32_bf16 a[36:39], a[136:139], v[212:215], a[36:39]
  s_add_u32 s50, s39, 3
  ds_read_b128 a[128:131], v19 offset:8192
  v_mfma_f32_16x16x32_bf16 a[40:43], a[136:139], v[216:219], a[40:43]
  s_lshl_b32 s51, s50, 1
  buffer_load_dwordx4 v2, s[16:19], s45 offen offset:1024 sc1 lds
  v_mfma_f32_16x16x32_bf16 a[44:47], a[136:139], v[220:223], a[44:47]
  s_sub_u32 s51, s51, s5
  ds_read_b128 a[132:135], v19 offset:9216
  v_mfma_f32_16x16x32_bf16 a[48:51], a[140:143], v[208:211], a[48:51]
  s_cmp_eq_u32 s50, s4
  buffer_load_dwordx4 v2, s[16:19], s45 offen offset:2048 sc1 lds
  v_mfma_f32_16x16x32_bf16 a[52:55], a[140:143], v[212:215], a[52:55]
  s_cselect_b32 s51, s6, s51
  ds_read_b128 a[136:139], v19 offset:10240
  v_mfma_f32_16x16x32_bf16 a[56:59], a[140:143], v[216:219], a[56:59]
  s_cmp_lt_u32 s50, s4
  v_exp_f32 v120, v120
  buffer_load_dwordx4 v2, s[16:19], s45 offen offset:3072 sc1 lds
  v_cndmask_b32 v120, 0, v120, s[8:9]
  v_mfma_f32_16x16x32_bf16 a[60:63], a[140:143], v[220:223], a[60:63]
  s_waitcnt lgkmcnt(3)
  v_exp_f32 v121, v121
  ds_read_b128 a[140:143], v19 offset:11264
  v_cndmask_b32 v121, 0, v121, s[10:11]
  v_cvt_pk_bf16_f32 v232, v120, v121
  v_mfma_f32_16x16x32_bf16 a[64:67], a[160:163], v[208:211], a[64:67]
  s_cselect_b32 s51, s50, s51
  v_exp_f32 v122, v122
  s_nop 0
  v_cndmask_b32 v122, 0, v122, s[12:13]
  v_mfma_f32_16x16x32_bf16 a[68:71], a[160:163], v[212:215], a[68:71]
  s_cmp_gt_u32 s50, 16
  v_exp_f32 v123, v123
  s_nop 0
  v_cndmask_b32 v123, 0, v123, s[14:15]
  v_cvt_pk_bf16_f32 v233, v122, v123
  v_mfma_f32_16x16x32_bf16 a[72:75], a[160:163], v[216:219], a[72:75]
  s_cselect_b32 s51, 0x8000, s51
  v_mov_b32 v152, 0
  v_mfma_f32_16x16x32_bf16 a[76:79], a[160:163], v[220:223], a[76:79]
  s_lshl_b32 s51, s51, 15
  v_mov_b32 v153, 0
  v_cvt_pk_bf16_f32 v234, v152, v153
  v_mfma_f32_16x16x32_bf16 a[80:83], a[164:167], v[208:211], a[80:83]
  s_add_u32 s42, s51, s40
  v_mov_b32 v154, 0
  v_mfma_f32_16x16x32_bf16 a[84:87], a[164:167], v[212:215], a[84:87]
  s_add_u32 s50, s39, 2
  v_mov_b32 v155, 0
  v_cvt_pk_bf16_f32 v235, v154, v155
  v_mfma_f32_16x16x32_bf16 a[88:91], a[164:167], v[216:219], a[88:91]
  s_lshl_b32 s51, s50, 1
  v_exp_f32 v124, v124
  v_mfma_f32_16x16x32_bf16 a[92:95], a[164:167], v[220:223], a[92:95]
  v_exp_f32 v125, v125
  s_nop 0
  v_cvt_pk_bf16_f32 v236, v124, v125
  v_mfma_f32_16x16x32_bf16 a[96:99], a[168:171], v[208:211], a[96:99]
  s_sub_u32 s51, s51, s5
  v_exp_f32 v126, v126
  v_mfma_f32_16x16x32_bf16 a[100:103], a[168:171], v[212:215], a[100:103]
  s_cmp_eq_u32 s50, s4
  v_exp_f32 v127, v127
  ds_read_b128 a[160:163], v19 offset:12288
  v_cvt_pk_bf16_f32 v237, v126, v127
  v_mfma_f32_16x16x32_bf16 a[104:107], a[168:171], v[216:219], a[104:107]
  s_cselect_b32 s51, s6, s51
  v_exp_f32 v156, v156
  s_nop 0
  v_cndmask_b32 v156, 0, v156, s[8:9]
  v_mfma_f32_16x16x32_bf16 a[108:111], a[168:171], v[220:223], a[108:111]
  s_cmp_lt_u32 s50, s4
  v_exp_f32 v157, v157
  ds_read_b128 a[164:167], v19 offset:13312
  v_cndmask_b32 v157, 0, v157, s[10:11]
  v_cvt_pk_bf16_f32 v238, v156, v157
  v_mfma_f32_16x16x32_bf16 a[112:115], a[172:175], v[208:211], a[112:115]
  s_cselect_b32 s51, s50, s51
  v_exp_f32 v158, v158
  s_nop 0
  v_cndmask_b32 v158, 0, v158, s[12:13]
  v_mfma_f32_16x16x32_bf16 a[116:119], a[172:175], v[212:215], a[116:119]
  s_cmp_gt_u32 s50, 16
  v_exp_f32 v159, v159
  ds_read_b128 a[168:171], v19 offset:14336
  v_cndmask_b32 v159, 0, v159, s[14:15]
  v_cvt_pk_bf16_f32 v239, v158, v159
  v_mfma_f32_16x16x32_bf16 a[120:123], a[172:175], v[216:219], a[120:123]
  s_cselect_b32 s51, 0x8000, s51
  s_lshl_b32 s51, s51, 15
  s_add_u32 s43, s51, s40
  v_mfma_f32_16x16x32_bf16 a[124:127], a[172:175], v[220:223], a[124:127]
  s_add_u32 s43, s43, 16384
  ds_read_b128 a[172:175], v19 offset:15360
  s_nop 7
  v_accvgpr_read_b32 v192, a192
  v_accvgpr_read_b32 v193, a196
  v_mov_b32 v196, 1585446912
  v_cmp_nle_f32 vcc, v192, v196
  s_or_b32 s55, s55, vcc_lo
  s_or_b32 s55, s55, vcc_hi
  v_cmp_nle_f32 vcc, v193, v196
  s_or_b32 s55, s55, vcc_lo
  s_or_b32 s55, s55, vcc_hi
  v_rcp_f32 v192, v192
  v_rcp_f32 v193, v193
  s_lshl_b32 s32, s56, 5
  s_add_u32 s32, s32, s37
  s_lshl_b32 s32, s32, 12
  s_add_u32 s32, s32, 41943040
  v_accvgpr_read_b32 v48, a0
  v_accvgpr_read_b32 v49, a1
  v_accvgpr_read_b32 v50, a2
  v_accvgpr_read_b32 v51, a3
  v_accvgpr_read_b32 v52, a16
  v_accvgpr_read_b32 v53, a17
  v_accvgpr_read_b32 v54, a18
  v_accvgpr_read_b32 v55, a19
  v_pk_mul_f32 v[48:49], v[48:49], v[192:193] op_sel:[0,0] op_sel_hi:[1,0]
  v_pk_mul_f32 v[50:51], v[50:51], v[192:193] op_sel:[0,0] op_sel_hi:[1,0]
  v_pk_mul_f32 v[52:53], v[52:53], v[192:193] op_sel:[0,0] op_sel_hi:[1,0]
  v_pk_mul_f32 v[54:55], v[54:55], v[192:193] op_sel:[0,0] op_sel_hi:[1,0]
  v_cvt_pk_bf16_f32 v112, v48, v49
  v_cvt_pk_bf16_f32 v113, v50, v51
  v_cvt_pk_bf16_f32 v114, v52, v53
  v_cvt_pk_bf16_f32 v115, v54, v55
  v_accvgpr_read_b32 v56, a32
  v_accvgpr_read_b32 v57, a33
  v_accvgpr_read_b32 v58, a34
  v_accvgpr_read_b32 v59, a35
  v_accvgpr_read_b32 v60, a48
  v_accvgpr_read_b32 v61, a49
  v_accvgpr_read_b32 v62, a50
  v_accvgpr_read_b32 v63, a51
  v_pk_mul_f32 v[56:57], v[56:57], v[192:193] op_sel:[0,0] op_sel_hi:[1,0]
  v_pk_mul_f32 v[58:59], v[58:59], v[192:193] op_sel:[0,0] op_sel_hi:[1,0]
  v_pk_mul_f32 v[60:61], v[60:61], v[192:193] op_sel:[0,0] op_sel_hi:[1,0]
  v_pk_mul_f32 v[62:63], v[62:63], v[192:193] op_sel:[0,0] op_sel_hi:[1,0]
  v_cvt_pk_bf16_f32 v116, v56, v57
  v_cvt_pk_bf16_f32 v117, v58, v59
  v_cvt_pk_bf16_f32 v118, v60, v61
  v_cvt_pk_bf16_f32 v119, v62, v63
  v_accvgpr_read_b32 v80, a64
  v_accvgpr_read_b32 v81, a65
  v_accvgpr_read_b32 v82, a66
  v_accvgpr_read_b32 v83, a67
  v_accvgpr_read_b32 v84, a80
  v_accvgpr_read_b32 v85, a81
  v_accvgpr_read_b32 v86, a82
  v_accvgpr_read_b32 v87, a83
  v_pk_mul_f32 v[80:81], v[80:81], v[192:193] op_sel:[0,0] op_sel_hi:[1,0]
  v_pk_mul_f32 v[82:83], v[82:83], v[192:193] op_sel:[0,0] op_sel_hi:[1,0]
  v_pk_mul_f32 v[84:85], v[84:85], v[192:193] op_sel:[0,0] op_sel_hi:[1,0]
  v_pk_mul_f32 v[86:87], v[86:87], v[192:193] op_sel:[0,0] op_sel_hi:[1,0]
  v_cvt_pk_bf16_f32 v120, v80, v81
  v_cvt_pk_bf16_f32 v121, v82, v83
  v_cvt_pk_bf16_f32 v122, v84, v85
  v_cvt_pk_bf16_f32 v123, v86, v87
  v_accvgpr_read_b32 v88, a96
  v_accvgpr_read_b32 v89, a97
  v_accvgpr_read_b32 v90, a98
  v_accvgpr_read_b32 v91, a99
  v_accvgpr_read_b32 v92, a112
  v_accvgpr_read_b32 v93, a113
  v_accvgpr_read_b32 v94, a114
  v_accvgpr_read_b32 v95, a115
  v_pk_mul_f32 v[88:89], v[88:89], v[192:193] op_sel:[0,0] op_sel_hi:[1,0]
  v_pk_mul_f32 v[90:91], v[90:91], v[192:193] op_sel:[0,0] op_sel_hi:[1,0]
  v_pk_mul_f32 v[92:93], v[92:93], v[192:193] op_sel:[0,0] op_sel_hi:[1,0]
  v_pk_mul_f32 v[94:95], v[94:95], v[192:193] op_sel:[0,0] op_sel_hi:[1,0]
  v_cvt_pk_bf16_f32 v124, v88, v89
  v_cvt_pk_bf16_f32 v125, v90, v91
  v_cvt_pk_bf16_f32 v126, v92, v93
  v_cvt_pk_bf16_f32 v127, v94, v95
  v_accvgpr_read_b32 v48, a4
  v_accvgpr_read_b32 v49, a5
  v_accvgpr_read_b32 v50, a6
  v_accvgpr_read_b32 v51, a7
  v_accvgpr_read_b32 v52, a20
  v_accvgpr_read_b32 v53, a21
  v_accvgpr_read_b32 v54, a22
  v_accvgpr_read_b32 v55, a23
  v_pk_mul_f32 v[48:49], v[48:49], v[192:193] op_sel:[0,1] op_sel_hi:[1,1]
  v_pk_mul_f32 v[50:51], v[50:51], v[192:193] op_sel:[0,1] op_sel_hi:[1,1]
  v_pk_mul_f32 v[52:53], v[52:53], v[192:193] op_sel:[0,1] op_sel_hi:[1,1]
  v_pk_mul_f32 v[54:55], v[54:55], v[192:193] op_sel:[0,1] op_sel_hi:[1,1]
  v_cvt_pk_bf16_f32 v144, v48, v49
  v_cvt_pk_bf16_f32 v145, v50, v51
  v_cvt_pk_bf16_f32 v146, v52, v53
  v_cvt_pk_bf16_f32 v147, v54, v55
  v_accvgpr_read_b32 v56, a36
  v_accvgpr_read_b32 v57, a37
  v_accvgpr_read_b32 v58, a38
  v_accvgpr_read_b32 v59, a39
  v_accvgpr_read_b32 v60, a52
  v_accvgpr_read_b32 v61, a53
  v_accvgpr_read_b32 v62, a54
  v_accvgpr_read_b32 v63, a55
  v_pk_mul_f32 v[56:57], v[56:57], v[192:193] op_sel:[0,1] op_sel_hi:[1,1]
  v_pk_mul_f32 v[58:59], v[58:59], v[192:193] op_sel:[0,1] op_sel_hi:[1,1]
  v_pk_mul_f32 v[60:61], v[60:61], v[192:193] op_sel:[0,1] op_sel_hi:[1,1]
  v_pk_mul_f32 v[62:63], v[62:63], v[192:193] op_sel:[0,1] op_sel_hi:[1,1]
  v_cvt_pk_bf16_f32 v148, v56, v57
  v_cvt_pk_bf16_f32 v149, v58, v59
  v_cvt_pk_bf16_f32 v150, v60, v61
  v_cvt_pk_bf16_f32 v151, v62, v63
  v_accvgpr_read_b32 v80, a68
  v_accvgpr_read_b32 v81, a69
  v_accvgpr_read_b32 v82, a70
  v_accvgpr_read_b32 v83, a71
  v_accvgpr_read_b32 v84, a84
  v_accvgpr_read_b32 v85, a85
  v_accvgpr_read_b32 v86, a86
  v_accvgpr_read_b32 v87, a87
  v_pk_mul_f32 v[80:81], v[80:81], v[192:193] op_sel:[0,1] op_sel_hi:[1,1]
  v_pk_mul_f32 v[82:83], v[82:83], v[192:193] op_sel:[0,1] op_sel_hi:[1,1]
  v_pk_mul_f32 v[84:85], v[84:85], v[192:193] op_sel:[0,1] op_sel_hi:[1,1]
  v_pk_mul_f32 v[86:87], v[86:87], v[192:193] op_sel:[0,1] op_sel_hi:[1,1]
  v_cvt_pk_bf16_f32 v152, v80, v81
  v_cvt_pk_bf16_f32 v153, v82, v83
  v_cvt_pk_bf16_f32 v154, v84, v85
  v_cvt_pk_bf16_f32 v155, v86, v87
  v_accvgpr_read_b32 v88, a100
  v_accvgpr_read_b32 v89, a101
  v_accvgpr_read_b32 v90, a102
  v_accvgpr_read_b32 v91, a103
  v_accvgpr_read_b32 v92, a116
  v_accvgpr_read_b32 v93, a117
  v_accvgpr_read_b32 v94, a118
  v_accvgpr_read_b32 v95, a119
  v_pk_mul_f32 v[88:89], v[88:89], v[192:193] op_sel:[0,1] op_sel_hi:[1,1]
  v_pk_mul_f32 v[90:91], v[90:91], v[192:193] op_sel:[0,1] op_sel_hi:[1,1]
  v_pk_mul_f32 v[92:93], v[92:93], v[192:193] op_sel:[0,1] op_sel_hi:[1,1]
  v_pk_mul_f32 v[94:95], v[94:95], v[192:193] op_sel:[0,1] op_sel_hi:[1,1]
  v_cvt_pk_bf16_f32 v156, v88, v89
  v_cvt_pk_bf16_f32 v157, v90, v91
  v_cvt_pk_bf16_f32 v158, v92, v93
  v_cvt_pk_bf16_f32 v159, v94, v95
  s_and_b32 s50, s39, 1
  v_mfma_f32_16x16x32_bf16 a[200:203], a[208:211], v[232:235], a[200:203]
  s_waitcnt lgkmcnt(4)
  v_mfma_f32_16x16x32_bf16 a[204:207], a[208:211], v[236:239], a[204:207]
  s_lshl_b32 s50, s50, 14
  s_add_u32 s51, s39, 2
  v_mfma_f32_16x16x32_bf16 a[8:11], a[128:131], v[232:235], a[8:11]
  s_sub_u32 s51, s51, s49
  s_cmp_ge_i32 s51, 2
  s_cselect_b32 s46, s48, 0
  v_mfma_f32_16x16x32_bf16 a[12:15], a[128:131], v[236:239], a[12:15]
  s_add_u32 s46, s46, s50
  s_cmp_ge_i32 s51, 3
  s_cselect_b32 s47, s48, 0
  s_xor_b32 s51, s50, 0x4000
  s_add_u32 s47, s47, s51
  s_add_u32 s47, s47, 0x8000
  v_mfma_f32_16x16x32_bf16 a[24:27], a[132:135], v[232:235], a[24:27]
  s_add_u32 s58, s51, s41
  s_add_u32 s59, s50, s41
  s_add_u32 s59, s59, 0x8000
  v_mfma_f32_16x16x32_bf16 a[28:31], a[132:135], v[236:239], a[28:31]
  s_waitcnt vmcnt(0) lgkmcnt(0)
  s_barrier
  s_nop 0
  s_add_u32 s34, s61, 16384
  buffer_load_dwordx4 v[200:203], v2, s[16:19], s34 offen
  ds_read_b128 v[32:35], v31 offset:0
  ds_read_b128 v[64:67], v31 offset:1024
  ds_read_b128 v[96:99], v31 offset:2048
  ds_read_b128 v[128:131], v31 offset:3072
  ds_read_b128 v[36:39], v31 offset:4096
  ds_read_b128 v[68:71], v31 offset:5120
  ds_read_b128 v[100:103], v31 offset:6144
  ds_read_b128 v[132:135], v31 offset:7168
  ds_read_b128 v[40:43], v31 offset:8192
  ds_read_b128 v[72:75], v31 offset:9216
  ds_read_b128 v[104:107], v31 offset:10240
  ds_read_b128 v[136:139], v31 offset:11264
  ds_read_b128 v[44:47], v31 offset:12288
  ds_read_b128 v[76:79], v31 offset:13312
  ds_read_b128 v[108:111], v31 offset:14336
  ds_read_b128 v[140:143], v31 offset:15360
  v_add_u32 v3, s46, v2
  v_add_u32 v19, s47, v2
  ds_read_b128 a[128:131], v19 offset:0
  v_mfma_f32_16x16x32_bf16 a[40:43], a[136:139], v[232:235], a[40:43]
  s_mov_b32 m0, s58
  s_nop 0
  buffer_load_dwordx4 v2, s[16:19], s42 offen offset:0 sc1 lds
  v_mfma_f32_16x16x32_bf16 a[44:47], a[136:139], v[236:239], a[44:47]
  s_add_u32 s50, s39, 3
  ds_read_b128 a[132:135], v19 offset:1024
  s_lshl_b32 s51, s50, 1
  buffer_load_dwordx4 v2, s[16:19], s42 offen offset:1024 sc1 lds
  s_sub_u32 s51, s51, s5
  ds_read_b128 a[136:139], v19 offset:2048
  v_mfma_f32_16x16x32_bf16 a[56:59], a[140:143], v[232:235], a[56:59]
  s_cmp_eq_u32 s50, s4
  buffer_load_dwordx4 v2, s[16:19], s42 offen offset:2048 sc1 lds
  v_mfma_f32_16x16x32_bf16 a[60:63], a[140:143], v[236:239], a[60:63]
  ds_read_b128 a[140:143], v19 offset:3072
  s_cselect_b32 s51, s6, s51
  buffer_load_dwordx4 v2, s[16:19], s42 offen offset:3072 sc1 lds
  s_add_u32 s51, s51, 1
  ds_read_b128 a[144:147], v3 offset:0
  v_mfma_f32_16x16x32_bf16 a[72:75], a[160:163], v[232:235], a[72:75]
  s_mov_b32 m0, s59
  s_add_u32 s33, s32, 0
  buffer_store_dwordx4 v[112:115], v2, s[16:19], s33 offen offset:0 sc1
  buffer_load_dwordx4 v2, s[16:19], s43 offen offset:0 sc1 lds
  v_mfma_f32_16x16x32_bf16 a[76:79], a[160:163], v[236:239], a[76:79]
  s_cmp_lt_u32 s50, s4
  buffer_store_dwordx4 v[116:119], v2, s[16:19], s33 offen offset:1024 sc1
  ds_read_b128 a[148:151], v3 offset:1024
  s_cselect_b32 s51, 0x8000, s51
  buffer_load_dwordx4 v2, s[16:19], s43 offen offset:1024 sc1 lds
  s_cmp_gt_u32 s50, 16
  ds_read_b128 a[152:155], v3 offset:2048
  v_mfma_f32_16x16x32_bf16 a[88:91], a[164:167], v[232:235], a[88:91]
  s_cselect_b32 s51, 0x8000, s51
  buffer_store_dwordx4 v[120:123], v2, s[16:19], s33 offen offset:2048 sc1
  buffer_load_dwordx4 v2, s[16:19], s43 offen offset:2048 sc1 lds
  v_mfma_f32_16x16x32_bf16 a[92:95], a[164:167], v[236:239], a[92:95]
  buffer_store_dwordx4 v[124:127], v2, s[16:19], s33 offen offset:3072 sc1
  ds_read_b128 a[156:159], v3 offset:3072
  s_lshl_b32 s51, s51, 15
  buffer_load_dwordx4 v2, s[16:19], s43 offen offset:3072 sc1 lds
  s_add_u32 s44, s51, s40
  ds_read_b128 a[160:163], v19 offset:4096
  v_mfma_f32_16x16x32_bf16 a[104:107], a[168:171], v[232:235], a[104:107]
  s_add_u32 s50, s39, 2
  s_add_u32 s33, s32, 131072
  buffer_store_dwordx4 v[144:147], v2, s[16:19], s33 offen offset:0 sc1
  s_lshl_b32 s51, s50, 1
  s_sub_u32 s51, s51, s5
  v_mfma_f32_16x16x32_bf16 a[108:111], a[168:171], v[236:239], a[108:111]
  s_cmp_eq_u32 s50, s4
  buffer_store_dwordx4 v[148:151], v2, s[16:19], s33 offen offset:1024 sc1
  ds_read_b128 a[164:167], v19 offset:5120
  s_cselect_b32 s51, s6, s51
  s_add_u32 s51, s51, 1
  s_cmp_lt_u32 s50, s4
  s_cselect_b32 s51, 0x8000, s51
  ds_read_b128 a[168:171], v19 offset:6144
  v_mfma_f32_16x16x32_bf16 a[120:123], a[172:175], v[232:235], a[120:123]
  s_cmp_gt_u32 s50, 16
  s_cselect_b32 s51, 0x8000, s51
  buffer_store_dwordx4 v[152:155], v2, s[16:19], s33 offen offset:2048 sc1
  s_lshl_b32 s51, s51, 15
  s_add_u32 s45, s51, s40
  v_mfma_f32_16x16x32_bf16 a[124:127], a[172:175], v[236:239], a[124:127]
  s_add_u32 s45, s45, 16384
  s_add_u32 s39, s39, 1
  buffer_store_dwordx4 v[156:159], v2, s[16:19], s33 offen offset:3072 sc1
  ds_read_b128 a[172:175], v19 offset:7168
  s_setpc_b64 s[52:53]
.p2align 6
L_w_b_None_diag_1epi:
  s_setpc_b64 s[52:53]
L_w2_b_None_diag_1epi:
  s_setpc_b64 s[56:57]
L_b_None_diag_1epi:
  v_mfma_f32_16x16x32_bf16 a[192:195], a[208:211], v[208:211], 0
  v_mfma_f32_16x16x32_bf16 a[196:199], a[208:211], v[212:215], 0
  v_mfma_f32_16x16x32_bf16 a[200:203], a[208:211], v[216:219], 0
  s_waitcnt lgkmcnt(8)
  v_mfma_f32_16x16x32_bf16 a[204:207], a[208:211], v[220:223], 0
  v_mfma_f32_16x16x32_bf16 a[0:3], a[128:131], v[208:211], 0
  s_add_u32 m0, s58, 0x10000
  s_nop 0
  buffer_load_dwordx4 v2, s[16:19], s44 offen offset:0 sc1 lds
  v_mfma_f32_16x16x32_bf16 a[4:7], a[128:131], v[212:215], 0
  v_mfma_f32_16x16x32_bf16 a[8:11], a[128:131], v[216:219], 0
  buffer_load_dwordx4 v2, s[16:19], s44 offen offset:1024 sc1 lds
  v_mfma_f32_16x16x32_bf16 a[12:15], a[128:131], v[220:223], 0
  v_mfma_f32_16x16x32_bf16 a[16:19], a[132:135], v[208:211], 0
  buffer_load_dwordx4 v2, s[16:19], s44 offen offset:2048 sc1 lds
  v_mfma_f32_16x16x32_bf16 a[20:23], a[132:135], v[212:215], 0
  v_mfma_f32_16x16x32_bf16 a[24:27], a[132:135], v[216:219], 0
  buffer_load_dwordx4 v2, s[16:19], s44 offen offset:3072 sc1 lds
  v_mfma_f32_16x16x32_bf16 a[28:31], a[132:135], v[220:223], 0
  s_waitcnt lgkmcnt(4)
  v_mfma_f32_16x16x32_bf16 a[32:35], a[136:139], v[208:211], 0
  s_add_u32 m0, s59, 0x10000
  s_nop 0
  buffer_load_dwordx4 v2, s[16:19], s45 offen offset:0 sc1 lds
  v_mfma_f32_16x16x32_bf16 a[36:39], a[136:139], v[212:215], 0
  s_add_u32 s50, s39, 3
  ds_read_b128 a[128:131], v19 offset:8192
  v_mfma_f32_16x16x32_bf16 a[40:43], a[136:139], v[216:219], 0
  s_lshl_b32 s51, s50, 1
  buffer_load_dwordx4 v2, s[16:19], s45 offen offset:1024 sc1 lds
  v_mfma_f32_16x16x32_bf16 a[44:47], a[136:139], v[220:223], 0
  s_sub_u32 s51, s51, s5
  ds_read_b128 a[132:135], v19 offset:9216
  v_mfma_f32_16x16x32_bf16 a[48:51], a[140:143], v[208:211], 0
  s_cmp_eq_u32 s50, s4
  buffer_load_dwordx4 v2, s[16:19], s45 offen offset:2048 sc1 lds
  v_mfma_f32_16x16x32_bf16 a[52:55], a[140:143], v[212:215], 0
  s_cselect_b32 s51, s6, s51
  ds_read_b128 a[136:139], v19 offset:10240
  v_mfma_f32_16x16x32_bf16 a[56:59], a[140:143], v[216:219], 0
  s_cmp_lt_u32 s50, s4
  v_exp_f32 v120, v120
  buffer_load_dwordx4 v2, s[16:19], s45 offen offset:3072 sc1 lds
  v_cndmask_b32 v120, 0, v120, s[8:9]
  v_mfma_f32_16x16x32_bf16 a[60:63], a[140:143], v[220:223], 0
  s_waitcnt lgkmcnt(3)
  v_exp_f32 v121, v121
  ds_read_b128 a[140:143], v19 offset:11264
  v_cndmask_b32 v121, 0, v121, s[10:11]
  v_cvt_pk_bf16_f32 v232, v120, v121
  v_mfma_f32_16x16x32_bf16 a[64:67], a[160:163], v[208:211], 0
  s_cselect_b32 s51, s50, s51
  v_exp_f32 v122, v122
  s_nop 0
  v_cndmask_b32 v122, 0, v122, s[12:13]
  v_mfma_f32_16x16x32_bf16 a[68:71], a[160:163], v[212:215], 0
  s_cmp_gt_u32 s50, 16
  v_exp_f32 v123, v123
  s_nop 0
  v_cndmask_b32 v123, 0, v123, s[14:15]
  v_cvt_pk_bf16_f32 v233, v122, v123
  v_mfma_f32_16x16x32_bf16 a[72:75], a[160:163], v[216:219], 0
  s_cselect_b32 s51, 0x8000, s51
  v_mov_b32 v152, 0
  v_mfma_f32_16x16x32_bf16 a[76:79], a[160:163], v[220:223], 0
  s_lshl_b32 s51, s51, 15
  v_mov_b32 v153, 0
  v_cvt_pk_bf16_f32 v234, v152, v153
  v_mfma_f32_16x16x32_bf16 a[80:83], a[164:167], v[208:211], 0
  s_add_u32 s42, s51, s40
  v_mov_b32 v154, 0
  v_mfma_f32_16x16x32_bf16 a[84:87], a[164:167], v[212:215], 0
  s_add_u32 s50, s39, 2
  v_mov_b32 v155, 0
  v_cvt_pk_bf16_f32 v235, v154, v155
  v_mfma_f32_16x16x32_bf16 a[88:91], a[164:167], v[216:219], 0
  s_lshl_b32 s51, s50, 1
  v_exp_f32 v124, v124
  v_mfma_f32_16x16x32_bf16 a[92:95], a[164:167], v[220:223], 0
  v_exp_f32 v125, v125
  s_nop 0
  v_cvt_pk_bf16_f32 v236, v124, v125
  v_mfma_f32_16x16x32_bf16 a[96:99], a[168:171], v[208:211], 0
  s_sub_u32 s51, s51, s5
  v_exp_f32 v126, v126
  v_mfma_f32_16x16x32_bf16 a[100:103], a[168:171], v[212:215], 0
  s_cmp_eq_u32 s50, s4
  v_exp_f32 v127, v127
  ds_read_b128 a[160:163], v19 offset:12288
  v_cvt_pk_bf16_f32 v237, v126, v127
  v_mfma_f32_16x16x32_bf16 a[104:107], a[168:171], v[216:219], 0
  s_cselect_b32 s51, s6, s51
  v_exp_f32 v156, v156
  s_nop 0
  v_cndmask_b32 v156, 0, v156, s[8:9]
  v_mfma_f32_16x16x32_bf16 a[108:111], a[168:171], v[220:223], 0
  s_cmp_lt_u32 s50, s4
  v_exp_f32 v157, v157
  ds_read_b128 a[164:167], v19 offset:13312
  v_cndmask_b32 v157, 0, v157, s[10:11]
  v_cvt_pk_bf16_f32 v238, v156, v157
  v_mfma_f32_16x16x32_bf16 a[112:115], a[172:175], v[208:211], 0
  s_cselect_b32 s51, s50, s51
  v_exp_f32 v158, v158
  s_nop 0
  v_cndmask_b32 v158, 0, v158, s[12:13]
  v_mfma_f32_16x16x32_bf16 a[116:119], a[172:175], v[212:215], 0
  s_cmp_gt_u32 s50, 16
  v_exp_f32 v159, v159
  ds_read_b128 a[168:171], v19 offset:14336
  v_cndmask_b32 v159, 0, v159, s[14:15]
  v_cvt_pk_bf16_f32 v239, v158, v159
  v_mfma_f32_16x16x32_bf16 a[120:123], a[172:175], v[216:219], 0
  s_cselect_b32 s51, 0x8000, s51
  s_lshl_b32 s51, s51, 15
  s_add_u32 s43, s51, s40
  v_mfma_f32_16x16x32_bf16 a[124:127], a[172:175], v[220:223], 0
  s_add_u32 s43, s43, 16384
  ds_read_b128 a[172:175], v19 offset:15360
  s_nop 7
  v_accvgpr_read_b32 v192, a192
  v_accvgpr_read_b32 v193, a196
  v_mov_b32 v196, 1585446912
  v_cmp_nle_f32 vcc, v192, v196
  s_or_b32 s55, s55, vcc_lo
  s_or_b32 s55, s55, vcc_hi
  v_cmp_nle_f32 vcc, v193, v196
  s_or_b32 s55, s55, vcc_lo
  s_or_b32 s55, s55, vcc_hi
  v_rcp_f32 v192, v192
  v_rcp_f32 v193, v193
  s_lshl_b32 s32, s56, 5
  s_add_u32 s32, s32, s37
  s_lshl_b32 s32, s32, 12
  s_add_u32 s32, s32, 41943040
  v_accvgpr_read_b32 v48, a0
  v_accvgpr_read_b32 v49, a1
  v_accvgpr_read_b32 v50, a2
  v_accvgpr_read_b32 v51, a3
  v_accvgpr_read_b32 v52, a16
  v_accvgpr_read_b32 v53, a17
  v_accvgpr_read_b32 v54, a18
  v_accvgpr_read_b32 v55, a19
  v_pk_mul_f32 v[48:49], v[48:49], v[192:193] op_sel:[0,0] op_sel_hi:[1,0]
  v_pk_mul_f32 v[50:51], v[50:51], v[192:193] op_sel:[0,0] op_sel_hi:[1,0]
  v_pk_mul_f32 v[52:53], v[52:53], v[192:193] op_sel:[0,0] op_sel_hi:[1,0]
  v_pk_mul_f32 v[54:55], v[54:55], v[192:193] op_sel:[0,0] op_sel_hi:[1,0]
  v_cvt_pk_bf16_f32 v112, v48, v49
  v_cvt_pk_bf16_f32 v113, v50, v51
  v_cvt_pk_bf16_f32 v114, v52, v53
  v_cvt_pk_bf16_f32 v115, v54, v55
  v_accvgpr_read_b32 v56, a32
  v_accvgpr_read_b32 v57, a33
  v_accvgpr_read_b32 v58, a34
  v_accvgpr_read_b32 v59, a35
  v_accvgpr_read_b32 v60, a48
  v_accvgpr_read_b32 v61, a49
  v_accvgpr_read_b32 v62, a50
  v_accvgpr_read_b32 v63, a51
  v_pk_mul_f32 v[56:57], v[56:57], v[192:193] op_sel:[0,0] op_sel_hi:[1,0]
  v_pk_mul_f32 v[58:59], v[58:59], v[192:193] op_sel:[0,0] op_sel_hi:[1,0]
  v_pk_mul_f32 v[60:61], v[60:61], v[192:193] op_sel:[0,0] op_sel_hi:[1,0]
  v_pk_mul_f32 v[62:63], v[62:63], v[192:193] op_sel:[0,0] op_sel_hi:[1,0]
  v_cvt_pk_bf16_f32 v116, v56, v57
  v_cvt_pk_bf16_f32 v117, v58, v59
  v_cvt_pk_bf16_f32 v118, v60, v61
  v_cvt_pk_bf16_f32 v119, v62, v63
  v_accvgpr_read_b32 v80, a64
  v_accvgpr_read_b32 v81, a65
  v_accvgpr_read_b32 v82, a66
  v_accvgpr_read_b32 v83, a67
  v_accvgpr_read_b32 v84, a80
  v_accvgpr_read_b32 v85, a81
  v_accvgpr_read_b32 v86, a82
  v_accvgpr_read_b32 v87, a83
  v_pk_mul_f32 v[80:81], v[80:81], v[192:193] op_sel:[0,0] op_sel_hi:[1,0]
  v_pk_mul_f32 v[82:83], v[82:83], v[192:193] op_sel:[0,0] op_sel_hi:[1,0]
  v_pk_mul_f32 v[84:85], v[84:85], v[192:193] op_sel:[0,0] op_sel_hi:[1,0]
  v_pk_mul_f32 v[86:87], v[86:87], v[192:193] op_sel:[0,0] op_sel_hi:[1,0]
  v_cvt_pk_bf16_f32 v120, v80, v81
  v_cvt_pk_bf16_f32 v121, v82, v83
  v_cvt_pk_bf16_f32 v122, v84, v85
  v_cvt_pk_bf16_f32 v123, v86, v87
  v_accvgpr_read_b32 v88, a96
  v_accvgpr_read_b32 v89, a97
  v_accvgpr_read_b32 v90, a98
  v_accvgpr_read_b32 v91, a99
  v_accvgpr_read_b32 v92, a112
  v_accvgpr_read_b32 v93, a113
  v_accvgpr_read_b32 v94, a114
  v_accvgpr_read_b32 v95, a115
  v_pk_mul_f32 v[88:89], v[88:89], v[192:193] op_sel:[0,0] op_sel_hi:[1,0]
  v_pk_mul_f32 v[90:91], v[90:91], v[192:193] op_sel:[0,0] op_sel_hi:[1,0]
  v_pk_mul_f32 v[92:93], v[92:93], v[192:193] op_sel:[0,0] op_sel_hi:[1,0]
  v_pk_mul_f32 v[94:95], v[94:95], v[192:193] op_sel:[0,0] op_sel_hi:[1,0]
  v_cvt_pk_bf16_f32 v124, v88, v89
  v_cvt_pk_bf16_f32 v125, v90, v91
  v_cvt_pk_bf16_f32 v126, v92, v93
  v_cvt_pk_bf16_f32 v127, v94, v95
  v_accvgpr_read_b32 v48, a4
  v_accvgpr_read_b32 v49, a5
  v_accvgpr_read_b32 v50, a6
  v_accvgpr_read_b32 v51, a7
  v_accvgpr_read_b32 v52, a20
  v_accvgpr_read_b32 v53, a21
  v_accvgpr_read_b32 v54, a22
  v_accvgpr_read_b32 v55, a23
  v_pk_mul_f32 v[48:49], v[48:49], v[192:193] op_sel:[0,1] op_sel_hi:[1,1]
  v_pk_mul_f32 v[50:51], v[50:51], v[192:193] op_sel:[0,1] op_sel_hi:[1,1]
  v_pk_mul_f32 v[52:53], v[52:53], v[192:193] op_sel:[0,1] op_sel_hi:[1,1]
  v_pk_mul_f32 v[54:55], v[54:55], v[192:193] op_sel:[0,1] op_sel_hi:[1,1]
  v_cvt_pk_bf16_f32 v144, v48, v49
  v_cvt_pk_bf16_f32 v145, v50, v51
  v_cvt_pk_bf16_f32 v146, v52, v53
  v_cvt_pk_bf16_f32 v147, v54, v55
  v_accvgpr_read_b32 v56, a36
  v_accvgpr_read_b32 v57, a37
  v_accvgpr_read_b32 v58, a38
  v_accvgpr_read_b32 v59, a39
  v_accvgpr_read_b32 v60, a52
  v_accvgpr_read_b32 v61, a53
  v_accvgpr_read_b32 v62, a54
  v_accvgpr_read_b32 v63, a55
  v_pk_mul_f32 v[56:57], v[56:57], v[192:193] op_sel:[0,1] op_sel_hi:[1,1]
  v_pk_mul_f32 v[58:59], v[58:59], v[192:193] op_sel:[0,1] op_sel_hi:[1,1]
  v_pk_mul_f32 v[60:61], v[60:61], v[192:193] op_sel:[0,1] op_sel_hi:[1,1]
  v_pk_mul_f32 v[62:63], v[62:63], v[192:193] op_sel:[0,1] op_sel_hi:[1,1]
  v_cvt_pk_bf16_f32 v148, v56, v57
  v_cvt_pk_bf16_f32 v149, v58, v59
  v_cvt_pk_bf16_f32 v150, v60, v61
  v_cvt_pk_bf16_f32 v151, v62, v63
  v_accvgpr_read_b32 v80, a68
  v_accvgpr_read_b32 v81, a69
  v_accvgpr_read_b32 v82, a70
  v_accvgpr_read_b32 v83, a71
  v_accvgpr_read_b32 v84, a84
  v_accvgpr_read_b32 v85, a85
  v_accvgpr_read_b32 v86, a86
  v_accvgpr_read_b32 v87, a87
  v_pk_mul_f32 v[80:81], v[80:81], v[192:193] op_sel:[0,1] op_sel_hi:[1,1]
  v_pk_mul_f32 v[82:83], v[82:83], v[192:193] op_sel:[0,1] op_sel_hi:[1,1]
  v_pk_mul_f32 v[84:85], v[84:85], v[192:193] op_sel:[0,1] op_sel_hi:[1,1]
  v_pk_mul_f32 v[86:87], v[86:87], v[192:193] op_sel:[0,1] op_sel_hi:[1,1]
  v_cvt_pk_bf16_f32 v152, v80, v81
  v_cvt_pk_bf16_f32 v153, v82, v83
  v_cvt_pk_bf16_f32 v154, v84, v85
  v_cvt_pk_bf16_f32 v155, v86, v87
  v_accvgpr_read_b32 v88, a100
  v_accvgpr_read_b32 v89, a101
  v_accvgpr_read_b32 v90, a102
  v_accvgpr_read_b32 v91, a103
  v_accvgpr_read_b32 v92, a116
  v_accvgpr_read_b32 v93, a117
  v_accvgpr_read_b32 v94, a118
  v_accvgpr_read_b32 v95, a119
  v_pk_mul_f32 v[88:89], v[88:89], v[192:193] op_sel:[0,1] op_sel_hi:[1,1]
  v_pk_mul_f32 v[90:91], v[90:91], v[192:193] op_sel:[0,1] op_sel_hi:[1,1]
  v_pk_mul_f32 v[92:93], v[92:93], v[192:193] op_sel:[0,1] op_sel_hi:[1,1]
  v_pk_mul_f32 v[94:95], v[94:95], v[192:193] op_sel:[0,1] op_sel_hi:[1,1]
  v_cvt_pk_bf16_f32 v156, v88, v89
  v_cvt_pk_bf16_f32 v157, v90, v91
  v_cvt_pk_bf16_f32 v158, v92, v93
  v_cvt_pk_bf16_f32 v159, v94, v95
  s_and_b32 s50, s39, 1
  v_mfma_f32_16x16x32_bf16 a[200:203], a[208:211], v[232:235], a[200:203]
  s_waitcnt lgkmcnt(4)
  v_mfma_f32_16x16x32_bf16 a[204:207], a[208:211], v[236:239], a[204:207]
  s_lshl_b32 s50, s50, 14
  s_add_u32 s51, s39, 2
  v_mfma_f32_16x16x32_bf16 a[8:11], a[128:131], v[232:235], a[8:11]
  s_sub_u32 s51, s51, s49
  s_cmp_ge_i32 s51, 2
  s_cselect_b32 s46, s48, 0
  v_mfma_f32_16x16x32_bf16 a[12:15], a[128:131], v[236:239], a[12:15]
  s_add_u32 s46, s46, s50
  s_cmp_ge_i32 s51, 3
  s_cselect_b32 s47, s48, 0
  s_xor_b32 s51, s50, 0x4000
  s_add_u32 s47, s47, s51
  s_add_u32 s47, s47, 0x8000
  v_mfma_f32_16x16x32_bf16 a[24:27], a[132:135], v[232:235], a[24:27]
  s_add_u32 s58, s51, s41
  s_add_u32 s59, s50, s41
  s_add_u32 s59, s59, 0x8000
  v_mfma_f32_16x16x32_bf16 a[28:31], a[132:135], v[236:239], a[28:31]
  s_waitcnt vmcnt(0) lgkmcnt(0)
  s_barrier
  s_nop 0
  s_add_u32 s34, s61, 16384
  buffer_load_dwordx4 v[200:203], v2, s[16:19], s34 offen
  ds_read_b128 v[32:35], v31 offset:0
  ds_read_b128 v[64:67], v31 offset:1024
  ds_read_b128 v[96:99], v31 offset:2048
  ds_read_b128 v[128:131], v31 offset:3072
  ds_read_b128 v[36:39], v31 offset:4096
  ds_read_b128 v[68:71], v31 offset:5120
  ds_read_b128 v[100:103], v31 offset:6144
  ds_read_b128 v[132:135], v31 offset:7168
  ds_read_b128 v[40:43], v31 offset:8192
  ds_read_b128 v[72:75], v31 offset:9216
  ds_read_b128 v[104:107], v31 offset:10240
  ds_read_b128 v[136:139], v31 offset:11264
  ds_read_b128 v[44:47], v31 offset:12288
  ds_read_b128 v[76:79], v31 offset:13312
  ds_read_b128 v[108:111], v31 offset:14336
  ds_read_b128 v[140:143], v31 offset:15360
  v_add_u32 v3, s46, v2
  v_add_u32 v19, s47, v2
  ds_read_b128 a[128:131], v19 offset:0
  v_mfma_f32_16x16x32_bf16 a[40:43], a[136:139], v[232:235], a[40:43]
  s_mov_b32 m0, s58
  s_nop 0
  buffer_load_dwordx4 v2, s[16:19], s42 offen offset:0 sc1 lds
  v_mfma_f32_16x16x32_bf16 a[44:47], a[136:139], v[236:239], a[44:47]
  s_add_u32 s50, s39, 3
  ds_read_b128 a[132:135], v19 offset:1024
  s_lshl_b32 s51, s50, 1
  buffer_load_dwordx4 v2, s[16:19], s42 offen offset:1024 sc1 lds
  s_sub_u32 s51, s51, s5
  ds_read_b128 a[136:139], v19 offset:2048
  v_mfma_f32_16x16x32_bf16 a[56:59], a[140:143], v[232:235], a[56:59]
  s_cmp_eq_u32 s50, s4
  buffer_load_dwordx4 v2, s[16:19], s42 offen offset:2048 sc1 lds
  v_mfma_f32_16x16x32_bf16 a[60:63], a[140:143], v[236:239], a[60:63]
  ds_read_b128 a[140:143], v19 offset:3072
  s_cselect_b32 s51, s6, s51
  buffer_load_dwordx4 v2, s[16:19], s42 offen offset:3072 sc1 lds
  s_add_u32 s51, s51, 1
  ds_read_b128 a[144:147], v3 offset:0
  v_mfma_f32_16x16x32_bf16 a[72:75], a[160:163], v[232:235], a[72:75]
  s_mov_b32 m0, s59
  s_add_u32 s33, s32, 0
  buffer_store_dwordx4 v[112:115], v2, s[16:19], s33 offen offset:0 sc1
  buffer_load_dwordx4 v2, s[16:19], s43 offen offset:0 sc1 lds
  v_mfma_f32_16x16x32_bf16 a[76:79], a[160:163], v[236:239], a[76:79]
  s_cmp_lt_u32 s50, s4
  buffer_store_dwordx4 v[116:119], v2, s[16:19], s33 offen offset:1024 sc1
  ds_read_b128 a[148:151], v3 offset:1024
  s_cselect_b32 s51, 0x8000, s51
  buffer_load_dwordx4 v2, s[16:19], s43 offen offset:1024 sc1 lds
  s_cmp_gt_u32 s50, 16
  ds_read_b128 a[152:155], v3 offset:2048
  v_mfma_f32_16x16x32_bf16 a[88:91], a[164:167], v[232:235], a[88:91]
  s_cselect_b32 s51, 0x8000, s51
  buffer_store_dwordx4 v[120:123], v2, s[16:19], s33 offen offset:2048 sc1
  buffer_load_dwordx4 v2, s[16:19], s43 offen offset:2048 sc1 lds
  v_mfma_f32_16x16x32_bf16 a[92:95], a[164:167], v[236:239], a[92:95]
  buffer_store_dwordx4 v[124:127], v2, s[16:19], s33 offen offset:3072 sc1
  ds_read_b128 a[156:159], v3 offset:3072
  s_lshl_b32 s51, s51, 15
  buffer_load_dwordx4 v2, s[16:19], s43 offen offset:3072 sc1 lds
  s_add_u32 s44, s51, s40
  ds_read_b128 a[160:163], v19 offset:4096
  v_mfma_f32_16x16x32_bf16 a[104:107], a[168:171], v[232:235], a[104:107]
  s_add_u32 s50, s39, 2
  s_add_u32 s33, s32, 131072
  buffer_store_dwordx4 v[144:147], v2, s[16:19], s33 offen offset:0 sc1
  s_lshl_b32 s51, s50, 1
  s_sub_u32 s51, s51, s5
  global_load_dword v4, v18, s[70:71]
  v_mfma_f32_16x16x32_bf16 a[108:111], a[168:171], v[236:239], a[108:111]
  s_cmp_eq_u32 s50, s4
  buffer_store_dwordx4 v[148:151], v2, s[16:19], s33 offen offset:1024 sc1
  ds_read_b128 a[164:167], v19 offset:5120
  s_cselect_b32 s51, s6, s51
  s_add_u32 s51, s51, 1
  s_cmp_lt_u32 s50, s4
  global_load_dword v4, v17, s[66:67]
  s_cselect_b32 s51, 0x8000, s51
  ds_read_b128 a[168:171], v19 offset:6144
  v_mfma_f32_16x16x32_bf16 a[120:123], a[172:175], v[232:235], a[120:123]
  s_cmp_gt_u32 s50, 16
  s_cselect_b32 s51, 0x8000, s51
  buffer_store_dwordx4 v[152:155], v2, s[16:19], s33 offen offset:2048 sc1
  s_lshl_b32 s51, s51, 15
  s_add_u32 s45, s51, s40
  v_mfma_f32_16x16x32_bf16 a[124:127], a[172:175], v[236:239], a[124:127]
  s_add_u32 s45, s45, 16384
  s_add_u32 s39, s39, 1
  buffer_store_dwordx4 v[156:159], v2, s[16:19], s33 offen offset:3072 sc1
  ds_read_b128 a[172:175], v19 offset:7168
  s_setpc_b64 s[52:53]
.p2align 6
L_w_b_diag_None_0st:
  s_setpc_b64 s[52:53]
L_w2_b_diag_None_0st:
  s_setpc_b64 s[56:57]
L_b_diag_None_0st:
  s_waitcnt lgkmcnt(4)
  ds_read_b128 a[176:179], v3 offset:4096
  v_mfma_f32_16x16x32_bf16 v[48:51], a[144:147], v[32:35], v[240:243]
  s_add_u32 m0, s58, 0x10000
  v_accvgpr_read_b32 v194, a200
  v_accvgpr_read_b32 v195, a204
  buffer_load_dwordx4 v2, s[16:19], s44 offen offset:0 sc1 lds
  v_mfma_f32_16x16x32_bf16 v[48:51], a[148:151], v[64:67], v[48:51]
  v_mov_b32 v196, 1585446912
  v_cmp_nle_f32 vcc, v194, v196
  ds_read_b128 a[180:183], v3 offset:5120
  v_mfma_f32_16x16x32_bf16 v[48:51], a[152:155], v[96:99], v[48:51]
  s_or_b32 s34, vcc_lo, vcc_hi
  s_or_b32 s55, s55, s34
  v_cmp_nle_f32 vcc, v195, v196
  s_or_b32 s34, vcc_lo, vcc_hi
  s_or_b32 s55, s55, s34
  v_rcp_f32 v194, v194
  buffer_load_dwordx4 v2, s[16:19], s44 offen offset:1024 sc1 lds
  v_mfma_f32_16x16x32_bf16 v[48:51], a[156:159], v[128:131], v[48:51]
  v_rcp_f32 v195, v195
  s_add_u32 s33, s32, 262144
  s_add_u32 s35, s32, 393216
  v_accvgpr_read_b32 v224, a8
  ds_read_b128 a[184:187], v3 offset:6144
  v_mfma_f32_16x16x32_bf16 v[52:55], a[144:147], v[36:39], v[244:247]
  v_accvgpr_read_b32 v225, a9
  v_accvgpr_read_b32 v226, a10
  buffer_load_dwordx4 v2, s[16:19], s44 offen offset:2048 sc1 lds
  v_mfma_f32_16x16x32_bf16 v[52:55], a[148:151], v[68:71], v[52:55]
  v_accvgpr_read_b32 v227, a11
  v_accvgpr_read_b32 v228, a24
  ds_read_b128 a[188:191], v3 offset:7168
  v_mfma_f32_16x16x32_bf16 v[52:55], a[152:155], v[100:103], v[52:55]
  v_accvgpr_read_b32 v229, a25
  v_accvgpr_read_b32 v230, a26
  buffer_load_dwordx4 v2, s[16:19], s44 offen offset:3072 sc1 lds
  v_mfma_f32_16x16x32_bf16 v[52:55], a[156:159], v[132:135], v[52:55]
  v_accvgpr_read_b32 v231, a27
  v_mul_f32 v224, v224, v194
  v_mfma_f32_16x16x32_bf16 v[56:59], a[144:147], v[40:43], v[248:251]
  s_add_u32 m0, s59, 0x10000
  v_mul_f32 v225, v225, v194
  v_mul_f32 v226, v226, v194
  buffer_load_dwordx4 v2, s[16:19], s45 offen offset:0 sc1 lds
  v_mfma_f32_16x16x32_bf16 v[56:59], a[148:151], v[72:75], v[56:59]
  s_add_u32 s50, s39, 3
  v_mul_f32 v227, v227, v194
  v_mul_f32 v228, v228, v194
  v_mfma_f32_16x16x32_bf16 v[56:59], a[152:155], v[104:107], v[56:59]
  s_lshl_b32 s51, s50, 1
  v_mul_f32 v229, v229, v194
  v_mul_f32 v230, v230, v194
  buffer_load_dwordx4 v2, s[16:19], s45 offen offset:1024 sc1 lds
  v_mfma_f32_16x16x32_bf16 v[56:59], a[156:159], v[136:139], v[56:59]
  s_sub_u32 s51, s51, s5
  v_mul_f32 v231, v231, v194
  v_cvt_pk_bf16_f32 v160, v224, v225
  v_mfma_f32_16x16x32_bf16 v[60:63], a[144:147], v[44:47], v[252:255]
  s_cmp_eq_u32 s50, s4
  v_cvt_pk_bf16_f32 v161, v226, v227
  v_cvt_pk_bf16_f32 v162, v228, v229
  buffer_load_dwordx4 v2, s[16:19], s45 offen offset:2048 sc1 lds
  v_mfma_f32_16x16x32_bf16 v[60:63], a[148:151], v[76:79], v[60:63]
  s_cselect_b32 s51, s6, s51
  v_cvt_pk_bf16_f32 v163, v230, v231
  buffer_store_dwordx4 v[160:163], v2, s[16:19], s33 offen offset:0 sc1
  v_mfma_f32_16x16x32_bf16 v[60:63], a[152:155], v[108:111], v[60:63]
  s_cmp_lt_u32 s50, s4
  v_accvgpr_read_b32 v232, a40
  v_accvgpr_read_b32 v233, a41
  buffer_load_dwordx4 v2, s[16:19], s45 offen offset:3072 sc1 lds
  v_mfma_f32_16x16x32_bf16 v[60:63], a[156:159], v[140:143], v[60:63]
  s_waitcnt lgkmcnt(0)
  v_accvgpr_read_b32 v234, a42
  v_accvgpr_read_b32 v235, a43
  s_cselect_b32 s51, s50, s51
  s_cmp_gt_u32 s50, 16
  ds_read_b128 a[144:147], v3 offset:8192
  s_cselect_b32 s51, 0x8000, s51
  s_lshl_b32 s51, s51, 15
  ds_read_b128 a[148:151], v3 offset:9216
  v_mfma_f32_16x16x32_bf16 v[84:87], a[176:179], v[36:39], v[244:247]
  s_add_u32 s42, s51, s40
  v_accvgpr_read_b32 v236, a56
  v_accvgpr_read_b32 v237, a57
  v_mfma_f32_16x16x32_bf16 v[84:87], a[180:183], v[68:71], v[84:87]
  s_add_u32 s50, s39, 2
  v_accvgpr_read_b32 v238, a58
  v_accvgpr_read_b32 v239, a59
  ds_read_b128 a[152:155], v3 offset:10240
  v_mfma_f32_16x16x32_bf16 v[84:87], a[184:187], v[100:103], v[84:87]
  s_lshl_b32 s51, s50, 1
  v_mul_f32 v232, v232, v194
  v_mul_f32 v233, v233, v194
  v_mfma_f32_16x16x32_bf16 v[84:87], a[188:191], v[132:135], v[84:87]
  v_mul_f32 v234, v234, v194
  v_mul_f32 v235, v235, v194
  ds_read_b128 a[156:159], v3 offset:11264
  v_mfma_f32_16x16x32_bf16 v[88:91], a[176:179], v[40:43], v[248:251]
  s_sub_u32 s51, s51, s5
  v_mul_f32 v236, v236, v194
  v_mul_f32 v237, v237, v194
  v_mfma_f32_16x16x32_bf16 v[88:91], a[180:183], v[72:75], v[88:91]
  s_cmp_eq_u32 s50, s4
  v_mul_f32 v238, v238, v194
  v_mul_f32 v239, v239, v194
  v_mfma_f32_16x16x32_bf16 v[88:91], a[184:187], v[104:107], v[88:91]
  s_cselect_b32 s51, s6, s51
  v_cvt_pk_bf16_f32 v164, v232, v233
  v_cvt_pk_bf16_f32 v165, v234, v235
  v_mfma_f32_16x16x32_bf16 v[88:91], a[188:191], v[136:139], v[88:91]
  s_cmp_lt_u32 s50, s4
  v_cvt_pk_bf16_f32 v166, v236, v237
  v_cvt_pk_bf16_f32 v167, v238, v239
  v_mfma_f32_16x16x32_bf16 v[92:95], a[176:179], v[44:47], v[252:255]
  s_cselect_b32 s51, s50, s51
  buffer_store_dwordx4 v[164:167], v2, s[16:19], s33 offen offset:1024 sc1
  v_mfma_f32_16x16x32_bf16 v[92:95], a[180:183], v[76:79], v[92:95]
  s_cmp_gt_u32 s50, 16
  v_accvgpr_read_b32 v224, a72
  v_accvgpr_read_b32 v225, a73
  v_mfma_f32_16x16x32_bf16 v[92:95], a[184:187], v[108:111], v[92:95]
  s_cselect_b32 s51, 0x8000, s51
  v_accvgpr_read_b32 v226, a74
  v_accvgpr_read_b32 v227, a75
  s_lshl_b32 s51, s51, 15
  s_add_u32 s43, s51, s40
  v_mfma_f32_16x16x32_bf16 v[92:95], a[188:191], v[140:143], v[92:95]
  s_add_u32 s43, s43, 16384
  v_accvgpr_read_b32 v228, a88
  v_accvgpr_read_b32 v229, a89
  v_accvgpr_read_b32 v230, a90
  v_accvgpr_read_b32 v231, a91
  v_pk_mul_f32 v[224:225], v[224:225], v[194:195] op_sel:[0,0] op_sel_hi:[1,0]
  v_pk_mul_f32 v[226:227], v[226:227], v[194:195] op_sel:[0,0] op_sel_hi:[1,0]
  v_pk_mul_f32 v[228:229], v[228:229], v[194:195] op_sel:[0,0] op_sel_hi:[1,0]
  v_pk_mul_f32 v[230:231], v[230:231], v[194:195] op_sel:[0,0] op_sel_hi:[1,0]
  v_cvt_pk_bf16_f32 v168, v224, v225
  v_cvt_pk_bf16_f32 v169, v226, v227
  v_cvt_pk_bf16_f32 v170, v228, v229
  v_cvt_pk_bf16_f32 v171, v230, v231
  buffer_store_dwordx4 v[168:171], v2, s[16:19], s33 offen offset:2048 sc1
  v_accvgpr_read_b32 v232, a104
  v_accvgpr_read_b32 v233, a105
  v_accvgpr_read_b32 v234, a106
  v_accvgpr_read_b32 v235, a107
  v_accvgpr_read_b32 v236, a120
  v_accvgpr_read_b32 v237, a121
  v_accvgpr_read_b32 v238, a122
  v_accvgpr_read_b32 v239, a123
  v_pk_mul_f32 v[232:233], v[232:233], v[194:195] op_sel:[0,0] op_sel_hi:[1,0]
  v_pk_mul_f32 v[234:235], v[234:235], v[194:195] op_sel:[0,0] op_sel_hi:[1,0]
  v_pk_mul_f32 v[236:237], v[236:237], v[194:195] op_sel:[0,0] op_sel_hi:[1,0]
  v_pk_mul_f32 v[238:239], v[238:239], v[194:195] op_sel:[0,0] op_sel_hi:[1,0]
  v_cvt_pk_bf16_f32 v172, v232, v233
  v_cvt_pk_bf16_f32 v173, v234, v235
  v_cvt_pk_bf16_f32 v174, v236, v237
  v_cvt_pk_bf16_f32 v175, v238, v239
  buffer_store_dwordx4 v[172:175], v2, s[16:19], s33 offen offset:3072 sc1
  v_accvgpr_read_b32 v224, a12
  v_accvgpr_read_b32 v225, a13
  v_accvgpr_read_b32 v226, a14
  v_accvgpr_read_b32 v227, a15
  v_accvgpr_read_b32 v228, a28
  v_accvgpr_read_b32 v229, a29
  v_accvgpr_read_b32 v230, a30
  v_accvgpr_read_b32 v231, a31
  v_pk_mul_f32 v[224:225], v[224:225], v[194:195] op_sel:[0,1] op_sel_hi:[1,1]
  v_pk_mul_f32 v[226:227], v[226:227], v[194:195] op_sel:[0,1] op_sel_hi:[1,1]
  v_pk_mul_f32 v[228:229], v[228:229], v[194:195] op_sel:[0,1] op_sel_hi:[1,1]
  v_pk_mul_f32 v[230:231], v[230:231], v[194:195] op_sel:[0,1] op_sel_hi:[1,1]
  v_cvt_pk_bf16_f32 v176, v224, v225
  v_cvt_pk_bf16_f32 v177, v226, v227
  v_cvt_pk_bf16_f32 v178, v228, v229
  v_cvt_pk_bf16_f32 v179, v230, v231
  buffer_store_dwordx4 v[176:179], v2, s[16:19], s35 offen offset:0 sc1
  v_accvgpr_read_b32 v232, a44
  v_accvgpr_read_b32 v233, a45
  v_accvgpr_read_b32 v234, a46
  v_accvgpr_read_b32 v235, a47
  v_accvgpr_read_b32 v236, a60
  v_accvgpr_read_b32 v237, a61
  v_accvgpr_read_b32 v238, a62
  v_accvgpr_read_b32 v239, a63
  v_pk_mul_f32 v[232:233], v[232:233], v[194:195] op_sel:[0,1] op_sel_hi:[1,1]
  v_pk_mul_f32 v[234:235], v[234:235], v[194:195] op_sel:[0,1] op_sel_hi:[1,1]
  v_pk_mul_f32 v[236:237], v[236:237], v[194:195] op_sel:[0,1] op_sel_hi:[1,1]
  v_pk_mul_f32 v[238:239], v[238:239], v[194:195] op_sel:[0,1] op_sel_hi:[1,1]
  v_cvt_pk_bf16_f32 v180, v232, v233
  v_cvt_pk_bf16_f32 v181, v234, v235
  v_cvt_pk_bf16_f32 v182, v236, v237
  v_cvt_pk_bf16_f32 v183, v238, v239
  buffer_store_dwordx4 v[180:183], v2, s[16:19], s35 offen offset:1024 sc1
  v_accvgpr_read_b32 v224, a76
  v_accvgpr_read_b32 v225, a77
  v_accvgpr_read_b32 v226, a78
  v_accvgpr_read_b32 v227, a79
  v_accvgpr_read_b32 v228, a92
  v_accvgpr_read_b32 v229, a93
  v_accvgpr_read_b32 v230, a94
  v_accvgpr_read_b32 v231, a95
  v_pk_mul_f32 v[224:225], v[224:225], v[194:195] op_sel:[0,1] op_sel_hi:[1,1]
  v_pk_mul_f32 v[226:227], v[226:227], v[194:195] op_sel:[0,1] op_sel_hi:[1,1]
  v_pk_mul_f32 v[228:229], v[228:229], v[194:195] op_sel:[0,1] op_sel_hi:[1,1]
  v_pk_mul_f32 v[230:231], v[230:231], v[194:195] op_sel:[0,1] op_sel_hi:[1,1]
  v_cvt_pk_bf16_f32 v184, v224, v225
  v_cvt_pk_bf16_f32 v185, v226, v227
  v_cvt_pk_bf16_f32 v186, v228, v229
  v_cvt_pk_bf16_f32 v187, v230, v231
  buffer_store_dwordx4 v[184:187], v2, s[16:19], s35 offen offset:2048 sc1
  v_accvgpr_read_b32 v232, a108
  v_accvgpr_read_b32 v233, a109
  v_accvgpr_read_b32 v234, a110
  v_accvgpr_read_b32 v235, a111
  v_accvgpr_read_b32 v236, a124
  v_accvgpr_read_b32 v237, a125
  v_accvgpr_read_b32 v238, a126
  v_accvgpr_read_b32 v239, a127
  v_pk_mul_f32 v[232:233], v[232:233], v[194:195] op_sel:[0,1] op_sel_hi:[1,1]
  v_pk_mul_f32 v[234:235], v[234:235], v[194:195] op_sel:[0,1] op_sel_hi:[1,1]
  v_pk_mul_f32 v[236:237], v[236:237], v[194:195] op_sel:[0,1] op_sel_hi:[1,1]
  v_pk_mul_f32 v[238:239], v[238:239], v[194:195] op_sel:[0,1] op_sel_hi:[1,1]
  v_cvt_pk_bf16_f32 v188, v232, v233
  v_cvt_pk_bf16_f32 v189, v234, v235
  v_cvt_pk_bf16_f32 v190, v236, v237
  v_cvt_pk_bf16_f32 v191, v238, v239
  buffer_store_dwordx4 v[188:191], v2, s[16:19], s35 offen offset:3072 sc1
  s_and_b32 s50, s39, 1
  v_exp_f32 v48, v48
  ds_read_b128 a[176:179], v3 offset:12288
  v_cndmask_b32 v48, 0, v48, s[8:9]
  s_waitcnt lgkmcnt(1)
  v_exp_f32 v49, v49
  ds_read_b128 a[180:183], v3 offset:13312
  v_cndmask_b32 v49, 0, v49, s[10:11]
  v_cvt_pk_bf16_f32 v208, v48, v49
  s_lshl_b32 s50, s50, 14
  v_exp_f32 v50, v50
  ds_read_b128 a[184:187], v3 offset:14336
  v_cndmask_b32 v50, 0, v50, s[12:13]
  s_add_u32 s51, s39, 2
  v_exp_f32 v51, v51
  ds_read_b128 a[188:191], v3 offset:15360
  v_cndmask_b32 v51, 0, v51, s[14:15]
  v_cvt_pk_bf16_f32 v209, v50, v51
  s_sub_u32 s51, s51, s49
  v_mov_b32 v80, 0
  s_cmp_ge_i32 s51, 2
  s_cselect_b32 s46, s48, 0
  s_add_u32 s46, s46, s50
  v_mov_b32 v81, 0
  s_cmp_ge_i32 s51, 3
  v_cvt_pk_bf16_f32 v210, v80, v81
  s_cselect_b32 s47, s48, 0
  v_mov_b32 v82, 0
  s_xor_b32 s51, s50, 0x4000
  s_add_u32 s47, s47, s51
  s_add_u32 s47, s47, 0x8000
  v_mov_b32 v83, 0
  v_cvt_pk_bf16_f32 v211, v82, v83
  s_add_u32 s58, s51, s41
  v_exp_f32 v52, v52
  s_add_u32 s59, s50, s41
  s_add_u32 s59, s59, 0x8000
  v_exp_f32 v53, v53
  s_waitcnt vmcnt(7) lgkmcnt(0)
  s_barrier
  v_cvt_pk_bf16_f32 v212, v52, v53
  v_mfma_f32_16x16x32_bf16 v[120:123], a[144:147], v[40:43], v[248:251]
  v_exp_f32 v54, v54
  v_add_u32 v3, s46, v2
  v_add_u32 v19, s47, v2
  v_mfma_f32_16x16x32_bf16 v[120:123], a[148:151], v[72:75], v[120:123]
  v_exp_f32 v55, v55
  ds_read_b128 a[128:131], v19 offset:0
  v_cvt_pk_bf16_f32 v213, v54, v55
  v_mfma_f32_16x16x32_bf16 v[120:123], a[152:155], v[104:107], v[120:123]
  s_mov_b32 m0, s58
  v_exp_f32 v84, v84
  buffer_load_dwordx4 v2, s[16:19], s42 offen offset:0 sc1 lds
  v_cndmask_b32 v84, 0, v84, s[8:9]
  v_mfma_f32_16x16x32_bf16 v[120:123], a[156:159], v[136:139], v[120:123]
  s_add_u32 s50, s39, 3
  v_exp_f32 v85, v85
  ds_read_b128 a[132:135], v19 offset:1024
  v_cndmask_b32 v85, 0, v85, s[10:11]
  v_cvt_pk_bf16_f32 v214, v84, v85
  v_mfma_f32_16x16x32_bf16 v[124:127], a[144:147], v[44:47], v[252:255]
  s_lshl_b32 s51, s50, 1
  v_exp_f32 v86, v86
  buffer_load_dwordx4 v2, s[16:19], s42 offen offset:1024 sc1 lds
  v_cndmask_b32 v86, 0, v86, s[12:13]
  v_mfma_f32_16x16x32_bf16 v[124:127], a[148:151], v[76:79], v[124:127]
  s_sub_u32 s51, s51, s5
  v_exp_f32 v87, v87
  ds_read_b128 a[136:139], v19 offset:2048
  v_cndmask_b32 v87, 0, v87, s[14:15]
  v_cvt_pk_bf16_f32 v215, v86, v87
  v_mfma_f32_16x16x32_bf16 v[124:127], a[152:155], v[108:111], v[124:127]
  s_cmp_eq_u32 s50, s4
  v_exp_f32 v56, v56
  buffer_load_dwordx4 v2, s[16:19], s42 offen offset:2048 sc1 lds
  v_mfma_f32_16x16x32_bf16 v[124:127], a[156:159], v[140:143], v[124:127]
  v_exp_f32 v57, v57
  ds_read_b128 a[140:143], v19 offset:3072
  v_cvt_pk_bf16_f32 v216, v56, v57
  s_cselect_b32 s51, s6, s51
  v_exp_f32 v58, v58
  buffer_load_dwordx4 v2, s[16:19], s42 offen offset:3072 sc1 lds
  s_add_u32 s51, s51, 1
  v_exp_f32 v59, v59
  ds_read_b128 a[144:147], v3 offset:0
  v_cvt_pk_bf16_f32 v217, v58, v59
  s_mov_b32 m0, s59
  v_exp_f32 v88, v88
  buffer_load_dwordx4 v2, s[16:19], s43 offen offset:0 sc1 lds
  s_cmp_lt_u32 s50, s4
  v_exp_f32 v89, v89
  ds_read_b128 a[148:151], v3 offset:1024
  v_cvt_pk_bf16_f32 v218, v88, v89
  s_cselect_b32 s51, 0x8000, s51
  v_exp_f32 v90, v90
  buffer_load_dwordx4 v2, s[16:19], s43 offen offset:1024 sc1 lds
  s_cmp_gt_u32 s50, 16
  v_exp_f32 v91, v91
  ds_read_b128 a[152:155], v3 offset:2048
  v_cvt_pk_bf16_f32 v219, v90, v91
  s_cselect_b32 s51, 0x8000, s51
  v_exp_f32 v60, v60
  buffer_load_dwordx4 v2, s[16:19], s43 offen offset:2048 sc1 lds
  v_exp_f32 v61, v61
  ds_read_b128 a[156:159], v3 offset:3072
  v_cvt_pk_bf16_f32 v220, v60, v61
  s_lshl_b32 s51, s51, 15
  v_exp_f32 v62, v62
  buffer_load_dwordx4 v2, s[16:19], s43 offen offset:3072 sc1 lds
  s_add_u32 s44, s51, s40
  v_exp_f32 v63, v63
  ds_read_b128 a[160:163], v19 offset:4096
  v_cvt_pk_bf16_f32 v221, v62, v63
  s_add_u32 s50, s39, 2
  v_exp_f32 v92, v92
  s_lshl_b32 s51, s50, 1
  s_sub_u32 s51, s51, s5
  s_cmp_eq_u32 s50, s4
  v_exp_f32 v93, v93
  ds_read_b128 a[164:167], v19 offset:5120
  v_cvt_pk_bf16_f32 v222, v92, v93
  v_mfma_f32_16x16x32_bf16 v[156:159], a[176:179], v[44:47], v[252:255]
  s_cselect_b32 s51, s6, s51
  v_exp_f32 v94, v94
  s_add_u32 s51, s51, 1
  s_cmp_lt_u32 s50, s4
  v_mfma_f32_16x16x32_bf16 v[156:159], a[180:183], v[76:79], v[156:159]
  s_cselect_b32 s51, 0x8000, s51
  v_exp_f32 v95, v95
  ds_read_b128 a[168:171], v19 offset:6144
  v_cvt_pk_bf16_f32 v223, v94, v95
  v_mfma_f32_16x16x32_bf16 v[156:159], a[184:187], v[108:111], v[156:159]
  s_cmp_gt_u32 s50, 16
  s_cselect_b32 s51, 0x8000, s51
  s_lshl_b32 s51, s51, 15
  s_add_u32 s45, s51, s40
  v_mfma_f32_16x16x32_bf16 v[156:159], a[188:191], v[140:143], v[156:159]
  s_add_u32 s45, s45, 16384
  s_add_u32 s39, s39, 1
  ds_read_b128 a[172:175], v19 offset:7168
  s_setpc_b64 s[52:53]
.p2align 6
L_w_b_full_diag_1:
  s_setpc_b64 s[52:53]
L_w2_b_full_diag_1:
  s_setpc_b64 s[56:57]
L_b_full_diag_1:
  v_mfma_f32_16x16x32_bf16 a[192:195], a[208:211], v[208:211], 0
  v_mfma_f32_16x16x32_bf16 a[196:199], a[208:211], v[212:215], 0
  v_mfma_f32_16x16x32_bf16 a[200:203], a[208:211], v[216:219], 0
  s_waitcnt lgkmcnt(8)
  v_mfma_f32_16x16x32_bf16 a[204:207], a[208:211], v[220:223], 0
  ds_read_b128 a[176:179], v3 offset:4096
  v_mfma_f32_16x16x32_bf16 a[0:3], a[128:131], v[208:211], 0
  s_add_u32 m0, s58, 0x10000
  v_mfma_f32_16x16x32_bf16 a[4:7], a[128:131], v[212:215], 0
  buffer_load_dwordx4 v2, s[16:19], s44 offen offset:0 sc1 lds
  v_mfma_f32_16x16x32_bf16 a[8:11], a[128:131], v[216:219], 0
  v_mfma_f32_16x16x32_bf16 a[12:15], a[128:131], v[220:223], 0
  ds_read_b128 a[180:183], v3 offset:5120
  v_mfma_f32_16x16x32_bf16 a[16:19], a[132:135], v[208:211], 0
  v_mfma_f32_16x16x32_bf16 a[20:23], a[132:135], v[212:215], 0
  buffer_load_dwordx4 v2, s[16:19], s44 offen offset:1024 sc1 lds
  v_mfma_f32_16x16x32_bf16 a[24:27], a[132:135], v[216:219], 0
  v_mfma_f32_16x16x32_bf16 a[28:31], a[132:135], v[220:223], 0
  ds_read_b128 a[184:187], v3 offset:6144
  v_mfma_f32_16x16x32_bf16 a[32:35], a[136:139], v[208:211], 0
  v_mfma_f32_16x16x32_bf16 a[36:39], a[136:139], v[212:215], 0
  buffer_load_dwordx4 v2, s[16:19], s44 offen offset:2048 sc1 lds
  v_mfma_f32_16x16x32_bf16 a[40:43], a[136:139], v[216:219], 0
  v_mfma_f32_16x16x32_bf16 a[44:47], a[136:139], v[220:223], 0
  ds_read_b128 a[188:191], v3 offset:7168
  v_mfma_f32_16x16x32_bf16 a[48:51], a[140:143], v[208:211], 0
  v_mfma_f32_16x16x32_bf16 a[52:55], a[140:143], v[212:215], 0
  buffer_load_dwordx4 v2, s[16:19], s44 offen offset:3072 sc1 lds
  v_mfma_f32_16x16x32_bf16 a[56:59], a[140:143], v[216:219], 0
  s_waitcnt lgkmcnt(8)
  v_mfma_f32_16x16x32_bf16 a[60:63], a[140:143], v[220:223], 0
  v_mfma_f32_16x16x32_bf16 v[48:51], a[144:147], v[32:35], v[240:243]
  s_add_u32 m0, s59, 0x10000
  v_mfma_f32_16x16x32_bf16 v[48:51], a[148:151], v[64:67], v[48:51]
  buffer_load_dwordx4 v2, s[16:19], s45 offen offset:0 sc1 lds
  v_mfma_f32_16x16x32_bf16 v[48:51], a[152:155], v[96:99], v[48:51]
  s_add_u32 s50, s39, 3
  v_mfma_f32_16x16x32_bf16 v[48:51], a[156:159], v[128:131], v[48:51]
  ds_read_b128 a[128:131], v19 offset:8192
  v_mfma_f32_16x16x32_bf16 v[52:55], a[144:147], v[36:39], v[244:247]
  s_lshl_b32 s51, s50, 1
  v_mfma_f32_16x16x32_bf16 v[52:55], a[148:151], v[68:71], v[52:55]
  buffer_load_dwordx4 v2, s[16:19], s45 offen offset:1024 sc1 lds
  v_mfma_f32_16x16x32_bf16 v[52:55], a[152:155], v[100:103], v[52:55]
  s_sub_u32 s51, s51, s5
  v_mfma_f32_16x16x32_bf16 v[52:55], a[156:159], v[132:135], v[52:55]
  ds_read_b128 a[132:135], v19 offset:9216
  v_mfma_f32_16x16x32_bf16 v[56:59], a[144:147], v[40:43], v[248:251]
  s_cmp_eq_u32 s50, s4
  v_mfma_f32_16x16x32_bf16 v[56:59], a[148:151], v[72:75], v[56:59]
  buffer_load_dwordx4 v2, s[16:19], s45 offen offset:2048 sc1 lds
  v_mfma_f32_16x16x32_bf16 v[56:59], a[152:155], v[104:107], v[56:59]
  s_cselect_b32 s51, s6, s51
  v_mfma_f32_16x16x32_bf16 v[56:59], a[156:159], v[136:139], v[56:59]
  ds_read_b128 a[136:139], v19 offset:10240
  v_mfma_f32_16x16x32_bf16 v[60:63], a[144:147], v[44:47], v[252:255]
  s_cmp_lt_u32 s50, s4
  v_exp_f32 v120, v120
  v_mfma_f32_16x16x32_bf16 v[60:63], a[148:151], v[76:79], v[60:63]
  buffer_load_dwordx4 v2, s[16:19], s45 offen offset:3072 sc1 lds
  v_cndmask_b32 v120, 0, v120, s[8:9]
  v_mfma_f32_16x16x32_bf16 v[60:63], a[152:155], v[108:111], v[60:63]
  s_waitcnt lgkmcnt(7)
  v_exp_f32 v121, v121
  v_mfma_f32_16x16x32_bf16 v[60:63], a[156:159], v[140:143], v[60:63]
  ds_read_b128 a[140:143], v19 offset:11264
  v_cndmask_b32 v121, 0, v121, s[10:11]
  v_cvt_pk_bf16_f32 v232, v120, v121
  v_mfma_f32_16x16x32_bf16 a[64:67], a[160:163], v[208:211], 0
  s_cselect_b32 s51, s50, s51
  v_exp_f32 v122, v122
  v_mfma_f32_16x16x32_bf16 a[68:71], a[160:163], v[212:215], 0
  v_cndmask_b32 v122, 0, v122, s[12:13]
  v_mfma_f32_16x16x32_bf16 a[72:75], a[160:163], v[216:219], 0
  s_cmp_gt_u32 s50, 16
  v_exp_f32 v123, v123
  v_mfma_f32_16x16x32_bf16 a[76:79], a[160:163], v[220:223], 0
  ds_read_b128 a[144:147], v3 offset:8192
  v_cndmask_b32 v123, 0, v123, s[14:15]
  v_cvt_pk_bf16_f32 v233, v122, v123
  v_mfma_f32_16x16x32_bf16 a[80:83], a[164:167], v[208:211], 0
  s_cselect_b32 s51, 0x8000, s51
  v_mov_b32 v152, 0
  v_mfma_f32_16x16x32_bf16 a[84:87], a[164:167], v[212:215], 0
  v_mfma_f32_16x16x32_bf16 a[88:91], a[164:167], v[216:219], 0
  s_lshl_b32 s51, s51, 15
  v_mov_b32 v153, 0
  v_mfma_f32_16x16x32_bf16 a[92:95], a[164:167], v[220:223], 0
  ds_read_b128 a[148:151], v3 offset:9216
  v_cvt_pk_bf16_f32 v234, v152, v153
  v_mfma_f32_16x16x32_bf16 a[96:99], a[168:171], v[208:211], 0
  s_add_u32 s42, s51, s40
  v_mov_b32 v154, 0
  v_mfma_f32_16x16x32_bf16 a[100:103], a[168:171], v[212:215], 0
  v_mfma_f32_16x16x32_bf16 a[104:107], a[168:171], v[216:219], 0
  s_add_u32 s50, s39, 2
  v_mov_b32 v155, 0
  v_mfma_f32_16x16x32_bf16 a[108:111], a[168:171], v[220:223], 0
  ds_read_b128 a[152:155], v3 offset:10240
  v_cvt_pk_bf16_f32 v235, v154, v155
  v_mfma_f32_16x16x32_bf16 a[112:115], a[172:175], v[208:211], 0
  s_lshl_b32 s51, s50, 1
  v_exp_f32 v124, v124
  v_mfma_f32_16x16x32_bf16 a[116:119], a[172:175], v[212:215], 0
  v_mfma_f32_16x16x32_bf16 a[120:123], a[172:175], v[216:219], 0
  s_waitcnt lgkmcnt(7)
  v_exp_f32 v125, v125
  v_mfma_f32_16x16x32_bf16 a[124:127], a[172:175], v[220:223], 0
  ds_read_b128 a[156:159], v3 offset:11264
  v_cvt_pk_bf16_f32 v236, v124, v125
  v_mfma_f32_16x16x32_bf16 v[80:83], a[176:179], v[32:35], v[240:243]
  s_sub_u32 s51, s51, s5
  v_exp_f32 v126, v126
  v_mfma_f32_16x16x32_bf16 v[80:83], a[180:183], v[64:67], v[80:83]
  v_mfma_f32_16x16x32_bf16 v[80:83], a[184:187], v[96:99], v[80:83]
  s_cmp_eq_u32 s50, s4
  v_exp_f32 v127, v127
  v_mfma_f32_16x16x32_bf16 v[80:83], a[188:191], v[128:131], v[80:83]
  ds_read_b128 a[160:163], v19 offset:12288
  v_cvt_pk_bf16_f32 v237, v126, v127
  v_mfma_f32_16x16x32_bf16 v[84:87], a[176:179], v[36:39], v[244:247]
  s_cselect_b32 s51, s6, s51
  v_exp_f32 v156, v156
  v_mfma_f32_16x16x32_bf16 v[84:87], a[180:183], v[68:71], v[84:87]
  v_cndmask_b32 v156, 0, v156, s[8:9]
  v_mfma_f32_16x16x32_bf16 v[84:87], a[184:187], v[100:103], v[84:87]
  s_cmp_lt_u32 s50, s4
  v_exp_f32 v157, v157
  v_mfma_f32_16x16x32_bf16 v[84:87], a[188:191], v[132:135], v[84:87]
  ds_read_b128 a[164:167], v19 offset:13312
  v_cndmask_b32 v157, 0, v157, s[10:11]
  v_cvt_pk_bf16_f32 v238, v156, v157
  v_mfma_f32_16x16x32_bf16 v[88:91], a[176:179], v[40:43], v[248:251]
  s_cselect_b32 s51, s50, s51
  v_exp_f32 v158, v158
  v_mfma_f32_16x16x32_bf16 v[88:91], a[180:183], v[72:75], v[88:91]
  v_cndmask_b32 v158, 0, v158, s[12:13]
  v_mfma_f32_16x16x32_bf16 v[88:91], a[184:187], v[104:107], v[88:91]
  s_cmp_gt_u32 s50, 16
  v_exp_f32 v159, v159
  v_mfma_f32_16x16x32_bf16 v[88:91], a[188:191], v[136:139], v[88:91]
  ds_read_b128 a[168:171], v19 offset:14336
  v_cndmask_b32 v159, 0, v159, s[14:15]
  v_cvt_pk_bf16_f32 v239, v158, v159
  v_mfma_f32_16x16x32_bf16 v[92:95], a[176:179], v[44:47], v[252:255]
  s_cselect_b32 s51, 0x8000, s51
  v_mfma_f32_16x16x32_bf16 v[92:95], a[180:183], v[76:79], v[92:95]
  s_lshl_b32 s51, s51, 15
  s_add_u32 s43, s51, s40
  v_mfma_f32_16x16x32_bf16 v[92:95], a[184:187], v[108:111], v[92:95]
  s_add_u32 s43, s43, 16384
  v_mfma_f32_16x16x32_bf16 v[92:95], a[188:191], v[140:143], v[92:95]
  ds_read_b128 a[172:175], v19 offset:15360
  s_and_b32 s50, s39, 1
  v_exp_f32 v48, v48
  ds_read_b128 a[176:179], v3 offset:12288
  v_mfma_f32_16x16x32_bf16 a[200:203], a[208:211], v[232:235], a[200:203]
  s_waitcnt lgkmcnt(9)
  v_exp_f32 v49, v49
  v_mfma_f32_16x16x32_bf16 a[204:207], a[208:211], v[236:239], a[204:207]
  ds_read_b128 a[180:183], v3 offset:13312
  v_cvt_pk_bf16_f32 v208, v48, v49
  s_lshl_b32 s50, s50, 14
  v_exp_f32 v50, v50
  ds_read_b128 a[184:187], v3 offset:14336
  v_mfma_f32_16x16x32_bf16 a[8:11], a[128:131], v[232:235], a[8:11]
  s_add_u32 s51, s39, 2
  v_exp_f32 v51, v51
  v_mfma_f32_16x16x32_bf16 a[12:15], a[128:131], v[236:239], a[12:15]
  ds_read_b128 a[188:191], v3 offset:15360
  v_cvt_pk_bf16_f32 v209, v50, v51
  s_sub_u32 s51, s51, s49
  v_exp_f32 v80, v80
  s_cmp_ge_i32 s51, 2
  s_cselect_b32 s46, s48, 0
  v_mfma_f32_16x16x32_bf16 a[24:27], a[132:135], v[232:235], a[24:27]
  s_add_u32 s46, s46, s50
  v_exp_f32 v81, v81
  v_mfma_f32_16x16x32_bf16 a[28:31], a[132:135], v[236:239], a[28:31]
  s_cmp_ge_i32 s51, 3
  v_cvt_pk_bf16_f32 v210, v80, v81
  s_cselect_b32 s47, s48, 0
  v_exp_f32 v82, v82
  s_xor_b32 s51, s50, 0x4000
  s_add_u32 s47, s47, s51
  v_mfma_f32_16x16x32_bf16 a[40:43], a[136:139], v[232:235], a[40:43]
  s_add_u32 s47, s47, 0x8000
  v_exp_f32 v83, v83
  v_mfma_f32_16x16x32_bf16 a[44:47], a[136:139], v[236:239], a[44:47]
  v_cvt_pk_bf16_f32 v211, v82, v83
  s_add_u32 s58, s51, s41
  v_exp_f32 v52, v52
  s_add_u32 s59, s50, s41
  s_add_u32 s59, s59, 0x8000
  v_mfma_f32_16x16x32_bf16 a[56:59], a[140:143], v[232:235], a[56:59]
  s_waitcnt lgkmcnt(8)
  v_exp_f32 v53, v53
  v_mfma_f32_16x16x32_bf16 a[60:63], a[140:143], v[236:239], a[60:63]
  s_waitcnt vmcnt(0) lgkmcnt(0)
  s_barrier
  v_cvt_pk_bf16_f32 v212, v52, v53
  v_mfma_f32_16x16x32_bf16 v[112:115], a[144:147], v[32:35], v[240:243]
  v_exp_f32 v54, v54
  v_mfma_f32_16x16x32_bf16 v[112:115], a[148:151], v[64:67], v[112:115]
  v_add_u32 v3, s46, v2
  v_add_u32 v19, s47, v2
  v_mfma_f32_16x16x32_bf16 v[112:115], a[152:155], v[96:99], v[112:115]
  v_exp_f32 v55, v55
  v_mfma_f32_16x16x32_bf16 v[112:115], a[156:159], v[128:131], v[112:115]
  ds_read_b128 a[128:131], v19 offset:0
  v_cvt_pk_bf16_f32 v213, v54, v55
  v_mfma_f32_16x16x32_bf16 v[116:119], a[144:147], v[36:39], v[244:247]
  s_mov_b32 m0, s58
  v_exp_f32 v84, v84
  v_mfma_f32_16x16x32_bf16 v[116:119], a[148:151], v[68:71], v[116:119]
  buffer_load_dwordx4 v2, s[16:19], s42 offen offset:0 sc1 lds
  v_mfma_f32_16x16x32_bf16 v[116:119], a[152:155], v[100:103], v[116:119]
  s_add_u32 s50, s39, 3
  v_exp_f32 v85, v85
  v_mfma_f32_16x16x32_bf16 v[116:119], a[156:159], v[132:135], v[116:119]
  ds_read_b128 a[132:135], v19 offset:1024
  v_cvt_pk_bf16_f32 v214, v84, v85
  v_mfma_f32_16x16x32_bf16 v[120:123], a[144:147], v[40:43], v[248:251]
  s_lshl_b32 s51, s50, 1
  v_exp_f32 v86, v86
  v_mfma_f32_16x16x32_bf16 v[120:123], a[148:151], v[72:75], v[120:123]
  buffer_load_dwordx4 v2, s[16:19], s42 offen offset:1024 sc1 lds
  v_mfma_f32_16x16x32_bf16 v[120:123], a[152:155], v[104:107], v[120:123]
  s_sub_u32 s51, s51, s5
  v_exp_f32 v87, v87
  v_mfma_f32_16x16x32_bf16 v[120:123], a[156:159], v[136:139], v[120:123]
  ds_read_b128 a[136:139], v19 offset:2048
  v_cvt_pk_bf16_f32 v215, v86, v87
  v_mfma_f32_16x16x32_bf16 v[124:127], a[144:147], v[44:47], v[252:255]
  s_cmp_eq_u32 s50, s4
  v_exp_f32 v56, v56
  v_mfma_f32_16x16x32_bf16 v[124:127], a[148:151], v[76:79], v[124:127]
  buffer_load_dwordx4 v2, s[16:19], s42 offen offset:2048 sc1 lds
  v_mfma_f32_16x16x32_bf16 v[124:127], a[152:155], v[108:111], v[124:127]
  v_exp_f32 v57, v57
  v_mfma_f32_16x16x32_bf16 v[124:127], a[156:159], v[140:143], v[124:127]
  ds_read_b128 a[140:143], v19 offset:3072
  v_cvt_pk_bf16_f32 v216, v56, v57
  s_cselect_b32 s51, s6, s51
  v_exp_f32 v58, v58
  buffer_load_dwordx4 v2, s[16:19], s42 offen offset:3072 sc1 lds
  v_mfma_f32_16x16x32_bf16 a[72:75], a[160:163], v[232:235], a[72:75]
  s_add_u32 s51, s51, 1
  v_exp_f32 v59, v59
  v_mfma_f32_16x16x32_bf16 a[76:79], a[160:163], v[236:239], a[76:79]
  ds_read_b128 a[144:147], v3 offset:0
  v_cvt_pk_bf16_f32 v217, v58, v59
  s_mov_b32 m0, s59
  v_exp_f32 v88, v88
  buffer_load_dwordx4 v2, s[16:19], s43 offen offset:0 sc1 lds
  v_mfma_f32_16x16x32_bf16 a[88:91], a[164:167], v[232:235], a[88:91]
  s_cmp_lt_u32 s50, s4
  v_exp_f32 v89, v89
  v_mfma_f32_16x16x32_bf16 a[92:95], a[164:167], v[236:239], a[92:95]
  ds_read_b128 a[148:151], v3 offset:1024
  v_cvt_pk_bf16_f32 v218, v88, v89
  s_cselect_b32 s51, 0x8000, s51
  v_exp_f32 v90, v90
  buffer_load_dwordx4 v2, s[16:19], s43 offen offset:1024 sc1 lds
  v_mfma_f32_16x16x32_bf16 a[104:107], a[168:171], v[232:235], a[104:107]
  s_cmp_gt_u32 s50, 16
  v_exp_f32 v91, v91
  v_mfma_f32_16x16x32_bf16 a[108:111], a[168:171], v[236:239], a[108:111]
  ds_read_b128 a[152:155], v3 offset:2048
  v_cvt_pk_bf16_f32 v219, v90, v91
  s_cselect_b32 s51, 0x8000, s51
  v_exp_f32 v60, v60
  buffer_load_dwordx4 v2, s[16:19], s43 offen offset:2048 sc1 lds
  v_mfma_f32_16x16x32_bf16 a[120:123], a[172:175], v[232:235], a[120:123]
  v_exp_f32 v61, v61
  v_mfma_f32_16x16x32_bf16 a[124:127], a[172:175], v[236:239], a[124:127]
  ds_read_b128 a[156:159], v3 offset:3072
  v_cvt_pk_bf16_f32 v220, v60, v61
  v_mfma_f32_16x16x32_bf16 v[144:147], a[176:179], v[32:35], v[240:243]
  s_lshl_b32 s51, s51, 15
  v_exp_f32 v62, v62
  v_mfma_f32_16x16x32_bf16 v[144:147], a[180:183], v[64:67], v[144:147]
  buffer_load_dwordx4 v2, s[16:19], s43 offen offset:3072 sc1 lds
  v_mfma_f32_16x16x32_bf16 v[144:147], a[184:187], v[96:99], v[144:147]
  s_add_u32 s44, s51, s40
  v_exp_f32 v63, v63
  v_mfma_f32_16x16x32_bf16 v[144:147], a[188:191], v[128:131], v[144:147]
  ds_read_b128 a[160:163], v19 offset:4096
  v_cvt_pk_bf16_f32 v221, v62, v63
  v_mfma_f32_16x16x32_bf16 v[148:151], a[176:179], v[36:39], v[244:247]
  s_add_u32 s50, s39, 2
  v_exp_f32 v92, v92
  v_mfma_f32_16x16x32_bf16 v[148:151], a[180:183], v[68:71], v[148:151]
  s_lshl_b32 s51, s50, 1
  s_sub_u32 s51, s51, s5
  v_mfma_f32_16x16x32_bf16 v[148:151], a[184:187], v[100:103], v[148:151]
  s_cmp_eq_u32 s50, s4
  v_exp_f32 v93, v93
  v_mfma_f32_16x16x32_bf16 v[148:151], a[188:191], v[132:135], v[148:151]
  ds_read_b128 a[164:167], v19 offset:5120
  v_cvt_pk_bf16_f32 v222, v92, v93
  v_mfma_f32_16x16x32_bf16 v[152:155], a[176:179], v[40:43], v[248:251]
  s_cselect_b32 s51, s6, s51
  v_exp_f32 v94, v94
  v_mfma_f32_16x16x32_bf16 v[152:155], a[180:183], v[72:75], v[152:155]
  s_add_u32 s51, s51, 1
  s_cmp_lt_u32 s50, s4
  v_mfma_f32_16x16x32_bf16 v[152:155], a[184:187], v[104:107], v[152:155]
  s_cselect_b32 s51, 0x8000, s51
  v_exp_f32 v95, v95
  v_mfma_f32_16x16x32_bf16 v[152:155], a[188:191], v[136:139], v[152:155]
  ds_read_b128 a[168:171], v19 offset:6144
  v_cvt_pk_bf16_f32 v223, v94, v95
  v_mfma_f32_16x16x32_bf16 v[156:159], a[176:179], v[44:47], v[252:255]
  s_cmp_gt_u32 s50, 16
  s_cselect_b32 s51, 0x8000, s51
  v_mfma_f32_16x16x32_bf16 v[156:159], a[180:183], v[76:79], v[156:159]
  s_lshl_b32 s51, s51, 15
  s_add_u32 s45, s51, s40
  v_mfma_f32_16x16x32_bf16 v[156:159], a[184:187], v[108:111], v[156:159]
  s_add_u32 s45, s45, 16384
  s_add_u32 s39, s39, 1
  v_mfma_f32_16x16x32_bf16 v[156:159], a[188:191], v[140:143], v[156:159]
  ds_read_b128 a[172:175], v19 offset:7168
  s_setpc_b64 s[52:53]
.p2align 6
L_w_b_None_full_0lasthi:
  s_setpc_b64 s[52:53]
L_w2_b_None_full_0lasthi:
  s_setpc_b64 s[56:57]
L_b_None_full_0lasthi:
  v_mfma_f32_16x16x32_bf16 a[192:195], a[208:211], v[208:211], a[192:195]
  v_exp_f32 v112, v112
  v_mfma_f32_16x16x32_bf16 a[196:199], a[208:211], v[212:215], a[196:199]
  v_mfma_f32_16x16x32_bf16 a[200:203], a[208:211], v[216:219], a[200:203]
  s_waitcnt lgkmcnt(8)
  v_exp_f32 v113, v113
  v_mfma_f32_16x16x32_bf16 a[204:207], a[208:211], v[220:223], a[204:207]
  v_cvt_pk_bf16_f32 v224, v112, v113
  v_mfma_f32_16x16x32_bf16 a[0:3], a[128:131], v[208:211], a[0:3]
  v_exp_f32 v114, v114
  v_mfma_f32_16x16x32_bf16 a[4:7], a[128:131], v[212:215], a[4:7]
  v_exp_f32 v115, v115
  s_nop 0
  v_cvt_pk_bf16_f32 v225, v114, v115
  v_mfma_f32_16x16x32_bf16 a[8:11], a[128:131], v[216:219], a[8:11]
  v_exp_f32 v144, v144
  v_mfma_f32_16x16x32_bf16 a[12:15], a[128:131], v[220:223], a[12:15]
  v_exp_f32 v145, v145
  s_nop 0
  v_cvt_pk_bf16_f32 v226, v144, v145
  v_mfma_f32_16x16x32_bf16 a[16:19], a[132:135], v[208:211], a[16:19]
  v_exp_f32 v146, v146
  v_mfma_f32_16x16x32_bf16 a[20:23], a[132:135], v[212:215], a[20:23]
  v_exp_f32 v147, v147
  s_nop 0
  v_cvt_pk_bf16_f32 v227, v146, v147
  v_mfma_f32_16x16x32_bf16 a[24:27], a[132:135], v[216:219], a[24:27]
  v_exp_f32 v116, v116
  v_mfma_f32_16x16x32_bf16 a[28:31], a[132:135], v[220:223], a[28:31]
  v_exp_f32 v117, v117
  s_nop 0
  v_cvt_pk_bf16_f32 v228, v116, v117
  v_mfma_f32_16x16x32_bf16 a[32:35], a[136:139], v[208:211], a[32:35]
  v_exp_f32 v118, v118
  v_mfma_f32_16x16x32_bf16 a[36:39], a[136:139], v[212:215], a[36:39]
  v_exp_f32 v119, v119
  ds_read_b128 a[128:131], v19 offset:8192
  v_cvt_pk_bf16_f32 v229, v118, v119
  v_mfma_f32_16x16x32_bf16 a[40:43], a[136:139], v[216:219], a[40:43]
  v_exp_f32 v148, v148
  v_mfma_f32_16x16x32_bf16 a[44:47], a[136:139], v[220:223], a[44:47]
  v_exp_f32 v149, v149
  ds_read_b128 a[132:135], v19 offset:9216
  v_cvt_pk_bf16_f32 v230, v148, v149
  v_mfma_f32_16x16x32_bf16 a[48:51], a[140:143], v[208:211], a[48:51]
  v_exp_f32 v150, v150
  v_mfma_f32_16x16x32_bf16 a[52:55], a[140:143], v[212:215], a[52:55]
  v_exp_f32 v151, v151
  ds_read_b128 a[136:139], v19 offset:10240
  v_cvt_pk_bf16_f32 v231, v150, v151
  v_mfma_f32_16x16x32_bf16 a[56:59], a[140:143], v[216:219], a[56:59]
  v_exp_f32 v120, v120
  v_mfma_f32_16x16x32_bf16 a[60:63], a[140:143], v[220:223], a[60:63]
  s_waitcnt lgkmcnt(3)
  v_exp_f32 v121, v121
  ds_read_b128 a[140:143], v19 offset:11264
  v_cvt_pk_bf16_f32 v232, v120, v121
  v_mfma_f32_16x16x32_bf16 a[64:67], a[160:163], v[208:211], a[64:67]
  v_exp_f32 v122, v122
  v_mfma_f32_16x16x32_bf16 a[68:71], a[160:163], v[212:215], a[68:71]
  v_exp_f32 v123, v123
  s_nop 0
  v_cvt_pk_bf16_f32 v233, v122, v123
  v_mfma_f32_16x16x32_bf16 a[72:75], a[160:163], v[216:219], a[72:75]
  v_exp_f32 v152, v152
  v_mfma_f32_16x16x32_bf16 a[76:79], a[160:163], v[220:223], a[76:79]
  v_exp_f32 v153, v153
  s_nop 0
  v_cvt_pk_bf16_f32 v234, v152, v153
  v_mfma_f32_16x16x32_bf16 a[80:83], a[164:167], v[208:211], a[80:83]
  v_exp_f32 v154, v154
  v_mfma_f32_16x16x32_bf16 a[84:87], a[164:167], v[212:215], a[84:87]
  v_exp_f32 v155, v155
  s_nop 0
  v_cvt_pk_bf16_f32 v235, v154, v155
  v_mfma_f32_16x16x32_bf16 a[88:91], a[164:167], v[216:219], a[88:91]
  v_exp_f32 v124, v124
  v_mfma_f32_16x16x32_bf16 a[92:95], a[164:167], v[220:223], a[92:95]
  v_exp_f32 v125, v125
  s_nop 0
  v_cvt_pk_bf16_f32 v236, v124, v125
  v_mfma_f32_16x16x32_bf16 a[96:99], a[168:171], v[208:211], a[96:99]
  v_exp_f32 v126, v126
  v_mfma_f32_16x16x32_bf16 a[100:103], a[168:171], v[212:215], a[100:103]
  v_exp_f32 v127, v127
  ds_read_b128 a[160:163], v19 offset:12288
  v_cvt_pk_bf16_f32 v237, v126, v127
  v_mfma_f32_16x16x32_bf16 a[104:107], a[168:171], v[216:219], a[104:107]
  v_exp_f32 v156, v156
  v_mfma_f32_16x16x32_bf16 a[108:111], a[168:171], v[220:223], a[108:111]
  v_exp_f32 v157, v157
  ds_read_b128 a[164:167], v19 offset:13312
  v_cvt_pk_bf16_f32 v238, v156, v157
  v_mfma_f32_16x16x32_bf16 a[112:115], a[172:175], v[208:211], a[112:115]
  v_exp_f32 v158, v158
  v_mfma_f32_16x16x32_bf16 a[116:119], a[172:175], v[212:215], a[116:119]
  v_exp_f32 v159, v159
  ds_read_b128 a[168:171], v19 offset:14336
  v_cvt_pk_bf16_f32 v239, v158, v159
  v_mfma_f32_16x16x32_bf16 a[120:123], a[172:175], v[216:219], a[120:123]
  v_mfma_f32_16x16x32_bf16 a[124:127], a[172:175], v[220:223], a[124:127]
  ds_read_b128 a[172:175], v19 offset:15360
  s_waitcnt vmcnt(0)
  v_mfma_f32_16x16x32_bf16 a[192:195], a[208:211], v[224:227], a[192:195]
  v_mfma_f32_16x16x32_bf16 a[196:199], a[208:211], v[228:231], a[196:199]
  v_mfma_f32_16x16x32_bf16 a[200:203], a[208:211], v[232:235], a[200:203]
  s_waitcnt lgkmcnt(4)
  v_mfma_f32_16x16x32_bf16 a[204:207], a[208:211], v[236:239], a[204:207]
  v_mfma_f32_16x16x32_bf16 a[0:3], a[128:131], v[224:227], a[0:3]
  v_mfma_f32_16x16x32_bf16 a[4:7], a[128:131], v[228:231], a[4:7]
  v_mfma_f32_16x16x32_bf16 a[8:11], a[128:131], v[232:235], a[8:11]
  v_mfma_f32_16x16x32_bf16 a[12:15], a[128:131], v[236:239], a[12:15]
  v_mfma_f32_16x16x32_bf16 a[16:19], a[132:135], v[224:227], a[16:19]
  v_mfma_f32_16x16x32_bf16 a[20:23], a[132:135], v[228:231], a[20:23]
  v_mfma_f32_16x16x32_bf16 a[24:27], a[132:135], v[232:235], a[24:27]
  v_mfma_f32_16x16x32_bf16 a[28:31], a[132:135], v[236:239], a[28:31]
  v_mfma_f32_16x16x32_bf16 a[32:35], a[136:139], v[224:227], a[32:35]
  ds_write_b128 v197, a[0:3] offset:0
  v_mfma_f32_16x16x32_bf16 a[36:39], a[136:139], v[228:231], a[36:39]
  ds_write_b128 v197, a[4:7] offset:8192
  v_mfma_f32_16x16x32_bf16 a[40:43], a[136:139], v[232:235], a[40:43]
  v_accvgpr_read_b32 v128, a8
  v_accvgpr_read_b32 v129, a9
  v_mfma_f32_16x16x32_bf16 a[44:47], a[136:139], v[236:239], a[44:47]
  v_accvgpr_read_b32 v130, a10
  v_accvgpr_read_b32 v131, a11
  v_mfma_f32_16x16x32_bf16 a[48:51], a[140:143], v[224:227], a[48:51]
  v_accvgpr_read_b32 v160, a12
  v_accvgpr_read_b32 v161, a13
  v_mfma_f32_16x16x32_bf16 a[52:55], a[140:143], v[228:231], a[52:55]
  v_accvgpr_read_b32 v162, a14
  v_accvgpr_read_b32 v163, a15
  v_mfma_f32_16x16x32_bf16 a[56:59], a[140:143], v[232:235], a[56:59]
  ds_write_b128 v197, a[16:19] offset:1024
  v_mfma_f32_16x16x32_bf16 a[60:63], a[140:143], v[236:239], a[60:63]
  s_waitcnt lgkmcnt(0)
  ds_write_b128 v197, a[20:23] offset:9216
  v_mfma_f32_16x16x32_bf16 a[64:67], a[160:163], v[224:227], a[64:67]
  v_accvgpr_read_b32 v132, a24
  v_accvgpr_read_b32 v133, a25
  v_mfma_f32_16x16x32_bf16 a[68:71], a[160:163], v[228:231], a[68:71]
  v_accvgpr_read_b32 v134, a26
  v_accvgpr_read_b32 v135, a27
  v_mfma_f32_16x16x32_bf16 a[72:75], a[160:163], v[232:235], a[72:75]
  v_accvgpr_read_b32 v164, a28
  v_accvgpr_read_b32 v165, a29
  v_mfma_f32_16x16x32_bf16 a[76:79], a[160:163], v[236:239], a[76:79]
  v_accvgpr_read_b32 v166, a30
  v_accvgpr_read_b32 v167, a31
  v_mfma_f32_16x16x32_bf16 a[80:83], a[164:167], v[224:227], a[80:83]
  ds_write_b128 v197, a[32:35] offset:2048
  v_mfma_f32_16x16x32_bf16 a[84:87], a[164:167], v[228:231], a[84:87]
  ds_write_b128 v197, a[36:39] offset:10240
  v_mfma_f32_16x16x32_bf16 a[88:91], a[164:167], v[232:235], a[88:91]
  v_accvgpr_read_b32 v136, a40
  v_accvgpr_read_b32 v137, a41
  v_mfma_f32_16x16x32_bf16 a[92:95], a[164:167], v[236:239], a[92:95]
  v_accvgpr_read_b32 v138, a42
  v_accvgpr_read_b32 v139, a43
  v_mfma_f32_16x16x32_bf16 a[96:99], a[168:171], v[224:227], a[96:99]
  v_accvgpr_read_b32 v168, a44
  v_accvgpr_read_b32 v169, a45
  v_mfma_f32_16x16x32_bf16 a[100:103], a[168:171], v[228:231], a[100:103]
  v_accvgpr_read_b32 v170, a46
  v_accvgpr_read_b32 v171, a47
  v_mfma_f32_16x16x32_bf16 a[104:107], a[168:171], v[232:235], a[104:107]
  ds_write_b128 v197, a[48:51] offset:3072
  v_mfma_f32_16x16x32_bf16 a[108:111], a[168:171], v[236:239], a[108:111]
  ds_write_b128 v197, a[52:55] offset:11264
  v_mfma_f32_16x16x32_bf16 a[112:115], a[172:175], v[224:227], a[112:115]
  v_accvgpr_read_b32 v140, a56
  v_accvgpr_read_b32 v141, a57
  v_mfma_f32_16x16x32_bf16 a[116:119], a[172:175], v[228:231], a[116:119]
  v_accvgpr_read_b32 v142, a58
  v_accvgpr_read_b32 v143, a59
  v_mfma_f32_16x16x32_bf16 a[120:123], a[172:175], v[232:235], a[120:123]
  v_accvgpr_read_b32 v172, a60
  v_accvgpr_read_b32 v173, a61
  v_mfma_f32_16x16x32_bf16 a[124:127], a[172:175], v[236:239], a[124:127]
  s_nop 0
  v_accvgpr_read_b32 v174, a62
  v_accvgpr_read_b32 v175, a63
  ds_write_b128 v197, a[64:67] offset:4096
  ds_write_b128 v197, a[68:71] offset:12288
  v_accvgpr_read_b32 v144, a72
  v_accvgpr_read_b32 v145, a73
  v_accvgpr_read_b32 v146, a74
  v_accvgpr_read_b32 v147, a75
  v_accvgpr_read_b32 v176, a76
  v_accvgpr_read_b32 v177, a77
  v_accvgpr_read_b32 v178, a78
  v_accvgpr_read_b32 v179, a79
  ds_write_b128 v197, a[80:83] offset:5120
  ds_write_b128 v197, a[84:87] offset:13312
  v_accvgpr_read_b32 v148, a88
  v_accvgpr_read_b32 v149, a89
  v_accvgpr_read_b32 v150, a90
  v_accvgpr_read_b32 v151, a91
  v_accvgpr_read_b32 v180, a92
  v_accvgpr_read_b32 v181, a93
  v_accvgpr_read_b32 v182, a94
  v_accvgpr_read_b32 v183, a95
  ds_write_b128 v197, a[96:99] offset:6144
  ds_write_b128 v197, a[100:103] offset:14336
  v_accvgpr_read_b32 v152, a104
  v_accvgpr_read_b32 v153, a105
  v_accvgpr_read_b32 v154, a106
  v_accvgpr_read_b32 v155, a107
  v_accvgpr_read_b32 v184, a108
  v_accvgpr_read_b32 v185, a109
  v_accvgpr_read_b32 v186, a110
  v_accvgpr_read_b32 v187, a111
  ds_write_b128 v197, a[112:115] offset:7168
  ds_write_b128 v197, a[116:119] offset:15360
  v_accvgpr_read_b32 v156, a120
  v_accvgpr_read_b32 v157, a121
  v_accvgpr_read_b32 v158, a122
  v_accvgpr_read_b32 v159, a123
  v_accvgpr_read_b32 v188, a124
  v_accvgpr_read_b32 v189, a125
  v_accvgpr_read_b32 v190, a126
  v_accvgpr_read_b32 v191, a127
  s_nop 7
  s_setpc_b64 s[52:53]
.p2align 6
L_w_b_None_diag_1lasthi:
  s_setpc_b64 s[52:53]
L_w2_b_None_diag_1lasthi:
  s_setpc_b64 s[56:57]
L_b_None_diag_1lasthi:
  v_mfma_f32_16x16x32_bf16 a[192:195], a[208:211], v[208:211], 0
  v_mfma_f32_16x16x32_bf16 a[196:199], a[208:211], v[212:215], 0
  v_mfma_f32_16x16x32_bf16 a[200:203], a[208:211], v[216:219], 0
  s_waitcnt lgkmcnt(8)
  v_mfma_f32_16x16x32_bf16 a[204:207], a[208:211], v[220:223], 0
  v_mfma_f32_16x16x32_bf16 a[0:3], a[128:131], v[208:211], 0
  v_mfma_f32_16x16x32_bf16 a[4:7], a[128:131], v[212:215], 0
  v_mfma_f32_16x16x32_bf16 a[8:11], a[128:131], v[216:219], 0
  v_mfma_f32_16x16x32_bf16 a[12:15], a[128:131], v[220:223], 0
  v_mfma_f32_16x16x32_bf16 a[16:19], a[132:135], v[208:211], 0
  v_mfma_f32_16x16x32_bf16 a[20:23], a[132:135], v[212:215], 0
  v_mfma_f32_16x16x32_bf16 a[24:27], a[132:135], v[216:219], 0
  v_mfma_f32_16x16x32_bf16 a[28:31], a[132:135], v[220:223], 0
  v_mfma_f32_16x16x32_bf16 a[32:35], a[136:139], v[208:211], 0
  v_mfma_f32_16x16x32_bf16 a[36:39], a[136:139], v[212:215], 0
  ds_read_b128 a[128:131], v19 offset:8192
  v_mfma_f32_16x16x32_bf16 a[40:43], a[136:139], v[216:219], 0
  v_mfma_f32_16x16x32_bf16 a[44:47], a[136:139], v[220:223], 0
  ds_read_b128 a[132:135], v19 offset:9216
  v_mfma_f32_16x16x32_bf16 a[48:51], a[140:143], v[208:211], 0
  v_mfma_f32_16x16x32_bf16 a[52:55], a[140:143], v[212:215], 0
  ds_read_b128 a[136:139], v19 offset:10240
  v_mfma_f32_16x16x32_bf16 a[56:59], a[140:143], v[216:219], 0
  v_exp_f32 v120, v120
  s_nop 0
  v_cndmask_b32 v120, 0, v120, s[8:9]
  v_mfma_f32_16x16x32_bf16 a[60:63], a[140:143], v[220:223], 0
  s_waitcnt lgkmcnt(3)
  v_exp_f32 v121, v121
  ds_read_b128 a[140:143], v19 offset:11264
  v_cndmask_b32 v121, 0, v121, s[10:11]
  v_cvt_pk_bf16_f32 v232, v120, v121
  v_mfma_f32_16x16x32_bf16 a[64:67], a[160:163], v[208:211], 0
  v_exp_f32 v122, v122
  s_nop 0
  v_cndmask_b32 v122, 0, v122, s[12:13]
  v_mfma_f32_16x16x32_bf16 a[68:71], a[160:163], v[212:215], 0
  v_exp_f32 v123, v123
  s_nop 0
  v_cndmask_b32 v123, 0, v123, s[14:15]
  v_cvt_pk_bf16_f32 v233, v122, v123
  v_mfma_f32_16x16x32_bf16 a[72:75], a[160:163], v[216:219], 0
  v_mov_b32 v152, 0
  v_mfma_f32_16x16x32_bf16 a[76:79], a[160:163], v[220:223], 0
  v_mov_b32 v153, 0
  v_cvt_pk_bf16_f32 v234, v152, v153
  v_mfma_f32_16x16x32_bf16 a[80:83], a[164:167], v[208:211], 0
  v_mov_b32 v154, 0
  v_mfma_f32_16x16x32_bf16 a[84:87], a[164:167], v[212:215], 0
  v_mov_b32 v155, 0
  v_cvt_pk_bf16_f32 v235, v154, v155
  v_mfma_f32_16x16x32_bf16 a[88:91], a[164:167], v[216:219], 0
  v_exp_f32 v124, v124
  v_mfma_f32_16x16x32_bf16 a[92:95], a[164:167], v[220:223], 0
  v_exp_f32 v125, v125
  s_nop 0
  v_cvt_pk_bf16_f32 v236, v124, v125
  v_mfma_f32_16x16x32_bf16 a[96:99], a[168:171], v[208:211], 0
  v_exp_f32 v126, v126
  v_mfma_f32_16x16x32_bf16 a[100:103], a[168:171], v[212:215], 0
  v_exp_f32 v127, v127
  ds_read_b128 a[160:163], v19 offset:12288
  v_cvt_pk_bf16_f32 v237, v126, v127
  v_mfma_f32_16x16x32_bf16 a[104:107], a[168:171], v[216:219], 0
  v_exp_f32 v156, v156
  s_nop 0
  v_cndmask_b32 v156, 0, v156, s[8:9]
  v_mfma_f32_16x16x32_bf16 a[108:111], a[168:171], v[220:223], 0
  v_exp_f32 v157, v157
  ds_read_b128 a[164:167], v19 offset:13312
  v_cndmask_b32 v157, 0, v157, s[10:11]
  v_cvt_pk_bf16_f32 v238, v156, v157
  v_mfma_f32_16x16x32_bf16 a[112:115], a[172:175], v[208:211], 0
  v_exp_f32 v158, v158
  s_nop 0
  v_cndmask_b32 v158, 0, v158, s[12:13]
  v_mfma_f32_16x16x32_bf16 a[116:119], a[172:175], v[212:215], 0
  v_exp_f32 v159, v159
  ds_read_b128 a[168:171], v19 offset:14336
  v_cndmask_b32 v159, 0, v159, s[14:15]
  v_cvt_pk_bf16_f32 v239, v158, v159
  v_mfma_f32_16x16x32_bf16 a[120:123], a[172:175], v[216:219], 0
  v_mfma_f32_16x16x32_bf16 a[124:127], a[172:175], v[220:223], 0
  ds_read_b128 a[172:175], v19 offset:15360
  s_waitcnt vmcnt(0)
  v_mfma_f32_16x16x32_bf16 a[200:203], a[208:211], v[232:235], a[200:203]
  s_waitcnt lgkmcnt(4)
  v_mfma_f32_16x16x32_bf16 a[204:207], a[208:211], v[236:239], a[204:207]
  v_mfma_f32_16x16x32_bf16 a[8:11], a[128:131], v[232:235], a[8:11]
  v_mfma_f32_16x16x32_bf16 a[12:15], a[128:131], v[236:239], a[12:15]
  v_mfma_f32_16x16x32_bf16 a[24:27], a[132:135], v[232:235], a[24:27]
  v_mfma_f32_16x16x32_bf16 a[28:31], a[132:135], v[236:239], a[28:31]
  v_mfma_f32_16x16x32_bf16 a[40:43], a[136:139], v[232:235], a[40:43]
  ds_write_b128 v197, a[0:3] offset:0
  v_mfma_f32_16x16x32_bf16 a[44:47], a[136:139], v[236:239], a[44:47]
  ds_write_b128 v197, a[4:7] offset:8192
  v_mfma_f32_16x16x32_bf16 a[56:59], a[140:143], v[232:235], a[56:59]
  v_accvgpr_read_b32 v128, a8
  v_accvgpr_read_b32 v129, a9
  v_mfma_f32_16x16x32_bf16 a[60:63], a[140:143], v[236:239], a[60:63]
  s_waitcnt lgkmcnt(0)
  v_accvgpr_read_b32 v130, a10
  v_accvgpr_read_b32 v131, a11
  v_mfma_f32_16x16x32_bf16 a[72:75], a[160:163], v[232:235], a[72:75]
  v_accvgpr_read_b32 v160, a12
  v_accvgpr_read_b32 v161, a13
  v_mfma_f32_16x16x32_bf16 a[76:79], a[160:163], v[236:239], a[76:79]
  v_accvgpr_read_b32 v162, a14
  v_accvgpr_read_b32 v163, a15
  v_mfma_f32_16x16x32_bf16 a[88:91], a[164:167], v[232:235], a[88:91]
  ds_write_b128 v197, a[16:19] offset:1024
  v_mfma_f32_16x16x32_bf16 a[92:95], a[164:167], v[236:239], a[92:95]
  ds_write_b128 v197, a[20:23] offset:9216
  v_mfma_f32_16x16x32_bf16 a[104:107], a[168:171], v[232:235], a[104:107]
  v_accvgpr_read_b32 v132, a24
  v_accvgpr_read_b32 v133, a25
  v_mfma_f32_16x16x32_bf16 a[108:111], a[168:171], v[236:239], a[108:111]
  v_accvgpr_read_b32 v134, a26
  v_accvgpr_read_b32 v135, a27
  v_mfma_f32_16x16x32_bf16 a[120:123], a[172:175], v[232:235], a[120:123]
  v_accvgpr_read_b32 v164, a28
  v_accvgpr_read_b32 v165, a29
  v_mfma_f32_16x16x32_bf16 a[124:127], a[172:175], v[236:239], a[124:127]
  s_nop 0
  v_accvgpr_read_b32 v166, a30
  v_accvgpr_read_b32 v167, a31
  ds_write_b128 v197, a[32:35] offset:2048
  ds_write_b128 v197, a[36:39] offset:10240
  v_accvgpr_read_b32 v136, a40
  v_accvgpr_read_b32 v137, a41
  v_accvgpr_read_b32 v138, a42
  v_accvgpr_read_b32 v139, a43
  v_accvgpr_read_b32 v168, a44
  v_accvgpr_read_b32 v169, a45
  v_accvgpr_read_b32 v170, a46
  v_accvgpr_read_b32 v171, a47
  ds_write_b128 v197, a[48:51] offset:3072
  ds_write_b128 v197, a[52:55] offset:11264
  v_accvgpr_read_b32 v140, a56
  v_accvgpr_read_b32 v141, a57
  v_accvgpr_read_b32 v142, a58
  v_accvgpr_read_b32 v143, a59
  v_accvgpr_read_b32 v172, a60
  v_accvgpr_read_b32 v173, a61
  v_accvgpr_read_b32 v174, a62
  v_accvgpr_read_b32 v175, a63
  ds_write_b128 v197, a[64:67] offset:4096
  ds_write_b128 v197, a[68:71] offset:12288
  v_accvgpr_read_b32 v144, a72
  v_accvgpr_read_b32 v145, a73
  v_accvgpr_read_b32 v146, a74
  v_accvgpr_read_b32 v147, a75
  v_accvgpr_read_b32 v176, a76
  v_accvgpr_read_b32 v177, a77
  v_accvgpr_read_b32 v178, a78
  v_accvgpr_read_b32 v179, a79
  ds_write_b128 v197, a[80:83] offset:5120
  ds_write_b128 v197, a[84:87] offset:13312
  v_accvgpr_read_b32 v148, a88
  v_accvgpr_read_b32 v149, a89
  v_accvgpr_read_b32 v150, a90
  v_accvgpr_read_b32 v151, a91
  v_accvgpr_read_b32 v180, a92
  v_accvgpr_read_b32 v181, a93
  v_accvgpr_read_b32 v182, a94
  v_accvgpr_read_b32 v183, a95
  ds_write_b128 v197, a[96:99] offset:6144
  ds_write_b128 v197, a[100:103] offset:14336
  v_accvgpr_read_b32 v152, a104
  v_accvgpr_read_b32 v153, a105
  v_accvgpr_read_b32 v154, a106
  v_accvgpr_read_b32 v155, a107
  v_accvgpr_read_b32 v184, a108
  v_accvgpr_read_b32 v185, a109
  v_accvgpr_read_b32 v186, a110
  v_accvgpr_read_b32 v187, a111
  ds_write_b128 v197, a[112:115] offset:7168
  ds_write_b128 v197, a[116:119] offset:15360
  v_accvgpr_read_b32 v156, a120
  v_accvgpr_read_b32 v157, a121
  v_accvgpr_read_b32 v158, a122
  v_accvgpr_read_b32 v159, a123
  v_accvgpr_read_b32 v188, a124
  v_accvgpr_read_b32 v189, a125
  v_accvgpr_read_b32 v190, a126
  v_accvgpr_read_b32 v191, a127
  s_nop 7
  s_setpc_b64 s[52:53]
.p2align 6
L_w_b_diag_full_1:
  s_setpc_b64 s[52:53]
L_w2_b_diag_full_1:
  s_setpc_b64 s[56:57]
L_b_diag_full_1:
  v_mfma_f32_16x16x32_bf16 a[192:195], a[208:211], v[208:211], 0
  v_exp_f32 v112, v112
  v_mfma_f32_16x16x32_bf16 a[196:199], a[208:211], v[212:215], 0
  v_mfma_f32_16x16x32_bf16 a[200:203], a[208:211], v[216:219], 0
  s_waitcnt lgkmcnt(8)
  v_exp_f32 v113, v113
  v_mfma_f32_16x16x32_bf16 a[204:207], a[208:211], v[220:223], 0
  ds_read_b128 a[176:179], v3 offset:4096
  v_cvt_pk_bf16_f32 v224, v112, v113
  v_mfma_f32_16x16x32_bf16 a[0:3], a[128:131], v[208:211], 0
  s_add_u32 m0, s58, 0x10000
  v_exp_f32 v114, v114
  v_mfma_f32_16x16x32_bf16 a[4:7], a[128:131], v[212:215], 0
  buffer_load_dwordx4 v2, s[16:19], s44 offen offset:0 sc1 lds
  v_mfma_f32_16x16x32_bf16 a[8:11], a[128:131], v[216:219], 0
  v_exp_f32 v115, v115
  v_mfma_f32_16x16x32_bf16 a[12:15], a[128:131], v[220:223], 0
  ds_read_b128 a[180:183], v3 offset:5120
  v_cvt_pk_bf16_f32 v225, v114, v115
  v_mfma_f32_16x16x32_bf16 a[16:19], a[132:135], v[208:211], 0
  v_exp_f32 v144, v144
  v_mfma_f32_16x16x32_bf16 a[20:23], a[132:135], v[212:215], 0
  buffer_load_dwordx4 v2, s[16:19], s44 offen offset:1024 sc1 lds
  v_mfma_f32_16x16x32_bf16 a[24:27], a[132:135], v[216:219], 0
  v_exp_f32 v145, v145
  v_mfma_f32_16x16x32_bf16 a[28:31], a[132:135], v[220:223], 0
  ds_read_b128 a[184:187], v3 offset:6144
  v_cvt_pk_bf16_f32 v226, v144, v145
  v_mfma_f32_16x16x32_bf16 a[32:35], a[136:139], v[208:211], 0
  v_exp_f32 v146, v146
  v_mfma_f32_16x16x32_bf16 a[36:39], a[136:139], v[212:215], 0
  buffer_load_dwordx4 v2, s[16:19], s44 offen offset:2048 sc1 lds
  v_mfma_f32_16x16x32_bf16 a[40:43], a[136:139], v[216:219], 0
  v_exp_f32 v147, v147
  v_mfma_f32_16x16x32_bf16 a[44:47], a[136:139], v[220:223], 0
  ds_read_b128 a[188:191], v3 offset:7168
  v_cvt_pk_bf16_f32 v227, v146, v147
  v_mfma_f32_16x16x32_bf16 a[48:51], a[140:143], v[208:211], 0
  v_exp_f32 v116, v116
  v_mfma_f32_16x16x32_bf16 a[52:55], a[140:143], v[212:215], 0
  buffer_load_dwordx4 v2, s[16:19], s44 offen offset:3072 sc1 lds
  v_mfma_f32_16x16x32_bf16 a[56:59], a[140:143], v[216:219], 0
  s_waitcnt lgkmcnt(8)
  v_exp_f32 v117, v117
  v_mfma_f32_16x16x32_bf16 a[60:63], a[140:143], v[220:223], 0
  v_cvt_pk_bf16_f32 v228, v116, v117
  v_mfma_f32_16x16x32_bf16 v[48:51], a[144:147], v[32:35], v[240:243]
  s_add_u32 m0, s59, 0x10000
  v_exp_f32 v118, v118
  v_mfma_f32_16x16x32_bf16 v[48:51], a[148:151], v[64:67], v[48:51]
  buffer_load_dwordx4 v2, s[16:19], s45 offen offset:0 sc1 lds
  v_mfma_f32_16x16x32_bf16 v[48:51], a[152:155], v[96:99], v[48:51]
  s_add_u32 s50, s39, 3
  v_exp_f32 v119, v119
  v_mfma_f32_16x16x32_bf16 v[48:51], a[156:159], v[128:131], v[48:51]
  ds_read_b128 a[128:131], v19 offset:8192
  v_cvt_pk_bf16_f32 v229, v118, v119
  v_mfma_f32_16x16x32_bf16 v[52:55], a[144:147], v[36:39], v[244:247]
  s_lshl_b32 s51, s50, 1
  v_exp_f32 v148, v148
  v_mfma_f32_16x16x32_bf16 v[52:55], a[148:151], v[68:71], v[52:55]
  buffer_load_dwordx4 v2, s[16:19], s45 offen offset:1024 sc1 lds
  v_mfma_f32_16x16x32_bf16 v[52:55], a[152:155], v[100:103], v[52:55]
  s_sub_u32 s51, s51, s5
  v_exp_f32 v149, v149
  v_mfma_f32_16x16x32_bf16 v[52:55], a[156:159], v[132:135], v[52:55]
  ds_read_b128 a[132:135], v19 offset:9216
  v_cvt_pk_bf16_f32 v230, v148, v149
  v_mfma_f32_16x16x32_bf16 v[56:59], a[144:147], v[40:43], v[248:251]
  s_cmp_eq_u32 s50, s4
  v_exp_f32 v150, v150
  v_mfma_f32_16x16x32_bf16 v[56:59], a[148:151], v[72:75], v[56:59]
  buffer_load_dwordx4 v2, s[16:19], s45 offen offset:2048 sc1 lds
  v_mfma_f32_16x16x32_bf16 v[56:59], a[152:155], v[104:107], v[56:59]
  s_cselect_b32 s51, s6, s51
  v_exp_f32 v151, v151
  v_mfma_f32_16x16x32_bf16 v[56:59], a[156:159], v[136:139], v[56:59]
  ds_read_b128 a[136:139], v19 offset:10240
  v_cvt_pk_bf16_f32 v231, v150, v151
  v_mfma_f32_16x16x32_bf16 v[60:63], a[144:147], v[44:47], v[252:255]
  s_cmp_lt_u32 s50, s4
  v_exp_f32 v120, v120
  v_mfma_f32_16x16x32_bf16 v[60:63], a[148:151], v[76:79], v[60:63]
  buffer_load_dwordx4 v2, s[16:19], s45 offen offset:3072 sc1 lds
  v_mfma_f32_16x16x32_bf16 v[60:63], a[152:155], v[108:111], v[60:63]
  s_waitcnt lgkmcnt(7)
  v_exp_f32 v121, v121
  v_mfma_f32_16x16x32_bf16 v[60:63], a[156:159], v[140:143], v[60:63]
  ds_read_b128 a[140:143], v19 offset:11264
  v_cvt_pk_bf16_f32 v232, v120, v121
  v_mfma_f32_16x16x32_bf16 a[64:67], a[160:163], v[208:211], 0
  s_cselect_b32 s51, s50, s51
  v_exp_f32 v122, v122
  v_mfma_f32_16x16x32_bf16 a[68:71], a[160:163], v[212:215], 0
  v_mfma_f32_16x16x32_bf16 a[72:75], a[160:163], v[216:219], 0
  s_cmp_gt_u32 s50, 16
  v_exp_f32 v123, v123
  v_mfma_f32_16x16x32_bf16 a[76:79], a[160:163], v[220:223], 0
  ds_read_b128 a[144:147], v3 offset:8192
  v_cvt_pk_bf16_f32 v233, v122, v123
  v_mfma_f32_16x16x32_bf16 a[80:83], a[164:167], v[208:211], 0
  s_cselect_b32 s51, 0x8000, s51
  v_exp_f32 v152, v152
  v_mfma_f32_16x16x32_bf16 a[84:87], a[164:167], v[212:215], 0
  v_mfma_f32_16x16x32_bf16 a[88:91], a[164:167], v[216:219], 0
  s_lshl_b32 s51, s51, 15
  v_exp_f32 v153, v153
  v_mfma_f32_16x16x32_bf16 a[92:95], a[164:167], v[220:223], 0
  ds_read_b128 a[148:151], v3 offset:9216
  v_cvt_pk_bf16_f32 v234, v152, v153
  v_mfma_f32_16x16x32_bf16 a[96:99], a[168:171], v[208:211], 0
  s_add_u32 s42, s51, s40
  v_exp_f32 v154, v154
  v_mfma_f32_16x16x32_bf16 a[100:103], a[168:171], v[212:215], 0
  v_mfma_f32_16x16x32_bf16 a[104:107], a[168:171], v[216:219], 0
  s_add_u32 s50, s39, 2
  v_exp_f32 v155, v155
  v_mfma_f32_16x16x32_bf16 a[108:111], a[168:171], v[220:223], 0
  ds_read_b128 a[152:155], v3 offset:10240
  v_cvt_pk_bf16_f32 v235, v154, v155
  v_mfma_f32_16x16x32_bf16 a[112:115], a[172:175], v[208:211], 0
  s_lshl_b32 s51, s50, 1
  v_exp_f32 v124, v124
  v_mfma_f32_16x16x32_bf16 a[116:119], a[172:175], v[212:215], 0
  v_mfma_f32_16x16x32_bf16 a[120:123], a[172:175], v[216:219], 0
  s_waitcnt lgkmcnt(7)
  v_exp_f32 v125, v125
  v_mfma_f32_16x16x32_bf16 a[124:127], a[172:175], v[220:223], 0
  ds_read_b128 a[156:159], v3 offset:11264
  v_cvt_pk_bf16_f32 v236, v124, v125
  s_sub_u32 s51, s51, s5
  v_exp_f32 v126, v126
  s_cmp_eq_u32 s50, s4
  v_exp_f32 v127, v127
  ds_read_b128 a[160:163], v19 offset:12288
  v_cvt_pk_bf16_f32 v237, v126, v127
  v_mfma_f32_16x16x32_bf16 v[84:87], a[176:179], v[36:39], v[244:247]
  s_cselect_b32 s51, s6, s51
  v_exp_f32 v156, v156
  v_mfma_f32_16x16x32_bf16 v[84:87], a[180:183], v[68:71], v[84:87]
  v_mfma_f32_16x16x32_bf16 v[84:87], a[184:187], v[100:103], v[84:87]
  s_cmp_lt_u32 s50, s4
  v_exp_f32 v157, v157
  v_mfma_f32_16x16x32_bf16 v[84:87], a[188:191], v[132:135], v[84:87]
  ds_read_b128 a[164:167], v19 offset:13312
  v_cvt_pk_bf16_f32 v238, v156, v157
  v_mfma_f32_16x16x32_bf16 v[88:91], a[176:179], v[40:43], v[248:251]
  s_cselect_b32 s51, s50, s51
  v_exp_f32 v158, v158
  v_mfma_f32_16x16x32_bf16 v[88:91], a[180:183], v[72:75], v[88:91]
  v_mfma_f32_16x16x32_bf16 v[88:91], a[184:187], v[104:107], v[88:91]
  s_cmp_gt_u32 s50, 16
  v_exp_f32 v159, v159
  v_mfma_f32_16x16x32_bf16 v[88:91], a[188:191], v[136:139], v[88:91]
  ds_read_b128 a[168:171], v19 offset:14336
  v_cvt_pk_bf16_f32 v239, v158, v159
  v_mfma_f32_16x16x32_bf16 v[92:95], a[176:179], v[44:47], v[252:255]
  s_cselect_b32 s51, 0x8000, s51
  v_mfma_f32_16x16x32_bf16 v[92:95], a[180:183], v[76:79], v[92:95]
  s_lshl_b32 s51, s51, 15
  s_add_u32 s43, s51, s40
  v_mfma_f32_16x16x32_bf16 v[92:95], a[184:187], v[108:111], v[92:95]
  s_add_u32 s43, s43, 16384
  v_mfma_f32_16x16x32_bf16 v[92:95], a[188:191], v[140:143], v[92:95]
  ds_read_b128 a[172:175], v19 offset:15360
  v_mfma_f32_16x16x32_bf16 a[192:195], a[208:211], v[224:227], a[192:195]
  s_and_b32 s50, s39, 1
  v_exp_f32 v48, v48
  v_mfma_f32_16x16x32_bf16 a[196:199], a[208:211], v[228:231], a[196:199]
  ds_read_b128 a[176:179], v3 offset:12288
  v_cndmask_b32 v48, 0, v48, s[8:9]
  v_mfma_f32_16x16x32_bf16 a[200:203], a[208:211], v[232:235], a[200:203]
  s_waitcnt lgkmcnt(9)
  v_exp_f32 v49, v49
  v_mfma_f32_16x16x32_bf16 a[204:207], a[208:211], v[236:239], a[204:207]
  ds_read_b128 a[180:183], v3 offset:13312
  v_cndmask_b32 v49, 0, v49, s[10:11]
  v_cvt_pk_bf16_f32 v208, v48, v49
  v_mfma_f32_16x16x32_bf16 a[0:3], a[128:131], v[224:227], a[0:3]
  s_lshl_b32 s50, s50, 14
  v_exp_f32 v50, v50
  v_mfma_f32_16x16x32_bf16 a[4:7], a[128:131], v[228:231], a[4:7]
  ds_read_b128 a[184:187], v3 offset:14336
  v_cndmask_b32 v50, 0, v50, s[12:13]
  v_mfma_f32_16x16x32_bf16 a[8:11], a[128:131], v[232:235], a[8:11]
  s_add_u32 s51, s39, 2
  v_exp_f32 v51, v51
  v_mfma_f32_16x16x32_bf16 a[12:15], a[128:131], v[236:239], a[12:15]
  ds_read_b128 a[188:191], v3 offset:15360
  v_cndmask_b32 v51, 0, v51, s[14:15]
  v_cvt_pk_bf16_f32 v209, v50, v51
  v_mfma_f32_16x16x32_bf16 a[16:19], a[132:135], v[224:227], a[16:19]
  s_sub_u32 s51, s51, s49
  v_mov_b32 v80, 0
  v_mfma_f32_16x16x32_bf16 a[20:23], a[132:135], v[228:231], a[20:23]
  s_cmp_ge_i32 s51, 2
  s_cselect_b32 s46, s48, 0
  v_mfma_f32_16x16x32_bf16 a[24:27], a[132:135], v[232:235], a[24:27]
  s_add_u32 s46, s46, s50
  v_mov_b32 v81, 0
  v_mfma_f32_16x16x32_bf16 a[28:31], a[132:135], v[236:239], a[28:31]
  s_cmp_ge_i32 s51, 3
  v_cvt_pk_bf16_f32 v210, v80, v81
  v_mfma_f32_16x16x32_bf16 a[32:35], a[136:139], v[224:227], a[32:35]
  s_cselect_b32 s47, s48, 0
  v_mov_b32 v82, 0
  v_mfma_f32_16x16x32_bf16 a[36:39], a[136:139], v[228:231], a[36:39]
  s_xor_b32 s51, s50, 0x4000
  s_add_u32 s47, s47, s51
  v_mfma_f32_16x16x32_bf16 a[40:43], a[136:139], v[232:235], a[40:43]
  s_add_u32 s47, s47, 0x8000
  v_mov_b32 v83, 0
  v_mfma_f32_16x16x32_bf16 a[44:47], a[136:139], v[236:239], a[44:47]
  v_cvt_pk_bf16_f32 v211, v82, v83
  v_mfma_f32_16x16x32_bf16 a[48:51], a[140:143], v[224:227], a[48:51]
  s_add_u32 s58, s51, s41
  v_exp_f32 v52, v52
  v_mfma_f32_16x16x32_bf16 a[52:55], a[140:143], v[228:231], a[52:55]
  s_add_u32 s59, s50, s41
  s_add_u32 s59, s59, 0x8000
  v_mfma_f32_16x16x32_bf16 a[56:59], a[140:143], v[232:235], a[56:59]
  s_waitcnt lgkmcnt(8)
  v_exp_f32 v53, v53
  v_mfma_f32_16x16x32_bf16 a[60:63], a[140:143], v[236:239], a[60:63]
  s_waitcnt vmcnt(0) lgkmcnt(0)
  s_barrier
  v_cvt_pk_bf16_f32 v212, v52, v53
  v_exp_f32 v54, v54
  v_add_u32 v3, s46, v2
  v_add_u32 v19, s47, v2
  v_exp_f32 v55, v55
  ds_read_b128 a[128:131], v19 offset:0
  v_cvt_pk_bf16_f32 v213, v54, v55
  s_mov_b32 m0, s58
  v_exp_f32 v84, v84
  buffer_load_dwordx4 v2, s[16:19], s42 offen offset:0 sc1 lds
  v_cndmask_b32 v84, 0, v84, s[8:9]
  s_add_u32 s50, s39, 3
  v_exp_f32 v85, v85
  ds_read_b128 a[132:135], v19 offset:1024
  v_cndmask_b32 v85, 0, v85, s[10:11]
  v_cvt_pk_bf16_f32 v214, v84, v85
  v_mfma_f32_16x16x32_bf16 v[120:123], a[144:147], v[40:43], v[248:251]
  s_lshl_b32 s51, s50, 1
  v_exp_f32 v86, v86
  v_mfma_f32_16x16x32_bf16 v[120:123], a[148:151], v[72:75], v[120:123]
  buffer_load_dwordx4 v2, s[16:19], s42 offen offset:1024 sc1 lds
  v_cndmask_b32 v86, 0, v86, s[12:13]
  v_mfma_f32_16x16x32_bf16 v[120:123], a[152:155], v[104:107], v[120:123]
  s_sub_u32 s51, s51, s5
  v_exp_f32 v87, v87
  v_mfma_f32_16x16x32_bf16 v[120:123], a[156:159], v[136:139], v[120:123]
  ds_read_b128 a[136:139], v19 offset:2048
  v_cndmask_b32 v87, 0, v87, s[14:15]
  v_cvt_pk_bf16_f32 v215, v86, v87
  v_mfma_f32_16x16x32_bf16 v[124:127], a[144:147], v[44:47], v[252:255]
  s_cmp_eq_u32 s50, s4
  v_exp_f32 v56, v56
  v_mfma_f32_16x16x32_bf16 v[124:127], a[148:151], v[76:79], v[124:127]
  buffer_load_dwordx4 v2, s[16:19], s42 offen offset:2048 sc1 lds
  v_mfma_f32_16x16x32_bf16 v[124:127], a[152:155], v[108:111], v[124:127]
  v_exp_f32 v57, v57
  v_mfma_f32_16x16x32_bf16 v[124:127], a[156:159], v[140:143], v[124:127]
  ds_read_b128 a[140:143], v19 offset:3072
  v_cvt_pk_bf16_f32 v216, v56, v57
  v_mfma_f32_16x16x32_bf16 a[64:67], a[160:163], v[224:227], a[64:67]
  s_cselect_b32 s51, s6, s51
  v_exp_f32 v58, v58
  v_mfma_f32_16x16x32_bf16 a[68:71], a[160:163], v[228:231], a[68:71]
  buffer_load_dwordx4 v2, s[16:19], s42 offen offset:3072 sc1 lds
  v_mfma_f32_16x16x32_bf16 a[72:75], a[160:163], v[232:235], a[72:75]
  s_add_u32 s51, s51, 1
  v_exp_f32 v59, v59
  v_mfma_f32_16x16x32_bf16 a[76:79], a[160:163], v[236:239], a[76:79]
  ds_read_b128 a[144:147], v3 offset:0
  v_cvt_pk_bf16_f32 v217, v58, v59
  v_mfma_f32_16x16x32_bf16 a[80:83], a[164:167], v[224:227], a[80:83]
  s_mov_b32 m0, s59
  v_exp_f32 v88, v88
  v_mfma_f32_16x16x32_bf16 a[84:87], a[164:167], v[228:231], a[84:87]
  buffer_load_dwordx4 v2, s[16:19], s43 offen offset:0 sc1 lds
  v_mfma_f32_16x16x32_bf16 a[88:91], a[164:167], v[232:235], a[88:91]
  s_cmp_lt_u32 s50, s4
  v_exp_f32 v89, v89
  v_mfma_f32_16x16x32_bf16 a[92:95], a[164:167], v[236:239], a[92:95]
  ds_read_b128 a[148:151], v3 offset:1024
  v_cvt_pk_bf16_f32 v218, v88, v89
  v_mfma_f32_16x16x32_bf16 a[96:99], a[168:171], v[224:227], a[96:99]
  s_cselect_b32 s51, 0x8000, s51
  v_exp_f32 v90, v90
  v_mfma_f32_16x16x32_bf16 a[100:103], a[168:171], v[228:231], a[100:103]
  buffer_load_dwordx4 v2, s[16:19], s43 offen offset:1024 sc1 lds
  v_mfma_f32_16x16x32_bf16 a[104:107], a[168:171], v[232:235], a[104:107]
  s_cmp_gt_u32 s50, 16
  v_exp_f32 v91, v91
  v_mfma_f32_16x16x32_bf16 a[108:111], a[168:171], v[236:239], a[108:111]
  ds_read_b128 a[152:155], v3 offset:2048
  v_cvt_pk_bf16_f32 v219, v90, v91
  v_mfma_f32_16x16x32_bf16 a[112:115], a[172:175], v[224:227], a[112:115]
  s_cselect_b32 s51, 0x8000, s51
  v_exp_f32 v60, v60
  v_mfma_f32_16x16x32_bf16 a[116:119], a[172:175], v[228:231], a[116:119]
  buffer_load_dwordx4 v2, s[16:19], s43 offen offset:2048 sc1 lds
  v_mfma_f32_16x16x32_bf16 a[120:123], a[172:175], v[232:235], a[120:123]
  v_exp_f32 v61, v61
  v_mfma_f32_16x16x32_bf16 a[124:127], a[172:175], v[236:239], a[124:127]
  ds_read_b128 a[156:159], v3 offset:3072
  v_cvt_pk_bf16_f32 v220, v60, v61
  s_lshl_b32 s51, s51, 15
  v_exp_f32 v62, v62
  buffer_load_dwordx4 v2, s[16:19], s43 offen offset:3072 sc1 lds
  s_add_u32 s44, s51, s40
  v_exp_f32 v63, v63
  ds_read_b128 a[160:163], v19 offset:4096
  v_cvt_pk_bf16_f32 v221, v62, v63
  s_add_u32 s50, s39, 2
  v_exp_f32 v92, v92
  s_lshl_b32 s51, s50, 1
  s_sub_u32 s51, s51, s5
  global_load_dword v4, v18, s[70:71]
  s_cmp_eq_u32 s50, s4
  v_exp_f32 v93, v93
  ds_read_b128 a[164:167], v19 offset:5120
  v_cvt_pk_bf16_f32 v222, v92, v93
  s_cselect_b32 s51, s6, s51
  v_exp_f32 v94, v94
  s_add_u32 s51, s51, 1
  s_cmp_lt_u32 s50, s4
  global_load_dword v4, v17, s[66:67]
  s_cselect_b32 s51, 0x8000, s51
  v_exp_f32 v95, v95
  ds_read_b128 a[168:171], v19 offset:6144
  v_cvt_pk_bf16_f32 v223, v94, v95
  v_mfma_f32_16x16x32_bf16 v[156:159], a[176:179], v[44:47], v[252:255]
  s_cmp_gt_u32 s50, 16
  s_cselect_b32 s51, 0x8000, s51
  v_mfma_f32_16x16x32_bf16 v[156:159], a[180:183], v[76:79], v[156:159]
  s_lshl_b32 s51, s51, 15
  s_add_u32 s45, s51, s40
  v_mfma_f32_16x16x32_bf16 v[156:159], a[184:187], v[108:111], v[156:159]
  s_add_u32 s45, s45, 16384
  s_add_u32 s39, s39, 1
  v_mfma_f32_16x16x32_bf16 v[156:159], a[188:191], v[140:143], v[156:159]
  ds_read_b128 a[172:175], v19 offset:7168
  s_setpc_b64 s[52:53]
.p2align 6
L_w_b_full_None_0st:
  s_setpc_b64 s[52:53]
L_w2_b_full_None_0st:
  s_setpc_b64 s[56:57]
L_b_full_None_0st:
  s_waitcnt lgkmcnt(4)
  ds_read_b128 a[176:179], v3 offset:4096
  v_mfma_f32_16x16x32_bf16 v[48:51], a[144:147], v[32:35], v[240:243]
  s_add_u32 m0, s58, 0x10000
  v_accvgpr_read_b32 v194, a200
  v_accvgpr_read_b32 v195, a204
  buffer_load_dwordx4 v2, s[16:19], s44 offen offset:0 sc1 lds
  v_mfma_f32_16x16x32_bf16 v[48:51], a[148:151], v[64:67], v[48:51]
  v_mov_b32 v196, 1585446912
  v_cmp_nle_f32 vcc, v194, v196
  ds_read_b128 a[180:183], v3 offset:5120
  v_mfma_f32_16x16x32_bf16 v[48:51], a[152:155], v[96:99], v[48:51]
  s_or_b32 s34, vcc_lo, vcc_hi
  s_or_b32 s55, s55, s34
  v_cmp_nle_f32 vcc, v195, v196
  s_or_b32 s34, vcc_lo, vcc_hi
  s_or_b32 s55, s55, s34
  v_rcp_f32 v194, v194
  buffer_load_dwordx4 v2, s[16:19], s44 offen offset:1024 sc1 lds
  v_mfma_f32_16x16x32_bf16 v[48:51], a[156:159], v[128:131], v[48:51]
  v_rcp_f32 v195, v195
  s_add_u32 s33, s32, 262144
  s_add_u32 s35, s32, 393216
  v_accvgpr_read_b32 v224, a8
  ds_read_b128 a[184:187], v3 offset:6144
  v_mfma_f32_16x16x32_bf16 v[52:55], a[144:147], v[36:39], v[244:247]
  v_accvgpr_read_b32 v225, a9
  v_accvgpr_read_b32 v226, a10
  buffer_load_dwordx4 v2, s[16:19], s44 offen offset:2048 sc1 lds
  v_mfma_f32_16x16x32_bf16 v[52:55], a[148:151], v[68:71], v[52:55]
  v_accvgpr_read_b32 v227, a11
  v_accvgpr_read_b32 v228, a24
  ds_read_b128 a[188:191], v3 offset:7168
  v_mfma_f32_16x16x32_bf16 v[52:55], a[152:155], v[100:103], v[52:55]
  v_accvgpr_read_b32 v229, a25
  v_accvgpr_read_b32 v230, a26
  buffer_load_dwordx4 v2, s[16:19], s44 offen offset:3072 sc1 lds
  v_mfma_f32_16x16x32_bf16 v[52:55], a[156:159], v[132:135], v[52:55]
  v_accvgpr_read_b32 v231, a27
  v_mul_f32 v224, v224, v194
  v_mfma_f32_16x16x32_bf16 v[56:59], a[144:147], v[40:43], v[248:251]
  s_add_u32 m0, s59, 0x10000
  v_mul_f32 v225, v225, v194
  v_mul_f32 v226, v226, v194
  buffer_load_dwordx4 v2, s[16:19], s45 offen offset:0 sc1 lds
  v_mfma_f32_16x16x32_bf16 v[56:59], a[148:151], v[72:75], v[56:59]
  s_add_u32 s50, s39, 3
  v_mul_f32 v227, v227, v194
  v_mul_f32 v228, v228, v194
  v_mfma_f32_16x16x32_bf16 v[56:59], a[152:155], v[104:107], v[56:59]
  s_lshl_b32 s51, s50, 1
  v_mul_f32 v229, v229, v194
  v_mul_f32 v230, v230, v194
  buffer_load_dwordx4 v2, s[16:19], s45 offen offset:1024 sc1 lds
  v_mfma_f32_16x16x32_bf16 v[56:59], a[156:159], v[136:139], v[56:59]
  s_sub_u32 s51, s51, s5
  v_mul_f32 v231, v231, v194
  v_cvt_pk_bf16_f32 v160, v224, v225
  v_mfma_f32_16x16x32_bf16 v[60:63], a[144:147], v[44:47], v[252:255]
  s_cmp_eq_u32 s50, s4
  v_cvt_pk_bf16_f32 v161, v226, v227
  v_cvt_pk_bf16_f32 v162, v228, v229
  buffer_load_dwordx4 v2, s[16:19], s45 offen offset:2048 sc1 lds
  v_mfma_f32_16x16x32_bf16 v[60:63], a[148:151], v[76:79], v[60:63]
  s_cselect_b32 s51, s6, s51
  v_cvt_pk_bf16_f32 v163, v230, v231
  buffer_store_dwordx4 v[160:163], v2, s[16:19], s33 offen offset:0 sc1
  v_mfma_f32_16x16x32_bf16 v[60:63], a[152:155], v[108:111], v[60:63]
  s_cmp_lt_u32 s50, s4
  v_accvgpr_read_b32 v232, a40
  v_accvgpr_read_b32 v233, a41
  buffer_load_dwordx4 v2, s[16:19], s45 offen offset:3072 sc1 lds
  v_mfma_f32_16x16x32_bf16 v[60:63], a[156:159], v[140:143], v[60:63]
  s_waitcnt lgkmcnt(0)
  v_accvgpr_read_b32 v234, a42
  v_accvgpr_read_b32 v235, a43
  v_mfma_f32_16x16x32_bf16 v[80:83], a[176:179], v[32:35], v[240:243]
  s_cselect_b32 s51, s50, s51
  v_accvgpr_read_b32 v236, a56
  v_accvgpr_read_b32 v237, a57
  v_mfma_f32_16x16x32_bf16 v[80:83], a[180:183], v[64:67], v[80:83]
  s_cmp_gt_u32 s50, 16
  v_accvgpr_read_b32 v238, a58
  v_accvgpr_read_b32 v239, a59
  ds_read_b128 a[144:147], v3 offset:8192
  v_mfma_f32_16x16x32_bf16 v[80:83], a[184:187], v[96:99], v[80:83]
  s_cselect_b32 s51, 0x8000, s51
  v_mul_f32 v232, v232, v194
  v_mul_f32 v233, v233, v194
  v_mfma_f32_16x16x32_bf16 v[80:83], a[188:191], v[128:131], v[80:83]
  s_lshl_b32 s51, s51, 15
  v_mul_f32 v234, v234, v194
  v_mul_f32 v235, v235, v194
  ds_read_b128 a[148:151], v3 offset:9216
  v_mfma_f32_16x16x32_bf16 v[84:87], a[176:179], v[36:39], v[244:247]
  s_add_u32 s42, s51, s40
  v_mul_f32 v236, v236, v194
  v_mul_f32 v237, v237, v194
  v_mfma_f32_16x16x32_bf16 v[84:87], a[180:183], v[68:71], v[84:87]
  s_add_u32 s50, s39, 2
  v_mul_f32 v238, v238, v194
  v_mul_f32 v239, v239, v194
  ds_read_b128 a[152:155], v3 offset:10240
  v_mfma_f32_16x16x32_bf16 v[84:87], a[184:187], v[100:103], v[84:87]
  s_lshl_b32 s51, s50, 1
  v_cvt_pk_bf16_f32 v164, v232, v233
  v_cvt_pk_bf16_f32 v165, v234, v235
  v_mfma_f32_16x16x32_bf16 v[84:87], a[188:191], v[132:135], v[84:87]
  v_cvt_pk_bf16_f32 v166, v236, v237
  v_cvt_pk_bf16_f32 v167, v238, v239
  ds_read_b128 a[156:159], v3 offset:11264
  v_mfma_f32_16x16x32_bf16 v[88:91], a[176:179], v[40:43], v[248:251]
  s_sub_u32 s51, s51, s5
  buffer_store_dwordx4 v[164:167], v2, s[16:19], s33 offen offset:1024 sc1
  v_mfma_f32_16x16x32_bf16 v[88:91], a[180:183], v[72:75], v[88:91]
  s_cmp_eq_u32 s50, s4
  v_accvgpr_read_b32 v224, a72
  v_accvgpr_read_b32 v225, a73
  v_mfma_f32_16x16x32_bf16 v[88:91], a[184:187], v[104:107], v[88:91]
  s_cselect_b32 s51, s6, s51
  v_accvgpr_read_b32 v226, a74
  v_accvgpr_read_b32 v227, a75
  v_mfma_f32_16x16x32_bf16 v[88:91], a[188:191], v[136:139], v[88:91]
  s_cmp_lt_u32 s50, s4
  v_accvgpr_read_b32 v228, a88
  v_accvgpr_read_b32 v229, a89
  v_mfma_f32_16x16x32_bf16 v[92:95], a[176:179], v[44:47], v[252:255]
  s_cselect_b32 s51, s50, s51
  v_accvgpr_read_b32 v230, a90
  v_accvgpr_read_b32 v231, a91
  v_mfma_f32_16x16x32_bf16 v[92:95], a[180:183], v[76:79], v[92:95]
  s_cmp_gt_u32 s50, 16
  v_mul_f32 v224, v224, v194
  v_mul_f32 v225, v225, v194
  v_mfma_f32_16x16x32_bf16 v[92:95], a[184:187], v[108:111], v[92:95]
  s_cselect_b32 s51, 0x8000, s51
  v_mul_f32 v226, v226, v194
  v_mul_f32 v227, v227, v194
  s_lshl_b32 s51, s51, 15
  s_add_u32 s43, s51, s40
  v_mfma_f32_16x16x32_bf16 v[92:95], a[188:191], v[140:143], v[92:95]
  s_add_u32 s43, s43, 16384
  v_mul_f32 v228, v228, v194
  v_mul_f32 v229, v229, v194
  v_mul_f32 v230, v230, v194
  v_mul_f32 v231, v231, v194
  v_cvt_pk_bf16_f32 v168, v224, v225
  v_cvt_pk_bf16_f32 v169, v226, v227
  v_cvt_pk_bf16_f32 v170, v228, v229
  v_cvt_pk_bf16_f32 v171, v230, v231
  buffer_store_dwordx4 v[168:171], v2, s[16:19], s33 offen offset:2048 sc1
  v_accvgpr_read_b32 v232, a104
  v_accvgpr_read_b32 v233, a105
  v_accvgpr_read_b32 v234, a106
  v_accvgpr_read_b32 v235, a107
  v_accvgpr_read_b32 v236, a120
  v_accvgpr_read_b32 v237, a121
  v_accvgpr_read_b32 v238, a122
  v_accvgpr_read_b32 v239, a123
  v_pk_mul_f32 v[232:233], v[232:233], v[194:195] op_sel:[0,0] op_sel_hi:[1,0]
  v_pk_mul_f32 v[234:235], v[234:235], v[194:195] op_sel:[0,0] op_sel_hi:[1,0]
  v_pk_mul_f32 v[236:237], v[236:237], v[194:195] op_sel:[0,0] op_sel_hi:[1,0]
  v_pk_mul_f32 v[238:239], v[238:239], v[194:195] op_sel:[0,0] op_sel_hi:[1,0]
  v_cvt_pk_bf16_f32 v172, v232, v233
  v_cvt_pk_bf16_f32 v173, v234, v235
  v_cvt_pk_bf16_f32 v174, v236, v237
  v_cvt_pk_bf16_f32 v175, v238, v239
  buffer_store_dwordx4 v[172:175], v2, s[16:19], s33 offen offset:3072 sc1
  v_accvgpr_read_b32 v224, a12
  v_accvgpr_read_b32 v225, a13
  v_accvgpr_read_b32 v226, a14
  v_accvgpr_read_b32 v227, a15
  v_accvgpr_read_b32 v228, a28
  v_accvgpr_read_b32 v229, a29
  v_accvgpr_read_b32 v230, a30
  v_accvgpr_read_b32 v231, a31
  v_pk_mul_f32 v[224:225], v[224:225], v[194:195] op_sel:[0,1] op_sel_hi:[1,1]
  v_pk_mul_f32 v[226:227], v[226:227], v[194:195] op_sel:[0,1] op_sel_hi:[1,1]
  v_pk_mul_f32 v[228:229], v[228:229], v[194:195] op_sel:[0,1] op_sel_hi:[1,1]
  v_pk_mul_f32 v[230:231], v[230:231], v[194:195] op_sel:[0,1] op_sel_hi:[1,1]
  v_cvt_pk_bf16_f32 v176, v224, v225
  v_cvt_pk_bf16_f32 v177, v226, v227
  v_cvt_pk_bf16_f32 v178, v228, v229
  v_cvt_pk_bf16_f32 v179, v230, v231
  buffer_store_dwordx4 v[176:179], v2, s[16:19], s35 offen offset:0 sc1
  v_accvgpr_read_b32 v232, a44
  v_accvgpr_read_b32 v233, a45
  v_accvgpr_read_b32 v234, a46
  v_accvgpr_read_b32 v235, a47
  v_accvgpr_read_b32 v236, a60
  v_accvgpr_read_b32 v237, a61
  v_accvgpr_read_b32 v238, a62
  v_accvgpr_read_b32 v239, a63
  v_pk_mul_f32 v[232:233], v[232:233], v[194:195] op_sel:[0,1] op_sel_hi:[1,1]
  v_pk_mul_f32 v[234:235], v[234:235], v[194:195] op_sel:[0,1] op_sel_hi:[1,1]
  v_pk_mul_f32 v[236:237], v[236:237], v[194:195] op_sel:[0,1] op_sel_hi:[1,1]
  v_pk_mul_f32 v[238:239], v[238:239], v[194:195] op_sel:[0,1] op_sel_hi:[1,1]
  v_cvt_pk_bf16_f32 v180, v232, v233
  v_cvt_pk_bf16_f32 v181, v234, v235
  v_cvt_pk_bf16_f32 v182, v236, v237
  v_cvt_pk_bf16_f32 v183, v238, v239
  buffer_store_dwordx4 v[180:183], v2, s[16:19], s35 offen offset:1024 sc1
  v_accvgpr_read_b32 v224, a76
  v_accvgpr_read_b32 v225, a77
  v_accvgpr_read_b32 v226, a78
  v_accvgpr_read_b32 v227, a79
  v_accvgpr_read_b32 v228, a92
  v_accvgpr_read_b32 v229, a93
  v_accvgpr_read_b32 v230, a94
  v_accvgpr_read_b32 v231, a95
  v_pk_mul_f32 v[224:225], v[224:225], v[194:195] op_sel:[0,1] op_sel_hi:[1,1]
  v_pk_mul_f32 v[226:227], v[226:227], v[194:195] op_sel:[0,1] op_sel_hi:[1,1]
  v_pk_mul_f32 v[228:229], v[228:229], v[194:195] op_sel:[0,1] op_sel_hi:[1,1]
  v_pk_mul_f32 v[230:231], v[230:231], v[194:195] op_sel:[0,1] op_sel_hi:[1,1]
  v_cvt_pk_bf16_f32 v184, v224, v225
  v_cvt_pk_bf16_f32 v185, v226, v227
  v_cvt_pk_bf16_f32 v186, v228, v229
  v_cvt_pk_bf16_f32 v187, v230, v231
  buffer_store_dwordx4 v[184:187], v2, s[16:19], s35 offen offset:2048 sc1
  v_accvgpr_read_b32 v232, a108
  v_accvgpr_read_b32 v233, a109
  v_accvgpr_read_b32 v234, a110
  v_accvgpr_read_b32 v235, a111
  v_accvgpr_read_b32 v236, a124
  v_accvgpr_read_b32 v237, a125
  v_accvgpr_read_b32 v238, a126
  v_accvgpr_read_b32 v239, a127
  v_pk_mul_f32 v[232:233], v[232:233], v[194:195] op_sel:[0,1] op_sel_hi:[1,1]
  v_pk_mul_f32 v[234:235], v[234:235], v[194:195] op_sel:[0,1] op_sel_hi:[1,1]
  v_pk_mul_f32 v[236:237], v[236:237], v[194:195] op_sel:[0,1] op_sel_hi:[1,1]
  v_pk_mul_f32 v[238:239], v[238:239], v[194:195] op_sel:[0,1] op_sel_hi:[1,1]
  v_cvt_pk_bf16_f32 v188, v232, v233
  v_cvt_pk_bf16_f32 v189, v234, v235
  v_cvt_pk_bf16_f32 v190, v236, v237
  v_cvt_pk_bf16_f32 v191, v238, v239
  buffer_store_dwordx4 v[188:191], v2, s[16:19], s35 offen offset:3072 sc1
  s_and_b32 s50, s39, 1
  v_exp_f32 v48, v48
  ds_read_b128 a[176:179], v3 offset:12288
  s_waitcnt lgkmcnt(1)
  v_exp_f32 v49, v49
  ds_read_b128 a[180:183], v3 offset:13312
  v_cvt_pk_bf16_f32 v208, v48, v49
  v_mfma_f32_16x16x32_bf16 v[112:115], a[144:147], v[32:35], v[240:243]
  s_lshl_b32 s50, s50, 14
  v_exp_f32 v50, v50
  ds_read_b128 a[184:187], v3 offset:14336
  v_mfma_f32_16x16x32_bf16 v[112:115], a[148:151], v[64:67], v[112:115]
  s_add_u32 s51, s39, 2
  v_exp_f32 v51, v51
  ds_read_b128 a[188:191], v3 offset:15360
  v_cvt_pk_bf16_f32 v209, v50, v51
  v_mfma_f32_16x16x32_bf16 v[112:115], a[152:155], v[96:99], v[112:115]
  s_sub_u32 s51, s51, s49
  v_exp_f32 v80, v80
  s_cmp_ge_i32 s51, 2
  s_cselect_b32 s46, s48, 0
  v_mfma_f32_16x16x32_bf16 v[112:115], a[156:159], v[128:131], v[112:115]
  s_add_u32 s46, s46, s50
  v_exp_f32 v81, v81
  s_cmp_ge_i32 s51, 3
  v_cvt_pk_bf16_f32 v210, v80, v81
  v_mfma_f32_16x16x32_bf16 v[116:119], a[144:147], v[36:39], v[244:247]
  s_cselect_b32 s47, s48, 0
  v_exp_f32 v82, v82
  s_xor_b32 s51, s50, 0x4000
  s_add_u32 s47, s47, s51
  v_mfma_f32_16x16x32_bf16 v[116:119], a[148:151], v[68:71], v[116:119]
  s_add_u32 s47, s47, 0x8000
  v_exp_f32 v83, v83
  s_nop 0
  v_cvt_pk_bf16_f32 v211, v82, v83
  v_mfma_f32_16x16x32_bf16 v[116:119], a[152:155], v[100:103], v[116:119]
  s_add_u32 s58, s51, s41
  v_exp_f32 v52, v52
  s_add_u32 s59, s50, s41
  s_add_u32 s59, s59, 0x8000
  v_mfma_f32_16x16x32_bf16 v[116:119], a[156:159], v[132:135], v[116:119]
  v_exp_f32 v53, v53
  s_waitcnt vmcnt(7) lgkmcnt(0)
  s_barrier
  v_cvt_pk_bf16_f32 v212, v52, v53
  v_mfma_f32_16x16x32_bf16 v[120:123], a[144:147], v[40:43], v[248:251]
  v_exp_f32 v54, v54
  v_add_u32 v3, s46, v2
  v_add_u32 v19, s47, v2
  v_mfma_f32_16x16x32_bf16 v[120:123], a[148:151], v[72:75], v[120:123]
  v_exp_f32 v55, v55
  ds_read_b128 a[128:131], v19 offset:0
  v_cvt_pk_bf16_f32 v213, v54, v55
  v_mfma_f32_16x16x32_bf16 v[120:123], a[152:155], v[104:107], v[120:123]
  s_mov_b32 m0, s58
  v_exp_f32 v84, v84
  buffer_load_dwordx4 v2, s[16:19], s42 offen offset:0 sc1 lds
  v_mfma_f32_16x16x32_bf16 v[120:123], a[156:159], v[136:139], v[120:123]
  s_add_u32 s50, s39, 3
  v_exp_f32 v85, v85
  ds_read_b128 a[132:135], v19 offset:1024
  v_cvt_pk_bf16_f32 v214, v84, v85
  v_mfma_f32_16x16x32_bf16 v[124:127], a[144:147], v[44:47], v[252:255]
  s_lshl_b32 s51, s50, 1
  v_exp_f32 v86, v86
  buffer_load_dwordx4 v2, s[16:19], s42 offen offset:1024 sc1 lds
  v_mfma_f32_16x16x32_bf16 v[124:127], a[148:151], v[76:79], v[124:127]
  s_sub_u32 s51, s51, s5
  v_exp_f32 v87, v87
  ds_read_b128 a[136:139], v19 offset:2048
  v_cvt_pk_bf16_f32 v215, v86, v87
  v_mfma_f32_16x16x32_bf16 v[124:127], a[152:155], v[108:111], v[124:127]
  s_cmp_eq_u32 s50, s4
  v_exp_f32 v56, v56
  buffer_load_dwordx4 v2, s[16:19], s42 offen offset:2048 sc1 lds
  v_mfma_f32_16x16x32_bf16 v[124:127], a[156:159], v[140:143], v[124:127]
  v_exp_f32 v57, v57
  ds_read_b128 a[140:143], v19 offset:3072
  v_cvt_pk_bf16_f32 v216, v56, v57
  v_mfma_f32_16x16x32_bf16 v[144:147], a[176:179], v[32:35], v[240:243]
  s_cselect_b32 s51, s6, s51
  v_exp_f32 v58, v58
  buffer_load_dwordx4 v2, s[16:19], s42 offen offset:3072 sc1 lds
  v_mfma_f32_16x16x32_bf16 v[144:147], a[180:183], v[64:67], v[144:147]
  s_add_u32 s51, s51, 1
  v_exp_f32 v59, v59
  ds_read_b128 a[144:147], v3 offset:0
  v_cvt_pk_bf16_f32 v217, v58, v59
  v_mfma_f32_16x16x32_bf16 v[144:147], a[184:187], v[96:99], v[144:147]
  s_mov_b32 m0, s59
  v_exp_f32 v88, v88
  buffer_load_dwordx4 v2, s[16:19], s43 offen offset:0 sc1 lds
  v_mfma_f32_16x16x32_bf16 v[144:147], a[188:191], v[128:131], v[144:147]
  s_cmp_lt_u32 s50, s4
  v_exp_f32 v89, v89
  ds_read_b128 a[148:151], v3 offset:1024
  v_cvt_pk_bf16_f32 v218, v88, v89
  v_mfma_f32_16x16x32_bf16 v[148:151], a[176:179], v[36:39], v[244:247]
  s_cselect_b32 s51, 0x8000, s51
  v_exp_f32 v90, v90
  buffer_load_dwordx4 v2, s[16:19], s43 offen offset:1024 sc1 lds
  v_mfma_f32_16x16x32_bf16 v[148:151], a[180:183], v[68:71], v[148:151]
  s_cmp_gt_u32 s50, 16
  v_exp_f32 v91, v91
  ds_read_b128 a[152:155], v3 offset:2048
  v_cvt_pk_bf16_f32 v219, v90, v91
  v_mfma_f32_16x16x32_bf16 v[148:151], a[184:187], v[100:103], v[148:151]
  s_cselect_b32 s51, 0x8000, s51
  v_exp_f32 v60, v60
  buffer_load_dwordx4 v2, s[16:19], s43 offen offset:2048 sc1 lds
  v_mfma_f32_16x16x32_bf16 v[148:151], a[188:191], v[132:135], v[148:151]
  v_exp_f32 v61, v61
  ds_read_b128 a[156:159], v3 offset:3072
  v_cvt_pk_bf16_f32 v220, v60, v61
  v_mfma_f32_16x16x32_bf16 v[152:155], a[176:179], v[40:43], v[248:251]
  s_lshl_b32 s51, s51, 15
  v_exp_f32 v62, v62
  buffer_load_dwordx4 v2, s[16:19], s43 offen offset:3072 sc1 lds
  v_mfma_f32_16x16x32_bf16 v[152:155], a[180:183], v[72:75], v[152:155]
  s_add_u32 s44, s51, s40
  v_exp_f32 v63, v63
  ds_read_b128 a[160:163], v19 offset:4096
  v_cvt_pk_bf16_f32 v221, v62, v63
  v_mfma_f32_16x16x32_bf16 v[152:155], a[184:187], v[104:107], v[152:155]
  s_add_u32 s50, s39, 2
  v_exp_f32 v92, v92
  s_lshl_b32 s51, s50, 1
  s_sub_u32 s51, s51, s5
  v_mfma_f32_16x16x32_bf16 v[152:155], a[188:191], v[136:139], v[152:155]
  s_cmp_eq_u32 s50, s4
  v_exp_f32 v93, v93
  ds_read_b128 a[164:167], v19 offset:5120
  v_cvt_pk_bf16_f32 v222, v92, v93
  v_mfma_f32_16x16x32_bf16 v[156:159], a[176:179], v[44:47], v[252:255]
  s_cselect_b32 s51, s6, s51
  v_exp_f32 v94, v94
  s_add_u32 s51, s51, 1
  s_cmp_lt_u32 s50, s4
  v_mfma_f32_16x16x32_bf16 v[156:159], a[180:183], v[76:79], v[156:159]
  s_cselect_b32 s51, 0x8000, s51
  v_exp_f32 v95, v95
  ds_read_b128 a[168:171], v19 offset:6144
  v_cvt_pk_bf16_f32 v223, v94, v95
  v_mfma_f32_16x16x32_bf16 v[156:159], a[184:187], v[108:111], v[156:159]
  s_cmp_gt_u32 s50, 16
  s_cselect_b32 s51, 0x8000, s51
  s_lshl_b32 s51, s51, 15
  s_add_u32 s45, s51, s40
  v_mfma_f32_16x16x32_bf16 v[156:159], a[188:191], v[140:143], v[156:159]
  s_add_u32 s45, s45, 16384
  s_add_u32 s39, s39, 1
  ds_read_b128 a[172:175], v19 offset:7168
  s_setpc_b64 s[52:53]
.p2align 6
L_w_b_full_full_1:
  s_setpc_b64 s[52:53]
L_w2_b_full_full_1:
  s_setpc_b64 s[56:57]
L_b_full_full_1:
  v_mfma_f32_16x16x32_bf16 a[192:195], a[208:211], v[208:211], 0
  v_exp_f32 v112, v112
  v_mfma_f32_16x16x32_bf16 a[196:199], a[208:211], v[212:215], 0
  v_mfma_f32_16x16x32_bf16 a[200:203], a[208:211], v[216:219], 0
  s_waitcnt lgkmcnt(8)
  v_exp_f32 v113, v113
  v_mfma_f32_16x16x32_bf16 a[204:207], a[208:211], v[220:223], 0
  ds_read_b128 a[176:179], v3 offset:4096
  v_cvt_pk_bf16_f32 v224, v112, v113
  v_mfma_f32_16x16x32_bf16 a[0:3], a[128:131], v[208:211], 0
  s_add_u32 m0, s58, 0x10000
  v_exp_f32 v114, v114
  v_mfma_f32_16x16x32_bf16 a[4:7], a[128:131], v[212:215], 0
  buffer_load_dwordx4 v2, s[16:19], s44 offen offset:0 sc1 lds
  v_mfma_f32_16x16x32_bf16 a[8:11], a[128:131], v[216:219], 0
  v_exp_f32 v115, v115
  v_mfma_f32_16x16x32_bf16 a[12:15], a[128:131], v[220:223], 0
  ds_read_b128 a[180:183], v3 offset:5120
  v_cvt_pk_bf16_f32 v225, v114, v115
  v_mfma_f32_16x16x32_bf16 a[16:19], a[132:135], v[208:211], 0
  v_exp_f32 v144, v144
  v_mfma_f32_16x16x32_bf16 a[20:23], a[132:135], v[212:215], 0
  buffer_load_dwordx4 v2, s[16:19], s44 offen offset:1024 sc1 lds
  v_mfma_f32_16x16x32_bf16 a[24:27], a[132:135], v[216:219], 0
  v_exp_f32 v145, v145
  v_mfma_f32_16x16x32_bf16 a[28:31], a[132:135], v[220:223], 0
  ds_read_b128 a[184:187], v3 offset:6144
  v_cvt_pk_bf16_f32 v226, v144, v145
  v_mfma_f32_16x16x32_bf16 a[32:35], a[136:139], v[208:211], 0
  v_exp_f32 v146, v146
  v_mfma_f32_16x16x32_bf16 a[36:39], a[136:139], v[212:215], 0
  buffer_load_dwordx4 v2, s[16:19], s44 offen offset:2048 sc1 lds
  v_mfma_f32_16x16x32_bf16 a[40:43], a[136:139], v[216:219], 0
  v_exp_f32 v147, v147
  v_mfma_f32_16x16x32_bf16 a[44:47], a[136:139], v[220:223], 0
  ds_read_b128 a[188:191], v3 offset:7168
  v_cvt_pk_bf16_f32 v227, v146, v147
  v_mfma_f32_16x16x32_bf16 a[48:51], a[140:143], v[208:211], 0
  v_exp_f32 v116, v116
  v_mfma_f32_16x16x32_bf16 a[52:55], a[140:143], v[212:215], 0
  buffer_load_dwordx4 v2, s[16:19], s44 offen offset:3072 sc1 lds
  v_mfma_f32_16x16x32_bf16 a[56:59], a[140:143], v[216:219], 0
  s_waitcnt lgkmcnt(8)
  v_exp_f32 v117, v117
  v_mfma_f32_16x16x32_bf16 a[60:63], a[140:143], v[220:223], 0
  v_cvt_pk_bf16_f32 v228, v116, v117
  v_mfma_f32_16x16x32_bf16 v[48:51], a[144:147], v[32:35], v[240:243]
  s_add_u32 m0, s59, 0x10000
  v_exp_f32 v118, v118
  v_mfma_f32_16x16x32_bf16 v[48:51], a[148:151], v[64:67], v[48:51]
  buffer_load_dwordx4 v2, s[16:19], s45 offen offset:0 sc1 lds
  v_mfma_f32_16x16x32_bf16 v[48:51], a[152:155], v[96:99], v[48:51]
  s_add_u32 s50, s39, 3
  v_exp_f32 v119, v119
  v_mfma_f32_16x16x32_bf16 v[48:51], a[156:159], v[128:131], v[48:51]
  ds_read_b128 a[128:131], v19 offset:8192
  v_cvt_pk_bf16_f32 v229, v118, v119
  v_mfma_f32_16x16x32_bf16 v[52:55], a[144:147], v[36:39], v[244:247]
  s_lshl_b32 s51, s50, 1
  v_exp_f32 v148, v148
  v_mfma_f32_16x16x32_bf16 v[52:55], a[148:151], v[68:71], v[52:55]
  buffer_load_dwordx4 v2, s[16:19], s45 offen offset:1024 sc1 lds
  v_mfma_f32_16x16x32_bf16 v[52:55], a[152:155], v[100:103], v[52:55]
  s_sub_u32 s51, s51, s5
  v_exp_f32 v149, v149
  v_mfma_f32_16x16x32_bf16 v[52:55], a[156:159], v[132:135], v[52:55]
  ds_read_b128 a[132:135], v19 offset:9216
  v_cvt_pk_bf16_f32 v230, v148, v149
  v_mfma_f32_16x16x32_bf16 v[56:59], a[144:147], v[40:43], v[248:251]
  s_cmp_eq_u32 s50, s4
  v_exp_f32 v150, v150
  v_mfma_f32_16x16x32_bf16 v[56:59], a[148:151], v[72:75], v[56:59]
  buffer_load_dwordx4 v2, s[16:19], s45 offen offset:2048 sc1 lds
  v_mfma_f32_16x16x32_bf16 v[56:59], a[152:155], v[104:107], v[56:59]
  s_cselect_b32 s51, s6, s51
  v_exp_f32 v151, v151
  v_mfma_f32_16x16x32_bf16 v[56:59], a[156:159], v[136:139], v[56:59]
  ds_read_b128 a[136:139], v19 offset:10240
  v_cvt_pk_bf16_f32 v231, v150, v151
  v_mfma_f32_16x16x32_bf16 v[60:63], a[144:147], v[44:47], v[252:255]
  s_cmp_lt_u32 s50, s4
  v_exp_f32 v120, v120
  v_mfma_f32_16x16x32_bf16 v[60:63], a[148:151], v[76:79], v[60:63]
  buffer_load_dwordx4 v2, s[16:19], s45 offen offset:3072 sc1 lds
  v_mfma_f32_16x16x32_bf16 v[60:63], a[152:155], v[108:111], v[60:63]
  s_waitcnt lgkmcnt(7)
  v_exp_f32 v121, v121
  v_mfma_f32_16x16x32_bf16 v[60:63], a[156:159], v[140:143], v[60:63]
  ds_read_b128 a[140:143], v19 offset:11264
  v_cvt_pk_bf16_f32 v232, v120, v121
  v_mfma_f32_16x16x32_bf16 a[64:67], a[160:163], v[208:211], 0
  s_cselect_b32 s51, s50, s51
  v_exp_f32 v122, v122
  v_mfma_f32_16x16x32_bf16 a[68:71], a[160:163], v[212:215], 0
  v_mfma_f32_16x16x32_bf16 a[72:75], a[160:163], v[216:219], 0
  s_cmp_gt_u32 s50, 16
  v_exp_f32 v123, v123
  v_mfma_f32_16x16x32_bf16 a[76:79], a[160:163], v[220:223], 0
  ds_read_b128 a[144:147], v3 offset:8192
  v_cvt_pk_bf16_f32 v233, v122, v123
  v_mfma_f32_16x16x32_bf16 a[80:83], a[164:167], v[208:211], 0
  s_cselect_b32 s51, 0x8000, s51
  v_exp_f32 v152, v152
  v_mfma_f32_16x16x32_bf16 a[84:87], a[164:167], v[212:215], 0
  v_mfma_f32_16x16x32_bf16 a[88:91], a[164:167], v[216:219], 0
  s_lshl_b32 s51, s51, 15
  v_exp_f32 v153, v153
  v_mfma_f32_16x16x32_bf16 a[92:95], a[164:167], v[220:223], 0
  ds_read_b128 a[148:151], v3 offset:9216
  v_cvt_pk_bf16_f32 v234, v152, v153
  v_mfma_f32_16x16x32_bf16 a[96:99], a[168:171], v[208:211], 0
  s_add_u32 s42, s51, s40
  v_exp_f32 v154, v154
  v_mfma_f32_16x16x32_bf16 a[100:103], a[168:171], v[212:215], 0
  v_mfma_f32_16x16x32_bf16 a[104:107], a[168:171], v[216:219], 0
  s_add_u32 s50, s39, 2
  v_exp_f32 v155, v155
  v_mfma_f32_16x16x32_bf16 a[108:111], a[168:171], v[220:223], 0
  ds_read_b128 a[152:155], v3 offset:10240
  v_cvt_pk_bf16_f32 v235, v154, v155
  v_mfma_f32_16x16x32_bf16 a[112:115], a[172:175], v[208:211], 0
  s_lshl_b32 s51, s50, 1
  v_exp_f32 v124, v124
  v_mfma_f32_16x16x32_bf16 a[116:119], a[172:175], v[212:215], 0
  v_mfma_f32_16x16x32_bf16 a[120:123], a[172:175], v[216:219], 0
  s_waitcnt lgkmcnt(7)
  v_exp_f32 v125, v125
  v_mfma_f32_16x16x32_bf16 a[124:127], a[172:175], v[220:223], 0
  ds_read_b128 a[156:159], v3 offset:11264
  v_cvt_pk_bf16_f32 v236, v124, v125
  v_mfma_f32_16x16x32_bf16 v[80:83], a[176:179], v[32:35], v[240:243]
  s_sub_u32 s51, s51, s5
  v_exp_f32 v126, v126
  v_mfma_f32_16x16x32_bf16 v[80:83], a[180:183], v[64:67], v[80:83]
  v_mfma_f32_16x16x32_bf16 v[80:83], a[184:187], v[96:99], v[80:83]
  s_cmp_eq_u32 s50, s4
  v_exp_f32 v127, v127
  v_mfma_f32_16x16x32_bf16 v[80:83], a[188:191], v[128:131], v[80:83]
  ds_read_b128 a[160:163], v19 offset:12288
  v_cvt_pk_bf16_f32 v237, v126, v127
  v_mfma_f32_16x16x32_bf16 v[84:87], a[176:179], v[36:39], v[244:247]
  s_cselect_b32 s51, s6, s51
  v_exp_f32 v156, v156
  v_mfma_f32_16x16x32_bf16 v[84:87], a[180:183], v[68:71], v[84:87]
  v_mfma_f32_16x16x32_bf16 v[84:87], a[184:187], v[100:103], v[84:87]
  s_cmp_lt_u32 s50, s4
  v_exp_f32 v157, v157
  v_mfma_f32_16x16x32_bf16 v[84:87], a[188:191], v[132:135], v[84:87]
  ds_read_b128 a[164:167], v19 offset:13312
  v_cvt_pk_bf16_f32 v238, v156, v157
  v_mfma_f32_16x16x32_bf16 v[88:91], a[176:179], v[40:43], v[248:251]
  s_cselect_b32 s51, s50, s51
  v_exp_f32 v158, v158
  v_mfma_f32_16x16x32_bf16 v[88:91], a[180:183], v[72:75], v[88:91]
  v_mfma_f32_16x16x32_bf16 v[88:91], a[184:187], v[104:107], v[88:91]
  s_cmp_gt_u32 s50, 16
  v_exp_f32 v159, v159
  v_mfma_f32_16x16x32_bf16 v[88:91], a[188:191], v[136:139], v[88:91]
  ds_read_b128 a[168:171], v19 offset:14336
  v_cvt_pk_bf16_f32 v239, v158, v159
  v_mfma_f32_16x16x32_bf16 v[92:95], a[176:179], v[44:47], v[252:255]
  s_cselect_b32 s51, 0x8000, s51
  v_mfma_f32_16x16x32_bf16 v[92:95], a[180:183], v[76:79], v[92:95]
  s_lshl_b32 s51, s51, 15
  s_add_u32 s43, s51, s40
  v_mfma_f32_16x16x32_bf16 v[92:95], a[184:187], v[108:111], v[92:95]
  s_add_u32 s43, s43, 16384
  v_mfma_f32_16x16x32_bf16 v[92:95], a[188:191], v[140:143], v[92:95]
  ds_read_b128 a[172:175], v19 offset:15360
  v_mfma_f32_16x16x32_bf16 a[192:195], a[208:211], v[224:227], a[192:195]
  s_and_b32 s50, s39, 1
  v_exp_f32 v48, v48
  v_mfma_f32_16x16x32_bf16 a[196:199], a[208:211], v[228:231], a[196:199]
  ds_read_b128 a[176:179], v3 offset:12288
  v_mfma_f32_16x16x32_bf16 a[200:203], a[208:211], v[232:235], a[200:203]
  s_waitcnt lgkmcnt(9)
  v_exp_f32 v49, v49
  v_mfma_f32_16x16x32_bf16 a[204:207], a[208:211], v[236:239], a[204:207]
  ds_read_b128 a[180:183], v3 offset:13312
  v_cvt_pk_bf16_f32 v208, v48, v49
  v_mfma_f32_16x16x32_bf16 a[0:3], a[128:131], v[224:227], a[0:3]
  s_lshl_b32 s50, s50, 14
  v_exp_f32 v50, v50
  v_mfma_f32_16x16x32_bf16 a[4:7], a[128:131], v[228:231], a[4:7]
  ds_read_b128 a[184:187], v3 offset:14336
  v_mfma_f32_16x16x32_bf16 a[8:11], a[128:131], v[232:235], a[8:11]
  s_add_u32 s51, s39, 2
  v_exp_f32 v51, v51
  v_mfma_f32_16x16x32_bf16 a[12:15], a[128:131], v[236:239], a[12:15]
  ds_read_b128 a[188:191], v3 offset:15360
  v_cvt_pk_bf16_f32 v209, v50, v51
  v_mfma_f32_16x16x32_bf16 a[16:19], a[132:135], v[224:227], a[16:19]
  s_sub_u32 s51, s51, s49
  v_exp_f32 v80, v80
  v_mfma_f32_16x16x32_bf16 a[20:23], a[132:135], v[228:231], a[20:23]
  s_cmp_ge_i32 s51, 2
  s_cselect_b32 s46, s48, 0
  v_mfma_f32_16x16x32_bf16 a[24:27], a[132:135], v[232:235], a[24:27]
  s_add_u32 s46, s46, s50
  v_exp_f32 v81, v81
  v_mfma_f32_16x16x32_bf16 a[28:31], a[132:135], v[236:239], a[28:31]
  s_cmp_ge_i32 s51, 3
  v_cvt_pk_bf16_f32 v210, v80, v81
  v_mfma_f32_16x16x32_bf16 a[32:35], a[136:139], v[224:227], a[32:35]
  s_cselect_b32 s47, s48, 0
  v_exp_f32 v82, v82
  v_mfma_f32_16x16x32_bf16 a[36:39], a[136:139], v[228:231], a[36:39]
  s_xor_b32 s51, s50, 0x4000
  s_add_u32 s47, s47, s51
  v_mfma_f32_16x16x32_bf16 a[40:43], a[136:139], v[232:235], a[40:43]
  s_add_u32 s47, s47, 0x8000
  v_exp_f32 v83, v83
  v_mfma_f32_16x16x32_bf16 a[44:47], a[136:139], v[236:239], a[44:47]
  v_cvt_pk_bf16_f32 v211, v82, v83
  v_mfma_f32_16x16x32_bf16 a[48:51], a[140:143], v[224:227], a[48:51]
  s_add_u32 s58, s51, s41
  v_exp_f32 v52, v52
  v_mfma_f32_16x16x32_bf16 a[52:55], a[140:143], v[228:231], a[52:55]
  s_add_u32 s59, s50, s41
  s_add_u32 s59, s59, 0x8000
  v_mfma_f32_16x16x32_bf16 a[56:59], a[140:143], v[232:235], a[56:59]
  s_waitcnt lgkmcnt(8)
  v_exp_f32 v53, v53
  v_mfma_f32_16x16x32_bf16 a[60:63], a[140:143], v[236:239], a[60:63]
  s_waitcnt vmcnt(0) lgkmcnt(0)
  s_barrier
  v_cvt_pk_bf16_f32 v212, v52, v53
  v_mfma_f32_16x16x32_bf16 v[112:115], a[144:147], v[32:35], v[240:243]
  v_exp_f32 v54, v54
  v_mfma_f32_16x16x32_bf16 v[112:115], a[148:151], v[64:67], v[112:115]
  v_add_u32 v3, s46, v2
  v_add_u32 v19, s47, v2
  v_mfma_f32_16x16x32_bf16 v[112:115], a[152:155], v[96:99], v[112:115]
  v_exp_f32 v55, v55
  v_mfma_f32_16x16x32_bf16 v[112:115], a[156:159], v[128:131], v[112:115]
  ds_read_b128 a[128:131], v19 offset:0
  v_cvt_pk_bf16_f32 v213, v54, v55
  v_mfma_f32_16x16x32_bf16 v[116:119], a[144:147], v[36:39], v[244:247]
  s_mov_b32 m0, s58
  v_exp_f32 v84, v84
  v_mfma_f32_16x16x32_bf16 v[116:119], a[148:151], v[68:71], v[116:119]
  buffer_load_dwordx4 v2, s[16:19], s42 offen offset:0 sc1 lds
  v_mfma_f32_16x16x32_bf16 v[116:119], a[152:155], v[100:103], v[116:119]
  s_add_u32 s50, s39, 3
  v_exp_f32 v85, v85
  v_mfma_f32_16x16x32_bf16 v[116:119], a[156:159], v[132:135], v[116:119]
  ds_read_b128 a[132:135], v19 offset:1024
  v_cvt_pk_bf16_f32 v214, v84, v85
  v_mfma_f32_16x16x32_bf16 v[120:123], a[144:147], v[40:43], v[248:251]
  s_lshl_b32 s51, s50, 1
  v_exp_f32 v86, v86
  v_mfma_f32_16x16x32_bf16 v[120:123], a[148:151], v[72:75], v[120:123]
  buffer_load_dwordx4 v2, s[16:19], s42 offen offset:1024 sc1 lds
  v_mfma_f32_16x16x32_bf16 v[120:123], a[152:155], v[104:107], v[120:123]
  s_sub_u32 s51, s51, s5
  v_exp_f32 v87, v87
  v_mfma_f32_16x16x32_bf16 v[120:123], a[156:159], v[136:139], v[120:123]
  ds_read_b128 a[136:139], v19 offset:2048
  v_cvt_pk_bf16_f32 v215, v86, v87
  v_mfma_f32_16x16x32_bf16 v[124:127], a[144:147], v[44:47], v[252:255]
  s_cmp_eq_u32 s50, s4
  v_exp_f32 v56, v56
  v_mfma_f32_16x16x32_bf16 v[124:127], a[148:151], v[76:79], v[124:127]
  buffer_load_dwordx4 v2, s[16:19], s42 offen offset:2048 sc1 lds
  v_mfma_f32_16x16x32_bf16 v[124:127], a[152:155], v[108:111], v[124:127]
  v_exp_f32 v57, v57
  v_mfma_f32_16x16x32_bf16 v[124:127], a[156:159], v[140:143], v[124:127]
  ds_read_b128 a[140:143], v19 offset:3072
  v_cvt_pk_bf16_f32 v216, v56, v57
  v_mfma_f32_16x16x32_bf16 a[64:67], a[160:163], v[224:227], a[64:67]
  s_cselect_b32 s51, s6, s51
  v_exp_f32 v58, v58
  v_mfma_f32_16x16x32_bf16 a[68:71], a[160:163], v[228:231], a[68:71]
  buffer_load_dwordx4 v2, s[16:19], s42 offen offset:3072 sc1 lds
  v_mfma_f32_16x16x32_bf16 a[72:75], a[160:163], v[232:235], a[72:75]
  s_add_u32 s51, s51, 1
  v_exp_f32 v59, v59
  v_mfma_f32_16x16x32_bf16 a[76:79], a[160:163], v[236:239], a[76:79]
  ds_read_b128 a[144:147], v3 offset:0
  v_cvt_pk_bf16_f32 v217, v58, v59
  v_mfma_f32_16x16x32_bf16 a[80:83], a[164:167], v[224:227], a[80:83]
  s_mov_b32 m0, s59
  v_exp_f32 v88, v88
  v_mfma_f32_16x16x32_bf16 a[84:87], a[164:167], v[228:231], a[84:87]
  buffer_load_dwordx4 v2, s[16:19], s43 offen offset:0 sc1 lds
  v_mfma_f32_16x16x32_bf16 a[88:91], a[164:167], v[232:235], a[88:91]
  s_cmp_lt_u32 s50, s4
  v_exp_f32 v89, v89
  v_mfma_f32_16x16x32_bf16 a[92:95], a[164:167], v[236:239], a[92:95]
  ds_read_b128 a[148:151], v3 offset:1024
  v_cvt_pk_bf16_f32 v218, v88, v89
  v_mfma_f32_16x16x32_bf16 a[96:99], a[168:171], v[224:227], a[96:99]
  s_cselect_b32 s51, 0x8000, s51
  v_exp_f32 v90, v90
  v_mfma_f32_16x16x32_bf16 a[100:103], a[168:171], v[228:231], a[100:103]
  buffer_load_dwordx4 v2, s[16:19], s43 offen offset:1024 sc1 lds
  v_mfma_f32_16x16x32_bf16 a[104:107], a[168:171], v[232:235], a[104:107]
  s_cmp_gt_u32 s50, 16
  v_exp_f32 v91, v91
  v_mfma_f32_16x16x32_bf16 a[108:111], a[168:171], v[236:239], a[108:111]
  ds_read_b128 a[152:155], v3 offset:2048
  v_cvt_pk_bf16_f32 v219, v90, v91
  v_mfma_f32_16x16x32_bf16 a[112:115], a[172:175], v[224:227], a[112:115]
  s_cselect_b32 s51, 0x8000, s51
  v_exp_f32 v60, v60
  v_mfma_f32_16x16x32_bf16 a[116:119], a[172:175], v[228:231], a[116:119]
  buffer_load_dwordx4 v2, s[16:19], s43 offen offset:2048 sc1 lds
  v_mfma_f32_16x16x32_bf16 a[120:123], a[172:175], v[232:235], a[120:123]
  v_exp_f32 v61, v61
  v_mfma_f32_16x16x32_bf16 a[124:127], a[172:175], v[236:239], a[124:127]
  ds_read_b128 a[156:159], v3 offset:3072
  v_cvt_pk_bf16_f32 v220, v60, v61
  v_mfma_f32_16x16x32_bf16 v[144:147], a[176:179], v[32:35], v[240:243]
  s_lshl_b32 s51, s51, 15
  v_exp_f32 v62, v62
  v_mfma_f32_16x16x32_bf16 v[144:147], a[180:183], v[64:67], v[144:147]
  buffer_load_dwordx4 v2, s[16:19], s43 offen offset:3072 sc1 lds
  v_mfma_f32_16x16x32_bf16 v[144:147], a[184:187], v[96:99], v[144:147]
  s_add_u32 s44, s51, s40
  v_exp_f32 v63, v63
  v_mfma_f32_16x16x32_bf16 v[144:147], a[188:191], v[128:131], v[144:147]
  ds_read_b128 a[160:163], v19 offset:4096
  v_cvt_pk_bf16_f32 v221, v62, v63
  v_mfma_f32_16x16x32_bf16 v[148:151], a[176:179], v[36:39], v[244:247]
  s_add_u32 s50, s39, 2
  v_exp_f32 v92, v92
  v_mfma_f32_16x16x32_bf16 v[148:151], a[180:183], v[68:71], v[148:151]
  s_lshl_b32 s51, s50, 1
  s_sub_u32 s51, s51, s5
  v_mfma_f32_16x16x32_bf16 v[148:151], a[184:187], v[100:103], v[148:151]
  s_cmp_eq_u32 s50, s4
  v_exp_f32 v93, v93
  v_mfma_f32_16x16x32_bf16 v[148:151], a[188:191], v[132:135], v[148:151]
  ds_read_b128 a[164:167], v19 offset:5120
  v_cvt_pk_bf16_f32 v222, v92, v93
  v_mfma_f32_16x16x32_bf16 v[152:155], a[176:179], v[40:43], v[248:251]
  s_cselect_b32 s51, s6, s51
  v_exp_f32 v94, v94
  v_mfma_f32_16x16x32_bf16 v[152:155], a[180:183], v[72:75], v[152:155]
  s_add_u32 s51, s51, 1
  s_cmp_lt_u32 s50, s4
  v_mfma_f32_16x16x32_bf16 v[152:155], a[184:187], v[104:107], v[152:155]
  s_cselect_b32 s51, 0x8000, s51
  v_exp_f32 v95, v95
  v_mfma_f32_16x16x32_bf16 v[152:155], a[188:191], v[136:139], v[152:155]
  ds_read_b128 a[168:171], v19 offset:6144
  v_cvt_pk_bf16_f32 v223, v94, v95
  v_mfma_f32_16x16x32_bf16 v[156:159], a[176:179], v[44:47], v[252:255]
  s_cmp_gt_u32 s50, 16
  s_cselect_b32 s51, 0x8000, s51
  v_mfma_f32_16x16x32_bf16 v[156:159], a[180:183], v[76:79], v[156:159]
  s_lshl_b32 s51, s51, 15
  s_add_u32 s45, s51, s40
  v_mfma_f32_16x16x32_bf16 v[156:159], a[184:187], v[108:111], v[156:159]
  s_add_u32 s45, s45, 16384
  s_add_u32 s39, s39, 1
  v_mfma_f32_16x16x32_bf16 v[156:159], a[188:191], v[140:143], v[156:159]
  ds_read_b128 a[172:175], v19 offset:7168
  s_setpc_b64 s[52:53]
.p2align 6
L_w_b_None_None_0lastst:
  s_setpc_b64 s[52:53]
L_w2_b_None_None_0lastst:
  s_setpc_b64 s[56:57]
L_b_None_None_0lastst:
  s_waitcnt lgkmcnt(8)
  s_waitcnt lgkmcnt(0)
  v_accvgpr_read_b32 v194, a200
  v_accvgpr_read_b32 v195, a204
  v_mov_b32 v196, 1585446912
  v_cmp_nle_f32 vcc, v194, v196
  s_or_b32 s34, vcc_lo, vcc_hi
  s_or_b32 s55, s55, s34
  v_cmp_nle_f32 vcc, v195, v196
  s_or_b32 s34, vcc_lo, vcc_hi
  s_or_b32 s55, s55, s34
  v_rcp_f32 v194, v194
  v_rcp_f32 v195, v195
  s_add_u32 s33, s32, 262144
  s_add_u32 s35, s32, 393216
  v_accvgpr_read_b32 v224, a8
  v_accvgpr_read_b32 v225, a9
  v_accvgpr_read_b32 v226, a10
  v_accvgpr_read_b32 v227, a11
  v_accvgpr_read_b32 v228, a24
  v_accvgpr_read_b32 v229, a25
  v_accvgpr_read_b32 v230, a26
  v_accvgpr_read_b32 v231, a27
  v_pk_mul_f32 v[224:225], v[224:225], v[194:195] op_sel:[0,0] op_sel_hi:[1,0]
  v_pk_mul_f32 v[226:227], v[226:227], v[194:195] op_sel:[0,0] op_sel_hi:[1,0]
  v_pk_mul_f32 v[228:229], v[228:229], v[194:195] op_sel:[0,0] op_sel_hi:[1,0]
  v_pk_mul_f32 v[230:231], v[230:231], v[194:195] op_sel:[0,0] op_sel_hi:[1,0]
  v_cvt_pk_bf16_f32 v160, v224, v225
  v_cvt_pk_bf16_f32 v161, v226, v227
  v_cvt_pk_bf16_f32 v162, v228, v229
  v_cvt_pk_bf16_f32 v163, v230, v231
  buffer_store_dwordx4 v[160:163], v2, s[16:19], s33 offen offset:0 sc1
  v_accvgpr_read_b32 v232, a40
  v_accvgpr_read_b32 v233, a41
  v_accvgpr_read_b32 v234, a42
  v_accvgpr_read_b32 v235, a43
  v_accvgpr_read_b32 v236, a56
  v_accvgpr_read_b32 v237, a57
  v_accvgpr_read_b32 v238, a58
  v_accvgpr_read_b32 v239, a59
  v_pk_mul_f32 v[232:233], v[232:233], v[194:195] op_sel:[0,0] op_sel_hi:[1,0]
  v_pk_mul_f32 v[234:235], v[234:235], v[194:195] op_sel:[0,0] op_sel_hi:[1,0]
  v_pk_mul_f32 v[236:237], v[236:237], v[194:195] op_sel:[0,0] op_sel_hi:[1,0]
  v_pk_mul_f32 v[238:239], v[238:239], v[194:195] op_sel:[0,0] op_sel_hi:[1,0]
  v_cvt_pk_bf16_f32 v164, v232, v233
  v_cvt_pk_bf16_f32 v165, v234, v235
  v_cvt_pk_bf16_f32 v166, v236, v237
  v_cvt_pk_bf16_f32 v167, v238, v239
  buffer_store_dwordx4 v[164:167], v2, s[16:19], s33 offen offset:1024 sc1
  v_accvgpr_read_b32 v224, a72
  v_accvgpr_read_b32 v225, a73
  v_accvgpr_read_b32 v226, a74
  v_accvgpr_read_b32 v227, a75
  v_accvgpr_read_b32 v228, a88
  v_accvgpr_read_b32 v229, a89
  v_accvgpr_read_b32 v230, a90
  v_accvgpr_read_b32 v231, a91
  v_pk_mul_f32 v[224:225], v[224:225], v[194:195] op_sel:[0,0] op_sel_hi:[1,0]
  v_pk_mul_f32 v[226:227], v[226:227], v[194:195] op_sel:[0,0] op_sel_hi:[1,0]
  v_pk_mul_f32 v[228:229], v[228:229], v[194:195] op_sel:[0,0] op_sel_hi:[1,0]
  v_pk_mul_f32 v[230:231], v[230:231], v[194:195] op_sel:[0,0] op_sel_hi:[1,0]
  v_cvt_pk_bf16_f32 v168, v224, v225
  v_cvt_pk_bf16_f32 v169, v226, v227
  v_cvt_pk_bf16_f32 v170, v228, v229
  v_cvt_pk_bf16_f32 v171, v230, v231
  buffer_store_dwordx4 v[168:171], v2, s[16:19], s33 offen offset:2048 sc1
  v_accvgpr_read_b32 v232, a104
  v_accvgpr_read_b32 v233, a105
  v_accvgpr_read_b32 v234, a106
  v_accvgpr_read_b32 v235, a107
  v_accvgpr_read_b32 v236, a120
  v_accvgpr_read_b32 v237, a121
  v_accvgpr_read_b32 v238, a122
  v_accvgpr_read_b32 v239, a123
  v_pk_mul_f32 v[232:233], v[232:233], v[194:195] op_sel:[0,0] op_sel_hi:[1,0]
  v_pk_mul_f32 v[234:235], v[234:235], v[194:195] op_sel:[0,0] op_sel_hi:[1,0]
  v_pk_mul_f32 v[236:237], v[236:237], v[194:195] op_sel:[0,0] op_sel_hi:[1,0]
  v_pk_mul_f32 v[238:239], v[238:239], v[194:195] op_sel:[0,0] op_sel_hi:[1,0]
  v_cvt_pk_bf16_f32 v172, v232, v233
  v_cvt_pk_bf16_f32 v173, v234, v235
  v_cvt_pk_bf16_f32 v174, v236, v237
  v_cvt_pk_bf16_f32 v175, v238, v239
  buffer_store_dwordx4 v[172:175], v2, s[16:19], s33 offen offset:3072 sc1
  v_accvgpr_read_b32 v224, a12
  v_accvgpr_read_b32 v225, a13
  v_accvgpr_read_b32 v226, a14
  v_accvgpr_read_b32 v227, a15
  v_accvgpr_read_b32 v228, a28
  v_accvgpr_read_b32 v229, a29
  v_accvgpr_read_b32 v230, a30
  v_accvgpr_read_b32 v231, a31
  v_pk_mul_f32 v[224:225], v[224:225], v[194:195] op_sel:[0,1] op_sel_hi:[1,1]
  v_pk_mul_f32 v[226:227], v[226:227], v[194:195] op_sel:[0,1] op_sel_hi:[1,1]
  v_pk_mul_f32 v[228:229], v[228:229], v[194:195] op_sel:[0,1] op_sel_hi:[1,1]
  v_pk_mul_f32 v[230:231], v[230:231], v[194:195] op_sel:[0,1] op_sel_hi:[1,1]
  v_cvt_pk_bf16_f32 v176, v224, v225
  v_cvt_pk_bf16_f32 v177, v226, v227
  v_cvt_pk_bf16_f32 v178, v228, v229
  v_cvt_pk_bf16_f32 v179, v230, v231
  buffer_store_dwordx4 v[176:179], v2, s[16:19], s35 offen offset:0 sc1
  v_accvgpr_read_b32 v232, a44
  v_accvgpr_read_b32 v233, a45
  v_accvgpr_read_b32 v234, a46
  v_accvgpr_read_b32 v235, a47
  v_accvgpr_read_b32 v236, a60
  v_accvgpr_read_b32 v237, a61
  v_accvgpr_read_b32 v238, a62
  v_accvgpr_read_b32 v239, a63
  v_pk_mul_f32 v[232:233], v[232:233], v[194:195] op_sel:[0,1] op_sel_hi:[1,1]
  v_pk_mul_f32 v[234:235], v[234:235], v[194:195] op_sel:[0,1] op_sel_hi:[1,1]
  v_pk_mul_f32 v[236:237], v[236:237], v[194:195] op_sel:[0,1] op_sel_hi:[1,1]
  v_pk_mul_f32 v[238:239], v[238:239], v[194:195] op_sel:[0,1] op_sel_hi:[1,1]
  v_cvt_pk_bf16_f32 v180, v232, v233
  v_cvt_pk_bf16_f32 v181, v234, v235
  v_cvt_pk_bf16_f32 v182, v236, v237
  v_cvt_pk_bf16_f32 v183, v238, v239
  buffer_store_dwordx4 v[180:183], v2, s[16:19], s35 offen offset:1024 sc1
  v_accvgpr_read_b32 v224, a76
  v_accvgpr_read_b32 v225, a77
  v_accvgpr_read_b32 v226, a78
  v_accvgpr_read_b32 v227, a79
  v_accvgpr_read_b32 v228, a92
  v_accvgpr_read_b32 v229, a93
  v_accvgpr_read_b32 v230, a94
  v_accvgpr_read_b32 v231, a95
  v_pk_mul_f32 v[224:225], v[224:225], v[194:195] op_sel:[0,1] op_sel_hi:[1,1]
  v_pk_mul_f32 v[226:227], v[226:227], v[194:195] op_sel:[0,1] op_sel_hi:[1,1]
  v_pk_mul_f32 v[228:229], v[228:229], v[194:195] op_sel:[0,1] op_sel_hi:[1,1]
  v_pk_mul_f32 v[230:231], v[230:231], v[194:195] op_sel:[0,1] op_sel_hi:[1,1]
  v_cvt_pk_bf16_f32 v184, v224, v225
  v_cvt_pk_bf16_f32 v185, v226, v227
  v_cvt_pk_bf16_f32 v186, v228, v229
  v_cvt_pk_bf16_f32 v187, v230, v231
  buffer_store_dwordx4 v[184:187], v2, s[16:19], s35 offen offset:2048 sc1
  v_accvgpr_read_b32 v232, a108
  v_accvgpr_read_b32 v233, a109
  v_accvgpr_read_b32 v234, a110
  v_accvgpr_read_b32 v235, a111
  v_accvgpr_read_b32 v236, a124
  v_accvgpr_read_b32 v237, a125
  v_accvgpr_read_b32 v238, a126
  v_accvgpr_read_b32 v239, a127
  v_pk_mul_f32 v[232:233], v[232:233], v[194:195] op_sel:[0,1] op_sel_hi:[1,1]
  v_pk_mul_f32 v[234:235], v[234:235], v[194:195] op_sel:[0,1] op_sel_hi:[1,1]
  v_pk_mul_f32 v[236:237], v[236:237], v[194:195] op_sel:[0,1] op_sel_hi:[1,1]
  v_pk_mul_f32 v[238:239], v[238:239], v[194:195] op_sel:[0,1] op_sel_hi:[1,1]
  v_cvt_pk_bf16_f32 v188, v232, v233
  v_cvt_pk_bf16_f32 v189, v234, v235
  v_cvt_pk_bf16_f32 v190, v236, v237
  v_cvt_pk_bf16_f32 v191, v238, v239
  buffer_store_dwordx4 v[188:191], v2, s[16:19], s35 offen offset:3072 sc1
  s_waitcnt vmcnt(0)
  s_nop 7
  s_setpc_b64 s[52:53]
L_codeend:
s_endpgm
.section .rodata,"a"
.p2align 6
.amdhsa_kernel recurrent_scan__compressed_kv_cla__dense_activation_gelu__prompt_kernel
  .amdhsa_next_free_vgpr 512
  .amdhsa_next_free_sgpr 80
  .amdhsa_accum_offset 256
  .amdhsa_group_segment_fixed_size 0
  .amdhsa_kernarg_size 112
  .amdhsa_user_sgpr_count 2
  .amdhsa_user_sgpr_kernarg_segment_ptr 1
  .amdhsa_system_sgpr_workgroup_id_x 1
  .amdhsa_float_denorm_mode_32 3
  .amdhsa_float_denorm_mode_16_64 3
.end_amdhsa_kernel
```
